```python
import torch

def _softmax(x, axis=-1):
    return torch.softmax(x, dim=axis)
def _gelu(x):
    return torch.nn.functional.gelu(x, approximate="tanh")
def _silu(x):
    return torch.nn.functional.silu(x)
def _sigmoid(x):
    return torch.sigmoid(x)
def _layernorm(x, axis=-1, eps=1e-5):
    m = x.mean(dim=axis, keepdim=True)
    v = x.var(dim=axis, keepdim=True, unbiased=False)
    return (x - m) / torch.sqrt(v + eps)
def _scatter_add(tgt, idx, src, axis=0):
    return tgt.clone().index_add_(axis, idx, src)
def _segment_sum(src, seg, n):
    out = torch.zeros((n,) + src.shape[1:], dtype=src.dtype)
    return out.index_add_(0, seg, src)
def _pad(x, pw):
    flat = tuple(v for pair in reversed(pw) for v in pair)
    return torch.nn.functional.pad(x, flat)

kernel_name = 'concat_heads__spectral_gfnet__grouped_kv_mqa__prompt'

def setup_inputs():

    _w = (lambda a: (lambda t: t.to(torch.bfloat16) if t.is_floating_point() else t)(torch.as_tensor(a)))
    def _A_setup():
        B, S, D = 1, 2048, 576
        Df = D // 2 + 1
        return {
            "x": _w((lambda *s: torch.randn(*s, dtype=torch.bfloat16) * 0.05)(B, S, D)),
            "w_r": _w((lambda *s: torch.randn(*s, dtype=torch.bfloat16) * 0.8)(S, Df) * 0.02),
            "w_i": _w((lambda *s: torch.randn(*s, dtype=torch.bfloat16) * 0.8)(S, Df) * 0.02),
        }
    _A_in = _A_setup()

    def _B_setup():
        B, S, D, H = 1, 2048, 576, 32
        Dh = D // H
        return {
            "x": _w((lambda *s: torch.randn(*s, dtype=torch.bfloat16) * 0.05)(B, S, D)),
            "wq": _w((lambda *s: torch.randn(*s, dtype=torch.bfloat16) * 0.8)(D, H * Dh)),
            "wk": _w((lambda *s: torch.randn(*s, dtype=torch.bfloat16) * 0.8)(D, Dh)),
            "wv": _w((lambda *s: torch.randn(*s, dtype=torch.bfloat16) * 0.05)(D, Dh)),
            "wo": _w((lambda *s: torch.randn(*s, dtype=torch.bfloat16) * 0.05)(H * Dh, D)),
        }
    _B_in = _B_setup()

    return {
        "A_x": _A_in["x"],
        "A_w_r": _A_in["w_r"],
        "A_w_i": _A_in["w_i"],
        "B_x": _B_in["x"],
        "B_wq": _B_in["wq"],
        "B_wk": _B_in["wk"],
        "B_wv": _B_in["wv"],
        "B_wo": _B_in["wo"],
    }

def reference(A_x, A_w_r, A_w_i, B_x, B_wq, B_wk, B_wv, B_wo):
    def _A_ref(x, w_r, w_i):
        B, S, D = x.shape
        X = (lambda x, axes=(-2,-1): torch.fft.rfft2(x.float(), dim=axes))(x, axes=(-2, -1))
        W = w_r + 1j * w_i
        X = X * W
        y = (lambda x, s, axes=(-2,-1): torch.fft.irfft2(x, s=s, dim=axes).to(torch.bfloat16))(X, (S, D), axes=(-2, -1))
        return y

    def _B_ref(x, wq, wk, wv, wo):
        B, S, D = x.shape
        H = 32
        Dh = D // H
        q = (lambda x, *d: x.permute(*d))((x @ wq).reshape(B, S, H, Dh), 0, 2, 1, 3)
        k = x @ wk
        v = x @ wv
        scores = torch.einsum("bhqd,bkd->bhqk", q, k) * (Dh ** -0.5)
        p = _softmax(scores, axis=-1)
        o = torch.einsum("bhqk,bkd->bhqd", p, v)
        return (lambda x, *d: x.permute(*d))(o, 0, 2, 1, 3).reshape(B, S, H * Dh) @ wo

    a = _A_ref(A_x, A_w_r, A_w_i)
    b = _B_ref(B_x, B_wq, B_wk, B_wv, B_wo)
    return torch.concatenate([a, b], axis=-1)
```

```asm
; @launch kernel=proj_kernel grid=(256,1,1) block=(256,1,1) lds=147456
; @launch kernel=attn_kernel grid=(256,1,1) block=(512,1,1) lds=160064
; @launch kernel=outp_kernel grid=(230,1,1) block=(256,1,1) lds=147456
.amdgcn_target "amdgcn-amd-amdhsa--gfx950"
.text
.globl proj_kernel
.p2align 8
.type proj_kernel,@function
proj_kernel:
  s_cmp_ge_u32 s2, 256
  s_cbranch_scc1 L_end_1
  s_load_dwordx4 s[32:35], s[0:1], 0
  s_load_dwordx4 s[36:39], s[0:1], 16
  s_load_dwordx4 s[40:43], s[0:1], 32
  s_load_dwordx2 s[44:45], s[0:1], 48
  s_load_dwordx2 s[46:47], s[0:1], 80
  v_lshrrev_b32 v1, 6, v0
  v_and_b32 v0, 63, v0
  s_nop 0
  v_readfirstlane_b32 s16, v1
  s_waitcnt lgkmcnt(0)
  s_mov_b32 s8, s46
  s_and_b32 s9, s47, 0xffff
  s_mov_b32 s10, 0xc00000
  s_mov_b32 s11, 0x20000
  s_sub_u32 s17, s2, 80
  s_cmp_lt_u32 s17, 32
  s_cbranch_scc1 L_w_5
  s_sub_u32 s17, s2, 0
  s_cmp_lt_u32 s17, 16
  s_cbranch_scc1 L_kv_4
  s_sub_u32 s17, s2, 16
  s_cmp_lt_u32 s17, 64
  s_cbranch_scc1 L_a1_3
  s_sub_u32 s17, s2, 112
  s_mov_b32 s12, s38
  s_and_b32 s13, s39, 0xffff
  s_mov_b32 s14, 0x240000
  s_mov_b32 s15, 0x20000
  s_mov_b32 s48, s40
  s_and_b32 s49, s41, 0xffff
  s_mov_b32 s50, 0xa2000
  s_mov_b32 s51, 0x20000
  s_and_b32 s20, s17, 7
  s_lshr_b32 s21, s17, 3
  s_and_b32 s22, s21, 1
  s_lshl_b32 s20, s20, 1
  s_add_u32 s24, s20, s22
  s_lshr_b32 s25, s17, 4
  s_mul_i32 s26, s24, 147456
  s_add_u32 s26, s26, 0x0
  s_lshl_b32 s27, s25, 7
  s_lshl_b32 s28, s16, 12
  s_lshl_b32 s29, s16, 11
  v_lshrrev_b32 v1, 3, v0
  v_and_b32 v2, 7, v0
  v_lshrrev_b32 v3, 1, v1
  v_xor_b32 v2, v2, v3
  v_lshlrev_b32 v2, 4, v2
  s_lshl_b32 s20, s16, 5
  v_add_u32 v1, s20, v1
  s_mov_b32 s20, 1152
  v_mul_lo_u32 v1, v1, s20
  v_add_u32 v5, v1, v2
  v_xor_b32 v15, 64, v5
  v_lshrrev_b32 v1, 3, v0
  v_and_b32 v2, 7, v0
  v_lshrrev_b32 v3, 1, v1
  v_and_b32 v3, 1, v3
  v_lshlrev_b32 v3, 2, v3
  v_xor_b32 v2, v2, v3
  v_lshlrev_b32 v2, 4, v2
  s_lshl_b32 s20, s16, 4
  v_add_u32 v1, s20, v1
  s_mov_b32 s20, 1152
  v_mul_lo_u32 v1, v1, s20
  v_add_u32 v6, v1, v2
  s_add_u32 s30, s24, s25
  s_cmp_ge_u32 s30, 18
  s_cselect_b32 s20, 18, 0
  s_sub_u32 s30, s30, s20
  s_cmp_ge_u32 s30, 9
  s_cselect_b32 s20, 9, 0
  s_sub_u32 s30, s30, s20
  s_mov_b32 s30, 0
  s_lshl_b32 s31, s30, 7
  s_add_u32 s31, s31, s26
  s_mul_i32 s19, s30, 73728
  s_add_u32 s19, s19, s27
  s_add_u32 s21, s28, 0
  s_mov_b32 m0, s21
  s_add_u32 s22, s31, 0
  buffer_load_dwordx4 v5, s[12:15], s22 offen lds
  s_add_u32 s21, s28, 1024
  s_mov_b32 m0, s21
  s_add_u32 s22, s31, 9216
  buffer_load_dwordx4 v15, s[12:15], s22 offen lds
  s_add_u32 s21, s28, 2048
  s_mov_b32 m0, s21
  s_add_u32 s22, s31, 18432
  buffer_load_dwordx4 v5, s[12:15], s22 offen lds
  s_add_u32 s21, s28, 3072
  s_mov_b32 m0, s21
  s_add_u32 s22, s31, 27648
  buffer_load_dwordx4 v15, s[12:15], s22 offen lds
  s_add_u32 s21, s29, 16384
  s_mov_b32 m0, s21
  s_add_u32 s22, s19, 0
  buffer_load_dwordx4 v6, s[48:51], s22 offen lds
  s_add_u32 s21, s29, 17408
  s_mov_b32 m0, s21
  s_add_u32 s22, s19, 9216
  buffer_load_dwordx4 v6, s[48:51], s22 offen lds
  s_add_u32 s30, s30, 1
  s_cmp_eq_u32 s30, 9
  s_cselect_b32 s30, 0, s30
  s_lshl_b32 s31, s30, 7
  s_add_u32 s31, s31, s26
  s_mul_i32 s19, s30, 73728
  s_add_u32 s19, s19, s27
  s_add_u32 s21, s28, 24576
  s_mov_b32 m0, s21
  s_add_u32 s22, s31, 0
  buffer_load_dwordx4 v5, s[12:15], s22 offen lds
  s_add_u32 s21, s28, 25600
  s_mov_b32 m0, s21
  s_add_u32 s22, s31, 9216
  buffer_load_dwordx4 v15, s[12:15], s22 offen lds
  s_add_u32 s21, s28, 26624
  s_mov_b32 m0, s21
  s_add_u32 s22, s31, 18432
  buffer_load_dwordx4 v5, s[12:15], s22 offen lds
  s_add_u32 s21, s28, 27648
  s_mov_b32 m0, s21
  s_add_u32 s22, s31, 27648
  buffer_load_dwordx4 v15, s[12:15], s22 offen lds
  s_add_u32 s21, s29, 40960
  s_mov_b32 m0, s21
  s_add_u32 s22, s19, 0
  buffer_load_dwordx4 v6, s[48:51], s22 offen lds
  s_add_u32 s21, s29, 41984
  s_mov_b32 m0, s21
  s_add_u32 s22, s19, 9216
  buffer_load_dwordx4 v6, s[48:51], s22 offen lds
  s_add_u32 s30, s30, 1
  s_cmp_eq_u32 s30, 9
  s_cselect_b32 s30, 0, s30
  s_lshl_b32 s31, s30, 7
  s_add_u32 s31, s31, s26
  s_mul_i32 s19, s30, 73728
  s_add_u32 s19, s19, s27
  s_add_u32 s21, s28, 49152
  s_mov_b32 m0, s21
  s_add_u32 s22, s31, 0
  buffer_load_dwordx4 v5, s[12:15], s22 offen lds
  s_add_u32 s21, s28, 50176
  s_mov_b32 m0, s21
  s_add_u32 s22, s31, 9216
  buffer_load_dwordx4 v15, s[12:15], s22 offen lds
  s_add_u32 s21, s28, 51200
  s_mov_b32 m0, s21
  s_add_u32 s22, s31, 18432
  buffer_load_dwordx4 v5, s[12:15], s22 offen lds
  s_add_u32 s21, s28, 52224
  s_mov_b32 m0, s21
  s_add_u32 s22, s31, 27648
  buffer_load_dwordx4 v15, s[12:15], s22 offen lds
  s_add_u32 s21, s29, 65536
  s_mov_b32 m0, s21
  s_add_u32 s22, s19, 0
  buffer_load_dwordx4 v6, s[48:51], s22 offen lds
  s_add_u32 s21, s29, 66560
  s_mov_b32 m0, s21
  s_add_u32 s22, s19, 9216
  buffer_load_dwordx4 v6, s[48:51], s22 offen lds
  v_and_b32 v1, 31, v0
  v_lshrrev_b32 v2, 5, v0
  v_bfe_u32 v3, v1, 1, 3
  s_lshl_b32 s20, s16, 12
  v_lshlrev_b32 v1, 7, v1
  v_add_u32 v1, s20, v1
  v_add_u32 v4, 0, v2
  v_xor_b32 v4, v4, v3
  v_lshl_add_u32 v8, v4, 4, v1
  v_add_u32 v4, 2, v2
  v_xor_b32 v4, v4, v3
  v_lshl_add_u32 v9, v4, 4, v1
  v_add_u32 v4, 4, v2
  v_xor_b32 v4, v4, v3
  v_lshl_add_u32 v10, v4, 4, v1
  v_add_u32 v4, 6, v2
  v_xor_b32 v4, v4, v3
  v_lshl_add_u32 v11, v4, 4, v1
  v_and_b32 v1, 15, v0
  v_lshrrev_b32 v2, 2, v1
  v_and_b32 v1, 3, v1
  v_lshrrev_b32 v3, 4, v0
  v_lshrrev_b32 v4, 1, v3
  v_and_b32 v3, 1, v3
  v_lshl_add_u32 v4, v4, 3, v2
  v_lshlrev_b32 v4, 7, v4
  v_lshrrev_b32 v7, 1, v1
  v_lshl_add_u32 v7, v3, 1, v7
  v_and_b32 v1, 1, v1
  v_lshlrev_b32 v1, 3, v1
  v_lshrrev_b32 v2, 1, v2
  v_lshlrev_b32 v2, 2, v2
  v_add_u32 v4, v4, v1
  v_add_u32 v4, 16384, v4
  v_xor_b32 v3, v7, v2
  v_lshl_add_u32 v12, v3, 4, v4
  v_xor_b32 v7, 4, v7
  v_xor_b32 v3, v7, v2
  v_lshl_add_u32 v13, v3, 4, v4
  v_and_b32 v1, 31, v0
  v_lshrrev_b32 v2, 5, v0
  s_lshl_b32 s20, s16, 5
  v_add_u32 v1, s20, v1
  s_mov_b32 s20, 1152
  v_mul_lo_u32 v1, v1, s20
  v_lshl_add_u32 v14, v2, 4, v1
  v_mov_b32 v48, 0
  v_mov_b32 v49, 0
  v_mov_b32 v50, 0
  v_mov_b32 v51, 0
  v_mov_b32 v52, 0
  v_mov_b32 v53, 0
  v_mov_b32 v54, 0
  v_mov_b32 v55, 0
  v_mov_b32 v56, 0
  v_mov_b32 v57, 0
  v_mov_b32 v58, 0
  v_mov_b32 v59, 0
  v_mov_b32 v60, 0
  v_mov_b32 v61, 0
  v_mov_b32 v62, 0
  v_mov_b32 v63, 0
  v_mov_b32 v64, 0
  v_mov_b32 v65, 0
  v_mov_b32 v66, 0
  v_mov_b32 v67, 0
  v_mov_b32 v68, 0
  v_mov_b32 v69, 0
  v_mov_b32 v70, 0
  v_mov_b32 v71, 0
  v_mov_b32 v72, 0
  v_mov_b32 v73, 0
  v_mov_b32 v74, 0
  v_mov_b32 v75, 0
  v_mov_b32 v76, 0
  v_mov_b32 v77, 0
  v_mov_b32 v78, 0
  v_mov_b32 v79, 0
  s_waitcnt vmcnt(12)
  s_barrier
  ds_read_b128 v[16:19], v8 offset:0
  ds_read_b64_tr_b16 v[24:25], v12 offset:0
  ds_read_b64_tr_b16 v[26:27], v12 offset:512
  ds_read_b64_tr_b16 v[28:29], v13 offset:0
  ds_read_b64_tr_b16 v[30:31], v13 offset:512
  ds_read_b128 v[20:23], v9 offset:0
  ds_read_b64_tr_b16 v[32:33], v12 offset:2048
  ds_read_b64_tr_b16 v[34:35], v12 offset:2560
  ds_read_b64_tr_b16 v[36:37], v13 offset:2048
  ds_read_b64_tr_b16 v[38:39], v13 offset:2560
  s_waitcnt lgkmcnt(5)
  v_mfma_f32_32x32x16_bf16 v[48:63], v[24:27], v[16:19], v[48:63]
  v_mfma_f32_32x32x16_bf16 v[64:79], v[28:31], v[16:19], v[64:79]
  s_add_u32 s30, s30, 1
  s_cmp_eq_u32 s30, 9
  s_cselect_b32 s30, 0, s30
  s_lshl_b32 s31, s30, 7
  s_add_u32 s31, s31, s26
  s_mul_i32 s19, s30, 73728
  s_add_u32 s19, s19, s27
  s_add_u32 s21, s28, 73728
  s_mov_b32 m0, s21
  s_add_u32 s22, s31, 0
  buffer_load_dwordx4 v5, s[12:15], s22 offen lds
  s_add_u32 s21, s28, 74752
  s_mov_b32 m0, s21
  s_add_u32 s22, s31, 9216
  buffer_load_dwordx4 v15, s[12:15], s22 offen lds
  ds_read_b128 v[16:19], v10 offset:0
  ds_read_b64_tr_b16 v[24:25], v12 offset:4096
  ds_read_b64_tr_b16 v[26:27], v12 offset:4608
  ds_read_b64_tr_b16 v[28:29], v13 offset:4096
  ds_read_b64_tr_b16 v[30:31], v13 offset:4608
  s_waitcnt lgkmcnt(5)
  v_mfma_f32_32x32x16_bf16 v[48:63], v[32:35], v[20:23], v[48:63]
  v_mfma_f32_32x32x16_bf16 v[64:79], v[36:39], v[20:23], v[64:79]
  s_add_u32 s21, s28, 75776
  s_mov_b32 m0, s21
  s_add_u32 s22, s31, 18432
  buffer_load_dwordx4 v5, s[12:15], s22 offen lds
  s_add_u32 s21, s28, 76800
  s_mov_b32 m0, s21
  s_add_u32 s22, s31, 27648
  buffer_load_dwordx4 v15, s[12:15], s22 offen lds
  ds_read_b128 v[20:23], v11 offset:0
  ds_read_b64_tr_b16 v[32:33], v12 offset:6144
  ds_read_b64_tr_b16 v[34:35], v12 offset:6656
  ds_read_b64_tr_b16 v[36:37], v13 offset:6144
  ds_read_b64_tr_b16 v[38:39], v13 offset:6656
  s_waitcnt lgkmcnt(5)
  v_mfma_f32_32x32x16_bf16 v[48:63], v[24:27], v[16:19], v[48:63]
  v_mfma_f32_32x32x16_bf16 v[64:79], v[28:31], v[16:19], v[64:79]
  s_add_u32 s21, s29, 90112
  s_mov_b32 m0, s21
  s_add_u32 s22, s19, 0
  buffer_load_dwordx4 v6, s[48:51], s22 offen lds
  s_waitcnt lgkmcnt(0)
  v_mfma_f32_32x32x16_bf16 v[48:63], v[32:35], v[20:23], v[48:63]
  v_mfma_f32_32x32x16_bf16 v[64:79], v[36:39], v[20:23], v[64:79]
  s_add_u32 s21, s29, 91136
  s_mov_b32 m0, s21
  s_add_u32 s22, s19, 9216
  buffer_load_dwordx4 v6, s[48:51], s22 offen lds
  s_waitcnt vmcnt(12)
  s_barrier
  ds_read_b128 v[16:19], v8 offset:24576
  ds_read_b64_tr_b16 v[24:25], v12 offset:24576
  ds_read_b64_tr_b16 v[26:27], v12 offset:25088
  ds_read_b64_tr_b16 v[28:29], v13 offset:24576
  ds_read_b64_tr_b16 v[30:31], v13 offset:25088
  ds_read_b128 v[20:23], v9 offset:24576
  ds_read_b64_tr_b16 v[32:33], v12 offset:26624
  ds_read_b64_tr_b16 v[34:35], v12 offset:27136
  ds_read_b64_tr_b16 v[36:37], v13 offset:26624
  ds_read_b64_tr_b16 v[38:39], v13 offset:27136
  s_waitcnt lgkmcnt(5)
  v_mfma_f32_32x32x16_bf16 v[48:63], v[24:27], v[16:19], v[48:63]
  v_mfma_f32_32x32x16_bf16 v[64:79], v[28:31], v[16:19], v[64:79]
  s_add_u32 s30, s30, 1
  s_cmp_eq_u32 s30, 9
  s_cselect_b32 s30, 0, s30
  s_lshl_b32 s31, s30, 7
  s_add_u32 s31, s31, s26
  s_mul_i32 s19, s30, 73728
  s_add_u32 s19, s19, s27
  s_add_u32 s21, s28, 98304
  s_mov_b32 m0, s21
  s_add_u32 s22, s31, 0
  buffer_load_dwordx4 v5, s[12:15], s22 offen lds
  s_add_u32 s21, s28, 99328
  s_mov_b32 m0, s21
  s_add_u32 s22, s31, 9216
  buffer_load_dwordx4 v15, s[12:15], s22 offen lds
  ds_read_b128 v[16:19], v10 offset:24576
  ds_read_b64_tr_b16 v[24:25], v12 offset:28672
  ds_read_b64_tr_b16 v[26:27], v12 offset:29184
  ds_read_b64_tr_b16 v[28:29], v13 offset:28672
  ds_read_b64_tr_b16 v[30:31], v13 offset:29184
  s_waitcnt lgkmcnt(5)
  v_mfma_f32_32x32x16_bf16 v[48:63], v[32:35], v[20:23], v[48:63]
  v_mfma_f32_32x32x16_bf16 v[64:79], v[36:39], v[20:23], v[64:79]
  s_add_u32 s21, s28, 100352
  s_mov_b32 m0, s21
  s_add_u32 s22, s31, 18432
  buffer_load_dwordx4 v5, s[12:15], s22 offen lds
  s_add_u32 s21, s28, 101376
  s_mov_b32 m0, s21
  s_add_u32 s22, s31, 27648
  buffer_load_dwordx4 v15, s[12:15], s22 offen lds
  ds_read_b128 v[20:23], v11 offset:24576
  ds_read_b64_tr_b16 v[32:33], v12 offset:30720
  ds_read_b64_tr_b16 v[34:35], v12 offset:31232
  ds_read_b64_tr_b16 v[36:37], v13 offset:30720
  ds_read_b64_tr_b16 v[38:39], v13 offset:31232
  s_waitcnt lgkmcnt(5)
  v_mfma_f32_32x32x16_bf16 v[48:63], v[24:27], v[16:19], v[48:63]
  v_mfma_f32_32x32x16_bf16 v[64:79], v[28:31], v[16:19], v[64:79]
  s_add_u32 s21, s29, 114688
  s_mov_b32 m0, s21
  s_add_u32 s22, s19, 0
  buffer_load_dwordx4 v6, s[48:51], s22 offen lds
  s_waitcnt lgkmcnt(0)
  v_mfma_f32_32x32x16_bf16 v[48:63], v[32:35], v[20:23], v[48:63]
  v_mfma_f32_32x32x16_bf16 v[64:79], v[36:39], v[20:23], v[64:79]
  s_add_u32 s21, s29, 115712
  s_mov_b32 m0, s21
  s_add_u32 s22, s19, 9216
  buffer_load_dwordx4 v6, s[48:51], s22 offen lds
  v_add_u32 v8, 49152, v8
  v_add_u32 v9, 49152, v9
  v_add_u32 v10, 49152, v10
  v_add_u32 v11, 49152, v11
  v_add_u32 v12, 49152, v12
  v_add_u32 v13, 49152, v13
  s_waitcnt vmcnt(12)
  s_barrier
  ds_read_b128 v[16:19], v8 offset:0
  ds_read_b64_tr_b16 v[24:25], v12 offset:0
  ds_read_b64_tr_b16 v[26:27], v12 offset:512
  ds_read_b64_tr_b16 v[28:29], v13 offset:0
  ds_read_b64_tr_b16 v[30:31], v13 offset:512
  ds_read_b128 v[20:23], v9 offset:0
  ds_read_b64_tr_b16 v[32:33], v12 offset:2048
  ds_read_b64_tr_b16 v[34:35], v12 offset:2560
  ds_read_b64_tr_b16 v[36:37], v13 offset:2048
  ds_read_b64_tr_b16 v[38:39], v13 offset:2560
  s_waitcnt lgkmcnt(5)
  v_mfma_f32_32x32x16_bf16 v[48:63], v[24:27], v[16:19], v[48:63]
  v_mfma_f32_32x32x16_bf16 v[64:79], v[28:31], v[16:19], v[64:79]
  s_add_u32 s30, s30, 1
  s_cmp_eq_u32 s30, 9
  s_cselect_b32 s30, 0, s30
  s_lshl_b32 s31, s30, 7
  s_add_u32 s31, s31, s26
  s_mul_i32 s19, s30, 73728
  s_add_u32 s19, s19, s27
  s_add_u32 s21, s28, 122880
  s_mov_b32 m0, s21
  s_add_u32 s22, s31, 0
  buffer_load_dwordx4 v5, s[12:15], s22 offen lds
  s_add_u32 s21, s28, 123904
  s_mov_b32 m0, s21
  s_add_u32 s22, s31, 9216
  buffer_load_dwordx4 v15, s[12:15], s22 offen lds
  ds_read_b128 v[16:19], v10 offset:0
  ds_read_b64_tr_b16 v[24:25], v12 offset:4096
  ds_read_b64_tr_b16 v[26:27], v12 offset:4608
  ds_read_b64_tr_b16 v[28:29], v13 offset:4096
  ds_read_b64_tr_b16 v[30:31], v13 offset:4608
  s_waitcnt lgkmcnt(5)
  v_mfma_f32_32x32x16_bf16 v[48:63], v[32:35], v[20:23], v[48:63]
  v_mfma_f32_32x32x16_bf16 v[64:79], v[36:39], v[20:23], v[64:79]
  s_add_u32 s21, s28, 124928
  s_mov_b32 m0, s21
  s_add_u32 s22, s31, 18432
  buffer_load_dwordx4 v5, s[12:15], s22 offen lds
  s_add_u32 s21, s28, 125952
  s_mov_b32 m0, s21
  s_add_u32 s22, s31, 27648
  buffer_load_dwordx4 v15, s[12:15], s22 offen lds
  ds_read_b128 v[20:23], v11 offset:0
  ds_read_b64_tr_b16 v[32:33], v12 offset:6144
  ds_read_b64_tr_b16 v[34:35], v12 offset:6656
  ds_read_b64_tr_b16 v[36:37], v13 offset:6144
  ds_read_b64_tr_b16 v[38:39], v13 offset:6656
  s_waitcnt lgkmcnt(5)
  v_mfma_f32_32x32x16_bf16 v[48:63], v[24:27], v[16:19], v[48:63]
  v_mfma_f32_32x32x16_bf16 v[64:79], v[28:31], v[16:19], v[64:79]
  s_add_u32 s21, s29, 139264
  s_mov_b32 m0, s21
  s_add_u32 s22, s19, 0
  buffer_load_dwordx4 v6, s[48:51], s22 offen lds
  s_waitcnt lgkmcnt(0)
  v_mfma_f32_32x32x16_bf16 v[48:63], v[32:35], v[20:23], v[48:63]
  v_mfma_f32_32x32x16_bf16 v[64:79], v[36:39], v[20:23], v[64:79]
  s_add_u32 s21, s29, 140288
  s_mov_b32 m0, s21
  s_add_u32 s22, s19, 9216
  buffer_load_dwordx4 v6, s[48:51], s22 offen lds
  s_waitcnt vmcnt(12)
  s_barrier
  ds_read_b128 v[16:19], v8 offset:24576
  ds_read_b64_tr_b16 v[24:25], v12 offset:24576
  ds_read_b64_tr_b16 v[26:27], v12 offset:25088
  ds_read_b64_tr_b16 v[28:29], v13 offset:24576
  ds_read_b64_tr_b16 v[30:31], v13 offset:25088
  ds_read_b128 v[20:23], v9 offset:24576
  ds_read_b64_tr_b16 v[32:33], v12 offset:26624
  ds_read_b64_tr_b16 v[34:35], v12 offset:27136
  ds_read_b64_tr_b16 v[36:37], v13 offset:26624
  ds_read_b64_tr_b16 v[38:39], v13 offset:27136
  s_waitcnt lgkmcnt(5)
  v_mfma_f32_32x32x16_bf16 v[48:63], v[24:27], v[16:19], v[48:63]
  v_mfma_f32_32x32x16_bf16 v[64:79], v[28:31], v[16:19], v[64:79]
  s_add_u32 s30, s30, 1
  s_cmp_eq_u32 s30, 9
  s_cselect_b32 s30, 0, s30
  s_lshl_b32 s31, s30, 7
  s_add_u32 s31, s31, s26
  s_mul_i32 s19, s30, 73728
  s_add_u32 s19, s19, s27
  s_add_u32 s21, s28, 0
  s_mov_b32 m0, s21
  s_add_u32 s22, s31, 0
  buffer_load_dwordx4 v5, s[12:15], s22 offen lds
  s_add_u32 s21, s28, 1024
  s_mov_b32 m0, s21
  s_add_u32 s22, s31, 9216
  buffer_load_dwordx4 v15, s[12:15], s22 offen lds
  ds_read_b128 v[16:19], v10 offset:24576
  ds_read_b64_tr_b16 v[24:25], v12 offset:28672
  ds_read_b64_tr_b16 v[26:27], v12 offset:29184
  ds_read_b64_tr_b16 v[28:29], v13 offset:28672
  ds_read_b64_tr_b16 v[30:31], v13 offset:29184
  s_waitcnt lgkmcnt(5)
  v_mfma_f32_32x32x16_bf16 v[48:63], v[32:35], v[20:23], v[48:63]
  v_mfma_f32_32x32x16_bf16 v[64:79], v[36:39], v[20:23], v[64:79]
  s_add_u32 s21, s28, 2048
  s_mov_b32 m0, s21
  s_add_u32 s22, s31, 18432
  buffer_load_dwordx4 v5, s[12:15], s22 offen lds
  s_add_u32 s21, s28, 3072
  s_mov_b32 m0, s21
  s_add_u32 s22, s31, 27648
  buffer_load_dwordx4 v15, s[12:15], s22 offen lds
  ds_read_b128 v[20:23], v11 offset:24576
  ds_read_b64_tr_b16 v[32:33], v12 offset:30720
  ds_read_b64_tr_b16 v[34:35], v12 offset:31232
  ds_read_b64_tr_b16 v[36:37], v13 offset:30720
  ds_read_b64_tr_b16 v[38:39], v13 offset:31232
  s_waitcnt lgkmcnt(5)
  v_mfma_f32_32x32x16_bf16 v[48:63], v[24:27], v[16:19], v[48:63]
  v_mfma_f32_32x32x16_bf16 v[64:79], v[28:31], v[16:19], v[64:79]
  s_add_u32 s21, s29, 16384
  s_mov_b32 m0, s21
  s_add_u32 s22, s19, 0
  buffer_load_dwordx4 v6, s[48:51], s22 offen lds
  s_waitcnt lgkmcnt(0)
  v_mfma_f32_32x32x16_bf16 v[48:63], v[32:35], v[20:23], v[48:63]
  v_mfma_f32_32x32x16_bf16 v[64:79], v[36:39], v[20:23], v[64:79]
  s_add_u32 s21, s29, 17408
  s_mov_b32 m0, s21
  s_add_u32 s22, s19, 9216
  buffer_load_dwordx4 v6, s[48:51], s22 offen lds
  v_add_u32 v8, 49152, v8
  v_add_u32 v9, 49152, v9
  v_add_u32 v10, 49152, v10
  v_add_u32 v11, 49152, v11
  v_add_u32 v12, 49152, v12
  v_add_u32 v13, 49152, v13
  s_waitcnt vmcnt(12)
  s_barrier
  ds_read_b128 v[16:19], v8 offset:0
  ds_read_b64_tr_b16 v[24:25], v12 offset:0
  ds_read_b64_tr_b16 v[26:27], v12 offset:512
  ds_read_b64_tr_b16 v[28:29], v13 offset:0
  ds_read_b64_tr_b16 v[30:31], v13 offset:512
  ds_read_b128 v[20:23], v9 offset:0
  ds_read_b64_tr_b16 v[32:33], v12 offset:2048
  ds_read_b64_tr_b16 v[34:35], v12 offset:2560
  ds_read_b64_tr_b16 v[36:37], v13 offset:2048
  ds_read_b64_tr_b16 v[38:39], v13 offset:2560
  s_waitcnt lgkmcnt(5)
  v_mfma_f32_32x32x16_bf16 v[48:63], v[24:27], v[16:19], v[48:63]
  v_mfma_f32_32x32x16_bf16 v[64:79], v[28:31], v[16:19], v[64:79]
  s_add_u32 s30, s30, 1
  s_cmp_eq_u32 s30, 9
  s_cselect_b32 s30, 0, s30
  s_lshl_b32 s31, s30, 7
  s_add_u32 s31, s31, s26
  s_mul_i32 s19, s30, 73728
  s_add_u32 s19, s19, s27
  s_add_u32 s21, s28, 24576
  s_mov_b32 m0, s21
  s_add_u32 s22, s31, 0
  buffer_load_dwordx4 v5, s[12:15], s22 offen lds
  s_add_u32 s21, s28, 25600
  s_mov_b32 m0, s21
  s_add_u32 s22, s31, 9216
  buffer_load_dwordx4 v15, s[12:15], s22 offen lds
  ds_read_b128 v[16:19], v10 offset:0
  ds_read_b64_tr_b16 v[24:25], v12 offset:4096
  ds_read_b64_tr_b16 v[26:27], v12 offset:4608
  ds_read_b64_tr_b16 v[28:29], v13 offset:4096
  ds_read_b64_tr_b16 v[30:31], v13 offset:4608
  s_waitcnt lgkmcnt(5)
  v_mfma_f32_32x32x16_bf16 v[48:63], v[32:35], v[20:23], v[48:63]
  v_mfma_f32_32x32x16_bf16 v[64:79], v[36:39], v[20:23], v[64:79]
  s_add_u32 s21, s28, 26624
  s_mov_b32 m0, s21
  s_add_u32 s22, s31, 18432
  buffer_load_dwordx4 v5, s[12:15], s22 offen lds
  s_add_u32 s21, s28, 27648
  s_mov_b32 m0, s21
  s_add_u32 s22, s31, 27648
  buffer_load_dwordx4 v15, s[12:15], s22 offen lds
  ds_read_b128 v[20:23], v11 offset:0
  ds_read_b64_tr_b16 v[32:33], v12 offset:6144
  ds_read_b64_tr_b16 v[34:35], v12 offset:6656
  ds_read_b64_tr_b16 v[36:37], v13 offset:6144
  ds_read_b64_tr_b16 v[38:39], v13 offset:6656
  s_waitcnt lgkmcnt(5)
  v_mfma_f32_32x32x16_bf16 v[48:63], v[24:27], v[16:19], v[48:63]
  v_mfma_f32_32x32x16_bf16 v[64:79], v[28:31], v[16:19], v[64:79]
  s_add_u32 s21, s29, 40960
  s_mov_b32 m0, s21
  s_add_u32 s22, s19, 0
  buffer_load_dwordx4 v6, s[48:51], s22 offen lds
  s_waitcnt lgkmcnt(0)
  v_mfma_f32_32x32x16_bf16 v[48:63], v[32:35], v[20:23], v[48:63]
  v_mfma_f32_32x32x16_bf16 v[64:79], v[36:39], v[20:23], v[64:79]
  s_add_u32 s21, s29, 41984
  s_mov_b32 m0, s21
  s_add_u32 s22, s19, 9216
  buffer_load_dwordx4 v6, s[48:51], s22 offen lds
  s_waitcnt vmcnt(12)
  s_barrier
  ds_read_b128 v[16:19], v8 offset:24576
  ds_read_b64_tr_b16 v[24:25], v12 offset:24576
  ds_read_b64_tr_b16 v[26:27], v12 offset:25088
  ds_read_b64_tr_b16 v[28:29], v13 offset:24576
  ds_read_b64_tr_b16 v[30:31], v13 offset:25088
  ds_read_b128 v[20:23], v9 offset:24576
  ds_read_b64_tr_b16 v[32:33], v12 offset:26624
  ds_read_b64_tr_b16 v[34:35], v12 offset:27136
  ds_read_b64_tr_b16 v[36:37], v13 offset:26624
  ds_read_b64_tr_b16 v[38:39], v13 offset:27136
  s_waitcnt lgkmcnt(5)
  v_mfma_f32_32x32x16_bf16 v[48:63], v[24:27], v[16:19], v[48:63]
  v_mfma_f32_32x32x16_bf16 v[64:79], v[28:31], v[16:19], v[64:79]
  s_add_u32 s30, s30, 1
  s_cmp_eq_u32 s30, 9
  s_cselect_b32 s30, 0, s30
  s_lshl_b32 s31, s30, 7
  s_add_u32 s31, s31, s26
  s_mul_i32 s19, s30, 73728
  s_add_u32 s19, s19, s27
  s_add_u32 s21, s28, 49152
  s_mov_b32 m0, s21
  s_add_u32 s22, s31, 0
  buffer_load_dwordx4 v5, s[12:15], s22 offen lds
  s_add_u32 s21, s28, 50176
  s_mov_b32 m0, s21
  s_add_u32 s22, s31, 9216
  buffer_load_dwordx4 v15, s[12:15], s22 offen lds
  ds_read_b128 v[16:19], v10 offset:24576
  ds_read_b64_tr_b16 v[24:25], v12 offset:28672
  ds_read_b64_tr_b16 v[26:27], v12 offset:29184
  ds_read_b64_tr_b16 v[28:29], v13 offset:28672
  ds_read_b64_tr_b16 v[30:31], v13 offset:29184
  s_waitcnt lgkmcnt(5)
  v_mfma_f32_32x32x16_bf16 v[48:63], v[32:35], v[20:23], v[48:63]
  v_mfma_f32_32x32x16_bf16 v[64:79], v[36:39], v[20:23], v[64:79]
  s_add_u32 s21, s28, 51200
  s_mov_b32 m0, s21
  s_add_u32 s22, s31, 18432
  buffer_load_dwordx4 v5, s[12:15], s22 offen lds
  s_add_u32 s21, s28, 52224
  s_mov_b32 m0, s21
  s_add_u32 s22, s31, 27648
  buffer_load_dwordx4 v15, s[12:15], s22 offen lds
  ds_read_b128 v[20:23], v11 offset:24576
  ds_read_b64_tr_b16 v[32:33], v12 offset:30720
  ds_read_b64_tr_b16 v[34:35], v12 offset:31232
  ds_read_b64_tr_b16 v[36:37], v13 offset:30720
  ds_read_b64_tr_b16 v[38:39], v13 offset:31232
  s_waitcnt lgkmcnt(5)
  v_mfma_f32_32x32x16_bf16 v[48:63], v[24:27], v[16:19], v[48:63]
  v_mfma_f32_32x32x16_bf16 v[64:79], v[28:31], v[16:19], v[64:79]
  s_add_u32 s21, s29, 65536
  s_mov_b32 m0, s21
  s_add_u32 s22, s19, 0
  buffer_load_dwordx4 v6, s[48:51], s22 offen lds
  s_waitcnt lgkmcnt(0)
  v_mfma_f32_32x32x16_bf16 v[48:63], v[32:35], v[20:23], v[48:63]
  v_mfma_f32_32x32x16_bf16 v[64:79], v[36:39], v[20:23], v[64:79]
  s_add_u32 s21, s29, 66560
  s_mov_b32 m0, s21
  s_add_u32 s22, s19, 9216
  buffer_load_dwordx4 v6, s[48:51], s22 offen lds
  v_add_u32 v8, 0xfffe8000, v8
  v_add_u32 v9, 0xfffe8000, v9
  v_add_u32 v10, 0xfffe8000, v10
  v_add_u32 v11, 0xfffe8000, v11
  v_add_u32 v12, 0xfffe8000, v12
  v_add_u32 v13, 0xfffe8000, v13
  s_waitcnt vmcnt(12)
  s_barrier
  ds_read_b128 v[16:19], v8 offset:0
  ds_read_b64_tr_b16 v[24:25], v12 offset:0
  ds_read_b64_tr_b16 v[26:27], v12 offset:512
  ds_read_b64_tr_b16 v[28:29], v13 offset:0
  ds_read_b64_tr_b16 v[30:31], v13 offset:512
  ds_read_b128 v[20:23], v9 offset:0
  ds_read_b64_tr_b16 v[32:33], v12 offset:2048
  ds_read_b64_tr_b16 v[34:35], v12 offset:2560
  ds_read_b64_tr_b16 v[36:37], v13 offset:2048
  ds_read_b64_tr_b16 v[38:39], v13 offset:2560
  s_waitcnt lgkmcnt(5)
  v_mfma_f32_32x32x16_bf16 v[48:63], v[24:27], v[16:19], v[48:63]
  v_mfma_f32_32x32x16_bf16 v[64:79], v[28:31], v[16:19], v[64:79]
  ds_read_b128 v[16:19], v10 offset:0
  ds_read_b64_tr_b16 v[24:25], v12 offset:4096
  ds_read_b64_tr_b16 v[26:27], v12 offset:4608
  ds_read_b64_tr_b16 v[28:29], v13 offset:4096
  ds_read_b64_tr_b16 v[30:31], v13 offset:4608
  s_waitcnt lgkmcnt(5)
  v_mfma_f32_32x32x16_bf16 v[48:63], v[32:35], v[20:23], v[48:63]
  v_mfma_f32_32x32x16_bf16 v[64:79], v[36:39], v[20:23], v[64:79]
  ds_read_b128 v[20:23], v11 offset:0
  ds_read_b64_tr_b16 v[32:33], v12 offset:6144
  ds_read_b64_tr_b16 v[34:35], v12 offset:6656
  ds_read_b64_tr_b16 v[36:37], v13 offset:6144
  ds_read_b64_tr_b16 v[38:39], v13 offset:6656
  s_waitcnt lgkmcnt(5)
  v_mfma_f32_32x32x16_bf16 v[48:63], v[24:27], v[16:19], v[48:63]
  v_mfma_f32_32x32x16_bf16 v[64:79], v[28:31], v[16:19], v[64:79]
  s_waitcnt lgkmcnt(0)
  v_mfma_f32_32x32x16_bf16 v[48:63], v[32:35], v[20:23], v[48:63]
  v_mfma_f32_32x32x16_bf16 v[64:79], v[36:39], v[20:23], v[64:79]
  s_waitcnt vmcnt(6)
  s_barrier
  ds_read_b128 v[16:19], v8 offset:24576
  ds_read_b64_tr_b16 v[24:25], v12 offset:24576
  ds_read_b64_tr_b16 v[26:27], v12 offset:25088
  ds_read_b64_tr_b16 v[28:29], v13 offset:24576
  ds_read_b64_tr_b16 v[30:31], v13 offset:25088
  ds_read_b128 v[20:23], v9 offset:24576
  ds_read_b64_tr_b16 v[32:33], v12 offset:26624
  ds_read_b64_tr_b16 v[34:35], v12 offset:27136
  ds_read_b64_tr_b16 v[36:37], v13 offset:26624
  ds_read_b64_tr_b16 v[38:39], v13 offset:27136
  s_waitcnt lgkmcnt(5)
  v_mfma_f32_32x32x16_bf16 v[48:63], v[24:27], v[16:19], v[48:63]
  v_mfma_f32_32x32x16_bf16 v[64:79], v[28:31], v[16:19], v[64:79]
  ds_read_b128 v[16:19], v10 offset:24576
  ds_read_b64_tr_b16 v[24:25], v12 offset:28672
  ds_read_b64_tr_b16 v[26:27], v12 offset:29184
  ds_read_b64_tr_b16 v[28:29], v13 offset:28672
  ds_read_b64_tr_b16 v[30:31], v13 offset:29184
  s_waitcnt lgkmcnt(5)
  v_mfma_f32_32x32x16_bf16 v[48:63], v[32:35], v[20:23], v[48:63]
  v_mfma_f32_32x32x16_bf16 v[64:79], v[36:39], v[20:23], v[64:79]
  ds_read_b128 v[20:23], v11 offset:24576
  ds_read_b64_tr_b16 v[32:33], v12 offset:30720
  ds_read_b64_tr_b16 v[34:35], v12 offset:31232
  ds_read_b64_tr_b16 v[36:37], v13 offset:30720
  ds_read_b64_tr_b16 v[38:39], v13 offset:31232
  s_waitcnt lgkmcnt(5)
  v_mfma_f32_32x32x16_bf16 v[48:63], v[24:27], v[16:19], v[48:63]
  v_mfma_f32_32x32x16_bf16 v[64:79], v[28:31], v[16:19], v[64:79]
  s_waitcnt lgkmcnt(0)
  v_mfma_f32_32x32x16_bf16 v[48:63], v[32:35], v[20:23], v[48:63]
  v_mfma_f32_32x32x16_bf16 v[64:79], v[36:39], v[20:23], v[64:79]
  v_add_u32 v8, 49152, v8
  v_add_u32 v9, 49152, v9
  v_add_u32 v10, 49152, v10
  v_add_u32 v11, 49152, v11
  v_add_u32 v12, 49152, v12
  v_add_u32 v13, 49152, v13
  s_waitcnt vmcnt(0)
  s_barrier
  ds_read_b128 v[16:19], v8 offset:0
  ds_read_b64_tr_b16 v[24:25], v12 offset:0
  ds_read_b64_tr_b16 v[26:27], v12 offset:512
  ds_read_b64_tr_b16 v[28:29], v13 offset:0
  ds_read_b64_tr_b16 v[30:31], v13 offset:512
  ds_read_b128 v[20:23], v9 offset:0
  ds_read_b64_tr_b16 v[32:33], v12 offset:2048
  ds_read_b64_tr_b16 v[34:35], v12 offset:2560
  ds_read_b64_tr_b16 v[36:37], v13 offset:2048
  ds_read_b64_tr_b16 v[38:39], v13 offset:2560
  s_waitcnt lgkmcnt(5)
  v_mfma_f32_32x32x16_bf16 v[48:63], v[24:27], v[16:19], v[48:63]
  v_mfma_f32_32x32x16_bf16 v[64:79], v[28:31], v[16:19], v[64:79]
  ds_read_b128 v[16:19], v10 offset:0
  ds_read_b64_tr_b16 v[24:25], v12 offset:4096
  ds_read_b64_tr_b16 v[26:27], v12 offset:4608
  ds_read_b64_tr_b16 v[28:29], v13 offset:4096
  ds_read_b64_tr_b16 v[30:31], v13 offset:4608
  s_waitcnt lgkmcnt(5)
  v_mfma_f32_32x32x16_bf16 v[48:63], v[32:35], v[20:23], v[48:63]
  v_mfma_f32_32x32x16_bf16 v[64:79], v[36:39], v[20:23], v[64:79]
  ds_read_b128 v[20:23], v11 offset:0
  ds_read_b64_tr_b16 v[32:33], v12 offset:6144
  ds_read_b64_tr_b16 v[34:35], v12 offset:6656
  ds_read_b64_tr_b16 v[36:37], v13 offset:6144
  ds_read_b64_tr_b16 v[38:39], v13 offset:6656
  s_waitcnt lgkmcnt(5)
  v_mfma_f32_32x32x16_bf16 v[48:63], v[24:27], v[16:19], v[48:63]
  v_mfma_f32_32x32x16_bf16 v[64:79], v[28:31], v[16:19], v[64:79]
  s_waitcnt lgkmcnt(0)
  v_mfma_f32_32x32x16_bf16 v[48:63], v[32:35], v[20:23], v[48:63]
  v_mfma_f32_32x32x16_bf16 v[64:79], v[36:39], v[20:23], v[64:79]
  s_nop 7
  s_nop 7
  s_mul_i32 s23, s24, 147456
  s_add_u32 s23, s23, s27
  s_add_u32 s23, s23, 0x0
  s_mov_b32 s20, 0x3eae1a93
  v_mul_f32 v48, s20, v48
  v_mul_f32 v49, s20, v49
  v_mul_f32 v50, s20, v50
  v_mul_f32 v51, s20, v51
  v_mul_f32 v52, s20, v52
  v_mul_f32 v53, s20, v53
  v_mul_f32 v54, s20, v54
  v_mul_f32 v55, s20, v55
  v_mul_f32 v56, s20, v56
  v_mul_f32 v57, s20, v57
  v_mul_f32 v58, s20, v58
  v_mul_f32 v59, s20, v59
  v_mul_f32 v60, s20, v60
  v_mul_f32 v61, s20, v61
  v_mul_f32 v62, s20, v62
  v_mul_f32 v63, s20, v63
  v_mul_f32 v64, s20, v64
  v_mul_f32 v65, s20, v65
  v_mul_f32 v66, s20, v66
  v_mul_f32 v67, s20, v67
  v_mul_f32 v68, s20, v68
  v_mul_f32 v69, s20, v69
  v_mul_f32 v70, s20, v70
  v_mul_f32 v71, s20, v71
  v_mul_f32 v72, s20, v72
  v_mul_f32 v73, s20, v73
  v_mul_f32 v74, s20, v74
  v_mul_f32 v75, s20, v75
  v_mul_f32 v76, s20, v76
  v_mul_f32 v77, s20, v77
  v_mul_f32 v78, s20, v78
  v_mul_f32 v79, s20, v79
  v_cvt_pk_bf16_f32 v80, v48, v49
  v_cvt_pk_bf16_f32 v81, v50, v51
  v_cvt_pk_bf16_f32 v82, v52, v53
  v_cvt_pk_bf16_f32 v83, v54, v55
  s_nop 1
  v_permlane32_swap_b32 v80, v82
  v_permlane32_swap_b32 v81, v83
  buffer_store_dwordx4 v[80:83], v14, s[8:11], s23 offen offset:0
  v_cvt_pk_bf16_f32 v84, v56, v57
  v_cvt_pk_bf16_f32 v85, v58, v59
  v_cvt_pk_bf16_f32 v86, v60, v61
  v_cvt_pk_bf16_f32 v87, v62, v63
  s_nop 1
  v_permlane32_swap_b32 v84, v86
  v_permlane32_swap_b32 v85, v87
  buffer_store_dwordx4 v[84:87], v14, s[8:11], s23 offen offset:32
  v_cvt_pk_bf16_f32 v88, v64, v65
  v_cvt_pk_bf16_f32 v89, v66, v67
  v_cvt_pk_bf16_f32 v90, v68, v69
  v_cvt_pk_bf16_f32 v91, v70, v71
  s_nop 1
  v_permlane32_swap_b32 v88, v90
  v_permlane32_swap_b32 v89, v91
  buffer_store_dwordx4 v[88:91], v14, s[8:11], s23 offen offset:64
  v_cvt_pk_bf16_f32 v92, v72, v73
  v_cvt_pk_bf16_f32 v93, v74, v75
  v_cvt_pk_bf16_f32 v94, v76, v77
  v_cvt_pk_bf16_f32 v95, v78, v79
  s_nop 1
  v_permlane32_swap_b32 v92, v94
  v_permlane32_swap_b32 v93, v95
  buffer_store_dwordx4 v[92:95], v14, s[8:11], s23 offen offset:96
  s_branch L_fin_2
L_a1_3:
  s_mov_b32 s12, s32
  s_and_b32 s13, s33, 0xffff
  s_mov_b32 s14, 0x240000
  s_mov_b32 s15, 0x20000
  s_getpc_b64 s[48:49]
L_pc_6:
  s_add_u32 s48, s48, tab_a1-L_pc_6
  s_addc_u32 s49, s49, 0
  s_and_b32 s49, s49, 0xffff
  s_mov_b32 s50, 0xd800
  s_mov_b32 s51, 0x20000
  v_lshlrev_b32 v6, 4, v0
  s_lshr_b32 s20, s16, 1
  s_lshl_b32 s20, s20, 4
  s_and_b32 s21, s16, 1
  s_lshl_b32 s21, s21, 2
  s_add_u32 s20, s20, s21
  s_lshl_b32 s20, s20, 6
  s_add_u32 s20, s20, s17
  s_mul_i32 s26, s20, 1152
  s_mul_i32 s27, s16, 9472
  s_add_u32 s21, s27, 0
  s_mov_b32 m0, s21
  v_add_u32 v4, 0x0, v6
  buffer_load_dwordx4 v4, s[12:15], s26 offen lds
  v_cmp_le_u32 vcc, 10, v0
  v_mov_b32 v5, 0x8ff60
  s_add_u32 s21, s27, 1024
  v_mov_b32 v4, 0x400
  s_mov_b32 m0, s21
  v_cndmask_b32 v4, v4, v5, vcc
  v_add_u32 v4, v4, v6
  buffer_load_dwordx4 v4, s[12:15], s26 offen lds
  v_cmp_le_u32 vcc, 20, v0
  v_mov_b32 v5, 0x11ec0
  s_add_u32 s21, s27, 2048
  v_mov_b32 v4, 0x90360
  s_mov_b32 m0, s21
  v_cndmask_b32 v4, v4, v5, vcc
  v_add_u32 v4, v4, v6
  buffer_load_dwordx4 v4, s[12:15], s26 offen lds
  v_cmp_le_u32 vcc, 30, v0
  v_mov_b32 v5, 0xa1e20
  s_add_u32 s21, s27, 3072
  v_mov_b32 v4, 0x122c0
  s_mov_b32 m0, s21
  v_cndmask_b32 v4, v4, v5, vcc
  v_add_u32 v4, v4, v6
  buffer_load_dwordx4 v4, s[12:15], s26 offen lds
  v_cmp_le_u32 vcc, 40, v0
  v_mov_b32 v5, 0x23d80
  s_add_u32 s21, s27, 4096
  v_mov_b32 v4, 0xa2220
  s_mov_b32 m0, s21
  v_cndmask_b32 v4, v4, v5, vcc
  v_add_u32 v4, v4, v6
  buffer_load_dwordx4 v4, s[12:15], s26 offen lds
  v_cmp_le_u32 vcc, 50, v0
  v_mov_b32 v5, 0xb3ce0
  s_add_u32 s21, s27, 5120
  v_mov_b32 v4, 0x24180
  s_mov_b32 m0, s21
  v_cndmask_b32 v4, v4, v5, vcc
  v_add_u32 v4, v4, v6
  buffer_load_dwordx4 v4, s[12:15], s26 offen lds
  v_cmp_le_u32 vcc, 60, v0
  v_mov_b32 v5, 0x35c40
  s_add_u32 s21, s27, 6144
  v_mov_b32 v4, 0xb40e0
  s_mov_b32 m0, s21
  v_cndmask_b32 v4, v4, v5, vcc
  v_add_u32 v4, v4, v6
  buffer_load_dwordx4 v4, s[12:15], s26 offen lds
  s_add_u32 s21, s27, 7168
  s_mov_b32 m0, s21
  v_add_u32 v4, 0x36040, v6
  buffer_load_dwordx4 v4, s[12:15], s26 offen lds
  v_cmp_le_u32 vcc, 6, v0
  v_mov_b32 v5, 0xc5fa0
  s_add_u32 s21, s27, 8192
  v_mov_b32 v4, 0x36440
  s_mov_b32 m0, s21
  v_cndmask_b32 v4, v4, v5, vcc
  v_add_u32 v4, v4, v6
  buffer_load_dwordx4 v4, s[12:15], s26 offen lds
  s_add_u32 s21, s27, 9216
  s_mov_b32 m0, s21
  v_add_u32 v4, 0xc63a0, v6
  s_mov_b64 exec, 0xffff
  buffer_load_dwordx4 v4, s[12:15], s26 offen lds
  s_mov_b64 exec, -1
  s_add_u32 s20, s16, 0
  s_min_u32 s20, s20, 53
  s_lshl_b32 s20, s20, 10
  s_add_u32 s21, s20, 40960
  s_mov_b32 m0, s21
  s_nop 0
  buffer_load_dwordx4 v6, s[48:51], s20 offen lds
  s_add_u32 s20, s16, 4
  s_min_u32 s20, s20, 53
  s_lshl_b32 s20, s20, 10
  s_add_u32 s21, s20, 40960
  s_mov_b32 m0, s21
  s_nop 0
  buffer_load_dwordx4 v6, s[48:51], s20 offen lds
  s_add_u32 s20, s16, 8
  s_min_u32 s20, s20, 53
  s_lshl_b32 s20, s20, 10
  s_add_u32 s21, s20, 40960
  s_mov_b32 m0, s21
  s_nop 0
  buffer_load_dwordx4 v6, s[48:51], s20 offen lds
  s_add_u32 s20, s16, 12
  s_min_u32 s20, s20, 53
  s_lshl_b32 s20, s20, 10
  s_add_u32 s21, s20, 40960
  s_mov_b32 m0, s21
  s_nop 0
  buffer_load_dwordx4 v6, s[48:51], s20 offen lds
  s_add_u32 s20, s16, 16
  s_min_u32 s20, s20, 53
  s_lshl_b32 s20, s20, 10
  s_add_u32 s21, s20, 40960
  s_mov_b32 m0, s21
  s_nop 0
  buffer_load_dwordx4 v6, s[48:51], s20 offen lds
  s_add_u32 s20, s16, 20
  s_min_u32 s20, s20, 53
  s_lshl_b32 s20, s20, 10
  s_add_u32 s21, s20, 40960
  s_mov_b32 m0, s21
  s_nop 0
  buffer_load_dwordx4 v6, s[48:51], s20 offen lds
  s_add_u32 s20, s16, 24
  s_min_u32 s20, s20, 53
  s_lshl_b32 s20, s20, 10
  s_add_u32 s21, s20, 40960
  s_mov_b32 m0, s21
  s_nop 0
  buffer_load_dwordx4 v6, s[48:51], s20 offen lds
  s_add_u32 s20, s16, 28
  s_min_u32 s20, s20, 53
  s_lshl_b32 s20, s20, 10
  s_add_u32 s21, s20, 40960
  s_mov_b32 m0, s21
  s_nop 0
  buffer_load_dwordx4 v6, s[48:51], s20 offen lds
  s_add_u32 s20, s16, 32
  s_min_u32 s20, s20, 53
  s_lshl_b32 s20, s20, 10
  s_add_u32 s21, s20, 40960
  s_mov_b32 m0, s21
  s_nop 0
  buffer_load_dwordx4 v6, s[48:51], s20 offen lds
  s_add_u32 s20, s16, 36
  s_min_u32 s20, s20, 53
  s_lshl_b32 s20, s20, 10
  s_add_u32 s21, s20, 40960
  s_mov_b32 m0, s21
  s_nop 0
  buffer_load_dwordx4 v6, s[48:51], s20 offen lds
  s_add_u32 s20, s16, 40
  s_min_u32 s20, s20, 53
  s_lshl_b32 s20, s20, 10
  s_add_u32 s21, s20, 40960
  s_mov_b32 m0, s21
  s_nop 0
  buffer_load_dwordx4 v6, s[48:51], s20 offen lds
  s_add_u32 s20, s16, 44
  s_min_u32 s20, s20, 53
  s_lshl_b32 s20, s20, 10
  s_add_u32 s21, s20, 40960
  s_mov_b32 m0, s21
  s_nop 0
  buffer_load_dwordx4 v6, s[48:51], s20 offen lds
  s_add_u32 s20, s16, 48
  s_min_u32 s20, s20, 53
  s_lshl_b32 s20, s20, 10
  s_add_u32 s21, s20, 40960
  s_mov_b32 m0, s21
  s_nop 0
  buffer_load_dwordx4 v6, s[48:51], s20 offen lds
  s_add_u32 s20, s16, 52
  s_min_u32 s20, s20, 53
  s_lshl_b32 s20, s20, 10
  s_add_u32 s21, s20, 40960
  s_mov_b32 m0, s21
  s_nop 0
  buffer_load_dwordx4 v6, s[48:51], s20 offen lds
  v_and_b32 v1, 15, v0
  v_lshrrev_b32 v2, 2, v1
  v_and_b32 v1, 3, v1
  v_lshrrev_b32 v3, 4, v0
  v_lshrrev_b32 v4, 1, v3
  v_and_b32 v3, 1, v3
  s_lshl_b32 s20, s16, 3
  v_lshl_add_u32 v3, v3, 2, v1
  v_add_u32 v3, s20, v3
  v_mul_u32_u24 v3, 1184, v3
  v_lshl_add_u32 v4, v4, 3, v2
  v_lshl_add_u32 v8, v4, 3, v3
  v_add_u32 v9, 40960, v6
  s_waitcnt vmcnt(14)
  ds_read_b64_tr_b16 v[16:17], v8 offset:0
  ds_read_b64_tr_b16 v[18:19], v8 offset:32
  ds_read_b64_tr_b16 v[20:21], v8 offset:128
  ds_read_b64_tr_b16 v[22:23], v8 offset:160
  ds_read_b64_tr_b16 v[24:25], v8 offset:256
  ds_read_b64_tr_b16 v[26:27], v8 offset:288
  ds_read_b64_tr_b16 v[28:29], v8 offset:384
  ds_read_b64_tr_b16 v[30:31], v8 offset:416
  s_waitcnt lgkmcnt(0)
  ds_read_b64_tr_b16 v[32:33], v8 offset:512
  ds_read_b64_tr_b16 v[34:35], v8 offset:544
  ds_read_b64_tr_b16 v[36:37], v8 offset:640
  ds_read_b64_tr_b16 v[38:39], v8 offset:672
  ds_read_b64_tr_b16 v[40:41], v8 offset:768
  ds_read_b64_tr_b16 v[42:43], v8 offset:800
  ds_read_b64_tr_b16 v[44:45], v8 offset:896
  ds_read_b64_tr_b16 v[46:47], v8 offset:928
  s_waitcnt lgkmcnt(0)
  ds_read_b64_tr_b16 v[48:49], v8 offset:1024
  ds_read_b64_tr_b16 v[50:51], v8 offset:1056
  v_and_b32 v1, 31, v0
  v_lshrrev_b32 v2, 5, v0
  s_lshl_b32 s24, s17, 6
  s_add_u32 s24, s24, 0x4c0000
  s_add_u32 s25, s24, 4096
  s_lshl_b32 s20, s16, 4
  v_lshlrev_b32 v3, 3, v2
  v_add_u32 v3, s20, v3
  v_add_u32 v3, 98304, v3
  v_mov_b32 v8, 144
  s_waitcnt vmcnt(9) lgkmcnt(0)
  s_barrier
  ds_read_b128 v[56:59], v9 offset:0
  ds_read_b128 v[60:63], v9 offset:9216
  ds_read_b128 v[176:179], v9 offset:1024
  ds_read_b128 v[180:183], v9 offset:10240
  s_waitcnt lgkmcnt(3)
  v_mfma_f32_32x32x16_bf16 v[64:79], v[16:19], v[56:59], 0
  ds_read_b128 v[56:59], v9 offset:2048
  s_waitcnt lgkmcnt(3)
  v_mfma_f32_32x32x16_bf16 v[80:95], v[16:19], v[60:63], 0
  ds_read_b128 v[60:63], v9 offset:11264
  s_waitcnt lgkmcnt(3)
  v_mfma_f32_32x32x16_bf16 v[64:79], v[20:23], v[176:179], v[64:79]
  ds_read_b128 v[176:179], v9 offset:3072
  s_waitcnt lgkmcnt(3)
  v_mfma_f32_32x32x16_bf16 v[80:95], v[20:23], v[180:183], v[80:95]
  ds_read_b128 v[180:183], v9 offset:12288
  s_waitcnt lgkmcnt(3)
  v_mfma_f32_32x32x16_bf16 v[64:79], v[24:27], v[56:59], v[64:79]
  ds_read_b128 v[56:59], v9 offset:4096
  s_waitcnt lgkmcnt(3)
  v_mfma_f32_32x32x16_bf16 v[80:95], v[24:27], v[60:63], v[80:95]
  ds_read_b128 v[60:63], v9 offset:13312
  s_waitcnt lgkmcnt(3)
  v_mfma_f32_32x32x16_bf16 v[64:79], v[28:31], v[176:179], v[64:79]
  ds_read_b128 v[176:179], v9 offset:5120
  s_waitcnt lgkmcnt(3)
  v_mfma_f32_32x32x16_bf16 v[80:95], v[28:31], v[180:183], v[80:95]
  ds_read_b128 v[180:183], v9 offset:14336
  s_waitcnt lgkmcnt(3)
  v_mfma_f32_32x32x16_bf16 v[64:79], v[32:35], v[56:59], v[64:79]
  ds_read_b128 v[56:59], v9 offset:6144
  s_waitcnt lgkmcnt(3)
  v_mfma_f32_32x32x16_bf16 v[80:95], v[32:35], v[60:63], v[80:95]
  ds_read_b128 v[60:63], v9 offset:15360
  s_waitcnt lgkmcnt(3)
  v_mfma_f32_32x32x16_bf16 v[64:79], v[36:39], v[176:179], v[64:79]
  ds_read_b128 v[176:179], v9 offset:7168
  s_waitcnt lgkmcnt(3)
  v_mfma_f32_32x32x16_bf16 v[80:95], v[36:39], v[180:183], v[80:95]
  ds_read_b128 v[180:183], v9 offset:16384
  s_waitcnt lgkmcnt(3)
  v_mfma_f32_32x32x16_bf16 v[64:79], v[40:43], v[56:59], v[64:79]
  ds_read_b128 v[56:59], v9 offset:8192
  s_waitcnt lgkmcnt(3)
  v_mfma_f32_32x32x16_bf16 v[80:95], v[40:43], v[60:63], v[80:95]
  ds_read_b128 v[60:63], v9 offset:17408
  s_waitcnt lgkmcnt(3)
  v_mfma_f32_32x32x16_bf16 v[64:79], v[44:47], v[176:179], v[64:79]
  s_waitcnt lgkmcnt(2)
  v_mfma_f32_32x32x16_bf16 v[80:95], v[44:47], v[180:183], v[80:95]
  s_waitcnt lgkmcnt(1)
  v_mfma_f32_32x32x16_bf16 v[64:79], v[48:51], v[56:59], v[64:79]
  s_waitcnt lgkmcnt(0)
  v_mfma_f32_32x32x16_bf16 v[80:95], v[48:51], v[60:63], v[80:95]
  v_add_u32 v4, 0, v1
  v_cvt_f32_u32 v5, v4
  v_mov_b32 v128, 1.0
  v_mov_b32 v132, 0
  v_mul_f32 v6, 0x3ae38e39, v5
  v_cos_f32 v129, v6
  v_sin_f32 v133, v6
  v_mul_f32 v6, 0x3b638e39, v5
  v_cos_f32 v130, v6
  v_sin_f32 v134, v6
  v_mul_f32 v6, 0x3baaaaab, v5
  v_cos_f32 v131, v6
  v_sin_f32 v135, v6
  v_cmp_gt_u32 vcc, 73, v4
  v_mov_b32 v7, 139920
  v_add_u32 v6, 0, v4
  v_mad_u32_u24 v6, v6, v8, v3
  v_cndmask_b32 v10, v7, v6, vcc
  v_add_u32 v6, 144, v4
  v_mad_u32_u24 v6, v6, v8, v3
  v_cndmask_b32 v11, v7, v6, vcc
  v_sub_u32 v6, 288, v4
  v_mad_u32_u24 v6, v6, v8, v3
  v_cndmask_b32 v12, v7, v6, vcc
  v_sub_u32 v6, 144, v4
  v_mad_u32_u24 v6, v6, v8, v3
  v_cndmask_b32 v13, v7, v6, vcc
  s_nop 1
  s_waitcnt vmcnt(5)
  s_barrier
  v_pk_mul_f32 v[136:137], v[80:81], v[132:133]
  v_pk_mul_f32 v[138:139], v[64:65], v[132:133]
  ds_read_b128 v[56:59], v9 offset:18432
  v_pk_mul_f32 v[148:149], v[82:83], v[134:135]
  ds_read_b128 v[60:63], v9 offset:27648
  v_pk_mul_f32 v[150:151], v[66:67], v[134:135]
  v_pk_fma_f32 v[64:65], v[64:65], v[128:129], v[136:137]
  ds_read_b128 v[176:179], v9 offset:19456
  v_pk_fma_f32 v[80:81], v[80:81], v[128:129], v[138:139] neg_lo:[0,0,1] neg_hi:[0,0,1]
  ds_read_b128 v[180:183], v9 offset:28672
  v_pk_fma_f32 v[66:67], v[66:67], v[130:131], v[148:149]
  v_pk_fma_f32 v[82:83], v[82:83], v[130:131], v[150:151] neg_lo:[0,0,1] neg_hi:[0,0,1]
  s_waitcnt lgkmcnt(3)
  v_pk_add_f32 v[140:141], v[64:65], v[66:67]
  v_mfma_f32_32x32x16_bf16 v[184:199], v[16:19], v[56:59], 0
  v_pk_add_f32 v[142:143], v[80:81], v[82:83]
  v_pk_add_f32 v[144:145], v[64:65], v[66:67] neg_lo:[0,1] neg_hi:[0,1]
  ds_read_b128 v[56:59], v9 offset:20480
  v_pk_add_f32 v[146:147], v[80:81], v[82:83] neg_lo:[0,1] neg_hi:[0,1]
  s_waitcnt lgkmcnt(3)
  v_add_f32 v96, v140, v141
  v_add_f32 v100, v142, v143
  v_mfma_f32_32x32x16_bf16 v[200:215], v[16:19], v[60:63], 0
  v_sub_f32 v112, v140, v141
  ds_read_b128 v[60:63], v9 offset:29696
  v_sub_f32 v116, v143, v142
  v_add_f32 v104, v144, v147
  s_waitcnt lgkmcnt(3)
  v_sub_f32 v108, v146, v145
  v_mfma_f32_32x32x16_bf16 v[184:199], v[20:23], v[176:179], v[184:199]
  v_sub_f32 v120, v144, v147
  v_add_f32_e64 v124, -v146, -v145
  ds_read_b128 v[176:179], v9 offset:21504
  v_pk_mul_f32 v[136:137], v[84:85], v[132:133]
  s_waitcnt lgkmcnt(3)
  v_pk_mul_f32 v[138:139], v[68:69], v[132:133]
  v_pk_mul_f32 v[148:149], v[86:87], v[134:135]
  v_mfma_f32_32x32x16_bf16 v[200:215], v[20:23], v[180:183], v[200:215]
  v_pk_mul_f32 v[150:151], v[70:71], v[134:135]
  ds_read_b128 v[180:183], v9 offset:30720
  v_pk_fma_f32 v[68:69], v[68:69], v[128:129], v[136:137]
  v_pk_fma_f32 v[84:85], v[84:85], v[128:129], v[138:139] neg_lo:[0,0,1] neg_hi:[0,0,1]
  s_waitcnt lgkmcnt(3)
  v_pk_fma_f32 v[70:71], v[70:71], v[130:131], v[148:149]
  v_mfma_f32_32x32x16_bf16 v[184:199], v[24:27], v[56:59], v[184:199]
  v_pk_fma_f32 v[86:87], v[86:87], v[130:131], v[150:151] neg_lo:[0,0,1] neg_hi:[0,0,1]
  v_pk_add_f32 v[140:141], v[68:69], v[70:71]
  ds_read_b128 v[56:59], v9 offset:22528
  v_pk_add_f32 v[142:143], v[84:85], v[86:87]
  s_waitcnt lgkmcnt(3)
  v_pk_add_f32 v[144:145], v[68:69], v[70:71] neg_lo:[0,1] neg_hi:[0,1]
  v_pk_add_f32 v[146:147], v[84:85], v[86:87] neg_lo:[0,1] neg_hi:[0,1]
  v_mfma_f32_32x32x16_bf16 v[200:215], v[24:27], v[60:63], v[200:215]
  v_add_f32 v97, v140, v141
  ds_read_b128 v[60:63], v9 offset:31744
  v_add_f32 v101, v142, v143
  v_sub_f32 v113, v140, v141
  s_waitcnt lgkmcnt(3)
  v_sub_f32 v117, v143, v142
  v_mfma_f32_32x32x16_bf16 v[184:199], v[28:31], v[176:179], v[184:199]
  v_add_f32 v105, v144, v147
  v_sub_f32 v109, v146, v145
  ds_read_b128 v[176:179], v9 offset:23552
  v_sub_f32 v121, v144, v147
  s_waitcnt lgkmcnt(3)
  v_add_f32_e64 v125, -v146, -v145
  v_mfma_f32_32x32x16_bf16 v[200:215], v[28:31], v[180:183], v[200:215]
  v_pk_mul_f32 v[136:137], v[88:89], v[132:133]
  v_pk_mul_f32 v[138:139], v[72:73], v[132:133]
  ds_read_b128 v[180:183], v9 offset:32768
  v_pk_mul_f32 v[148:149], v[90:91], v[134:135]
  s_waitcnt lgkmcnt(3)
  v_pk_mul_f32 v[150:151], v[74:75], v[134:135]
  v_pk_fma_f32 v[72:73], v[72:73], v[128:129], v[136:137]
  v_mfma_f32_32x32x16_bf16 v[184:199], v[32:35], v[56:59], v[184:199]
  v_pk_fma_f32 v[88:89], v[88:89], v[128:129], v[138:139] neg_lo:[0,0,1] neg_hi:[0,0,1]
  ds_read_b128 v[56:59], v9 offset:24576
  v_pk_fma_f32 v[74:75], v[74:75], v[130:131], v[148:149]
  v_pk_fma_f32 v[90:91], v[90:91], v[130:131], v[150:151] neg_lo:[0,0,1] neg_hi:[0,0,1]
  s_waitcnt lgkmcnt(3)
  v_pk_add_f32 v[140:141], v[72:73], v[74:75]
  v_mfma_f32_32x32x16_bf16 v[200:215], v[32:35], v[60:63], v[200:215]
  v_pk_add_f32 v[142:143], v[88:89], v[90:91]
  v_pk_add_f32 v[144:145], v[72:73], v[74:75] neg_lo:[0,1] neg_hi:[0,1]
  ds_read_b128 v[60:63], v9 offset:33792
  v_pk_add_f32 v[146:147], v[88:89], v[90:91] neg_lo:[0,1] neg_hi:[0,1]
  s_waitcnt lgkmcnt(3)
  v_add_f32 v98, v140, v141
  v_add_f32 v102, v142, v143
  v_mfma_f32_32x32x16_bf16 v[184:199], v[36:39], v[176:179], v[184:199]
  v_sub_f32 v114, v140, v141
  ds_read_b128 v[176:179], v9 offset:25600
  v_sub_f32 v118, v143, v142
  v_add_f32 v106, v144, v147
  s_waitcnt lgkmcnt(3)
  v_sub_f32 v110, v146, v145
  v_mfma_f32_32x32x16_bf16 v[200:215], v[36:39], v[180:183], v[200:215]
  v_sub_f32 v122, v144, v147
  v_add_f32_e64 v126, -v146, -v145
  ds_read_b128 v[180:183], v9 offset:34816
  v_pk_mul_f32 v[136:137], v[92:93], v[132:133]
  s_waitcnt lgkmcnt(3)
  v_pk_mul_f32 v[138:139], v[76:77], v[132:133]
  v_pk_mul_f32 v[148:149], v[94:95], v[134:135]
  v_mfma_f32_32x32x16_bf16 v[184:199], v[40:43], v[56:59], v[184:199]
  v_pk_mul_f32 v[150:151], v[78:79], v[134:135]
  ds_read_b128 v[56:59], v9 offset:26624
  v_pk_fma_f32 v[76:77], v[76:77], v[128:129], v[136:137]
  v_pk_fma_f32 v[92:93], v[92:93], v[128:129], v[138:139] neg_lo:[0,0,1] neg_hi:[0,0,1]
  s_waitcnt lgkmcnt(3)
  v_pk_fma_f32 v[78:79], v[78:79], v[130:131], v[148:149]
  v_mfma_f32_32x32x16_bf16 v[200:215], v[40:43], v[60:63], v[200:215]
  v_pk_fma_f32 v[94:95], v[94:95], v[130:131], v[150:151] neg_lo:[0,0,1] neg_hi:[0,0,1]
  v_pk_add_f32 v[140:141], v[76:77], v[78:79]
  ds_read_b128 v[60:63], v9 offset:35840
  v_pk_add_f32 v[142:143], v[92:93], v[94:95]
  s_waitcnt lgkmcnt(3)
  v_pk_add_f32 v[144:145], v[76:77], v[78:79] neg_lo:[0,1] neg_hi:[0,1]
  v_pk_add_f32 v[146:147], v[92:93], v[94:95] neg_lo:[0,1] neg_hi:[0,1]
  v_mfma_f32_32x32x16_bf16 v[184:199], v[44:47], v[176:179], v[184:199]
  v_add_f32 v99, v140, v141
  s_waitcnt lgkmcnt(2)
  v_add_f32 v103, v142, v143
  v_sub_f32 v115, v140, v141
  v_mfma_f32_32x32x16_bf16 v[200:215], v[44:47], v[180:183], v[200:215]
  v_sub_f32 v119, v143, v142
  s_waitcnt lgkmcnt(1)
  v_add_f32 v107, v144, v147
  v_sub_f32 v111, v146, v145
  v_mfma_f32_32x32x16_bf16 v[184:199], v[48:51], v[56:59], v[184:199]
  v_sub_f32 v123, v144, v147
  s_waitcnt lgkmcnt(0)
  v_add_f32_e64 v127, -v146, -v145
  v_mfma_f32_32x32x16_bf16 v[200:215], v[48:51], v[60:63], v[200:215]
  v_cvt_pk_bf16_f32 v160, v96, v97
  v_cvt_pk_bf16_f32 v161, v98, v99
  ds_write_b64 v10, v[160:161] offset:0
  v_cvt_pk_bf16_f32 v162, v100, v101
  v_cvt_pk_bf16_f32 v163, v102, v103
  ds_write_b64 v10, v[162:163] offset:64
  v_cvt_pk_bf16_f32 v164, v104, v105
  v_cvt_pk_bf16_f32 v165, v106, v107
  ds_write_b64 v11, v[164:165] offset:0
  v_cvt_pk_bf16_f32 v166, v108, v109
  v_cvt_pk_bf16_f32 v167, v110, v111
  ds_write_b64 v11, v[166:167] offset:64
  v_cvt_pk_bf16_f32 v168, v112, v113
  v_cvt_pk_bf16_f32 v169, v114, v115
  ds_write_b64 v12, v[168:169] offset:0
  v_cvt_pk_bf16_f32 v170, v116, v117
  v_cvt_pk_bf16_f32 v171, v118, v119
  ds_write_b64 v12, v[170:171] offset:64
  v_cvt_pk_bf16_f32 v172, v120, v121
  v_cvt_pk_bf16_f32 v173, v122, v123
  ds_write_b64 v13, v[172:173] offset:0
  v_cvt_pk_bf16_f32 v174, v124, v125
  v_cvt_pk_bf16_f32 v175, v126, v127
  ds_write_b64 v13, v[174:175] offset:64
  s_waitcnt lgkmcnt(0)
  v_add_u32 v4, 32, v1
  v_cvt_f32_u32 v5, v4
  v_mov_b32 v128, 1.0
  v_mov_b32 v132, 0
  v_mul_f32 v6, 0x3ae38e39, v5
  v_cos_f32 v129, v6
  v_sin_f32 v133, v6
  v_mul_f32 v6, 0x3b638e39, v5
  v_cos_f32 v130, v6
  v_sin_f32 v134, v6
  v_mul_f32 v6, 0x3baaaaab, v5
  v_cos_f32 v131, v6
  v_sin_f32 v135, v6
  v_cmp_gt_u32 vcc, 73, v4
  v_mov_b32 v7, 139920
  v_add_u32 v6, 0, v4
  v_mad_u32_u24 v6, v6, v8, v3
  v_cndmask_b32 v10, v7, v6, vcc
  v_add_u32 v6, 144, v4
  v_mad_u32_u24 v6, v6, v8, v3
  v_cndmask_b32 v11, v7, v6, vcc
  v_sub_u32 v6, 288, v4
  v_mad_u32_u24 v6, v6, v8, v3
  v_cndmask_b32 v12, v7, v6, vcc
  v_sub_u32 v6, 144, v4
  v_mad_u32_u24 v6, v6, v8, v3
  v_cndmask_b32 v13, v7, v6, vcc
  s_waitcnt vmcnt(0)
  s_barrier
  v_pk_mul_f32 v[136:137], v[200:201], v[132:133]
  v_pk_mul_f32 v[138:139], v[184:185], v[132:133]
  ds_read_b128 v[56:59], v9 offset:36864
  v_pk_mul_f32 v[148:149], v[202:203], v[134:135]
  ds_read_b128 v[60:63], v9 offset:46080
  v_pk_mul_f32 v[150:151], v[186:187], v[134:135]
  v_pk_fma_f32 v[184:185], v[184:185], v[128:129], v[136:137]
  ds_read_b128 v[176:179], v9 offset:37888
  v_pk_fma_f32 v[200:201], v[200:201], v[128:129], v[138:139] neg_lo:[0,0,1] neg_hi:[0,0,1]
  ds_read_b128 v[180:183], v9 offset:47104
  v_pk_fma_f32 v[186:187], v[186:187], v[130:131], v[148:149]
  v_pk_fma_f32 v[202:203], v[202:203], v[130:131], v[150:151] neg_lo:[0,0,1] neg_hi:[0,0,1]
  s_waitcnt lgkmcnt(3)
  v_pk_add_f32 v[140:141], v[184:185], v[186:187]
  v_mfma_f32_32x32x16_bf16 v[64:79], v[16:19], v[56:59], 0
  v_pk_add_f32 v[142:143], v[200:201], v[202:203]
  v_pk_add_f32 v[144:145], v[184:185], v[186:187] neg_lo:[0,1] neg_hi:[0,1]
  ds_read_b128 v[56:59], v9 offset:38912
  v_pk_add_f32 v[146:147], v[200:201], v[202:203] neg_lo:[0,1] neg_hi:[0,1]
  s_waitcnt lgkmcnt(3)
  v_add_f32 v96, v140, v141
  v_add_f32 v100, v142, v143
  v_mfma_f32_32x32x16_bf16 v[80:95], v[16:19], v[60:63], 0
  v_sub_f32 v112, v140, v141
  ds_read_b128 v[60:63], v9 offset:48128
  v_sub_f32 v116, v143, v142
  v_add_f32 v104, v144, v147
  s_waitcnt lgkmcnt(3)
  v_sub_f32 v108, v146, v145
  v_mfma_f32_32x32x16_bf16 v[64:79], v[20:23], v[176:179], v[64:79]
  v_sub_f32 v120, v144, v147
  v_add_f32_e64 v124, -v146, -v145
  ds_read_b128 v[176:179], v9 offset:39936
  v_pk_mul_f32 v[136:137], v[204:205], v[132:133]
  s_waitcnt lgkmcnt(3)
  v_pk_mul_f32 v[138:139], v[188:189], v[132:133]
  v_pk_mul_f32 v[148:149], v[206:207], v[134:135]
  v_mfma_f32_32x32x16_bf16 v[80:95], v[20:23], v[180:183], v[80:95]
  v_pk_mul_f32 v[150:151], v[190:191], v[134:135]
  ds_read_b128 v[180:183], v9 offset:49152
  v_pk_fma_f32 v[188:189], v[188:189], v[128:129], v[136:137]
  v_pk_fma_f32 v[204:205], v[204:205], v[128:129], v[138:139] neg_lo:[0,0,1] neg_hi:[0,0,1]
  s_waitcnt lgkmcnt(3)
  v_pk_fma_f32 v[190:191], v[190:191], v[130:131], v[148:149]
  v_mfma_f32_32x32x16_bf16 v[64:79], v[24:27], v[56:59], v[64:79]
  v_pk_fma_f32 v[206:207], v[206:207], v[130:131], v[150:151] neg_lo:[0,0,1] neg_hi:[0,0,1]
  v_pk_add_f32 v[140:141], v[188:189], v[190:191]
  ds_read_b128 v[56:59], v9 offset:40960
  v_pk_add_f32 v[142:143], v[204:205], v[206:207]
  s_waitcnt lgkmcnt(3)
  v_pk_add_f32 v[144:145], v[188:189], v[190:191] neg_lo:[0,1] neg_hi:[0,1]
  v_pk_add_f32 v[146:147], v[204:205], v[206:207] neg_lo:[0,1] neg_hi:[0,1]
  v_mfma_f32_32x32x16_bf16 v[80:95], v[24:27], v[60:63], v[80:95]
  v_add_f32 v97, v140, v141
  ds_read_b128 v[60:63], v9 offset:50176
  v_add_f32 v101, v142, v143
  v_sub_f32 v113, v140, v141
  s_waitcnt lgkmcnt(3)
  v_sub_f32 v117, v143, v142
  v_mfma_f32_32x32x16_bf16 v[64:79], v[28:31], v[176:179], v[64:79]
  v_add_f32 v105, v144, v147
  v_sub_f32 v109, v146, v145
  ds_read_b128 v[176:179], v9 offset:41984
  v_sub_f32 v121, v144, v147
  s_waitcnt lgkmcnt(3)
  v_add_f32_e64 v125, -v146, -v145
  v_mfma_f32_32x32x16_bf16 v[80:95], v[28:31], v[180:183], v[80:95]
  v_pk_mul_f32 v[136:137], v[208:209], v[132:133]
  v_pk_mul_f32 v[138:139], v[192:193], v[132:133]
  ds_read_b128 v[180:183], v9 offset:51200
  v_pk_mul_f32 v[148:149], v[210:211], v[134:135]
  s_waitcnt lgkmcnt(3)
  v_pk_mul_f32 v[150:151], v[194:195], v[134:135]
  v_pk_fma_f32 v[192:193], v[192:193], v[128:129], v[136:137]
  v_mfma_f32_32x32x16_bf16 v[64:79], v[32:35], v[56:59], v[64:79]
  v_pk_fma_f32 v[208:209], v[208:209], v[128:129], v[138:139] neg_lo:[0,0,1] neg_hi:[0,0,1]
  ds_read_b128 v[56:59], v9 offset:43008
  v_pk_fma_f32 v[194:195], v[194:195], v[130:131], v[148:149]
  v_pk_fma_f32 v[210:211], v[210:211], v[130:131], v[150:151] neg_lo:[0,0,1] neg_hi:[0,0,1]
  s_waitcnt lgkmcnt(3)
  v_pk_add_f32 v[140:141], v[192:193], v[194:195]
  v_mfma_f32_32x32x16_bf16 v[80:95], v[32:35], v[60:63], v[80:95]
  v_pk_add_f32 v[142:143], v[208:209], v[210:211]
  v_pk_add_f32 v[144:145], v[192:193], v[194:195] neg_lo:[0,1] neg_hi:[0,1]
  ds_read_b128 v[60:63], v9 offset:52224
  v_pk_add_f32 v[146:147], v[208:209], v[210:211] neg_lo:[0,1] neg_hi:[0,1]
  s_waitcnt lgkmcnt(3)
  v_add_f32 v98, v140, v141
  v_add_f32 v102, v142, v143
  v_mfma_f32_32x32x16_bf16 v[64:79], v[36:39], v[176:179], v[64:79]
  v_sub_f32 v114, v140, v141
  ds_read_b128 v[176:179], v9 offset:44032
  v_sub_f32 v118, v143, v142
  v_add_f32 v106, v144, v147
  s_waitcnt lgkmcnt(3)
  v_sub_f32 v110, v146, v145
  v_mfma_f32_32x32x16_bf16 v[80:95], v[36:39], v[180:183], v[80:95]
  v_sub_f32 v122, v144, v147
  v_add_f32_e64 v126, -v146, -v145
  ds_read_b128 v[180:183], v9 offset:53248
  v_pk_mul_f32 v[136:137], v[212:213], v[132:133]
  s_waitcnt lgkmcnt(3)
  v_pk_mul_f32 v[138:139], v[196:197], v[132:133]
  v_pk_mul_f32 v[148:149], v[214:215], v[134:135]
  v_mfma_f32_32x32x16_bf16 v[64:79], v[40:43], v[56:59], v[64:79]
  v_pk_mul_f32 v[150:151], v[198:199], v[134:135]
  ds_read_b128 v[56:59], v9 offset:45056
  v_pk_fma_f32 v[196:197], v[196:197], v[128:129], v[136:137]
  v_pk_fma_f32 v[212:213], v[212:213], v[128:129], v[138:139] neg_lo:[0,0,1] neg_hi:[0,0,1]
  s_waitcnt lgkmcnt(3)
  v_pk_fma_f32 v[198:199], v[198:199], v[130:131], v[148:149]
  v_mfma_f32_32x32x16_bf16 v[80:95], v[40:43], v[60:63], v[80:95]
  v_pk_fma_f32 v[214:215], v[214:215], v[130:131], v[150:151] neg_lo:[0,0,1] neg_hi:[0,0,1]
  v_pk_add_f32 v[140:141], v[196:197], v[198:199]
  ds_read_b128 v[60:63], v9 offset:54272
  v_pk_add_f32 v[142:143], v[212:213], v[214:215]
  s_waitcnt lgkmcnt(3)
  v_pk_add_f32 v[144:145], v[196:197], v[198:199] neg_lo:[0,1] neg_hi:[0,1]
  v_pk_add_f32 v[146:147], v[212:213], v[214:215] neg_lo:[0,1] neg_hi:[0,1]
  v_mfma_f32_32x32x16_bf16 v[64:79], v[44:47], v[176:179], v[64:79]
  v_add_f32 v99, v140, v141
  s_waitcnt lgkmcnt(2)
  v_add_f32 v103, v142, v143
  v_sub_f32 v115, v140, v141
  v_mfma_f32_32x32x16_bf16 v[80:95], v[44:47], v[180:183], v[80:95]
  v_sub_f32 v119, v143, v142
  s_waitcnt lgkmcnt(1)
  v_add_f32 v107, v144, v147
  v_sub_f32 v111, v146, v145
  v_mfma_f32_32x32x16_bf16 v[64:79], v[48:51], v[56:59], v[64:79]
  v_sub_f32 v123, v144, v147
  s_waitcnt lgkmcnt(0)
  v_add_f32_e64 v127, -v146, -v145
  v_mfma_f32_32x32x16_bf16 v[80:95], v[48:51], v[60:63], v[80:95]
  v_cvt_pk_bf16_f32 v160, v96, v97
  v_cvt_pk_bf16_f32 v161, v98, v99
  ds_write_b64 v10, v[160:161] offset:0
  v_cvt_pk_bf16_f32 v162, v100, v101
  v_cvt_pk_bf16_f32 v163, v102, v103
  ds_write_b64 v10, v[162:163] offset:64
  v_cvt_pk_bf16_f32 v164, v104, v105
  v_cvt_pk_bf16_f32 v165, v106, v107
  ds_write_b64 v11, v[164:165] offset:0
  v_cvt_pk_bf16_f32 v166, v108, v109
  v_cvt_pk_bf16_f32 v167, v110, v111
  ds_write_b64 v11, v[166:167] offset:64
  v_cvt_pk_bf16_f32 v168, v112, v113
  v_cvt_pk_bf16_f32 v169, v114, v115
  ds_write_b64 v12, v[168:169] offset:0
  v_cvt_pk_bf16_f32 v170, v116, v117
  v_cvt_pk_bf16_f32 v171, v118, v119
  ds_write_b64 v12, v[170:171] offset:64
  v_cvt_pk_bf16_f32 v172, v120, v121
  v_cvt_pk_bf16_f32 v173, v122, v123
  ds_write_b64 v13, v[172:173] offset:0
  v_cvt_pk_bf16_f32 v174, v124, v125
  v_cvt_pk_bf16_f32 v175, v126, v127
  ds_write_b64 v13, v[174:175] offset:64
  s_waitcnt lgkmcnt(0)
  v_add_u32 v4, 64, v1
  v_cvt_f32_u32 v5, v4
  v_mov_b32 v128, 1.0
  v_mov_b32 v132, 0
  v_mul_f32 v6, 0x3ae38e39, v5
  v_cos_f32 v129, v6
  v_sin_f32 v133, v6
  v_mul_f32 v6, 0x3b638e39, v5
  v_cos_f32 v130, v6
  v_sin_f32 v134, v6
  v_mul_f32 v6, 0x3baaaaab, v5
  v_cos_f32 v131, v6
  v_sin_f32 v135, v6
  v_cmp_gt_u32 vcc, 73, v4
  v_mov_b32 v7, 139920
  v_add_u32 v6, 0, v4
  v_mad_u32_u24 v6, v6, v8, v3
  v_cndmask_b32 v10, v7, v6, vcc
  v_add_u32 v6, 144, v4
  v_mad_u32_u24 v6, v6, v8, v3
  v_cndmask_b32 v11, v7, v6, vcc
  v_sub_u32 v6, 288, v4
  v_mad_u32_u24 v6, v6, v8, v3
  v_cndmask_b32 v12, v7, v6, vcc
  v_sub_u32 v6, 144, v4
  v_mad_u32_u24 v6, v6, v8, v3
  v_cndmask_b32 v13, v7, v6, vcc
  v_pk_mul_f32 v[136:137], v[80:81], v[132:133]
  v_pk_mul_f32 v[138:139], v[64:65], v[132:133]
  v_pk_mul_f32 v[148:149], v[82:83], v[134:135]
  v_pk_mul_f32 v[150:151], v[66:67], v[134:135]
  v_pk_fma_f32 v[64:65], v[64:65], v[128:129], v[136:137]
  v_pk_fma_f32 v[80:81], v[80:81], v[128:129], v[138:139] neg_lo:[0,0,1] neg_hi:[0,0,1]
  v_pk_fma_f32 v[66:67], v[66:67], v[130:131], v[148:149]
  v_pk_fma_f32 v[82:83], v[82:83], v[130:131], v[150:151] neg_lo:[0,0,1] neg_hi:[0,0,1]
  v_pk_add_f32 v[140:141], v[64:65], v[66:67]
  v_pk_add_f32 v[142:143], v[80:81], v[82:83]
  v_pk_add_f32 v[144:145], v[64:65], v[66:67] neg_lo:[0,1] neg_hi:[0,1]
  v_pk_add_f32 v[146:147], v[80:81], v[82:83] neg_lo:[0,1] neg_hi:[0,1]
  v_add_f32 v96, v140, v141
  v_add_f32 v100, v142, v143
  v_sub_f32 v112, v140, v141
  v_sub_f32 v116, v143, v142
  v_add_f32 v104, v144, v147
  v_sub_f32 v108, v146, v145
  v_sub_f32 v120, v144, v147
  v_add_f32_e64 v124, -v146, -v145
  v_pk_mul_f32 v[136:137], v[84:85], v[132:133]
  v_pk_mul_f32 v[138:139], v[68:69], v[132:133]
  v_pk_mul_f32 v[148:149], v[86:87], v[134:135]
  v_pk_mul_f32 v[150:151], v[70:71], v[134:135]
  v_pk_fma_f32 v[68:69], v[68:69], v[128:129], v[136:137]
  v_pk_fma_f32 v[84:85], v[84:85], v[128:129], v[138:139] neg_lo:[0,0,1] neg_hi:[0,0,1]
  v_pk_fma_f32 v[70:71], v[70:71], v[130:131], v[148:149]
  v_pk_fma_f32 v[86:87], v[86:87], v[130:131], v[150:151] neg_lo:[0,0,1] neg_hi:[0,0,1]
  v_pk_add_f32 v[140:141], v[68:69], v[70:71]
  v_pk_add_f32 v[142:143], v[84:85], v[86:87]
  v_pk_add_f32 v[144:145], v[68:69], v[70:71] neg_lo:[0,1] neg_hi:[0,1]
  v_pk_add_f32 v[146:147], v[84:85], v[86:87] neg_lo:[0,1] neg_hi:[0,1]
  v_add_f32 v97, v140, v141
  v_add_f32 v101, v142, v143
  v_sub_f32 v113, v140, v141
  v_sub_f32 v117, v143, v142
  v_add_f32 v105, v144, v147
  v_sub_f32 v109, v146, v145
  v_sub_f32 v121, v144, v147
  v_add_f32_e64 v125, -v146, -v145
  v_pk_mul_f32 v[136:137], v[88:89], v[132:133]
  v_pk_mul_f32 v[138:139], v[72:73], v[132:133]
  v_pk_mul_f32 v[148:149], v[90:91], v[134:135]
  v_pk_mul_f32 v[150:151], v[74:75], v[134:135]
  v_pk_fma_f32 v[72:73], v[72:73], v[128:129], v[136:137]
  v_pk_fma_f32 v[88:89], v[88:89], v[128:129], v[138:139] neg_lo:[0,0,1] neg_hi:[0,0,1]
  v_pk_fma_f32 v[74:75], v[74:75], v[130:131], v[148:149]
  v_pk_fma_f32 v[90:91], v[90:91], v[130:131], v[150:151] neg_lo:[0,0,1] neg_hi:[0,0,1]
  v_pk_add_f32 v[140:141], v[72:73], v[74:75]
  v_pk_add_f32 v[142:143], v[88:89], v[90:91]
  v_pk_add_f32 v[144:145], v[72:73], v[74:75] neg_lo:[0,1] neg_hi:[0,1]
  v_pk_add_f32 v[146:147], v[88:89], v[90:91] neg_lo:[0,1] neg_hi:[0,1]
  v_add_f32 v98, v140, v141
  v_add_f32 v102, v142, v143
  v_sub_f32 v114, v140, v141
  v_sub_f32 v118, v143, v142
  v_add_f32 v106, v144, v147
  v_sub_f32 v110, v146, v145
  v_sub_f32 v122, v144, v147
  v_add_f32_e64 v126, -v146, -v145
  v_pk_mul_f32 v[136:137], v[92:93], v[132:133]
  v_pk_mul_f32 v[138:139], v[76:77], v[132:133]
  v_pk_mul_f32 v[148:149], v[94:95], v[134:135]
  v_pk_mul_f32 v[150:151], v[78:79], v[134:135]
  v_pk_fma_f32 v[76:77], v[76:77], v[128:129], v[136:137]
  v_pk_fma_f32 v[92:93], v[92:93], v[128:129], v[138:139] neg_lo:[0,0,1] neg_hi:[0,0,1]
  v_pk_fma_f32 v[78:79], v[78:79], v[130:131], v[148:149]
  v_pk_fma_f32 v[94:95], v[94:95], v[130:131], v[150:151] neg_lo:[0,0,1] neg_hi:[0,0,1]
  v_pk_add_f32 v[140:141], v[76:77], v[78:79]
  v_pk_add_f32 v[142:143], v[92:93], v[94:95]
  v_pk_add_f32 v[144:145], v[76:77], v[78:79] neg_lo:[0,1] neg_hi:[0,1]
  v_pk_add_f32 v[146:147], v[92:93], v[94:95] neg_lo:[0,1] neg_hi:[0,1]
  v_add_f32 v99, v140, v141
  v_add_f32 v103, v142, v143
  v_sub_f32 v115, v140, v141
  v_sub_f32 v119, v143, v142
  v_add_f32 v107, v144, v147
  v_sub_f32 v111, v146, v145
  v_sub_f32 v123, v144, v147
  v_add_f32_e64 v127, -v146, -v145
  v_cvt_pk_bf16_f32 v160, v96, v97
  v_cvt_pk_bf16_f32 v161, v98, v99
  ds_write_b64 v10, v[160:161] offset:0
  v_cvt_pk_bf16_f32 v162, v100, v101
  v_cvt_pk_bf16_f32 v163, v102, v103
  ds_write_b64 v10, v[162:163] offset:64
  v_cvt_pk_bf16_f32 v164, v104, v105
  v_cvt_pk_bf16_f32 v165, v106, v107
  ds_write_b64 v11, v[164:165] offset:0
  v_cvt_pk_bf16_f32 v166, v108, v109
  v_cvt_pk_bf16_f32 v167, v110, v111
  ds_write_b64 v11, v[166:167] offset:64
  v_cvt_pk_bf16_f32 v168, v112, v113
  v_cvt_pk_bf16_f32 v169, v114, v115
  ds_write_b64 v12, v[168:169] offset:0
  v_cvt_pk_bf16_f32 v170, v116, v117
  v_cvt_pk_bf16_f32 v171, v118, v119
  ds_write_b64 v12, v[170:171] offset:64
  v_cvt_pk_bf16_f32 v172, v120, v121
  v_cvt_pk_bf16_f32 v173, v122, v123
  ds_write_b64 v13, v[172:173] offset:0
  v_cvt_pk_bf16_f32 v174, v124, v125
  v_cvt_pk_bf16_f32 v175, v126, v127
  ds_write_b64 v13, v[174:175] offset:64
  s_waitcnt lgkmcnt(0)
  s_waitcnt lgkmcnt(0)
  s_barrier
  v_lshrrev_b32 v1, 3, v0
  v_and_b32 v2, 7, v0
  s_lshl_b32 s20, s16, 3
  v_add_u32 v1, s20, v1
  v_mul_u32_u24 v3, 144, v1
  v_lshl_add_u32 v3, v2, 4, v3
  v_add_u32 v3, 98304, v3
  v_lshrrev_b32 v4, 2, v2
  v_and_b32 v5, 3, v2
  v_lshlrev_b32 v4, 12, v4
  v_lshl_add_u32 v4, v5, 4, v4
  v_lshl_add_u32 v4, v1, 13, v4
  v_mov_b32 v7, 0x7ff00000
  ds_read_b128 v[16:19], v3 offset:0
  ds_read_b128 v[20:23], v3 offset:4608
  ds_read_b128 v[24:27], v3 offset:9216
  ds_read_b128 v[28:31], v3 offset:13824
  ds_read_b128 v[32:35], v3 offset:18432
  v_add_u32 v5, 0, v1
  v_cmp_gt_u32 vcc, 289, v5
  v_add_u32 v6, 0x0, v4
  s_waitcnt lgkmcnt(4)
  v_cndmask_b32 v60, v7, v6, vcc
  buffer_store_dwordx4 v[16:19], v60, s[8:11], s24 offen
  v_add_u32 v5, 32, v1
  v_cmp_gt_u32 vcc, 289, v5
  v_add_u32 v6, 0x40000, v4
  s_waitcnt lgkmcnt(3)
  v_cndmask_b32 v61, v7, v6, vcc
  buffer_store_dwordx4 v[20:23], v61, s[8:11], s24 offen
  v_add_u32 v5, 64, v1
  v_cmp_gt_u32 vcc, 289, v5
  v_add_u32 v6, 0x80000, v4
  s_waitcnt lgkmcnt(2)
  v_cndmask_b32 v62, v7, v6, vcc
  buffer_store_dwordx4 v[24:27], v62, s[8:11], s24 offen
  v_add_u32 v5, 96, v1
  v_cmp_gt_u32 vcc, 289, v5
  v_add_u32 v6, 0xc0000, v4
  s_waitcnt lgkmcnt(1)
  v_cndmask_b32 v63, v7, v6, vcc
  buffer_store_dwordx4 v[28:31], v63, s[8:11], s24 offen
  v_add_u32 v5, 128, v1
  v_cmp_gt_u32 vcc, 289, v5
  v_add_u32 v6, 0x100000, v4
  s_waitcnt lgkmcnt(0)
  v_cndmask_b32 v64, v7, v6, vcc
  buffer_store_dwordx4 v[32:35], v64, s[8:11], s24 offen
  ds_read_b128 v[36:39], v3 offset:23040
  ds_read_b128 v[40:43], v3 offset:27648
  ds_read_b128 v[44:47], v3 offset:32256
  ds_read_b128 v[48:51], v3 offset:36864
  ds_read_b128 v[52:55], v3 offset:41472
  v_add_u32 v5, 160, v1
  v_cmp_gt_u32 vcc, 289, v5
  v_add_u32 v6, 0x140000, v4
  s_waitcnt lgkmcnt(4)
  v_cndmask_b32 v65, v7, v6, vcc
  buffer_store_dwordx4 v[36:39], v65, s[8:11], s24 offen
  v_add_u32 v5, 192, v1
  v_cmp_gt_u32 vcc, 289, v5
  v_add_u32 v6, 0x180000, v4
  s_waitcnt lgkmcnt(3)
  v_cndmask_b32 v66, v7, v6, vcc
  buffer_store_dwordx4 v[40:43], v66, s[8:11], s24 offen
  v_add_u32 v5, 224, v1
  v_cmp_gt_u32 vcc, 289, v5
  v_add_u32 v6, 0x1c0000, v4
  s_waitcnt lgkmcnt(2)
  v_cndmask_b32 v67, v7, v6, vcc
  buffer_store_dwordx4 v[44:47], v67, s[8:11], s24 offen
  v_add_u32 v5, 256, v1
  v_cmp_gt_u32 vcc, 289, v5
  v_add_u32 v6, 0x200000, v4
  s_waitcnt lgkmcnt(1)
  v_cndmask_b32 v68, v7, v6, vcc
  buffer_store_dwordx4 v[48:51], v68, s[8:11], s24 offen
  v_add_u32 v5, 288, v1
  v_cmp_gt_u32 vcc, 289, v5
  v_add_u32 v6, 0x240000, v4
  s_waitcnt lgkmcnt(0)
  v_cndmask_b32 v69, v7, v6, vcc
  buffer_store_dwordx4 v[52:55], v69, s[8:11], s24 offen
  s_branch L_fin_2
L_kv_4:
  s_mov_b32 s12, s38
  s_and_b32 s13, s39, 0xffff
  s_mov_b32 s14, 0x240000
  s_mov_b32 s15, 0x20000
  s_mov_b32 s48, s42
  s_and_b32 s49, s43, 0xffff
  s_mov_b32 s50, 0x5100
  s_mov_b32 s51, 0x20000
  s_mov_b32 s52, s44
  s_and_b32 s53, s45, 0xffff
  s_mov_b32 s54, 0x5100
  s_mov_b32 s55, 0x20000
  s_mul_i32 s26, s17, 147456
  s_lshl_b32 s28, s16, 12
  v_lshrrev_b32 v1, 3, v0
  v_and_b32 v2, 7, v0
  v_lshrrev_b32 v3, 1, v1
  v_xor_b32 v2, v2, v3
  v_lshlrev_b32 v2, 4, v2
  s_lshl_b32 s20, s16, 5
  v_add_u32 v1, s20, v1
  s_mov_b32 s20, 1152
  v_mul_lo_u32 v1, v1, s20
  v_add_u32 v5, v1, v2
  v_xor_b32 v15, 64, v5
  s_lshl_b32 s20, s16, 6
  v_add_u32 v1, s20, v0
  v_mul_u32_u24 v2, 21846, v1
  v_lshrrev_b32 v2, 16, v2
  v_mul_u32_u24 v3, 3, v2
  v_sub_u32 v3, v1, v3
  v_mul_u32_u24 v3, 12, v3
  v_mul_u32_u24 v6, 36, v2
  v_add_u32 v6, v6, v3
  v_mul_u32_u24 v7, 80, v2
  v_add_u32 v7, v7, v3
  v_add_u32 v7, 98304, v7
  s_mov_b32 s20, 0
  buffer_load_dwordx3 v[96:98], v6, s[48:51], s20 offen
  s_mov_b32 s20, 3060
  buffer_load_dwordx3 v[100:102], v6, s[48:51], s20 offen
  s_mov_b32 s20, 6120
  buffer_load_dwordx3 v[104:106], v6, s[48:51], s20 offen
  s_mov_b32 s20, 9180
  buffer_load_dwordx3 v[108:110], v6, s[48:51], s20 offen
  s_mov_b32 s20, 12240
  buffer_load_dwordx3 v[112:114], v6, s[48:51], s20 offen
  s_mov_b32 s20, 15300
  buffer_load_dwordx3 v[116:118], v6, s[48:51], s20 offen
  s_mov_b32 s20, 18360
  buffer_load_dwordx3 v[120:122], v6, s[48:51], s20 offen
  s_mov_b32 s20, 0
  buffer_load_dwordx3 v[124:126], v6, s[52:55], s20 offen
  s_mov_b32 s20, 3060
  buffer_load_dwordx3 v[128:130], v6, s[52:55], s20 offen
  s_mov_b32 s20, 6120
  buffer_load_dwordx3 v[132:134], v6, s[52:55], s20 offen
  s_mov_b32 s20, 9180
  buffer_load_dwordx3 v[136:138], v6, s[52:55], s20 offen
  s_mov_b32 s20, 12240
  buffer_load_dwordx3 v[140:142], v6, s[52:55], s20 offen
  s_mov_b32 s20, 15300
  buffer_load_dwordx3 v[144:146], v6, s[52:55], s20 offen
  s_mov_b32 s20, 18360
  buffer_load_dwordx3 v[148:150], v6, s[52:55], s20 offen
  s_add_u32 s21, s28, 0
  s_mov_b32 m0, s21
  s_add_u32 s22, s26, 0
  buffer_load_dwordx4 v5, s[12:15], s22 offen lds
  s_add_u32 s21, s28, 1024
  s_mov_b32 m0, s21
  s_add_u32 s22, s26, 9216
  buffer_load_dwordx4 v15, s[12:15], s22 offen lds
  s_add_u32 s21, s28, 2048
  s_mov_b32 m0, s21
  s_add_u32 s22, s26, 18432
  buffer_load_dwordx4 v5, s[12:15], s22 offen lds
  s_add_u32 s21, s28, 3072
  s_mov_b32 m0, s21
  s_add_u32 s22, s26, 27648
  buffer_load_dwordx4 v15, s[12:15], s22 offen lds
  s_add_u32 s21, s28, 16384
  s_mov_b32 m0, s21
  s_add_u32 s22, s26, 128
  buffer_load_dwordx4 v5, s[12:15], s22 offen lds
  s_add_u32 s21, s28, 17408
  s_mov_b32 m0, s21
  s_add_u32 s22, s26, 9344
  buffer_load_dwordx4 v15, s[12:15], s22 offen lds
  s_add_u32 s21, s28, 18432
  s_mov_b32 m0, s21
  s_add_u32 s22, s26, 18560
  buffer_load_dwordx4 v5, s[12:15], s22 offen lds
  s_add_u32 s21, s28, 19456
  s_mov_b32 m0, s21
  s_add_u32 s22, s26, 27776
  buffer_load_dwordx4 v15, s[12:15], s22 offen lds
  s_add_u32 s21, s28, 32768
  s_mov_b32 m0, s21
  s_add_u32 s22, s26, 256
  buffer_load_dwordx4 v5, s[12:15], s22 offen lds
  s_add_u32 s21, s28, 33792
  s_mov_b32 m0, s21
  s_add_u32 s22, s26, 9472
  buffer_load_dwordx4 v15, s[12:15], s22 offen lds
  s_add_u32 s21, s28, 34816
  s_mov_b32 m0, s21
  s_add_u32 s22, s26, 18688
  buffer_load_dwordx4 v5, s[12:15], s22 offen lds
  s_add_u32 s21, s28, 35840
  s_mov_b32 m0, s21
  s_add_u32 s22, s26, 27904
  buffer_load_dwordx4 v15, s[12:15], s22 offen lds
  s_add_u32 s21, s28, 49152
  s_mov_b32 m0, s21
  s_add_u32 s22, s26, 384
  buffer_load_dwordx4 v5, s[12:15], s22 offen lds
  s_add_u32 s21, s28, 50176
  s_mov_b32 m0, s21
  s_add_u32 s22, s26, 9600
  buffer_load_dwordx4 v15, s[12:15], s22 offen lds
  s_add_u32 s21, s28, 51200
  s_mov_b32 m0, s21
  s_add_u32 s22, s26, 18816
  buffer_load_dwordx4 v5, s[12:15], s22 offen lds
  s_add_u32 s21, s28, 52224
  s_mov_b32 m0, s21
  s_add_u32 s22, s26, 28032
  buffer_load_dwordx4 v15, s[12:15], s22 offen lds
  v_and_b32 v1, 31, v0
  v_lshrrev_b32 v2, 5, v0
  v_bfe_u32 v3, v1, 1, 3
  s_lshl_b32 s20, s16, 12
  v_lshlrev_b32 v1, 7, v1
  v_add_u32 v1, s20, v1
  v_add_u32 v4, 0, v2
  v_xor_b32 v4, v4, v3
  v_lshl_add_u32 v8, v4, 4, v1
  v_add_u32 v4, 2, v2
  v_xor_b32 v4, v4, v3
  v_lshl_add_u32 v9, v4, 4, v1
  v_add_u32 v4, 4, v2
  v_xor_b32 v4, v4, v3
  v_lshl_add_u32 v10, v4, 4, v1
  v_add_u32 v4, 6, v2
  v_xor_b32 v4, v4, v3
  v_lshl_add_u32 v11, v4, 4, v1
  v_and_b32 v1, 15, v0
  v_lshrrev_b32 v2, 2, v1
  v_and_b32 v1, 3, v1
  v_lshrrev_b32 v3, 4, v0
  v_lshrrev_b32 v4, 1, v3
  v_and_b32 v3, 1, v3
  v_lshl_add_u32 v4, v4, 3, v2
  v_mul_u32_u24 v4, 80, v4
  v_lshl_add_u32 v4, v3, 5, v4
  v_lshl_add_u32 v4, v1, 3, v4
  v_add_u32 v12, 98304, v4
  v_mov_b32 v48, 0
  v_mov_b32 v49, 0
  v_mov_b32 v50, 0
  v_mov_b32 v51, 0
  v_mov_b32 v52, 0
  v_mov_b32 v53, 0
  v_mov_b32 v54, 0
  v_mov_b32 v55, 0
  v_mov_b32 v56, 0
  v_mov_b32 v57, 0
  v_mov_b32 v58, 0
  v_mov_b32 v59, 0
  v_mov_b32 v60, 0
  v_mov_b32 v61, 0
  v_mov_b32 v62, 0
  v_mov_b32 v63, 0
  v_mov_b32 v64, 0
  v_mov_b32 v65, 0
  v_mov_b32 v66, 0
  v_mov_b32 v67, 0
  v_mov_b32 v68, 0
  v_mov_b32 v69, 0
  v_mov_b32 v70, 0
  v_mov_b32 v71, 0
  v_mov_b32 v72, 0
  v_mov_b32 v73, 0
  v_mov_b32 v74, 0
  v_mov_b32 v75, 0
  v_mov_b32 v76, 0
  v_mov_b32 v77, 0
  v_mov_b32 v78, 0
  v_mov_b32 v79, 0
  s_waitcnt vmcnt(16)
  ds_write_b32 v7, v96 offset:0
  ds_write_b32 v7, v97 offset:4
  ds_write_b32 v7, v98 offset:8
  ds_write_b32 v7, v100 offset:6800
  ds_write_b32 v7, v101 offset:6804
  ds_write_b32 v7, v102 offset:6808
  ds_write_b32 v7, v104 offset:13600
  ds_write_b32 v7, v105 offset:13604
  ds_write_b32 v7, v106 offset:13608
  ds_write_b32 v7, v108 offset:20400
  ds_write_b32 v7, v109 offset:20404
  ds_write_b32 v7, v110 offset:20408
  ds_write_b32 v7, v112 offset:27200
  ds_write_b32 v7, v113 offset:27204
  ds_write_b32 v7, v114 offset:27208
  ds_write_b32 v7, v116 offset:34000
  ds_write_b32 v7, v117 offset:34004
  ds_write_b32 v7, v118 offset:34008
  ds_write_b32 v7, v120 offset:40800
  ds_write_b32 v7, v121 offset:40804
  ds_write_b32 v7, v122 offset:40808
  ds_write_b32 v7, v124 offset:40
  ds_write_b32 v7, v125 offset:44
  ds_write_b32 v7, v126 offset:48
  ds_write_b32 v7, v128 offset:6840
  ds_write_b32 v7, v129 offset:6844
  ds_write_b32 v7, v130 offset:6848
  ds_write_b32 v7, v132 offset:13640
  ds_write_b32 v7, v133 offset:13644
  ds_write_b32 v7, v134 offset:13648
  ds_write_b32 v7, v136 offset:20440
  ds_write_b32 v7, v137 offset:20444
  ds_write_b32 v7, v138 offset:20448
  ds_write_b32 v7, v140 offset:27240
  ds_write_b32 v7, v141 offset:27244
  ds_write_b32 v7, v142 offset:27248
  ds_write_b32 v7, v144 offset:34040
  ds_write_b32 v7, v145 offset:34044
  ds_write_b32 v7, v146 offset:34048
  ds_write_b32 v7, v148 offset:40840
  ds_write_b32 v7, v149 offset:40844
  ds_write_b32 v7, v150 offset:40848
  v_add_u32 v172, 65536, v8
  v_add_u32 v173, 65536, v9
  v_add_u32 v174, 65536, v10
  v_add_u32 v175, 65536, v11
  s_waitcnt lgkmcnt(0)
  s_barrier
  s_waitcnt vmcnt(12)
  ds_read_b128 v[16:19], v8 offset:0
  ds_read_b64_tr_b16 v[24:25], v12 offset:0
  ds_read_b64_tr_b16 v[32:33], v12 offset:40
  ds_read_b64_tr_b16 v[26:27], v12 offset:320
  ds_read_b64_tr_b16 v[34:35], v12 offset:360
  ds_read_b128 v[20:23], v9 offset:0
  ds_read_b64_tr_b16 v[28:29], v12 offset:1280
  ds_read_b64_tr_b16 v[36:37], v12 offset:1320
  ds_read_b64_tr_b16 v[30:31], v12 offset:1600
  ds_read_b64_tr_b16 v[38:39], v12 offset:1640
  ds_read_b128 v[160:163], v10 offset:0
  ds_read_b64_tr_b16 v[164:165], v12 offset:2560
  ds_read_b64_tr_b16 v[168:169], v12 offset:2600
  ds_read_b64_tr_b16 v[166:167], v12 offset:2880
  ds_read_b64_tr_b16 v[170:171], v12 offset:2920
  s_waitcnt lgkmcnt(10)
  v_mfma_f32_32x32x16_bf16 v[48:63], v[24:27], v[16:19], v[48:63]
  v_mfma_f32_32x32x16_bf16 v[64:79], v[16:19], v[32:35], v[64:79]
  s_add_u32 s21, s28, 65536
  s_mov_b32 m0, s21
  s_add_u32 s22, s26, 512
  buffer_load_dwordx4 v5, s[12:15], s22 offen lds
  ds_read_b128 v[16:19], v11 offset:0
  ds_read_b64_tr_b16 v[24:25], v12 offset:3840
  ds_read_b64_tr_b16 v[32:33], v12 offset:3880
  ds_read_b64_tr_b16 v[26:27], v12 offset:4160
  ds_read_b64_tr_b16 v[34:35], v12 offset:4200
  s_waitcnt lgkmcnt(10)
  v_mfma_f32_32x32x16_bf16 v[48:63], v[28:31], v[20:23], v[48:63]
  v_mfma_f32_32x32x16_bf16 v[64:79], v[20:23], v[36:39], v[64:79]
  s_add_u32 s21, s28, 66560
  s_mov_b32 m0, s21
  s_add_u32 s22, s26, 9728
  buffer_load_dwordx4 v15, s[12:15], s22 offen lds
  s_waitcnt vmcnt(10)
  ds_read_b128 v[20:23], v8 offset:16384
  ds_read_b64_tr_b16 v[28:29], v12 offset:5120
  ds_read_b64_tr_b16 v[36:37], v12 offset:5160
  ds_read_b64_tr_b16 v[30:31], v12 offset:5440
  ds_read_b64_tr_b16 v[38:39], v12 offset:5480
  s_waitcnt lgkmcnt(10)
  v_mfma_f32_32x32x16_bf16 v[48:63], v[164:167], v[160:163], v[48:63]
  v_mfma_f32_32x32x16_bf16 v[64:79], v[160:163], v[168:171], v[64:79]
  s_add_u32 s21, s28, 67584
  s_mov_b32 m0, s21
  s_add_u32 s22, s26, 18944
  buffer_load_dwordx4 v5, s[12:15], s22 offen lds
  ds_read_b128 v[160:163], v9 offset:16384
  ds_read_b64_tr_b16 v[164:165], v12 offset:6400
  ds_read_b64_tr_b16 v[168:169], v12 offset:6440
  ds_read_b64_tr_b16 v[166:167], v12 offset:6720
  ds_read_b64_tr_b16 v[170:171], v12 offset:6760
  s_waitcnt lgkmcnt(10)
  v_mfma_f32_32x32x16_bf16 v[48:63], v[24:27], v[16:19], v[48:63]
  v_mfma_f32_32x32x16_bf16 v[64:79], v[16:19], v[32:35], v[64:79]
  s_add_u32 s21, s28, 68608
  s_mov_b32 m0, s21
  s_add_u32 s22, s26, 28160
  buffer_load_dwordx4 v15, s[12:15], s22 offen lds
  ds_read_b128 v[16:19], v10 offset:16384
  ds_read_b64_tr_b16 v[24:25], v12 offset:7680
  ds_read_b64_tr_b16 v[32:33], v12 offset:7720
  ds_read_b64_tr_b16 v[26:27], v12 offset:8000
  ds_read_b64_tr_b16 v[34:35], v12 offset:8040
  s_waitcnt lgkmcnt(10)
  v_mfma_f32_32x32x16_bf16 v[48:63], v[28:31], v[20:23], v[48:63]
  v_mfma_f32_32x32x16_bf16 v[64:79], v[20:23], v[36:39], v[64:79]
  s_add_u32 s21, s28, 81920
  s_mov_b32 m0, s21
  s_add_u32 s22, s26, 640
  buffer_load_dwordx4 v5, s[12:15], s22 offen lds
  ds_read_b128 v[20:23], v11 offset:16384
  ds_read_b64_tr_b16 v[28:29], v12 offset:8960
  ds_read_b64_tr_b16 v[36:37], v12 offset:9000
  ds_read_b64_tr_b16 v[30:31], v12 offset:9280
  ds_read_b64_tr_b16 v[38:39], v12 offset:9320
  s_waitcnt lgkmcnt(10)
  v_mfma_f32_32x32x16_bf16 v[48:63], v[164:167], v[160:163], v[48:63]
  v_mfma_f32_32x32x16_bf16 v[64:79], v[160:163], v[168:171], v[64:79]
  s_add_u32 s21, s28, 82944
  s_mov_b32 m0, s21
  s_add_u32 s22, s26, 9856
  buffer_load_dwordx4 v15, s[12:15], s22 offen lds
  s_waitcnt vmcnt(10)
  ds_read_b128 v[160:163], v8 offset:32768
  ds_read_b64_tr_b16 v[164:165], v12 offset:10240
  ds_read_b64_tr_b16 v[168:169], v12 offset:10280
  ds_read_b64_tr_b16 v[166:167], v12 offset:10560
  ds_read_b64_tr_b16 v[170:171], v12 offset:10600
  s_waitcnt lgkmcnt(10)
  v_mfma_f32_32x32x16_bf16 v[48:63], v[24:27], v[16:19], v[48:63]
  v_mfma_f32_32x32x16_bf16 v[64:79], v[16:19], v[32:35], v[64:79]
  s_add_u32 s21, s28, 83968
  s_mov_b32 m0, s21
  s_add_u32 s22, s26, 19072
  buffer_load_dwordx4 v5, s[12:15], s22 offen lds
  ds_read_b128 v[16:19], v9 offset:32768
  ds_read_b64_tr_b16 v[24:25], v12 offset:11520
  ds_read_b64_tr_b16 v[32:33], v12 offset:11560
  ds_read_b64_tr_b16 v[26:27], v12 offset:11840
  ds_read_b64_tr_b16 v[34:35], v12 offset:11880
  s_waitcnt lgkmcnt(10)
  v_mfma_f32_32x32x16_bf16 v[48:63], v[28:31], v[20:23], v[48:63]
  v_mfma_f32_32x32x16_bf16 v[64:79], v[20:23], v[36:39], v[64:79]
  s_add_u32 s21, s28, 84992
  s_mov_b32 m0, s21
  s_add_u32 s22, s26, 28288
  buffer_load_dwordx4 v15, s[12:15], s22 offen lds
  ds_read_b128 v[20:23], v10 offset:32768
  ds_read_b64_tr_b16 v[28:29], v12 offset:12800
  ds_read_b64_tr_b16 v[36:37], v12 offset:12840
  ds_read_b64_tr_b16 v[30:31], v12 offset:13120
  ds_read_b64_tr_b16 v[38:39], v12 offset:13160
  s_waitcnt lgkmcnt(10)
  v_mfma_f32_32x32x16_bf16 v[48:63], v[164:167], v[160:163], v[48:63]
  v_mfma_f32_32x32x16_bf16 v[64:79], v[160:163], v[168:171], v[64:79]
  s_add_u32 s21, s28, 0
  s_mov_b32 m0, s21
  s_add_u32 s22, s26, 768
  buffer_load_dwordx4 v5, s[12:15], s22 offen lds
  ds_read_b128 v[160:163], v11 offset:32768
  ds_read_b64_tr_b16 v[164:165], v12 offset:14080
  ds_read_b64_tr_b16 v[168:169], v12 offset:14120
  ds_read_b64_tr_b16 v[166:167], v12 offset:14400
  ds_read_b64_tr_b16 v[170:171], v12 offset:14440
  s_waitcnt lgkmcnt(10)
  v_mfma_f32_32x32x16_bf16 v[48:63], v[24:27], v[16:19], v[48:63]
  v_mfma_f32_32x32x16_bf16 v[64:79], v[16:19], v[32:35], v[64:79]
  s_add_u32 s21, s28, 1024
  s_mov_b32 m0, s21
  s_add_u32 s22, s26, 9984
  buffer_load_dwordx4 v15, s[12:15], s22 offen lds
  s_waitcnt vmcnt(10)
  ds_read_b128 v[16:19], v8 offset:49152
  ds_read_b64_tr_b16 v[24:25], v12 offset:15360
  ds_read_b64_tr_b16 v[32:33], v12 offset:15400
  ds_read_b64_tr_b16 v[26:27], v12 offset:15680
  ds_read_b64_tr_b16 v[34:35], v12 offset:15720
  s_waitcnt lgkmcnt(10)
  v_mfma_f32_32x32x16_bf16 v[48:63], v[28:31], v[20:23], v[48:63]
  v_mfma_f32_32x32x16_bf16 v[64:79], v[20:23], v[36:39], v[64:79]
  s_add_u32 s21, s28, 2048
  s_mov_b32 m0, s21
  s_add_u32 s22, s26, 19200
  buffer_load_dwordx4 v5, s[12:15], s22 offen lds
  ds_read_b128 v[20:23], v9 offset:49152
  ds_read_b64_tr_b16 v[28:29], v12 offset:16640
  ds_read_b64_tr_b16 v[36:37], v12 offset:16680
  ds_read_b64_tr_b16 v[30:31], v12 offset:16960
  ds_read_b64_tr_b16 v[38:39], v12 offset:17000
  s_waitcnt lgkmcnt(10)
  v_mfma_f32_32x32x16_bf16 v[48:63], v[164:167], v[160:163], v[48:63]
  v_mfma_f32_32x32x16_bf16 v[64:79], v[160:163], v[168:171], v[64:79]
  s_add_u32 s21, s28, 3072
  s_mov_b32 m0, s21
  s_add_u32 s22, s26, 28416
  buffer_load_dwordx4 v15, s[12:15], s22 offen lds
  ds_read_b128 v[160:163], v10 offset:49152
  ds_read_b64_tr_b16 v[164:165], v12 offset:17920
  ds_read_b64_tr_b16 v[168:169], v12 offset:17960
  ds_read_b64_tr_b16 v[166:167], v12 offset:18240
  ds_read_b64_tr_b16 v[170:171], v12 offset:18280
  s_waitcnt lgkmcnt(10)
  v_mfma_f32_32x32x16_bf16 v[48:63], v[24:27], v[16:19], v[48:63]
  v_mfma_f32_32x32x16_bf16 v[64:79], v[16:19], v[32:35], v[64:79]
  s_add_u32 s21, s28, 16384
  s_mov_b32 m0, s21
  s_add_u32 s22, s26, 896
  buffer_load_dwordx4 v5, s[12:15], s22 offen lds
  ds_read_b128 v[16:19], v11 offset:49152
  ds_read_b64_tr_b16 v[24:25], v12 offset:19200
  ds_read_b64_tr_b16 v[32:33], v12 offset:19240
  ds_read_b64_tr_b16 v[26:27], v12 offset:19520
  ds_read_b64_tr_b16 v[34:35], v12 offset:19560
  s_waitcnt lgkmcnt(10)
  v_mfma_f32_32x32x16_bf16 v[48:63], v[28:31], v[20:23], v[48:63]
  v_mfma_f32_32x32x16_bf16 v[64:79], v[20:23], v[36:39], v[64:79]
  s_add_u32 s21, s28, 17408
  s_mov_b32 m0, s21
  s_add_u32 s22, s26, 10112
  buffer_load_dwordx4 v15, s[12:15], s22 offen lds
  s_waitcnt vmcnt(10)
  ds_read_b128 v[20:23], v172 offset:0
  ds_read_b64_tr_b16 v[28:29], v12 offset:20480
  ds_read_b64_tr_b16 v[36:37], v12 offset:20520
  ds_read_b64_tr_b16 v[30:31], v12 offset:20800
  ds_read_b64_tr_b16 v[38:39], v12 offset:20840
  s_waitcnt lgkmcnt(10)
  v_mfma_f32_32x32x16_bf16 v[48:63], v[164:167], v[160:163], v[48:63]
  v_mfma_f32_32x32x16_bf16 v[64:79], v[160:163], v[168:171], v[64:79]
  s_add_u32 s21, s28, 18432
  s_mov_b32 m0, s21
  s_add_u32 s22, s26, 19328
  buffer_load_dwordx4 v5, s[12:15], s22 offen lds
  ds_read_b128 v[160:163], v173 offset:0
  ds_read_b64_tr_b16 v[164:165], v12 offset:21760
  ds_read_b64_tr_b16 v[168:169], v12 offset:21800
  ds_read_b64_tr_b16 v[166:167], v12 offset:22080
  ds_read_b64_tr_b16 v[170:171], v12 offset:22120
  s_waitcnt lgkmcnt(10)
  v_mfma_f32_32x32x16_bf16 v[48:63], v[24:27], v[16:19], v[48:63]
  v_mfma_f32_32x32x16_bf16 v[64:79], v[16:19], v[32:35], v[64:79]
  s_add_u32 s21, s28, 19456
  s_mov_b32 m0, s21
  s_add_u32 s22, s26, 28544
  buffer_load_dwordx4 v15, s[12:15], s22 offen lds
  ds_read_b128 v[16:19], v174 offset:0
  ds_read_b64_tr_b16 v[24:25], v12 offset:23040
  ds_read_b64_tr_b16 v[32:33], v12 offset:23080
  ds_read_b64_tr_b16 v[26:27], v12 offset:23360
  ds_read_b64_tr_b16 v[34:35], v12 offset:23400
  s_waitcnt lgkmcnt(10)
  v_mfma_f32_32x32x16_bf16 v[48:63], v[28:31], v[20:23], v[48:63]
  v_mfma_f32_32x32x16_bf16 v[64:79], v[20:23], v[36:39], v[64:79]
  s_add_u32 s21, s28, 32768
  s_mov_b32 m0, s21
  s_add_u32 s22, s26, 1024
  buffer_load_dwordx4 v5, s[12:15], s22 offen lds
  ds_read_b128 v[20:23], v175 offset:0
  ds_read_b64_tr_b16 v[28:29], v12 offset:24320
  ds_read_b64_tr_b16 v[36:37], v12 offset:24360
  ds_read_b64_tr_b16 v[30:31], v12 offset:24640
  ds_read_b64_tr_b16 v[38:39], v12 offset:24680
  s_waitcnt lgkmcnt(10)
  v_mfma_f32_32x32x16_bf16 v[48:63], v[164:167], v[160:163], v[48:63]
  v_mfma_f32_32x32x16_bf16 v[64:79], v[160:163], v[168:171], v[64:79]
  s_add_u32 s21, s28, 33792
  s_mov_b32 m0, s21
  s_add_u32 s22, s26, 10240
  buffer_load_dwordx4 v15, s[12:15], s22 offen lds
  s_waitcnt vmcnt(10)
  ds_read_b128 v[160:163], v172 offset:16384
  ds_read_b64_tr_b16 v[164:165], v12 offset:25600
  ds_read_b64_tr_b16 v[168:169], v12 offset:25640
  ds_read_b64_tr_b16 v[166:167], v12 offset:25920
  ds_read_b64_tr_b16 v[170:171], v12 offset:25960
  s_waitcnt lgkmcnt(10)
  v_mfma_f32_32x32x16_bf16 v[48:63], v[24:27], v[16:19], v[48:63]
  v_mfma_f32_32x32x16_bf16 v[64:79], v[16:19], v[32:35], v[64:79]
  s_add_u32 s21, s28, 34816
  s_mov_b32 m0, s21
  s_add_u32 s22, s26, 19456
  buffer_load_dwordx4 v5, s[12:15], s22 offen lds
  ds_read_b128 v[16:19], v173 offset:16384
  ds_read_b64_tr_b16 v[24:25], v12 offset:26880
  ds_read_b64_tr_b16 v[32:33], v12 offset:26920
  ds_read_b64_tr_b16 v[26:27], v12 offset:27200
  ds_read_b64_tr_b16 v[34:35], v12 offset:27240
  s_waitcnt lgkmcnt(10)
  v_mfma_f32_32x32x16_bf16 v[48:63], v[28:31], v[20:23], v[48:63]
  v_mfma_f32_32x32x16_bf16 v[64:79], v[20:23], v[36:39], v[64:79]
  s_add_u32 s21, s28, 35840
  s_mov_b32 m0, s21
  s_add_u32 s22, s26, 28672
  buffer_load_dwordx4 v15, s[12:15], s22 offen lds
  ds_read_b128 v[20:23], v174 offset:16384
  ds_read_b64_tr_b16 v[28:29], v12 offset:28160
  ds_read_b64_tr_b16 v[36:37], v12 offset:28200
  ds_read_b64_tr_b16 v[30:31], v12 offset:28480
  ds_read_b64_tr_b16 v[38:39], v12 offset:28520
  s_waitcnt lgkmcnt(10)
  v_mfma_f32_32x32x16_bf16 v[48:63], v[164:167], v[160:163], v[48:63]
  v_mfma_f32_32x32x16_bf16 v[64:79], v[160:163], v[168:171], v[64:79]
  ds_read_b128 v[160:163], v175 offset:16384
  ds_read_b64_tr_b16 v[164:165], v12 offset:29440
  ds_read_b64_tr_b16 v[168:169], v12 offset:29480
  ds_read_b64_tr_b16 v[166:167], v12 offset:29760
  ds_read_b64_tr_b16 v[170:171], v12 offset:29800
  s_waitcnt lgkmcnt(10)
  v_mfma_f32_32x32x16_bf16 v[48:63], v[24:27], v[16:19], v[48:63]
  v_mfma_f32_32x32x16_bf16 v[64:79], v[16:19], v[32:35], v[64:79]
  s_waitcnt vmcnt(8)
  ds_read_b128 v[16:19], v8 offset:0
  ds_read_b64_tr_b16 v[24:25], v12 offset:30720
  ds_read_b64_tr_b16 v[32:33], v12 offset:30760
  ds_read_b64_tr_b16 v[26:27], v12 offset:31040
  ds_read_b64_tr_b16 v[34:35], v12 offset:31080
  s_waitcnt lgkmcnt(10)
  v_mfma_f32_32x32x16_bf16 v[48:63], v[28:31], v[20:23], v[48:63]
  v_mfma_f32_32x32x16_bf16 v[64:79], v[20:23], v[36:39], v[64:79]
  ds_read_b128 v[20:23], v9 offset:0
  ds_read_b64_tr_b16 v[28:29], v12 offset:32000
  ds_read_b64_tr_b16 v[36:37], v12 offset:32040
  ds_read_b64_tr_b16 v[30:31], v12 offset:32320
  ds_read_b64_tr_b16 v[38:39], v12 offset:32360
  s_waitcnt lgkmcnt(10)
  v_mfma_f32_32x32x16_bf16 v[48:63], v[164:167], v[160:163], v[48:63]
  v_mfma_f32_32x32x16_bf16 v[64:79], v[160:163], v[168:171], v[64:79]
  ds_read_b128 v[160:163], v10 offset:0
  ds_read_b64_tr_b16 v[164:165], v12 offset:33280
  ds_read_b64_tr_b16 v[168:169], v12 offset:33320
  ds_read_b64_tr_b16 v[166:167], v12 offset:33600
  ds_read_b64_tr_b16 v[170:171], v12 offset:33640
  s_waitcnt lgkmcnt(10)
  v_mfma_f32_32x32x16_bf16 v[48:63], v[24:27], v[16:19], v[48:63]
  v_mfma_f32_32x32x16_bf16 v[64:79], v[16:19], v[32:35], v[64:79]
  ds_read_b128 v[16:19], v11 offset:0
  ds_read_b64_tr_b16 v[24:25], v12 offset:34560
  ds_read_b64_tr_b16 v[32:33], v12 offset:34600
  ds_read_b64_tr_b16 v[26:27], v12 offset:34880
  ds_read_b64_tr_b16 v[34:35], v12 offset:34920
  s_waitcnt lgkmcnt(10)
  v_mfma_f32_32x32x16_bf16 v[48:63], v[28:31], v[20:23], v[48:63]
  v_mfma_f32_32x32x16_bf16 v[64:79], v[20:23], v[36:39], v[64:79]
  s_waitcnt vmcnt(4)
  ds_read_b128 v[20:23], v8 offset:16384
  ds_read_b64_tr_b16 v[28:29], v12 offset:35840
  ds_read_b64_tr_b16 v[36:37], v12 offset:35880
  ds_read_b64_tr_b16 v[30:31], v12 offset:36160
  ds_read_b64_tr_b16 v[38:39], v12 offset:36200
  s_waitcnt lgkmcnt(10)
  v_mfma_f32_32x32x16_bf16 v[48:63], v[164:167], v[160:163], v[48:63]
  v_mfma_f32_32x32x16_bf16 v[64:79], v[160:163], v[168:171], v[64:79]
  ds_read_b128 v[160:163], v9 offset:16384
  ds_read_b64_tr_b16 v[164:165], v12 offset:37120
  ds_read_b64_tr_b16 v[168:169], v12 offset:37160
  ds_read_b64_tr_b16 v[166:167], v12 offset:37440
  ds_read_b64_tr_b16 v[170:171], v12 offset:37480
  s_waitcnt lgkmcnt(10)
  v_mfma_f32_32x32x16_bf16 v[48:63], v[24:27], v[16:19], v[48:63]
  v_mfma_f32_32x32x16_bf16 v[64:79], v[16:19], v[32:35], v[64:79]
  ds_read_b128 v[16:19], v10 offset:16384
  ds_read_b64_tr_b16 v[24:25], v12 offset:38400
  ds_read_b64_tr_b16 v[32:33], v12 offset:38440
  ds_read_b64_tr_b16 v[26:27], v12 offset:38720
  ds_read_b64_tr_b16 v[34:35], v12 offset:38760
  s_waitcnt lgkmcnt(10)
  v_mfma_f32_32x32x16_bf16 v[48:63], v[28:31], v[20:23], v[48:63]
  v_mfma_f32_32x32x16_bf16 v[64:79], v[20:23], v[36:39], v[64:79]
  ds_read_b128 v[20:23], v11 offset:16384
  ds_read_b64_tr_b16 v[28:29], v12 offset:39680
  ds_read_b64_tr_b16 v[36:37], v12 offset:39720
  ds_read_b64_tr_b16 v[30:31], v12 offset:40000
  ds_read_b64_tr_b16 v[38:39], v12 offset:40040
  s_waitcnt lgkmcnt(10)
  v_mfma_f32_32x32x16_bf16 v[48:63], v[164:167], v[160:163], v[48:63]
  v_mfma_f32_32x32x16_bf16 v[64:79], v[160:163], v[168:171], v[64:79]
  s_waitcnt vmcnt(0)
  ds_read_b128 v[160:163], v8 offset:32768
  ds_read_b64_tr_b16 v[164:165], v12 offset:40960
  ds_read_b64_tr_b16 v[168:169], v12 offset:41000
  ds_read_b64_tr_b16 v[166:167], v12 offset:41280
  ds_read_b64_tr_b16 v[170:171], v12 offset:41320
  s_waitcnt lgkmcnt(10)
  v_mfma_f32_32x32x16_bf16 v[48:63], v[24:27], v[16:19], v[48:63]
  v_mfma_f32_32x32x16_bf16 v[64:79], v[16:19], v[32:35], v[64:79]
  ds_read_b128 v[16:19], v9 offset:32768
  ds_read_b64_tr_b16 v[24:25], v12 offset:42240
  ds_read_b64_tr_b16 v[32:33], v12 offset:42280
  ds_read_b64_tr_b16 v[26:27], v12 offset:42560
  ds_read_b64_tr_b16 v[34:35], v12 offset:42600
  s_waitcnt lgkmcnt(10)
  v_mfma_f32_32x32x16_bf16 v[48:63], v[28:31], v[20:23], v[48:63]
  v_mfma_f32_32x32x16_bf16 v[64:79], v[20:23], v[36:39], v[64:79]
  ds_read_b128 v[20:23], v10 offset:32768
  ds_read_b64_tr_b16 v[28:29], v12 offset:43520
  ds_read_b64_tr_b16 v[36:37], v12 offset:43560
  ds_read_b64_tr_b16 v[30:31], v12 offset:43840
  ds_read_b64_tr_b16 v[38:39], v12 offset:43880
  s_waitcnt lgkmcnt(10)
  v_mfma_f32_32x32x16_bf16 v[48:63], v[164:167], v[160:163], v[48:63]
  v_mfma_f32_32x32x16_bf16 v[64:79], v[160:163], v[168:171], v[64:79]
  ds_read_b128 v[160:163], v11 offset:32768
  ds_read_b64_tr_b16 v[164:165], v12 offset:44800
  ds_read_b64_tr_b16 v[168:169], v12 offset:44840
  ds_read_b64_tr_b16 v[166:167], v12 offset:45120
  ds_read_b64_tr_b16 v[170:171], v12 offset:45160
  s_waitcnt lgkmcnt(10)
  v_mfma_f32_32x32x16_bf16 v[48:63], v[24:27], v[16:19], v[48:63]
  v_mfma_f32_32x32x16_bf16 v[64:79], v[16:19], v[32:35], v[64:79]
  s_waitcnt lgkmcnt(5)
  v_mfma_f32_32x32x16_bf16 v[48:63], v[28:31], v[20:23], v[48:63]
  v_mfma_f32_32x32x16_bf16 v[64:79], v[20:23], v[36:39], v[64:79]
  s_waitcnt lgkmcnt(0)
  v_mfma_f32_32x32x16_bf16 v[48:63], v[164:167], v[160:163], v[48:63]
  v_mfma_f32_32x32x16_bf16 v[64:79], v[160:163], v[168:171], v[64:79]
  s_nop 7
  s_nop 7
  s_lshl_b32 s20, s17, 2
  s_add_u32 s20, s20, s16
  s_mul_i32 s21, s20, 2368
  s_add_u32 s21, s21, 0x240000
  v_and_b32 v1, 31, v0
  v_lshrrev_b32 v2, 5, v0
  v_cvt_pk_bf16_f32 v96, v48, v49
  v_cvt_pk_bf16_f32 v97, v50, v51
  v_cvt_pk_bf16_f32 v98, v52, v53
  v_cvt_pk_bf16_f32 v99, v54, v55
  v_cvt_pk_bf16_f32 v100, v56, v57
  v_lshlrev_b32 v3, 4, v0
  buffer_store_dwordx4 v[96:99], v3, s[8:11], s21 offen
  v_lshlrev_b32 v3, 2, v1
  v_cmp_gt_u32 vcc, 32, v0
  v_mov_b32 v4, 0x7ff00000
  s_nop 0
  v_cndmask_b32 v3, v4, v3, vcc
  buffer_store_dword v100, v3, s[8:11], s21 offen offset:1024
  v_cndmask_b32 v6, 0, v56, vcc
  v_cndmask_b32 v7, 0, v57, vcc
  v_max_f32 v6, |v6|, |v7|
  v_max3_f32 v6, |v48|, |v49|, v6
  v_max3_f32 v6, |v50|, |v51|, v6
  v_max3_f32 v6, |v52|, |v53|, v6
  v_max3_f32 v6, |v54|, |v55|, v6
  v_mov_b32 v7, 0
  v_max3_f32 v7, |v64|, |v65|, v7
  v_max3_f32 v7, |v66|, |v67|, v7
  v_max3_f32 v7, |v68|, |v69|, v7
  v_max3_f32 v7, |v70|, |v71|, v7
  v_max3_f32 v7, |v72|, |v73|, v7
  v_max3_f32 v7, |v74|, |v75|, v7
  v_max3_f32 v7, |v76|, |v77|, v7
  v_max3_f32 v7, |v78|, |v79|, v7
  v_cmp_gt_u32 vcc, 18, v1
  s_nop 1
  v_cndmask_b32 v7, 0, v7, vcc
  v_max_f32 v6, v6, v7
  v_cmp_eq_u32 s[24:25], 18, v1
  v_mov_b32 v8, 0x3f803f80
  v_mul_u32_u24 v3, 19, v2
  v_add_u32 v3, v3, v1
  v_lshlrev_b32 v3, 4, v3
  v_cmp_gt_u32 vcc, 19, v1
  s_nop 1
  v_cndmask_b32 v3, v4, v3, vcc
  s_add_u32 s23, s21, 1152
  v_cvt_pk_bf16_f32 v104, v64, v65
  v_cndmask_b32 v104, v104, v8, s[24:25]
  v_cvt_pk_bf16_f32 v105, v66, v67
  v_cndmask_b32 v105, v105, v8, s[24:25]
  v_cvt_pk_bf16_f32 v106, v68, v69
  v_cndmask_b32 v106, v106, v8, s[24:25]
  v_cvt_pk_bf16_f32 v107, v70, v71
  v_cndmask_b32 v107, v107, v8, s[24:25]
  buffer_store_dwordx4 v[104:107], v3, s[8:11], s23 offen offset:0
  v_cvt_pk_bf16_f32 v108, v72, v73
  v_cndmask_b32 v108, v108, v8, s[24:25]
  v_cvt_pk_bf16_f32 v109, v74, v75
  v_cndmask_b32 v109, v109, v8, s[24:25]
  v_cvt_pk_bf16_f32 v110, v76, v77
  v_cndmask_b32 v110, v110, v8, s[24:25]
  v_cvt_pk_bf16_f32 v111, v78, v79
  v_cndmask_b32 v111, v111, v8, s[24:25]
  buffer_store_dwordx4 v[108:111], v3, s[8:11], s23 offen offset:608
  s_nop 1
  v_max_f32_dpp v6, v6, v6 row_shr:1 row_mask:0xf bank_mask:0xf
  s_nop 1
  v_max_f32_dpp v6, v6, v6 row_shr:2 row_mask:0xf bank_mask:0xf
  s_nop 1
  v_max_f32_dpp v6, v6, v6 row_shr:4 row_mask:0xf bank_mask:0xf
  s_nop 1
  v_max_f32_dpp v6, v6, v6 row_shr:8 row_mask:0xf bank_mask:0xf
  s_nop 1
  v_max_f32_dpp v6, v6, v6 row_bcast:15 row_mask:0xa bank_mask:0xf
  s_nop 1
  v_max_f32_dpp v6, v6, v6 row_bcast:31 row_mask:0xc bank_mask:0xf
  s_nop 1
  v_mul_f32 v6, 0x3f810000, v6
  v_cmp_eq_u32 vcc, 63, v0
  v_mov_b32 v3, 0
  s_nop 0
  v_cndmask_b32 v3, v4, v3, vcc
  s_lshl_b32 s23, s20, 2
  s_add_u32 s23, s23, 0x270000
  buffer_store_dword v6, v3, s[8:11], s23 offen
  s_branch L_fin_2
L_w_5:
  s_mov_b32 s48, s34
  s_and_b32 s49, s35, 0xffff
  s_mov_b32 s50, 0x121000
  s_mov_b32 s51, 0x20000
  s_mov_b32 s52, s36
  s_and_b32 s53, s37, 0xffff
  s_mov_b32 s54, 0x121000
  s_mov_b32 s55, 0x20000
  s_load_dwordx2 s[56:57], s[0:1], 56
  s_waitcnt lgkmcnt(0)
  s_mov_b32 s92, s56
  s_and_b32 s93, s57, 0xffff
  s_mov_b32 s94, 0xa2000
  s_mov_b32 s95, 0x20000
  s_getpc_b64 s[96:97]
L_pc_7:
  s_add_u32 s96, s96, attn_kernel-L_pc_7
  s_addc_u32 s97, s97, 0
  s_and_b32 s97, s97, 0xffff
  s_mov_b32 s98, 0x2c500
  s_mov_b32 s99, 0x20000
  s_lshr_b32 s24, s17, 1
  s_and_b32 s25, s17, 1
  s_lshl_b32 s20, s24, 7
  s_lshl_b32 s21, s25, 4
  s_add_u32 s20, s20, s21
  s_mul_i32 s26, s20, 578
  v_lshlrev_b32 v1, 4, v0
  s_and_b32 s27, s16, 1
  s_lshr_b32 s28, s16, 1
  s_cmp_eq_u32 s28, 1
  s_cbranch_scc1 L_wi_8
  s_lshl_b32 s20, s27, 1
  s_add_u32 s20, s20, 0
  s_mul_i32 s21, s20, 18496
  s_add_u32 s21, s21, s26
  s_add_u32 s21, s21, 0
  s_lshl_b32 s22, s28, 2
  s_add_u32 s22, s22, s20
  s_mul_i32 s22, s22, 10240
  s_add_u32 s22, s22, 0
  s_mov_b32 m0, s22
  s_nop 0
  buffer_load_dwordx4 v1, s[48:51], s21 offen lds
  s_lshl_b32 s20, s27, 1
  s_add_u32 s20, s20, 0
  s_mul_i32 s21, s20, 18496
  s_add_u32 s21, s21, s26
  s_add_u32 s21, s21, 1024
  s_lshl_b32 s22, s28, 2
  s_add_u32 s22, s22, s20
  s_mul_i32 s22, s22, 10240
  s_add_u32 s22, s22, 1024
  s_mov_b32 m0, s22
  s_nop 0
  buffer_load_dwordx4 v1, s[48:51], s21 offen lds
  s_lshl_b32 s20, s27, 1
  s_add_u32 s20, s20, 0
  s_mul_i32 s21, s20, 18496
  s_add_u32 s21, s21, s26
  s_add_u32 s21, s21, 2048
  s_lshl_b32 s22, s28, 2
  s_add_u32 s22, s22, s20
  s_mul_i32 s22, s22, 10240
  s_add_u32 s22, s22, 2048
  s_mov_b32 m0, s22
  s_nop 0
  buffer_load_dwordx4 v1, s[48:51], s21 offen lds
  s_lshl_b32 s20, s27, 1
  s_add_u32 s20, s20, 0
  s_mul_i32 s21, s20, 18496
  s_add_u32 s21, s21, s26
  s_add_u32 s21, s21, 3072
  s_lshl_b32 s22, s28, 2
  s_add_u32 s22, s22, s20
  s_mul_i32 s22, s22, 10240
  s_add_u32 s22, s22, 3072
  s_mov_b32 m0, s22
  s_nop 0
  buffer_load_dwordx4 v1, s[48:51], s21 offen lds
  s_lshl_b32 s20, s27, 1
  s_add_u32 s20, s20, 0
  s_mul_i32 s21, s20, 18496
  s_add_u32 s21, s21, s26
  s_add_u32 s21, s21, 4096
  s_lshl_b32 s22, s28, 2
  s_add_u32 s22, s22, s20
  s_mul_i32 s22, s22, 10240
  s_add_u32 s22, s22, 4096
  s_mov_b32 m0, s22
  s_nop 0
  buffer_load_dwordx4 v1, s[48:51], s21 offen lds
  s_lshl_b32 s20, s27, 1
  s_add_u32 s20, s20, 0
  s_mul_i32 s21, s20, 18496
  s_add_u32 s21, s21, s26
  s_add_u32 s21, s21, 5120
  s_lshl_b32 s22, s28, 2
  s_add_u32 s22, s22, s20
  s_mul_i32 s22, s22, 10240
  s_add_u32 s22, s22, 5120
  s_mov_b32 m0, s22
  s_nop 0
  buffer_load_dwordx4 v1, s[48:51], s21 offen lds
  s_lshl_b32 s20, s27, 1
  s_add_u32 s20, s20, 0
  s_mul_i32 s21, s20, 18496
  s_add_u32 s21, s21, s26
  s_add_u32 s21, s21, 6144
  s_lshl_b32 s22, s28, 2
  s_add_u32 s22, s22, s20
  s_mul_i32 s22, s22, 10240
  s_add_u32 s22, s22, 6144
  s_mov_b32 m0, s22
  s_nop 0
  buffer_load_dwordx4 v1, s[48:51], s21 offen lds
  s_lshl_b32 s20, s27, 1
  s_add_u32 s20, s20, 0
  s_mul_i32 s21, s20, 18496
  s_add_u32 s21, s21, s26
  s_add_u32 s21, s21, 7168
  s_lshl_b32 s22, s28, 2
  s_add_u32 s22, s22, s20
  s_mul_i32 s22, s22, 10240
  s_add_u32 s22, s22, 7168
  s_mov_b32 m0, s22
  s_nop 0
  buffer_load_dwordx4 v1, s[48:51], s21 offen lds
  s_lshl_b32 s20, s27, 1
  s_add_u32 s20, s20, 0
  s_mul_i32 s21, s20, 18496
  s_add_u32 s21, s21, s26
  s_add_u32 s21, s21, 8192
  s_lshl_b32 s22, s28, 2
  s_add_u32 s22, s22, s20
  s_mul_i32 s22, s22, 10240
  s_add_u32 s22, s22, 8192
  s_mov_b32 m0, s22
  s_nop 0
  buffer_load_dwordx4 v1, s[48:51], s21 offen lds
  s_lshl_b32 s20, s27, 1
  s_add_u32 s20, s20, 0
  s_mul_i32 s21, s20, 18496
  s_add_u32 s21, s21, s26
  s_add_u32 s21, s21, 9216
  s_lshl_b32 s22, s28, 2
  s_add_u32 s22, s22, s20
  s_mul_i32 s22, s22, 10240
  s_add_u32 s22, s22, 9216
  s_mov_b32 m0, s22
  s_nop 0
  buffer_load_dwordx4 v1, s[48:51], s21 offen lds
  s_lshl_b32 s20, s27, 1
  s_add_u32 s20, s20, 1
  s_mul_i32 s21, s20, 18496
  s_add_u32 s21, s21, s26
  s_add_u32 s21, s21, 0
  s_lshl_b32 s22, s28, 2
  s_add_u32 s22, s22, s20
  s_mul_i32 s22, s22, 10240
  s_add_u32 s22, s22, 0
  s_mov_b32 m0, s22
  s_nop 0
  buffer_load_dwordx4 v1, s[48:51], s21 offen lds
  s_lshl_b32 s20, s27, 1
  s_add_u32 s20, s20, 1
  s_mul_i32 s21, s20, 18496
  s_add_u32 s21, s21, s26
  s_add_u32 s21, s21, 1024
  s_lshl_b32 s22, s28, 2
  s_add_u32 s22, s22, s20
  s_mul_i32 s22, s22, 10240
  s_add_u32 s22, s22, 1024
  s_mov_b32 m0, s22
  s_nop 0
  buffer_load_dwordx4 v1, s[48:51], s21 offen lds
  s_lshl_b32 s20, s27, 1
  s_add_u32 s20, s20, 1
  s_mul_i32 s21, s20, 18496
  s_add_u32 s21, s21, s26
  s_add_u32 s21, s21, 2048
  s_lshl_b32 s22, s28, 2
  s_add_u32 s22, s22, s20
  s_mul_i32 s22, s22, 10240
  s_add_u32 s22, s22, 2048
  s_mov_b32 m0, s22
  s_nop 0
  buffer_load_dwordx4 v1, s[48:51], s21 offen lds
  s_lshl_b32 s20, s27, 1
  s_add_u32 s20, s20, 1
  s_mul_i32 s21, s20, 18496
  s_add_u32 s21, s21, s26
  s_add_u32 s21, s21, 3072
  s_lshl_b32 s22, s28, 2
  s_add_u32 s22, s22, s20
  s_mul_i32 s22, s22, 10240
  s_add_u32 s22, s22, 3072
  s_mov_b32 m0, s22
  s_nop 0
  buffer_load_dwordx4 v1, s[48:51], s21 offen lds
  s_lshl_b32 s20, s27, 1
  s_add_u32 s20, s20, 1
  s_mul_i32 s21, s20, 18496
  s_add_u32 s21, s21, s26
  s_add_u32 s21, s21, 4096
  s_lshl_b32 s22, s28, 2
  s_add_u32 s22, s22, s20
  s_mul_i32 s22, s22, 10240
  s_add_u32 s22, s22, 4096
  s_mov_b32 m0, s22
  s_nop 0
  buffer_load_dwordx4 v1, s[48:51], s21 offen lds
  s_lshl_b32 s20, s27, 1
  s_add_u32 s20, s20, 1
  s_mul_i32 s21, s20, 18496
  s_add_u32 s21, s21, s26
  s_add_u32 s21, s21, 5120
  s_lshl_b32 s22, s28, 2
  s_add_u32 s22, s22, s20
  s_mul_i32 s22, s22, 10240
  s_add_u32 s22, s22, 5120
  s_mov_b32 m0, s22
  s_nop 0
  buffer_load_dwordx4 v1, s[48:51], s21 offen lds
  s_lshl_b32 s20, s27, 1
  s_add_u32 s20, s20, 1
  s_mul_i32 s21, s20, 18496
  s_add_u32 s21, s21, s26
  s_add_u32 s21, s21, 6144
  s_lshl_b32 s22, s28, 2
  s_add_u32 s22, s22, s20
  s_mul_i32 s22, s22, 10240
  s_add_u32 s22, s22, 6144
  s_mov_b32 m0, s22
  s_nop 0
  buffer_load_dwordx4 v1, s[48:51], s21 offen lds
  s_lshl_b32 s20, s27, 1
  s_add_u32 s20, s20, 1
  s_mul_i32 s21, s20, 18496
  s_add_u32 s21, s21, s26
  s_add_u32 s21, s21, 7168
  s_lshl_b32 s22, s28, 2
  s_add_u32 s22, s22, s20
  s_mul_i32 s22, s22, 10240
  s_add_u32 s22, s22, 7168
  s_mov_b32 m0, s22
  s_nop 0
  buffer_load_dwordx4 v1, s[48:51], s21 offen lds
  s_lshl_b32 s20, s27, 1
  s_add_u32 s20, s20, 1
  s_mul_i32 s21, s20, 18496
  s_add_u32 s21, s21, s26
  s_add_u32 s21, s21, 8192
  s_lshl_b32 s22, s28, 2
  s_add_u32 s22, s22, s20
  s_mul_i32 s22, s22, 10240
  s_add_u32 s22, s22, 8192
  s_mov_b32 m0, s22
  s_nop 0
  buffer_load_dwordx4 v1, s[48:51], s21 offen lds
  s_lshl_b32 s20, s27, 1
  s_add_u32 s20, s20, 1
  s_mul_i32 s21, s20, 18496
  s_add_u32 s21, s21, s26
  s_add_u32 s21, s21, 9216
  s_lshl_b32 s22, s28, 2
  s_add_u32 s22, s22, s20
  s_mul_i32 s22, s22, 10240
  s_add_u32 s22, s22, 9216
  s_mov_b32 m0, s22
  s_nop 0
  buffer_load_dwordx4 v1, s[48:51], s21 offen lds
  s_branch L_wd_9
L_wi_8:
  s_lshl_b32 s20, s27, 1
  s_add_u32 s20, s20, 0
  s_mul_i32 s21, s20, 18496
  s_add_u32 s21, s21, s26
  s_add_u32 s21, s21, 0
  s_lshl_b32 s22, s28, 2
  s_add_u32 s22, s22, s20
  s_mul_i32 s22, s22, 10240
  s_add_u32 s22, s22, 0
  s_mov_b32 m0, s22
  s_nop 0
  buffer_load_dwordx4 v1, s[52:55], s21 offen lds
  s_lshl_b32 s20, s27, 1
  s_add_u32 s20, s20, 0
  s_mul_i32 s21, s20, 18496
  s_add_u32 s21, s21, s26
  s_add_u32 s21, s21, 1024
  s_lshl_b32 s22, s28, 2
  s_add_u32 s22, s22, s20
  s_mul_i32 s22, s22, 10240
  s_add_u32 s22, s22, 1024
  s_mov_b32 m0, s22
  s_nop 0
  buffer_load_dwordx4 v1, s[52:55], s21 offen lds
  s_lshl_b32 s20, s27, 1
  s_add_u32 s20, s20, 0
  s_mul_i32 s21, s20, 18496
  s_add_u32 s21, s21, s26
  s_add_u32 s21, s21, 2048
  s_lshl_b32 s22, s28, 2
  s_add_u32 s22, s22, s20
  s_mul_i32 s22, s22, 10240
  s_add_u32 s22, s22, 2048
  s_mov_b32 m0, s22
  s_nop 0
  buffer_load_dwordx4 v1, s[52:55], s21 offen lds
  s_lshl_b32 s20, s27, 1
  s_add_u32 s20, s20, 0
  s_mul_i32 s21, s20, 18496
  s_add_u32 s21, s21, s26
  s_add_u32 s21, s21, 3072
  s_lshl_b32 s22, s28, 2
  s_add_u32 s22, s22, s20
  s_mul_i32 s22, s22, 10240
  s_add_u32 s22, s22, 3072
  s_mov_b32 m0, s22
  s_nop 0
  buffer_load_dwordx4 v1, s[52:55], s21 offen lds
  s_lshl_b32 s20, s27, 1
  s_add_u32 s20, s20, 0
  s_mul_i32 s21, s20, 18496
  s_add_u32 s21, s21, s26
  s_add_u32 s21, s21, 4096
  s_lshl_b32 s22, s28, 2
  s_add_u32 s22, s22, s20
  s_mul_i32 s22, s22, 10240
  s_add_u32 s22, s22, 4096
  s_mov_b32 m0, s22
  s_nop 0
  buffer_load_dwordx4 v1, s[52:55], s21 offen lds
  s_lshl_b32 s20, s27, 1
  s_add_u32 s20, s20, 0
  s_mul_i32 s21, s20, 18496
  s_add_u32 s21, s21, s26
  s_add_u32 s21, s21, 5120
  s_lshl_b32 s22, s28, 2
  s_add_u32 s22, s22, s20
  s_mul_i32 s22, s22, 10240
  s_add_u32 s22, s22, 5120
  s_mov_b32 m0, s22
  s_nop 0
  buffer_load_dwordx4 v1, s[52:55], s21 offen lds
  s_lshl_b32 s20, s27, 1
  s_add_u32 s20, s20, 0
  s_mul_i32 s21, s20, 18496
  s_add_u32 s21, s21, s26
  s_add_u32 s21, s21, 6144
  s_lshl_b32 s22, s28, 2
  s_add_u32 s22, s22, s20
  s_mul_i32 s22, s22, 10240
  s_add_u32 s22, s22, 6144
  s_mov_b32 m0, s22
  s_nop 0
  buffer_load_dwordx4 v1, s[52:55], s21 offen lds
  s_lshl_b32 s20, s27, 1
  s_add_u32 s20, s20, 0
  s_mul_i32 s21, s20, 18496
  s_add_u32 s21, s21, s26
  s_add_u32 s21, s21, 7168
  s_lshl_b32 s22, s28, 2
  s_add_u32 s22, s22, s20
  s_mul_i32 s22, s22, 10240
  s_add_u32 s22, s22, 7168
  s_mov_b32 m0, s22
  s_nop 0
  buffer_load_dwordx4 v1, s[52:55], s21 offen lds
  s_lshl_b32 s20, s27, 1
  s_add_u32 s20, s20, 0
  s_mul_i32 s21, s20, 18496
  s_add_u32 s21, s21, s26
  s_add_u32 s21, s21, 8192
  s_lshl_b32 s22, s28, 2
  s_add_u32 s22, s22, s20
  s_mul_i32 s22, s22, 10240
  s_add_u32 s22, s22, 8192
  s_mov_b32 m0, s22
  s_nop 0
  buffer_load_dwordx4 v1, s[52:55], s21 offen lds
  s_lshl_b32 s20, s27, 1
  s_add_u32 s20, s20, 0
  s_mul_i32 s21, s20, 18496
  s_add_u32 s21, s21, s26
  s_add_u32 s21, s21, 9216
  s_lshl_b32 s22, s28, 2
  s_add_u32 s22, s22, s20
  s_mul_i32 s22, s22, 10240
  s_add_u32 s22, s22, 9216
  s_mov_b32 m0, s22
  s_nop 0
  buffer_load_dwordx4 v1, s[52:55], s21 offen lds
  s_lshl_b32 s20, s27, 1
  s_add_u32 s20, s20, 1
  s_mul_i32 s21, s20, 18496
  s_add_u32 s21, s21, s26
  s_add_u32 s21, s21, 0
  s_lshl_b32 s22, s28, 2
  s_add_u32 s22, s22, s20
  s_mul_i32 s22, s22, 10240
  s_add_u32 s22, s22, 0
  s_mov_b32 m0, s22
  s_nop 0
  buffer_load_dwordx4 v1, s[52:55], s21 offen lds
  s_lshl_b32 s20, s27, 1
  s_add_u32 s20, s20, 1
  s_mul_i32 s21, s20, 18496
  s_add_u32 s21, s21, s26
  s_add_u32 s21, s21, 1024
  s_lshl_b32 s22, s28, 2
  s_add_u32 s22, s22, s20
  s_mul_i32 s22, s22, 10240
  s_add_u32 s22, s22, 1024
  s_mov_b32 m0, s22
  s_nop 0
  buffer_load_dwordx4 v1, s[52:55], s21 offen lds
  s_lshl_b32 s20, s27, 1
  s_add_u32 s20, s20, 1
  s_mul_i32 s21, s20, 18496
  s_add_u32 s21, s21, s26
  s_add_u32 s21, s21, 2048
  s_lshl_b32 s22, s28, 2
  s_add_u32 s22, s22, s20
  s_mul_i32 s22, s22, 10240
  s_add_u32 s22, s22, 2048
  s_mov_b32 m0, s22
  s_nop 0
  buffer_load_dwordx4 v1, s[52:55], s21 offen lds
  s_lshl_b32 s20, s27, 1
  s_add_u32 s20, s20, 1
  s_mul_i32 s21, s20, 18496
  s_add_u32 s21, s21, s26
  s_add_u32 s21, s21, 3072
  s_lshl_b32 s22, s28, 2
  s_add_u32 s22, s22, s20
  s_mul_i32 s22, s22, 10240
  s_add_u32 s22, s22, 3072
  s_mov_b32 m0, s22
  s_nop 0
  buffer_load_dwordx4 v1, s[52:55], s21 offen lds
  s_lshl_b32 s20, s27, 1
  s_add_u32 s20, s20, 1
  s_mul_i32 s21, s20, 18496
  s_add_u32 s21, s21, s26
  s_add_u32 s21, s21, 4096
  s_lshl_b32 s22, s28, 2
  s_add_u32 s22, s22, s20
  s_mul_i32 s22, s22, 10240
  s_add_u32 s22, s22, 4096
  s_mov_b32 m0, s22
  s_nop 0
  buffer_load_dwordx4 v1, s[52:55], s21 offen lds
  s_lshl_b32 s20, s27, 1
  s_add_u32 s20, s20, 1
  s_mul_i32 s21, s20, 18496
  s_add_u32 s21, s21, s26
  s_add_u32 s21, s21, 5120
  s_lshl_b32 s22, s28, 2
  s_add_u32 s22, s22, s20
  s_mul_i32 s22, s22, 10240
  s_add_u32 s22, s22, 5120
  s_mov_b32 m0, s22
  s_nop 0
  buffer_load_dwordx4 v1, s[52:55], s21 offen lds
  s_lshl_b32 s20, s27, 1
  s_add_u32 s20, s20, 1
  s_mul_i32 s21, s20, 18496
  s_add_u32 s21, s21, s26
  s_add_u32 s21, s21, 6144
  s_lshl_b32 s22, s28, 2
  s_add_u32 s22, s22, s20
  s_mul_i32 s22, s22, 10240
  s_add_u32 s22, s22, 6144
  s_mov_b32 m0, s22
  s_nop 0
  buffer_load_dwordx4 v1, s[52:55], s21 offen lds
  s_lshl_b32 s20, s27, 1
  s_add_u32 s20, s20, 1
  s_mul_i32 s21, s20, 18496
  s_add_u32 s21, s21, s26
  s_add_u32 s21, s21, 7168
  s_lshl_b32 s22, s28, 2
  s_add_u32 s22, s22, s20
  s_mul_i32 s22, s22, 10240
  s_add_u32 s22, s22, 7168
  s_mov_b32 m0, s22
  s_nop 0
  buffer_load_dwordx4 v1, s[52:55], s21 offen lds
  s_lshl_b32 s20, s27, 1
  s_add_u32 s20, s20, 1
  s_mul_i32 s21, s20, 18496
  s_add_u32 s21, s21, s26
  s_add_u32 s21, s21, 8192
  s_lshl_b32 s22, s28, 2
  s_add_u32 s22, s22, s20
  s_mul_i32 s22, s22, 10240
  s_add_u32 s22, s22, 8192
  s_mov_b32 m0, s22
  s_nop 0
  buffer_load_dwordx4 v1, s[52:55], s21 offen lds
  s_lshl_b32 s20, s27, 1
  s_add_u32 s20, s20, 1
  s_mul_i32 s21, s20, 18496
  s_add_u32 s21, s21, s26
  s_add_u32 s21, s21, 9216
  s_lshl_b32 s22, s28, 2
  s_add_u32 s22, s22, s20
  s_mul_i32 s22, s22, 10240
  s_add_u32 s22, s22, 9216
  s_mov_b32 m0, s22
  s_nop 0
  buffer_load_dwordx4 v1, s[52:55], s21 offen lds
L_wd_9:
  v_and_b32 v2, 15, v0
  v_lshrrev_b32 v3, 4, v0
  s_lshl_b32 s20, s16, 2
  v_add_u32 v3, s20, v3
  v_mul_u32_u24 v4, 578, v2
  v_lshl_add_u32 v4, v3, 1, v4
  v_add_u32 v5, 40960, v4
  s_lshr_b32 s20, s24, 1
  s_lshl_b32 s20, s20, 6
  s_and_b32 s21, s24, 1
  s_lshl_b32 s21, s21, 5
  s_add_u32 s20, s20, s21
  s_lshl_b32 s21, s25, 4
  s_add_u32 s20, s20, s21
  s_lshl_b32 s20, s20, 4
  s_add_u32 s29, s20, 0x710000
  v_lshlrev_b32 v6, 13, v3
  v_lshl_add_u32 v6, v2, 4, v6
  v_mov_b32 v8, 0x7ff00000
  s_waitcnt vmcnt(0)
  s_barrier
  s_lshl_b32 s20, s17, 2
  s_add_u32 s20, s20, s16
  s_mul_i32 s21, s20, 6144
  s_add_u32 s22, s21, 0
  buffer_load_dwordx4 v[64:67], v1, s[92:95], s22 offen
  s_add_u32 s22, s21, 1024
  buffer_load_dwordx4 v[68:71], v1, s[92:95], s22 offen
  s_add_u32 s22, s21, 2048
  buffer_load_dwordx4 v[72:75], v1, s[92:95], s22 offen
  s_add_u32 s22, s21, 3072
  buffer_load_dwordx4 v[76:79], v1, s[92:95], s22 offen
  s_add_u32 s22, s21, 4096
  buffer_load_dwordx4 v[80:83], v1, s[92:95], s22 offen
  s_add_u32 s22, s21, 5120
  buffer_load_dwordx4 v[84:87], v1, s[92:95], s22 offen
  s_lshl_b32 s21, s20, 11
  s_add_u32 s22, s21, 0
  buffer_load_dwordx4 v[88:91], v1, s[96:99], s22 offen
  s_add_u32 s22, s21, 1024
  buffer_load_dwordx4 v[92:95], v1, s[96:99], s22 offen
  ds_read_u16 v16, v4 offset:0
  ds_read_u16 v48, v5 offset:0
  ds_read_u16 v17, v4 offset:10240
  ds_read_u16 v49, v5 offset:10240
  ds_read_u16 v18, v4 offset:20480
  ds_read_u16 v50, v5 offset:20480
  ds_read_u16 v19, v4 offset:30720
  ds_read_u16 v51, v5 offset:30720
  s_waitcnt lgkmcnt(0)
  ds_read_u16 v20, v4 offset:32
  ds_read_u16 v52, v5 offset:32
  ds_read_u16 v21, v4 offset:10272
  ds_read_u16 v53, v5 offset:10272
  ds_read_u16 v22, v4 offset:20512
  ds_read_u16 v54, v5 offset:20512
  ds_read_u16 v23, v4 offset:30752
  ds_read_u16 v55, v5 offset:30752
  s_waitcnt lgkmcnt(0)
  v_lshl_or_b32 v16, v48, 16, v16
  v_lshl_or_b32 v17, v49, 16, v17
  v_lshl_or_b32 v18, v50, 16, v18
  v_lshl_or_b32 v19, v51, 16, v19
  v_lshl_or_b32 v20, v52, 16, v20
  v_lshl_or_b32 v21, v53, 16, v21
  v_lshl_or_b32 v22, v54, 16, v22
  v_lshl_or_b32 v23, v55, 16, v23
  v_add_u32 v7, 0, v3
  v_cmp_gt_u32 vcc, 289, v7
  v_add_u32 v9, 0x0, v6
  s_nop 0
  v_cndmask_b32 v9, v8, v9, vcc
  buffer_store_dwordx4 v[16:19], v9, s[8:11], s29 offen
  v_add_u32 v7, 16, v3
  v_cmp_gt_u32 vcc, 289, v7
  v_add_u32 v9, 0x20000, v6
  s_nop 0
  v_cndmask_b32 v9, v8, v9, vcc
  buffer_store_dwordx4 v[20:23], v9, s[8:11], s29 offen
  ds_read_u16 v24, v4 offset:64
  ds_read_u16 v56, v5 offset:64
  ds_read_u16 v25, v4 offset:10304
  ds_read_u16 v57, v5 offset:10304
  ds_read_u16 v26, v4 offset:20544
  ds_read_u16 v58, v5 offset:20544
  ds_read_u16 v27, v4 offset:30784
  ds_read_u16 v59, v5 offset:30784
  s_waitcnt lgkmcnt(0)
  ds_read_u16 v28, v4 offset:96
  ds_read_u16 v60, v5 offset:96
  ds_read_u16 v29, v4 offset:10336
  ds_read_u16 v61, v5 offset:10336
  ds_read_u16 v30, v4 offset:20576
  ds_read_u16 v62, v5 offset:20576
  ds_read_u16 v31, v4 offset:30816
  ds_read_u16 v63, v5 offset:30816
  s_waitcnt lgkmcnt(0)
  v_lshl_or_b32 v24, v56, 16, v24
  v_lshl_or_b32 v25, v57, 16, v25
  v_lshl_or_b32 v26, v58, 16, v26
  v_lshl_or_b32 v27, v59, 16, v27
  v_lshl_or_b32 v28, v60, 16, v28
  v_lshl_or_b32 v29, v61, 16, v29
  v_lshl_or_b32 v30, v62, 16, v30
  v_lshl_or_b32 v31, v63, 16, v31
  v_add_u32 v7, 32, v3
  v_cmp_gt_u32 vcc, 289, v7
  v_add_u32 v9, 0x40000, v6
  s_nop 0
  v_cndmask_b32 v9, v8, v9, vcc
  buffer_store_dwordx4 v[24:27], v9, s[8:11], s29 offen
  v_add_u32 v7, 48, v3
  v_cmp_gt_u32 vcc, 289, v7
  v_add_u32 v9, 0x60000, v6
  s_nop 0
  v_cndmask_b32 v9, v8, v9, vcc
  buffer_store_dwordx4 v[28:31], v9, s[8:11], s29 offen
  ds_read_u16 v16, v4 offset:128
  ds_read_u16 v48, v5 offset:128
  ds_read_u16 v17, v4 offset:10368
  ds_read_u16 v49, v5 offset:10368
  ds_read_u16 v18, v4 offset:20608
  ds_read_u16 v50, v5 offset:20608
  ds_read_u16 v19, v4 offset:30848
  ds_read_u16 v51, v5 offset:30848
  s_waitcnt lgkmcnt(0)
  ds_read_u16 v20, v4 offset:160
  ds_read_u16 v52, v5 offset:160
  ds_read_u16 v21, v4 offset:10400
  ds_read_u16 v53, v5 offset:10400
  ds_read_u16 v22, v4 offset:20640
  ds_read_u16 v54, v5 offset:20640
  ds_read_u16 v23, v4 offset:30880
  ds_read_u16 v55, v5 offset:30880
  s_waitcnt lgkmcnt(0)
  v_lshl_or_b32 v16, v48, 16, v16
  v_lshl_or_b32 v17, v49, 16, v17
  v_lshl_or_b32 v18, v50, 16, v18
  v_lshl_or_b32 v19, v51, 16, v19
  v_lshl_or_b32 v20, v52, 16, v20
  v_lshl_or_b32 v21, v53, 16, v21
  v_lshl_or_b32 v22, v54, 16, v22
  v_lshl_or_b32 v23, v55, 16, v23
  v_add_u32 v7, 64, v3
  v_cmp_gt_u32 vcc, 289, v7
  v_add_u32 v9, 0x80000, v6
  s_nop 0
  v_cndmask_b32 v9, v8, v9, vcc
  buffer_store_dwordx4 v[16:19], v9, s[8:11], s29 offen
  v_add_u32 v7, 80, v3
  v_cmp_gt_u32 vcc, 289, v7
  v_add_u32 v9, 0xa0000, v6
  s_nop 0
  v_cndmask_b32 v9, v8, v9, vcc
  buffer_store_dwordx4 v[20:23], v9, s[8:11], s29 offen
  ds_read_u16 v24, v4 offset:192
  ds_read_u16 v56, v5 offset:192
  ds_read_u16 v25, v4 offset:10432
  ds_read_u16 v57, v5 offset:10432
  ds_read_u16 v26, v4 offset:20672
  ds_read_u16 v58, v5 offset:20672
  ds_read_u16 v27, v4 offset:30912
  ds_read_u16 v59, v5 offset:30912
  s_waitcnt lgkmcnt(0)
  ds_read_u16 v28, v4 offset:224
  ds_read_u16 v60, v5 offset:224
  ds_read_u16 v29, v4 offset:10464
  ds_read_u16 v61, v5 offset:10464
  ds_read_u16 v30, v4 offset:20704
  ds_read_u16 v62, v5 offset:20704
  ds_read_u16 v31, v4 offset:30944
  ds_read_u16 v63, v5 offset:30944
  s_waitcnt lgkmcnt(0)
  v_lshl_or_b32 v24, v56, 16, v24
  v_lshl_or_b32 v25, v57, 16, v25
  v_lshl_or_b32 v26, v58, 16, v26
  v_lshl_or_b32 v27, v59, 16, v27
  v_lshl_or_b32 v28, v60, 16, v28
  v_lshl_or_b32 v29, v61, 16, v29
  v_lshl_or_b32 v30, v62, 16, v30
  v_lshl_or_b32 v31, v63, 16, v31
  v_add_u32 v7, 96, v3
  v_cmp_gt_u32 vcc, 289, v7
  v_add_u32 v9, 0xc0000, v6
  s_nop 0
  v_cndmask_b32 v9, v8, v9, vcc
  buffer_store_dwordx4 v[24:27], v9, s[8:11], s29 offen
  v_add_u32 v7, 112, v3
  v_cmp_gt_u32 vcc, 289, v7
  v_add_u32 v9, 0xe0000, v6
  s_nop 0
  v_cndmask_b32 v9, v8, v9, vcc
  buffer_store_dwordx4 v[28:31], v9, s[8:11], s29 offen
  ds_read_u16 v16, v4 offset:256
  ds_read_u16 v48, v5 offset:256
  ds_read_u16 v17, v4 offset:10496
  ds_read_u16 v49, v5 offset:10496
  ds_read_u16 v18, v4 offset:20736
  ds_read_u16 v50, v5 offset:20736
  ds_read_u16 v19, v4 offset:30976
  ds_read_u16 v51, v5 offset:30976
  s_waitcnt lgkmcnt(0)
  ds_read_u16 v20, v4 offset:288
  ds_read_u16 v52, v5 offset:288
  ds_read_u16 v21, v4 offset:10528
  ds_read_u16 v53, v5 offset:10528
  ds_read_u16 v22, v4 offset:20768
  ds_read_u16 v54, v5 offset:20768
  ds_read_u16 v23, v4 offset:31008
  ds_read_u16 v55, v5 offset:31008
  s_waitcnt lgkmcnt(0)
  v_lshl_or_b32 v16, v48, 16, v16
  v_lshl_or_b32 v17, v49, 16, v17
  v_lshl_or_b32 v18, v50, 16, v18
  v_lshl_or_b32 v19, v51, 16, v19
  v_lshl_or_b32 v20, v52, 16, v20
  v_lshl_or_b32 v21, v53, 16, v21
  v_lshl_or_b32 v22, v54, 16, v22
  v_lshl_or_b32 v23, v55, 16, v23
  v_add_u32 v7, 128, v3
  v_cmp_gt_u32 vcc, 289, v7
  v_add_u32 v9, 0x100000, v6
  s_nop 0
  v_cndmask_b32 v9, v8, v9, vcc
  buffer_store_dwordx4 v[16:19], v9, s[8:11], s29 offen
  v_add_u32 v7, 144, v3
  v_cmp_gt_u32 vcc, 289, v7
  v_add_u32 v9, 0x120000, v6
  s_nop 0
  v_cndmask_b32 v9, v8, v9, vcc
  buffer_store_dwordx4 v[20:23], v9, s[8:11], s29 offen
  ds_read_u16 v24, v4 offset:320
  ds_read_u16 v56, v5 offset:320
  ds_read_u16 v25, v4 offset:10560
  ds_read_u16 v57, v5 offset:10560
  ds_read_u16 v26, v4 offset:20800
  ds_read_u16 v58, v5 offset:20800
  ds_read_u16 v27, v4 offset:31040
  ds_read_u16 v59, v5 offset:31040
  s_waitcnt lgkmcnt(0)
  ds_read_u16 v28, v4 offset:352
  ds_read_u16 v60, v5 offset:352
  ds_read_u16 v29, v4 offset:10592
  ds_read_u16 v61, v5 offset:10592
  ds_read_u16 v30, v4 offset:20832
  ds_read_u16 v62, v5 offset:20832
  ds_read_u16 v31, v4 offset:31072
  ds_read_u16 v63, v5 offset:31072
  s_waitcnt lgkmcnt(0)
  v_lshl_or_b32 v24, v56, 16, v24
  v_lshl_or_b32 v25, v57, 16, v25
  v_lshl_or_b32 v26, v58, 16, v26
  v_lshl_or_b32 v27, v59, 16, v27
  v_lshl_or_b32 v28, v60, 16, v28
  v_lshl_or_b32 v29, v61, 16, v29
  v_lshl_or_b32 v30, v62, 16, v30
  v_lshl_or_b32 v31, v63, 16, v31
  v_add_u32 v7, 160, v3
  v_cmp_gt_u32 vcc, 289, v7
  v_add_u32 v9, 0x140000, v6
  s_nop 0
  v_cndmask_b32 v9, v8, v9, vcc
  buffer_store_dwordx4 v[24:27], v9, s[8:11], s29 offen
  v_add_u32 v7, 176, v3
  v_cmp_gt_u32 vcc, 289, v7
  v_add_u32 v9, 0x160000, v6
  s_nop 0
  v_cndmask_b32 v9, v8, v9, vcc
  buffer_store_dwordx4 v[28:31], v9, s[8:11], s29 offen
  ds_read_u16 v16, v4 offset:384
  ds_read_u16 v48, v5 offset:384
  ds_read_u16 v17, v4 offset:10624
  ds_read_u16 v49, v5 offset:10624
  ds_read_u16 v18, v4 offset:20864
  ds_read_u16 v50, v5 offset:20864
  ds_read_u16 v19, v4 offset:31104
  ds_read_u16 v51, v5 offset:31104
  s_waitcnt lgkmcnt(0)
  ds_read_u16 v20, v4 offset:416
  ds_read_u16 v52, v5 offset:416
  ds_read_u16 v21, v4 offset:10656
  ds_read_u16 v53, v5 offset:10656
  ds_read_u16 v22, v4 offset:20896
  ds_read_u16 v54, v5 offset:20896
  ds_read_u16 v23, v4 offset:31136
  ds_read_u16 v55, v5 offset:31136
  s_waitcnt lgkmcnt(0)
  v_lshl_or_b32 v16, v48, 16, v16
  v_lshl_or_b32 v17, v49, 16, v17
  v_lshl_or_b32 v18, v50, 16, v18
  v_lshl_or_b32 v19, v51, 16, v19
  v_lshl_or_b32 v20, v52, 16, v20
  v_lshl_or_b32 v21, v53, 16, v21
  v_lshl_or_b32 v22, v54, 16, v22
  v_lshl_or_b32 v23, v55, 16, v23
  v_add_u32 v7, 192, v3
  v_cmp_gt_u32 vcc, 289, v7
  v_add_u32 v9, 0x180000, v6
  s_nop 0
  v_cndmask_b32 v9, v8, v9, vcc
  buffer_store_dwordx4 v[16:19], v9, s[8:11], s29 offen
  v_add_u32 v7, 208, v3
  v_cmp_gt_u32 vcc, 289, v7
  v_add_u32 v9, 0x1a0000, v6
  s_nop 0
  v_cndmask_b32 v9, v8, v9, vcc
  buffer_store_dwordx4 v[20:23], v9, s[8:11], s29 offen
  ds_read_u16 v24, v4 offset:448
  ds_read_u16 v56, v5 offset:448
  ds_read_u16 v25, v4 offset:10688
  ds_read_u16 v57, v5 offset:10688
  ds_read_u16 v26, v4 offset:20928
  ds_read_u16 v58, v5 offset:20928
  ds_read_u16 v27, v4 offset:31168
  ds_read_u16 v59, v5 offset:31168
  s_waitcnt lgkmcnt(0)
  ds_read_u16 v28, v4 offset:480
  ds_read_u16 v60, v5 offset:480
  ds_read_u16 v29, v4 offset:10720
  ds_read_u16 v61, v5 offset:10720
  ds_read_u16 v30, v4 offset:20960
  ds_read_u16 v62, v5 offset:20960
  ds_read_u16 v31, v4 offset:31200
  ds_read_u16 v63, v5 offset:31200
  s_waitcnt lgkmcnt(0)
  v_lshl_or_b32 v24, v56, 16, v24
  v_lshl_or_b32 v25, v57, 16, v25
  v_lshl_or_b32 v26, v58, 16, v26
  v_lshl_or_b32 v27, v59, 16, v27
  v_lshl_or_b32 v28, v60, 16, v28
  v_lshl_or_b32 v29, v61, 16, v29
  v_lshl_or_b32 v30, v62, 16, v30
  v_lshl_or_b32 v31, v63, 16, v31
  v_add_u32 v7, 224, v3
  v_cmp_gt_u32 vcc, 289, v7
  v_add_u32 v9, 0x1c0000, v6
  s_nop 0
  v_cndmask_b32 v9, v8, v9, vcc
  buffer_store_dwordx4 v[24:27], v9, s[8:11], s29 offen
  v_add_u32 v7, 240, v3
  v_cmp_gt_u32 vcc, 289, v7
  v_add_u32 v9, 0x1e0000, v6
  s_nop 0
  v_cndmask_b32 v9, v8, v9, vcc
  buffer_store_dwordx4 v[28:31], v9, s[8:11], s29 offen
  ds_read_u16 v16, v4 offset:512
  ds_read_u16 v48, v5 offset:512
  ds_read_u16 v17, v4 offset:10752
  ds_read_u16 v49, v5 offset:10752
  ds_read_u16 v18, v4 offset:20992
  ds_read_u16 v50, v5 offset:20992
  ds_read_u16 v19, v4 offset:31232
  ds_read_u16 v51, v5 offset:31232
  s_waitcnt lgkmcnt(0)
  ds_read_u16 v20, v4 offset:544
  ds_read_u16 v52, v5 offset:544
  ds_read_u16 v21, v4 offset:10784
  ds_read_u16 v53, v5 offset:10784
  ds_read_u16 v22, v4 offset:21024
  ds_read_u16 v54, v5 offset:21024
  ds_read_u16 v23, v4 offset:31264
  ds_read_u16 v55, v5 offset:31264
  s_waitcnt lgkmcnt(0)
  v_lshl_or_b32 v16, v48, 16, v16
  v_lshl_or_b32 v17, v49, 16, v17
  v_lshl_or_b32 v18, v50, 16, v18
  v_lshl_or_b32 v19, v51, 16, v19
  v_lshl_or_b32 v20, v52, 16, v20
  v_lshl_or_b32 v21, v53, 16, v21
  v_lshl_or_b32 v22, v54, 16, v22
  v_lshl_or_b32 v23, v55, 16, v23
  v_add_u32 v7, 256, v3
  v_cmp_gt_u32 vcc, 289, v7
  v_add_u32 v9, 0x200000, v6
  s_nop 0
  v_cndmask_b32 v9, v8, v9, vcc
  buffer_store_dwordx4 v[16:19], v9, s[8:11], s29 offen
  v_add_u32 v7, 272, v3
  v_cmp_gt_u32 vcc, 289, v7
  v_add_u32 v9, 0x220000, v6
  s_nop 0
  v_cndmask_b32 v9, v8, v9, vcc
  buffer_store_dwordx4 v[20:23], v9, s[8:11], s29 offen
  ds_read_u16 v24, v4 offset:576
  ds_read_u16 v56, v5 offset:576
  ds_read_u16 v25, v4 offset:10816
  ds_read_u16 v57, v5 offset:10816
  ds_read_u16 v26, v4 offset:21056
  ds_read_u16 v58, v5 offset:21056
  ds_read_u16 v27, v4 offset:31296
  ds_read_u16 v59, v5 offset:31296
  s_waitcnt lgkmcnt(0)
  v_lshl_or_b32 v24, v56, 16, v24
  v_lshl_or_b32 v25, v57, 16, v25
  v_lshl_or_b32 v26, v58, 16, v26
  v_lshl_or_b32 v27, v59, 16, v27
  v_add_u32 v7, 288, v3
  v_cmp_gt_u32 vcc, 289, v7
  v_add_u32 v9, 0x240000, v6
  s_nop 0
  v_cndmask_b32 v9, v8, v9, vcc
  buffer_store_dwordx4 v[24:27], v9, s[8:11], s29 offen
  s_waitcnt vmcnt(0)
L_fin_2:
L_end_1:
  s_endpgm
.section .rodata,"a"
.p2align 6
.amdhsa_kernel proj_kernel
  .amdhsa_next_free_vgpr 256
  .amdhsa_next_free_sgpr 102
  .amdhsa_accum_offset 256
  .amdhsa_group_segment_fixed_size 0
  .amdhsa_kernarg_size 88
  .amdhsa_user_sgpr_count 2
  .amdhsa_user_sgpr_kernarg_segment_ptr 1
  .amdhsa_system_sgpr_workgroup_id_x 1
  .amdhsa_float_denorm_mode_32 3
.end_amdhsa_kernel
.text
.text
.globl attn_kernel
.p2align 8
.type attn_kernel,@function
attn_kernel:
  s_cmp_ge_u32 s2, 256
  s_cbranch_scc1 L_end_10
  s_load_dwordx2 s[4:5], s[0:1], 80
  v_lshrrev_b32 v1, 6, v0
  v_and_b32 v0, 63, v0
  v_mov_b32 v5, 151552
  v_readfirstlane_b32 s16, v1
  v_mov_b32 v6, 0
  v_mov_b32 v7, 0
  v_mov_b32 v8, 0x100
  v_mov_b32 v9, 0
  ds_write_b64 v5, v[6:7]
  ds_write_b64 v5, v[6:7] offset:8
  ds_write_b64 v5, v[8:9] offset:16
  ds_write_b64 v5, v[6:7] offset:24
  ds_write_b64 v5, v[6:7] offset:32
  s_getpc_b64 s[12:13]
L_pc_11:
  s_add_u32 s12, s12, tab_a2-L_pc_11
  s_addc_u32 s13, s13, 0
  s_and_b32 s13, s13, 0xffff
  s_mov_b32 s14, 0xc800
  s_mov_b32 s15, 0x20000
  s_lshl_b32 s28, s2, 3
  s_add_u32 s28, s28, s16
  s_mul_i32 s28, s28, 1152
  s_waitcnt lgkmcnt(0)
  s_mov_b32 s8, s4
  s_and_b32 s9, s5, 0xffff
  s_mov_b32 s10, 0xc00000
  s_mov_b32 s11, 0x20000
  s_barrier
  s_mov_b32 s18, 0
  s_mov_b32 s33, 0
  s_mov_b32 s34, 0
  s_mov_b32 s37, 0
  s_mov_b32 s39, 99
  s_mov_b32 s42, 0
  s_mov_b32 s50, 0
  s_cmp_lt_u32 s16, 4
  s_cbranch_scc0 L_q
  s_mov_b32 s19, s2
  s_cmp_eq_u32 s16, 0
  s_cbranch_scc1 L_fft_12
  s_cmp_eq_u32 s16, 1
  s_cbranch_scc0 L_aw
  s_add_u32 s19, s2, 256
  s_cmp_lt_u32 s19, 289
  s_cbranch_scc1 L_fft_12
L_aw:
  s_cmp_ge_u32 s16, 2
  s_cselect_b32 s18, 3, 0
  s_branch L_q
L_fft_12:
L_fw_15:
  ds_read_b32 v13, v5 offset:24
  s_waitcnt lgkmcnt(0)
  v_readfirstlane_b32 s21, v13
  s_nop 0
  s_cmp_lt_u32 s21, 64
  s_cbranch_scc1 L_fw_15
  s_setprio 2
  s_lshl_b32 s20, s19, 13
  s_add_u32 s21, s20, 0x4c0000
  s_add_u32 s22, s20, 0x710000
  s_mul_i32 s23, s19, 48
  s_add_u32 s23, s23, 0x960000
  v_and_b32 v3, 31, v0
  v_lshrrev_b32 v4, 5, v0
  v_lshlrev_b32 v1, 7, v3
  v_lshl_add_u32 v1, v4, 4, v1
  v_lshlrev_b32 v2, 4, v0
  buffer_load_dwordx4 v[8:11], v1, s[8:11], s21 offen offset:0
  buffer_load_dwordx4 v[12:15], v1, s[8:11], s21 offen offset:32
  s_add_u32 s24, s21, 4096
  buffer_load_dwordx4 v[16:19], v1, s[8:11], s24 offen offset:0
  s_add_u32 s24, s21, 4096
  buffer_load_dwordx4 v[20:23], v1, s[8:11], s24 offen offset:32
  buffer_load_dwordx4 v[24:27], v1, s[8:11], s21 offen offset:64
  buffer_load_dwordx4 v[28:31], v1, s[8:11], s21 offen offset:96
  s_add_u32 s24, s21, 4096
  buffer_load_dwordx4 v[32:35], v1, s[8:11], s24 offen offset:64
  s_add_u32 s24, s21, 4096
  buffer_load_dwordx4 v[36:39], v1, s[8:11], s24 offen offset:96
  s_mov_b32 s24, 0
  buffer_load_dwordx4 v[40:43], v2, s[12:15], s24 offen offset:0
  s_mov_b32 s24, 0
  buffer_load_dwordx4 v[44:47], v2, s[12:15], s24 offen offset:1024
  s_mov_b32 s24, 0
  buffer_load_dwordx4 v[48:51], v2, s[12:15], s24 offen offset:2048
  s_mov_b32 s24, 0
  buffer_load_dwordx4 v[52:55], v2, s[12:15], s24 offen offset:3072
  s_mov_b32 s24, 4096
  buffer_load_dwordx4 v[56:59], v2, s[12:15], s24 offen offset:0
  s_mov_b32 s24, 4096
  buffer_load_dwordx4 v[60:63], v2, s[12:15], s24 offen offset:1024
  s_mov_b32 s24, 16384
  buffer_load_dwordx4 v[176:179], v2, s[12:15], s24 offen offset:2048
  s_mov_b32 s24, 16384
  buffer_load_dwordx4 v[180:183], v2, s[12:15], s24 offen offset:3072
  s_mov_b32 s24, 20480
  buffer_load_dwordx4 v[184:187], v2, s[12:15], s24 offen offset:0
  s_mov_b32 s24, 20480
  buffer_load_dwordx4 v[188:191], v2, s[12:15], s24 offen offset:1024
  s_mov_b32 s24, 20480
  buffer_load_dwordx4 v[192:195], v2, s[12:15], s24 offen offset:2048
  s_mov_b32 s24, 20480
  buffer_load_dwordx4 v[196:199], v2, s[12:15], s24 offen offset:3072
  s_mov_b32 s24, 24576
  buffer_load_dwordx4 v[200:203], v2, s[12:15], s24 offen offset:0
  s_mov_b32 s24, 24576
  buffer_load_dwordx4 v[204:207], v2, s[12:15], s24 offen offset:1024
  s_mov_b32 s24, 24576
  buffer_load_dwordx4 v[208:211], v2, s[12:15], s24 offen offset:2048
  s_mov_b32 s24, 24576
  buffer_load_dwordx4 v[212:215], v2, s[12:15], s24 offen offset:3072
  s_mov_b32 s24, 28672
  buffer_load_dwordx4 v[216:219], v2, s[12:15], s24 offen offset:0
  s_mov_b32 s24, 28672
  buffer_load_dwordx4 v[220:223], v2, s[12:15], s24 offen offset:1024
  s_mov_b32 s24, 28672
  buffer_load_dwordx4 v[224:227], v2, s[12:15], s24 offen offset:2048
  s_mov_b32 s24, 28672
  buffer_load_dwordx4 v[228:231], v2, s[12:15], s24 offen offset:3072
  s_mov_b32 s24, 32768
  buffer_load_dwordx4 v[232:235], v2, s[12:15], s24 offen offset:0
  s_mov_b32 s24, 32768
  buffer_load_dwordx4 v[236:239], v2, s[12:15], s24 offen offset:1024
  s_mov_b32 s24, 4096
  buffer_load_dwordx4 v[64:67], v2, s[12:15], s24 offen offset:2048
  s_mov_b32 s24, 4096
  buffer_load_dwordx4 v[68:71], v2, s[12:15], s24 offen offset:3072
  s_mov_b32 s24, 8192
  buffer_load_dwordx4 v[72:75], v2, s[12:15], s24 offen offset:0
  s_mov_b32 s24, 8192
  buffer_load_dwordx4 v[76:79], v2, s[12:15], s24 offen offset:1024
  s_mov_b32 s24, 8192
  buffer_load_dwordx4 v[80:83], v2, s[12:15], s24 offen offset:2048
  s_mov_b32 s24, 8192
  buffer_load_dwordx4 v[84:87], v2, s[12:15], s24 offen offset:3072
  s_mov_b32 s24, 12288
  buffer_load_dwordx4 v[88:91], v2, s[12:15], s24 offen offset:0
  s_mov_b32 s24, 12288
  buffer_load_dwordx4 v[92:95], v2, s[12:15], s24 offen offset:1024
  s_mov_b32 s24, 12288
  buffer_load_dwordx4 v[96:99], v2, s[12:15], s24 offen offset:2048
  s_mov_b32 s24, 12288
  buffer_load_dwordx4 v[100:103], v2, s[12:15], s24 offen offset:3072
  s_mov_b32 s24, 16384
  buffer_load_dwordx4 v[104:107], v2, s[12:15], s24 offen offset:0
  s_mov_b32 s24, 16384
  buffer_load_dwordx4 v[108:111], v2, s[12:15], s24 offen offset:1024
  s_waitcnt vmcnt(28)
  v_mfma_f32_32x32x16_bf16 v[112:127], v[8:11], v[40:43], 0
  v_mfma_f32_32x32x16_bf16 v[128:143], v[16:19], v[40:43], 0
  v_mfma_f32_32x32x16_bf16 v[112:127], v[12:15], v[44:47], v[112:127]
  v_mfma_f32_32x32x16_bf16 v[128:143], v[20:23], v[44:47], v[128:143]
  v_mfma_f32_32x32x16_bf16 v[112:127], v[16:19], v[48:51], v[112:127]
  v_mfma_f32_32x32x16_bf16 v[128:143], v[8:11], v[56:59], v[128:143]
  v_mfma_f32_32x32x16_bf16 v[112:127], v[20:23], v[52:55], v[112:127]
  v_mfma_f32_32x32x16_bf16 v[128:143], v[12:15], v[60:63], v[128:143]
  v_mfma_f32_32x32x16_bf16 v[144:159], v[24:27], v[40:43], 0
  v_mfma_f32_32x32x16_bf16 v[160:175], v[32:35], v[40:43], 0
  v_mfma_f32_32x32x16_bf16 v[144:159], v[28:31], v[44:47], v[144:159]
  v_mfma_f32_32x32x16_bf16 v[160:175], v[36:39], v[44:47], v[160:175]
  v_mfma_f32_32x32x16_bf16 v[144:159], v[32:35], v[48:51], v[144:159]
  v_mfma_f32_32x32x16_bf16 v[160:175], v[24:27], v[56:59], v[160:175]
  v_mfma_f32_32x32x16_bf16 v[144:159], v[36:39], v[52:55], v[144:159]
  v_mfma_f32_32x32x16_bf16 v[160:175], v[28:31], v[60:63], v[160:175]
  s_waitcnt vmcnt(12)
  s_nop 7
  v_pk_mul_f32 v[240:241], v[128:129], v[180:181]
  v_pk_mul_f32 v[242:243], v[112:113], v[180:181]
  v_pk_fma_f32 v[112:113], v[112:113], v[176:177], v[240:241]
  v_pk_fma_f32 v[128:129], v[128:129], v[176:177], v[242:243] neg_lo:[0,0,1] neg_hi:[0,0,1]
  v_pk_mul_f32 v[244:245], v[130:131], v[182:183]
  v_pk_mul_f32 v[246:247], v[114:115], v[182:183]
  v_pk_fma_f32 v[114:115], v[114:115], v[178:179], v[244:245]
  v_pk_fma_f32 v[130:131], v[130:131], v[178:179], v[246:247] neg_lo:[0,0,1] neg_hi:[0,0,1]
  v_pk_mul_f32 v[240:241], v[132:133], v[188:189]
  v_pk_mul_f32 v[242:243], v[116:117], v[188:189]
  v_pk_fma_f32 v[116:117], v[116:117], v[184:185], v[240:241]
  v_pk_fma_f32 v[132:133], v[132:133], v[184:185], v[242:243] neg_lo:[0,0,1] neg_hi:[0,0,1]
  v_pk_mul_f32 v[244:245], v[134:135], v[190:191]
  v_pk_mul_f32 v[246:247], v[118:119], v[190:191]
  v_pk_fma_f32 v[118:119], v[118:119], v[186:187], v[244:245]
  v_pk_fma_f32 v[134:135], v[134:135], v[186:187], v[246:247] neg_lo:[0,0,1] neg_hi:[0,0,1]
  v_pk_mul_f32 v[240:241], v[136:137], v[196:197]
  v_pk_mul_f32 v[242:243], v[120:121], v[196:197]
  v_pk_fma_f32 v[120:121], v[120:121], v[192:193], v[240:241]
  v_pk_fma_f32 v[136:137], v[136:137], v[192:193], v[242:243] neg_lo:[0,0,1] neg_hi:[0,0,1]
  v_pk_mul_f32 v[244:245], v[138:139], v[198:199]
  v_pk_mul_f32 v[246:247], v[122:123], v[198:199]
  v_pk_fma_f32 v[122:123], v[122:123], v[194:195], v[244:245]
  v_pk_fma_f32 v[138:139], v[138:139], v[194:195], v[246:247] neg_lo:[0,0,1] neg_hi:[0,0,1]
  v_pk_mul_f32 v[240:241], v[140:141], v[204:205]
  v_pk_mul_f32 v[242:243], v[124:125], v[204:205]
  v_pk_fma_f32 v[124:125], v[124:125], v[200:201], v[240:241]
  v_pk_fma_f32 v[140:141], v[140:141], v[200:201], v[242:243] neg_lo:[0,0,1] neg_hi:[0,0,1]
  v_pk_mul_f32 v[244:245], v[142:143], v[206:207]
  v_pk_mul_f32 v[246:247], v[126:127], v[206:207]
  v_pk_fma_f32 v[126:127], v[126:127], v[202:203], v[244:245]
  v_pk_fma_f32 v[142:143], v[142:143], v[202:203], v[246:247] neg_lo:[0,0,1] neg_hi:[0,0,1]
  v_cvt_pk_bf16_f32 v8, v112, v113
  v_cvt_pk_bf16_f32 v9, v114, v115
  v_cvt_pk_bf16_f32 v10, v116, v117
  v_cvt_pk_bf16_f32 v11, v118, v119
  v_cvt_pk_bf16_f32 v12, v120, v121
  v_cvt_pk_bf16_f32 v13, v122, v123
  v_cvt_pk_bf16_f32 v14, v124, v125
  v_cvt_pk_bf16_f32 v15, v126, v127
  v_cvt_pk_bf16_f32 v16, v128, v129
  v_cvt_pk_bf16_f32 v17, v130, v131
  v_cvt_pk_bf16_f32 v18, v132, v133
  v_cvt_pk_bf16_f32 v19, v134, v135
  v_cvt_pk_bf16_f32 v20, v136, v137
  v_cvt_pk_bf16_f32 v21, v138, v139
  v_cvt_pk_bf16_f32 v22, v140, v141
  v_cvt_pk_bf16_f32 v23, v142, v143
  v_pk_mul_f32 v[240:241], v[160:161], v[212:213]
  v_pk_mul_f32 v[242:243], v[144:145], v[212:213]
  v_pk_fma_f32 v[144:145], v[144:145], v[208:209], v[240:241]
  v_pk_fma_f32 v[160:161], v[160:161], v[208:209], v[242:243] neg_lo:[0,0,1] neg_hi:[0,0,1]
  v_pk_mul_f32 v[244:245], v[162:163], v[214:215]
  v_pk_mul_f32 v[246:247], v[146:147], v[214:215]
  v_pk_fma_f32 v[146:147], v[146:147], v[210:211], v[244:245]
  v_pk_fma_f32 v[162:163], v[162:163], v[210:211], v[246:247] neg_lo:[0,0,1] neg_hi:[0,0,1]
  v_pk_mul_f32 v[240:241], v[164:165], v[220:221]
  v_pk_mul_f32 v[242:243], v[148:149], v[220:221]
  v_pk_fma_f32 v[148:149], v[148:149], v[216:217], v[240:241]
  v_pk_fma_f32 v[164:165], v[164:165], v[216:217], v[242:243] neg_lo:[0,0,1] neg_hi:[0,0,1]
  v_pk_mul_f32 v[244:245], v[166:167], v[222:223]
  v_pk_mul_f32 v[246:247], v[150:151], v[222:223]
  v_pk_fma_f32 v[150:151], v[150:151], v[218:219], v[244:245]
  v_pk_fma_f32 v[166:167], v[166:167], v[218:219], v[246:247] neg_lo:[0,0,1] neg_hi:[0,0,1]
  v_pk_mul_f32 v[240:241], v[168:169], v[228:229]
  v_pk_mul_f32 v[242:243], v[152:153], v[228:229]
  v_pk_fma_f32 v[152:153], v[152:153], v[224:225], v[240:241]
  v_pk_fma_f32 v[168:169], v[168:169], v[224:225], v[242:243] neg_lo:[0,0,1] neg_hi:[0,0,1]
  v_pk_mul_f32 v[244:245], v[170:171], v[230:231]
  v_pk_mul_f32 v[246:247], v[154:155], v[230:231]
  v_pk_fma_f32 v[154:155], v[154:155], v[226:227], v[244:245]
  v_pk_fma_f32 v[170:171], v[170:171], v[226:227], v[246:247] neg_lo:[0,0,1] neg_hi:[0,0,1]
  v_pk_mul_f32 v[240:241], v[172:173], v[236:237]
  v_pk_mul_f32 v[242:243], v[156:157], v[236:237]
  v_pk_fma_f32 v[156:157], v[156:157], v[232:233], v[240:241]
  v_pk_fma_f32 v[172:173], v[172:173], v[232:233], v[242:243] neg_lo:[0,0,1] neg_hi:[0,0,1]
  v_pk_mul_f32 v[244:245], v[174:175], v[238:239]
  v_pk_mul_f32 v[246:247], v[158:159], v[238:239]
  v_pk_fma_f32 v[158:159], v[158:159], v[234:235], v[244:245]
  v_pk_fma_f32 v[174:175], v[174:175], v[234:235], v[246:247] neg_lo:[0,0,1] neg_hi:[0,0,1]
  v_cvt_pk_bf16_f32 v24, v144, v145
  v_cvt_pk_bf16_f32 v25, v146, v147
  v_cvt_pk_bf16_f32 v26, v148, v149
  v_cvt_pk_bf16_f32 v27, v150, v151
  v_cvt_pk_bf16_f32 v28, v152, v153
  v_cvt_pk_bf16_f32 v29, v154, v155
  v_cvt_pk_bf16_f32 v30, v156, v157
  v_cvt_pk_bf16_f32 v31, v158, v159
  v_cvt_pk_bf16_f32 v32, v160, v161
  v_cvt_pk_bf16_f32 v33, v162, v163
  v_cvt_pk_bf16_f32 v34, v164, v165
  v_cvt_pk_bf16_f32 v35, v166, v167
  v_cvt_pk_bf16_f32 v36, v168, v169
  v_cvt_pk_bf16_f32 v37, v170, v171
  v_cvt_pk_bf16_f32 v38, v172, v173
  v_cvt_pk_bf16_f32 v39, v174, v175
  buffer_load_dwordx4 v[176:179], v2, s[8:11], s22 offen offset:0
  buffer_load_dwordx4 v[180:183], v2, s[8:11], s22 offen offset:1024
  buffer_load_dwordx4 v[184:187], v2, s[8:11], s22 offen offset:2048
  buffer_load_dwordx4 v[188:191], v2, s[8:11], s22 offen offset:3072
  s_add_u32 s24, s22, 4096
  buffer_load_dwordx4 v[192:195], v2, s[8:11], s24 offen offset:0
  s_add_u32 s24, s22, 4096
  buffer_load_dwordx4 v[196:199], v2, s[8:11], s24 offen offset:1024
  s_add_u32 s24, s22, 4096
  buffer_load_dwordx4 v[200:203], v2, s[8:11], s24 offen offset:2048
  s_add_u32 s24, s22, 4096
  buffer_load_dwordx4 v[204:207], v2, s[8:11], s24 offen offset:3072
  s_mov_b32 s24, 32768
  buffer_load_dwordx4 v[208:211], v2, s[12:15], s24 offen offset:2048
  s_mov_b32 s24, 32768
  buffer_load_dwordx4 v[212:215], v2, s[12:15], s24 offen offset:3072
  s_mov_b32 s24, 36864
  buffer_load_dwordx4 v[216:219], v2, s[12:15], s24 offen offset:0
  s_mov_b32 s24, 36864
  buffer_load_dwordx4 v[220:223], v2, s[12:15], s24 offen offset:1024
  s_mov_b32 s24, 36864
  buffer_load_dwordx4 v[224:227], v2, s[12:15], s24 offen offset:2048
  s_mov_b32 s24, 36864
  buffer_load_dwordx4 v[228:231], v2, s[12:15], s24 offen offset:3072
  s_mov_b32 s24, 40960
  buffer_load_dwordx4 v[232:235], v2, s[12:15], s24 offen offset:0
  s_mov_b32 s24, 40960
  buffer_load_dwordx4 v[236:239], v2, s[12:15], s24 offen offset:1024
  s_waitcnt vmcnt(16)
  v_mfma_f32_32x32x16_bf16 v[112:127], v[40:43], v[8:11], 0
  v_mfma_f32_32x32x16_bf16 v[128:143], v[40:43], v[16:19], 0
  v_mfma_f32_32x32x16_bf16 v[112:127], v[44:47], v[12:15], v[112:127]
  v_mfma_f32_32x32x16_bf16 v[128:143], v[44:47], v[20:23], v[128:143]
  v_mfma_f32_32x32x16_bf16 v[112:127], v[48:51], v[16:19], v[112:127]
  v_mfma_f32_32x32x16_bf16 v[128:143], v[56:59], v[8:11], v[128:143]
  v_mfma_f32_32x32x16_bf16 v[112:127], v[52:55], v[20:23], v[112:127]
  v_mfma_f32_32x32x16_bf16 v[128:143], v[60:63], v[12:15], v[128:143]
  v_mfma_f32_32x32x16_bf16 v[144:159], v[64:67], v[24:27], 0
  v_mfma_f32_32x32x16_bf16 v[160:175], v[64:67], v[32:35], 0
  v_mfma_f32_32x32x16_bf16 v[144:159], v[68:71], v[28:31], v[144:159]
  v_mfma_f32_32x32x16_bf16 v[160:175], v[68:71], v[36:39], v[160:175]
  v_mfma_f32_32x32x16_bf16 v[144:159], v[72:75], v[32:35], v[144:159]
  v_mfma_f32_32x32x16_bf16 v[160:175], v[80:83], v[24:27], v[160:175]
  v_mfma_f32_32x32x16_bf16 v[144:159], v[76:79], v[36:39], v[144:159]
  v_mfma_f32_32x32x16_bf16 v[160:175], v[84:87], v[28:31], v[160:175]
  s_waitcnt vmcnt(8)
  s_nop 7
  s_nop 3
  s_mov_b32 s25, 0xffff0000
  v_pk_add_f32 v[240:241], v[112:113], v[144:145]
  v_pk_add_f32 v[242:243], v[128:129], v[160:161]
  v_pk_add_f32 v[144:145], v[112:113], v[144:145] neg_lo:[0,1] neg_hi:[0,1]
  v_pk_add_f32 v[160:161], v[128:129], v[160:161] neg_lo:[0,1] neg_hi:[0,1]
  v_lshlrev_b32 v244, 16, v176
  v_lshlrev_b32 v245, 16, v177
  v_and_b32 v246, s25, v176
  v_and_b32 v247, s25, v177
  v_pk_mul_f32 v[248:249], v[242:243], v[246:247]
  v_pk_mul_f32 v[250:251], v[240:241], v[246:247]
  v_pk_fma_f32 v[240:241], v[240:241], v[244:245], v[248:249] neg_lo:[0,0,1] neg_hi:[0,0,1]
  v_pk_fma_f32 v[242:243], v[242:243], v[244:245], v[250:251]
  v_lshlrev_b32 v244, 16, v192
  v_lshlrev_b32 v245, 16, v193
  v_and_b32 v246, s25, v192
  v_and_b32 v247, s25, v193
  v_pk_mul_f32 v[248:249], v[160:161], v[246:247]
  v_pk_mul_f32 v[250:251], v[144:145], v[246:247]
  v_pk_fma_f32 v[144:145], v[144:145], v[244:245], v[248:249] neg_lo:[0,0,1] neg_hi:[0,0,1]
  v_pk_fma_f32 v[160:161], v[160:161], v[244:245], v[250:251]
  v_pk_add_f32 v[112:113], v[240:241], v[144:145]
  v_pk_add_f32 v[128:129], v[242:243], v[160:161]
  v_pk_add_f32 v[144:145], v[240:241], v[144:145] neg_lo:[0,1] neg_hi:[0,1]
  v_pk_add_f32 v[160:161], v[242:243], v[160:161] neg_lo:[0,1] neg_hi:[0,1]
  v_pk_add_f32 v[240:241], v[114:115], v[146:147]
  v_pk_add_f32 v[242:243], v[130:131], v[162:163]
  v_pk_add_f32 v[146:147], v[114:115], v[146:147] neg_lo:[0,1] neg_hi:[0,1]
  v_pk_add_f32 v[162:163], v[130:131], v[162:163] neg_lo:[0,1] neg_hi:[0,1]
  v_lshlrev_b32 v244, 16, v178
  v_lshlrev_b32 v245, 16, v179
  v_and_b32 v246, s25, v178
  v_and_b32 v247, s25, v179
  v_pk_mul_f32 v[248:249], v[242:243], v[246:247]
  v_pk_mul_f32 v[250:251], v[240:241], v[246:247]
  v_pk_fma_f32 v[240:241], v[240:241], v[244:245], v[248:249] neg_lo:[0,0,1] neg_hi:[0,0,1]
  v_pk_fma_f32 v[242:243], v[242:243], v[244:245], v[250:251]
  v_lshlrev_b32 v244, 16, v194
  v_lshlrev_b32 v245, 16, v195
  v_and_b32 v246, s25, v194
  v_and_b32 v247, s25, v195
  v_pk_mul_f32 v[248:249], v[162:163], v[246:247]
  v_pk_mul_f32 v[250:251], v[146:147], v[246:247]
  v_pk_fma_f32 v[146:147], v[146:147], v[244:245], v[248:249] neg_lo:[0,0,1] neg_hi:[0,0,1]
  v_pk_fma_f32 v[162:163], v[162:163], v[244:245], v[250:251]
  v_pk_add_f32 v[114:115], v[240:241], v[146:147]
  v_pk_add_f32 v[130:131], v[242:243], v[162:163]
  v_pk_add_f32 v[146:147], v[240:241], v[146:147] neg_lo:[0,1] neg_hi:[0,1]
  v_pk_add_f32 v[162:163], v[242:243], v[162:163] neg_lo:[0,1] neg_hi:[0,1]
  v_pk_add_f32 v[240:241], v[116:117], v[148:149]
  v_pk_add_f32 v[242:243], v[132:133], v[164:165]
  v_pk_add_f32 v[148:149], v[116:117], v[148:149] neg_lo:[0,1] neg_hi:[0,1]
  v_pk_add_f32 v[164:165], v[132:133], v[164:165] neg_lo:[0,1] neg_hi:[0,1]
  v_lshlrev_b32 v244, 16, v180
  v_lshlrev_b32 v245, 16, v181
  v_and_b32 v246, s25, v180
  v_and_b32 v247, s25, v181
  v_pk_mul_f32 v[248:249], v[242:243], v[246:247]
  v_pk_mul_f32 v[250:251], v[240:241], v[246:247]
  v_pk_fma_f32 v[240:241], v[240:241], v[244:245], v[248:249] neg_lo:[0,0,1] neg_hi:[0,0,1]
  v_pk_fma_f32 v[242:243], v[242:243], v[244:245], v[250:251]
  v_lshlrev_b32 v244, 16, v196
  v_lshlrev_b32 v245, 16, v197
  v_and_b32 v246, s25, v196
  v_and_b32 v247, s25, v197
  v_pk_mul_f32 v[248:249], v[164:165], v[246:247]
  v_pk_mul_f32 v[250:251], v[148:149], v[246:247]
  v_pk_fma_f32 v[148:149], v[148:149], v[244:245], v[248:249] neg_lo:[0,0,1] neg_hi:[0,0,1]
  v_pk_fma_f32 v[164:165], v[164:165], v[244:245], v[250:251]
  v_pk_add_f32 v[116:117], v[240:241], v[148:149]
  v_pk_add_f32 v[132:133], v[242:243], v[164:165]
  v_pk_add_f32 v[148:149], v[240:241], v[148:149] neg_lo:[0,1] neg_hi:[0,1]
  v_pk_add_f32 v[164:165], v[242:243], v[164:165] neg_lo:[0,1] neg_hi:[0,1]
  v_pk_add_f32 v[240:241], v[118:119], v[150:151]
  v_pk_add_f32 v[242:243], v[134:135], v[166:167]
  v_pk_add_f32 v[150:151], v[118:119], v[150:151] neg_lo:[0,1] neg_hi:[0,1]
  v_pk_add_f32 v[166:167], v[134:135], v[166:167] neg_lo:[0,1] neg_hi:[0,1]
  v_lshlrev_b32 v244, 16, v182
  v_lshlrev_b32 v245, 16, v183
  v_and_b32 v246, s25, v182
  v_and_b32 v247, s25, v183
  v_pk_mul_f32 v[248:249], v[242:243], v[246:247]
  v_pk_mul_f32 v[250:251], v[240:241], v[246:247]
  v_pk_fma_f32 v[240:241], v[240:241], v[244:245], v[248:249] neg_lo:[0,0,1] neg_hi:[0,0,1]
  v_pk_fma_f32 v[242:243], v[242:243], v[244:245], v[250:251]
  v_lshlrev_b32 v244, 16, v198
  v_lshlrev_b32 v245, 16, v199
  v_and_b32 v246, s25, v198
  v_and_b32 v247, s25, v199
  v_pk_mul_f32 v[248:249], v[166:167], v[246:247]
  v_pk_mul_f32 v[250:251], v[150:151], v[246:247]
  v_pk_fma_f32 v[150:151], v[150:151], v[244:245], v[248:249] neg_lo:[0,0,1] neg_hi:[0,0,1]
  v_pk_fma_f32 v[166:167], v[166:167], v[244:245], v[250:251]
  v_pk_add_f32 v[118:119], v[240:241], v[150:151]
  v_pk_add_f32 v[134:135], v[242:243], v[166:167]
  v_pk_add_f32 v[150:151], v[240:241], v[150:151] neg_lo:[0,1] neg_hi:[0,1]
  v_pk_add_f32 v[166:167], v[242:243], v[166:167] neg_lo:[0,1] neg_hi:[0,1]
  v_pk_add_f32 v[240:241], v[120:121], v[152:153]
  v_pk_add_f32 v[242:243], v[136:137], v[168:169]
  v_pk_add_f32 v[152:153], v[120:121], v[152:153] neg_lo:[0,1] neg_hi:[0,1]
  v_pk_add_f32 v[168:169], v[136:137], v[168:169] neg_lo:[0,1] neg_hi:[0,1]
  v_lshlrev_b32 v244, 16, v184
  v_lshlrev_b32 v245, 16, v185
  v_and_b32 v246, s25, v184
  v_and_b32 v247, s25, v185
  v_pk_mul_f32 v[248:249], v[242:243], v[246:247]
  v_pk_mul_f32 v[250:251], v[240:241], v[246:247]
  v_pk_fma_f32 v[240:241], v[240:241], v[244:245], v[248:249] neg_lo:[0,0,1] neg_hi:[0,0,1]
  v_pk_fma_f32 v[242:243], v[242:243], v[244:245], v[250:251]
  v_lshlrev_b32 v244, 16, v200
  v_lshlrev_b32 v245, 16, v201
  v_and_b32 v246, s25, v200
  v_and_b32 v247, s25, v201
  v_pk_mul_f32 v[248:249], v[168:169], v[246:247]
  v_pk_mul_f32 v[250:251], v[152:153], v[246:247]
  v_pk_fma_f32 v[152:153], v[152:153], v[244:245], v[248:249] neg_lo:[0,0,1] neg_hi:[0,0,1]
  v_pk_fma_f32 v[168:169], v[168:169], v[244:245], v[250:251]
  v_pk_add_f32 v[120:121], v[240:241], v[152:153]
  v_pk_add_f32 v[136:137], v[242:243], v[168:169]
  v_pk_add_f32 v[152:153], v[240:241], v[152:153] neg_lo:[0,1] neg_hi:[0,1]
  v_pk_add_f32 v[168:169], v[242:243], v[168:169] neg_lo:[0,1] neg_hi:[0,1]
  v_pk_add_f32 v[240:241], v[122:123], v[154:155]
  v_pk_add_f32 v[242:243], v[138:139], v[170:171]
  v_pk_add_f32 v[154:155], v[122:123], v[154:155] neg_lo:[0,1] neg_hi:[0,1]
  v_pk_add_f32 v[170:171], v[138:139], v[170:171] neg_lo:[0,1] neg_hi:[0,1]
  v_lshlrev_b32 v244, 16, v186
  v_lshlrev_b32 v245, 16, v187
  v_and_b32 v246, s25, v186
  v_and_b32 v247, s25, v187
  v_pk_mul_f32 v[248:249], v[242:243], v[246:247]
  v_pk_mul_f32 v[250:251], v[240:241], v[246:247]
  v_pk_fma_f32 v[240:241], v[240:241], v[244:245], v[248:249] neg_lo:[0,0,1] neg_hi:[0,0,1]
  v_pk_fma_f32 v[242:243], v[242:243], v[244:245], v[250:251]
  v_lshlrev_b32 v244, 16, v202
  v_lshlrev_b32 v245, 16, v203
  v_and_b32 v246, s25, v202
  v_and_b32 v247, s25, v203
  v_pk_mul_f32 v[248:249], v[170:171], v[246:247]
  v_pk_mul_f32 v[250:251], v[154:155], v[246:247]
  v_pk_fma_f32 v[154:155], v[154:155], v[244:245], v[248:249] neg_lo:[0,0,1] neg_hi:[0,0,1]
  v_pk_fma_f32 v[170:171], v[170:171], v[244:245], v[250:251]
  v_pk_add_f32 v[122:123], v[240:241], v[154:155]
  v_pk_add_f32 v[138:139], v[242:243], v[170:171]
  v_pk_add_f32 v[154:155], v[240:241], v[154:155] neg_lo:[0,1] neg_hi:[0,1]
  v_pk_add_f32 v[170:171], v[242:243], v[170:171] neg_lo:[0,1] neg_hi:[0,1]
  v_pk_add_f32 v[240:241], v[124:125], v[156:157]
  v_pk_add_f32 v[242:243], v[140:141], v[172:173]
  v_pk_add_f32 v[156:157], v[124:125], v[156:157] neg_lo:[0,1] neg_hi:[0,1]
  v_pk_add_f32 v[172:173], v[140:141], v[172:173] neg_lo:[0,1] neg_hi:[0,1]
  v_lshlrev_b32 v244, 16, v188
  v_lshlrev_b32 v245, 16, v189
  v_and_b32 v246, s25, v188
  v_and_b32 v247, s25, v189
  v_pk_mul_f32 v[248:249], v[242:243], v[246:247]
  v_pk_mul_f32 v[250:251], v[240:241], v[246:247]
  v_pk_fma_f32 v[240:241], v[240:241], v[244:245], v[248:249] neg_lo:[0,0,1] neg_hi:[0,0,1]
  v_pk_fma_f32 v[242:243], v[242:243], v[244:245], v[250:251]
  v_lshlrev_b32 v244, 16, v204
  v_lshlrev_b32 v245, 16, v205
  v_and_b32 v246, s25, v204
  v_and_b32 v247, s25, v205
  v_pk_mul_f32 v[248:249], v[172:173], v[246:247]
  v_pk_mul_f32 v[250:251], v[156:157], v[246:247]
  v_pk_fma_f32 v[156:157], v[156:157], v[244:245], v[248:249] neg_lo:[0,0,1] neg_hi:[0,0,1]
  v_pk_fma_f32 v[172:173], v[172:173], v[244:245], v[250:251]
  v_pk_add_f32 v[124:125], v[240:241], v[156:157]
  v_pk_add_f32 v[140:141], v[242:243], v[172:173]
  v_pk_add_f32 v[156:157], v[240:241], v[156:157] neg_lo:[0,1] neg_hi:[0,1]
  v_pk_add_f32 v[172:173], v[242:243], v[172:173] neg_lo:[0,1] neg_hi:[0,1]
  v_pk_add_f32 v[240:241], v[126:127], v[158:159]
  v_pk_add_f32 v[242:243], v[142:143], v[174:175]
  v_pk_add_f32 v[158:159], v[126:127], v[158:159] neg_lo:[0,1] neg_hi:[0,1]
  v_pk_add_f32 v[174:175], v[142:143], v[174:175] neg_lo:[0,1] neg_hi:[0,1]
  v_lshlrev_b32 v244, 16, v190
  v_lshlrev_b32 v245, 16, v191
  v_and_b32 v246, s25, v190
  v_and_b32 v247, s25, v191
  v_pk_mul_f32 v[248:249], v[242:243], v[246:247]
  v_pk_mul_f32 v[250:251], v[240:241], v[246:247]
  v_pk_fma_f32 v[240:241], v[240:241], v[244:245], v[248:249] neg_lo:[0,0,1] neg_hi:[0,0,1]
  v_pk_fma_f32 v[242:243], v[242:243], v[244:245], v[250:251]
  v_lshlrev_b32 v244, 16, v206
  v_lshlrev_b32 v245, 16, v207
  v_and_b32 v246, s25, v206
  v_and_b32 v247, s25, v207
  v_pk_mul_f32 v[248:249], v[174:175], v[246:247]
  v_pk_mul_f32 v[250:251], v[158:159], v[246:247]
  v_pk_fma_f32 v[158:159], v[158:159], v[244:245], v[248:249] neg_lo:[0,0,1] neg_hi:[0,0,1]
  v_pk_fma_f32 v[174:175], v[174:175], v[244:245], v[250:251]
  v_pk_add_f32 v[126:127], v[240:241], v[158:159]
  v_pk_add_f32 v[142:143], v[242:243], v[174:175]
  v_pk_add_f32 v[158:159], v[240:241], v[158:159] neg_lo:[0,1] neg_hi:[0,1]
  v_pk_add_f32 v[174:175], v[242:243], v[174:175] neg_lo:[0,1] neg_hi:[0,1]
  s_mov_b32 s24, 40960
  buffer_load_dwordx4 v[176:179], v2, s[12:15], s24 offen offset:2048
  s_mov_b32 s24, 40960
  buffer_load_dwordx4 v[180:183], v2, s[12:15], s24 offen offset:3072
  s_mov_b32 s24, 45056
  buffer_load_dwordx4 v[184:187], v2, s[12:15], s24 offen offset:0
  s_mov_b32 s24, 45056
  buffer_load_dwordx4 v[188:191], v2, s[12:15], s24 offen offset:1024
  s_mov_b32 s24, 45056
  buffer_load_dwordx4 v[192:195], v2, s[12:15], s24 offen offset:2048
  s_mov_b32 s24, 45056
  buffer_load_dwordx4 v[196:199], v2, s[12:15], s24 offen offset:3072
  s_mov_b32 s24, 49152
  buffer_load_dwordx4 v[200:203], v2, s[12:15], s24 offen offset:0
  s_mov_b32 s24, 49152
  buffer_load_dwordx4 v[204:207], v2, s[12:15], s24 offen offset:1024
  v_cvt_pk_bf16_f32 v8, v112, v113
  v_cvt_pk_bf16_f32 v9, v114, v115
  v_cvt_pk_bf16_f32 v10, v116, v117
  v_cvt_pk_bf16_f32 v11, v118, v119
  v_cvt_pk_bf16_f32 v12, v120, v121
  v_cvt_pk_bf16_f32 v13, v122, v123
  v_cvt_pk_bf16_f32 v14, v124, v125
  v_cvt_pk_bf16_f32 v15, v126, v127
  v_cvt_pk_bf16_f32 v16, v128, v129
  v_cvt_pk_bf16_f32 v17, v130, v131
  v_cvt_pk_bf16_f32 v18, v132, v133
  v_cvt_pk_bf16_f32 v19, v134, v135
  v_cvt_pk_bf16_f32 v20, v136, v137
  v_cvt_pk_bf16_f32 v21, v138, v139
  v_cvt_pk_bf16_f32 v22, v140, v141
  v_cvt_pk_bf16_f32 v23, v142, v143
  v_cvt_pk_bf16_f32 v24, v144, v145
  v_cvt_pk_bf16_f32 v25, v146, v147
  v_cvt_pk_bf16_f32 v26, v148, v149
  v_cvt_pk_bf16_f32 v27, v150, v151
  v_cvt_pk_bf16_f32 v28, v152, v153
  v_cvt_pk_bf16_f32 v29, v154, v155
  v_cvt_pk_bf16_f32 v30, v156, v157
  v_cvt_pk_bf16_f32 v31, v158, v159
  v_cvt_pk_bf16_f32 v32, v160, v161
  v_cvt_pk_bf16_f32 v33, v162, v163
  v_cvt_pk_bf16_f32 v34, v164, v165
  v_cvt_pk_bf16_f32 v35, v166, v167
  v_cvt_pk_bf16_f32 v36, v168, v169
  v_cvt_pk_bf16_f32 v37, v170, v171
  v_cvt_pk_bf16_f32 v38, v172, v173
  v_cvt_pk_bf16_f32 v39, v174, v175
  s_nop 1
  v_mfma_f32_32x32x16_bf16 v[112:127], v[8:11], v[40:43], 0
  v_mfma_f32_32x32x16_bf16 v[128:143], v[16:19], v[40:43], 0
  v_mfma_f32_32x32x16_bf16 v[112:127], v[12:15], v[44:47], v[112:127]
  v_mfma_f32_32x32x16_bf16 v[128:143], v[20:23], v[44:47], v[128:143]
  v_mfma_f32_32x32x16_bf16 v[112:127], v[16:19], v[56:59], v[112:127]
  v_mfma_f32_32x32x16_bf16 v[128:143], v[8:11], v[48:51], v[128:143]
  v_mfma_f32_32x32x16_bf16 v[112:127], v[20:23], v[60:63], v[112:127]
  v_mfma_f32_32x32x16_bf16 v[128:143], v[12:15], v[52:55], v[128:143]
  v_mfma_f32_32x32x16_bf16 v[144:159], v[24:27], v[88:91], 0
  v_mfma_f32_32x32x16_bf16 v[160:175], v[32:35], v[88:91], 0
  v_mfma_f32_32x32x16_bf16 v[144:159], v[28:31], v[92:95], v[144:159]
  v_mfma_f32_32x32x16_bf16 v[160:175], v[36:39], v[92:95], v[160:175]
  v_mfma_f32_32x32x16_bf16 v[144:159], v[32:35], v[104:107], v[144:159]
  v_mfma_f32_32x32x16_bf16 v[160:175], v[24:27], v[96:99], v[160:175]
  v_mfma_f32_32x32x16_bf16 v[144:159], v[36:39], v[108:111], v[144:159]
  v_mfma_f32_32x32x16_bf16 v[160:175], v[28:31], v[100:103], v[160:175]
  s_waitcnt vmcnt(0)
  s_nop 7
  s_nop 3
  v_and_b32 v6, 31, v0
  v_lshrrev_b32 v7, 5, v0
  v_mul_u32_u24 v252, 36, v6
  v_lshl_add_u32 v253, v7, 3, v252
  buffer_load_dwordx2 v[76:77], v253, s[8:11], s28 offen
  buffer_load_dwordx2 v[78:79], v253, s[8:11], s28 offen offset:16
  buffer_load_dword v80, v252, s[8:11], s28 offen offset:32
  v_lshlrev_b32 v254, 2, v0
  s_mov_b32 s21, 0x270000
  buffer_load_dword v82, v254, s[8:11], s21 offen
  v_pk_mul_f32 v[240:241], v[128:129], v[212:213]
  v_pk_mul_f32 v[242:243], v[112:113], v[212:213]
  v_pk_fma_f32 v[112:113], v[112:113], v[208:209], v[240:241] neg_lo:[0,0,1] neg_hi:[0,0,1]
  v_pk_fma_f32 v[128:129], v[128:129], v[208:209], v[242:243]
  v_pk_mul_f32 v[244:245], v[130:131], v[214:215]
  v_pk_mul_f32 v[246:247], v[114:115], v[214:215]
  v_pk_fma_f32 v[114:115], v[114:115], v[210:211], v[244:245] neg_lo:[0,0,1] neg_hi:[0,0,1]
  v_pk_fma_f32 v[130:131], v[130:131], v[210:211], v[246:247]
  v_pk_mul_f32 v[240:241], v[132:133], v[220:221]
  v_pk_mul_f32 v[242:243], v[116:117], v[220:221]
  v_pk_fma_f32 v[116:117], v[116:117], v[216:217], v[240:241] neg_lo:[0,0,1] neg_hi:[0,0,1]
  v_pk_fma_f32 v[132:133], v[132:133], v[216:217], v[242:243]
  v_pk_mul_f32 v[244:245], v[134:135], v[222:223]
  v_pk_mul_f32 v[246:247], v[118:119], v[222:223]
  v_pk_fma_f32 v[118:119], v[118:119], v[218:219], v[244:245] neg_lo:[0,0,1] neg_hi:[0,0,1]
  v_pk_fma_f32 v[134:135], v[134:135], v[218:219], v[246:247]
  v_pk_mul_f32 v[240:241], v[136:137], v[228:229]
  v_pk_mul_f32 v[242:243], v[120:121], v[228:229]
  v_pk_fma_f32 v[120:121], v[120:121], v[224:225], v[240:241] neg_lo:[0,0,1] neg_hi:[0,0,1]
  v_pk_fma_f32 v[136:137], v[136:137], v[224:225], v[242:243]
  v_pk_mul_f32 v[244:245], v[138:139], v[230:231]
  v_pk_mul_f32 v[246:247], v[122:123], v[230:231]
  v_pk_fma_f32 v[122:123], v[122:123], v[226:227], v[244:245] neg_lo:[0,0,1] neg_hi:[0,0,1]
  v_pk_fma_f32 v[138:139], v[138:139], v[226:227], v[246:247]
  v_pk_mul_f32 v[240:241], v[140:141], v[236:237]
  v_pk_mul_f32 v[242:243], v[124:125], v[236:237]
  v_pk_fma_f32 v[124:125], v[124:125], v[232:233], v[240:241] neg_lo:[0,0,1] neg_hi:[0,0,1]
  v_pk_fma_f32 v[140:141], v[140:141], v[232:233], v[242:243]
  v_pk_mul_f32 v[244:245], v[142:143], v[238:239]
  v_pk_mul_f32 v[246:247], v[126:127], v[238:239]
  v_pk_fma_f32 v[126:127], v[126:127], v[234:235], v[244:245] neg_lo:[0,0,1] neg_hi:[0,0,1]
  v_pk_fma_f32 v[142:143], v[142:143], v[234:235], v[246:247]
  v_cvt_pk_bf16_f32 v8, v112, v113
  v_cvt_pk_bf16_f32 v9, v114, v115
  v_cvt_pk_bf16_f32 v10, v116, v117
  v_cvt_pk_bf16_f32 v11, v118, v119
  v_cvt_pk_bf16_f32 v12, v120, v121
  v_cvt_pk_bf16_f32 v13, v122, v123
  v_cvt_pk_bf16_f32 v14, v124, v125
  v_cvt_pk_bf16_f32 v15, v126, v127
  v_cvt_pk_bf16_f32 v16, v128, v129
  v_cvt_pk_bf16_f32 v17, v130, v131
  v_cvt_pk_bf16_f32 v18, v132, v133
  v_cvt_pk_bf16_f32 v19, v134, v135
  v_cvt_pk_bf16_f32 v20, v136, v137
  v_cvt_pk_bf16_f32 v21, v138, v139
  v_cvt_pk_bf16_f32 v22, v140, v141
  v_cvt_pk_bf16_f32 v23, v142, v143
  v_pk_mul_f32 v[240:241], v[160:161], v[180:181]
  v_pk_mul_f32 v[242:243], v[144:145], v[180:181]
  v_pk_fma_f32 v[144:145], v[144:145], v[176:177], v[240:241] neg_lo:[0,0,1] neg_hi:[0,0,1]
  v_pk_fma_f32 v[160:161], v[160:161], v[176:177], v[242:243]
  v_pk_mul_f32 v[244:245], v[162:163], v[182:183]
  v_pk_mul_f32 v[246:247], v[146:147], v[182:183]
  v_pk_fma_f32 v[146:147], v[146:147], v[178:179], v[244:245] neg_lo:[0,0,1] neg_hi:[0,0,1]
  v_pk_fma_f32 v[162:163], v[162:163], v[178:179], v[246:247]
  v_pk_mul_f32 v[240:241], v[164:165], v[188:189]
  v_pk_mul_f32 v[242:243], v[148:149], v[188:189]
  v_pk_fma_f32 v[148:149], v[148:149], v[184:185], v[240:241] neg_lo:[0,0,1] neg_hi:[0,0,1]
  v_pk_fma_f32 v[164:165], v[164:165], v[184:185], v[242:243]
  v_pk_mul_f32 v[244:245], v[166:167], v[190:191]
  v_pk_mul_f32 v[246:247], v[150:151], v[190:191]
  v_pk_fma_f32 v[150:151], v[150:151], v[186:187], v[244:245] neg_lo:[0,0,1] neg_hi:[0,0,1]
  v_pk_fma_f32 v[166:167], v[166:167], v[186:187], v[246:247]
  v_pk_mul_f32 v[240:241], v[168:169], v[196:197]
  v_pk_mul_f32 v[242:243], v[152:153], v[196:197]
  v_pk_fma_f32 v[152:153], v[152:153], v[192:193], v[240:241] neg_lo:[0,0,1] neg_hi:[0,0,1]
  v_pk_fma_f32 v[168:169], v[168:169], v[192:193], v[242:243]
  v_pk_mul_f32 v[244:245], v[170:171], v[198:199]
  v_pk_mul_f32 v[246:247], v[154:155], v[198:199]
  v_pk_fma_f32 v[154:155], v[154:155], v[194:195], v[244:245] neg_lo:[0,0,1] neg_hi:[0,0,1]
  v_pk_fma_f32 v[170:171], v[170:171], v[194:195], v[246:247]
  v_pk_mul_f32 v[240:241], v[172:173], v[204:205]
  v_pk_mul_f32 v[242:243], v[156:157], v[204:205]
  v_pk_fma_f32 v[156:157], v[156:157], v[200:201], v[240:241] neg_lo:[0,0,1] neg_hi:[0,0,1]
  v_pk_fma_f32 v[172:173], v[172:173], v[200:201], v[242:243]
  v_pk_mul_f32 v[244:245], v[174:175], v[206:207]
  v_pk_mul_f32 v[246:247], v[158:159], v[206:207]
  v_pk_fma_f32 v[158:159], v[158:159], v[202:203], v[244:245] neg_lo:[0,0,1] neg_hi:[0,0,1]
  v_pk_fma_f32 v[174:175], v[174:175], v[202:203], v[246:247]
  v_cvt_pk_bf16_f32 v24, v144, v145
  v_cvt_pk_bf16_f32 v25, v146, v147
  v_cvt_pk_bf16_f32 v26, v148, v149
  v_cvt_pk_bf16_f32 v27, v150, v151
  v_cvt_pk_bf16_f32 v28, v152, v153
  v_cvt_pk_bf16_f32 v29, v154, v155
  v_cvt_pk_bf16_f32 v30, v156, v157
  v_cvt_pk_bf16_f32 v31, v158, v159
  v_cvt_pk_bf16_f32 v32, v160, v161
  v_cvt_pk_bf16_f32 v33, v162, v163
  v_cvt_pk_bf16_f32 v34, v164, v165
  v_cvt_pk_bf16_f32 v35, v166, v167
  v_cvt_pk_bf16_f32 v36, v168, v169
  v_cvt_pk_bf16_f32 v37, v170, v171
  v_cvt_pk_bf16_f32 v38, v172, v173
  v_cvt_pk_bf16_f32 v39, v174, v175
  s_nop 1
  v_mfma_f32_32x32x16_bf16 v[112:127], v[8:11], v[40:43], 0
  v_mfma_f32_32x32x16_bf16 v[128:143], v[16:19], v[40:43], 0
  v_mfma_f32_32x32x16_bf16 v[112:127], v[12:15], v[44:47], v[112:127]
  v_mfma_f32_32x32x16_bf16 v[128:143], v[20:23], v[44:47], v[128:143]
  v_mfma_f32_32x32x16_bf16 v[112:127], v[16:19], v[56:59], v[112:127]
  v_mfma_f32_32x32x16_bf16 v[128:143], v[8:11], v[48:51], v[128:143]
  v_mfma_f32_32x32x16_bf16 v[112:127], v[20:23], v[60:63], v[112:127]
  v_mfma_f32_32x32x16_bf16 v[128:143], v[12:15], v[52:55], v[128:143]
  v_mfma_f32_32x32x16_bf16 v[144:159], v[24:27], v[40:43], 0
  v_mfma_f32_32x32x16_bf16 v[160:175], v[32:35], v[40:43], 0
  v_mfma_f32_32x32x16_bf16 v[144:159], v[28:31], v[44:47], v[144:159]
  v_mfma_f32_32x32x16_bf16 v[160:175], v[36:39], v[44:47], v[160:175]
  v_mfma_f32_32x32x16_bf16 v[144:159], v[32:35], v[56:59], v[144:159]
  v_mfma_f32_32x32x16_bf16 v[160:175], v[24:27], v[48:51], v[160:175]
  v_mfma_f32_32x32x16_bf16 v[144:159], v[36:39], v[60:63], v[144:159]
  v_mfma_f32_32x32x16_bf16 v[160:175], v[28:31], v[52:55], v[160:175]
  v_and_b32 v3, 31, v0
  v_lshrrev_b32 v4, 5, v0
  v_lshl_add_u32 v3, v3, 3, v4
  v_mov_b32 v248, 27744
  v_add_u32 v4, 0, v3
  v_mul_u32_u24 v240, 21846, v4
  v_lshrrev_b32 v240, 16, v240
  v_mul_u32_u24 v242, 3, v240
  v_sub_u32 v242, v4, v242
  v_lshlrev_b32 v242, 4, v242
  v_mad_u32_u24 v244, v240, v248, v242
  v_add_u32 v4, 2, v3
  v_mul_u32_u24 v240, 21846, v4
  v_lshrrev_b32 v240, 16, v240
  v_mul_u32_u24 v242, 3, v240
  v_sub_u32 v242, v4, v242
  v_lshlrev_b32 v242, 4, v242
  v_mad_u32_u24 v245, v240, v248, v242
  v_add_u32 v4, 4, v3
  v_mul_u32_u24 v240, 21846, v4
  v_lshrrev_b32 v240, 16, v240
  v_mul_u32_u24 v242, 3, v240
  v_sub_u32 v242, v4, v242
  v_lshlrev_b32 v242, 4, v242
  v_mad_u32_u24 v246, v240, v248, v242
  v_add_u32 v4, 6, v3
  v_mul_u32_u24 v240, 21846, v4
  v_lshrrev_b32 v240, 16, v240
  v_mul_u32_u24 v242, 3, v240
  v_sub_u32 v242, v4, v242
  v_lshlrev_b32 v242, 4, v242
  v_mad_u32_u24 v247, v240, v248, v242
  s_mov_b32 s35, s23
  s_add_u32 s36, s23, 13872
  s_mov_b32 s37, 1
  s_waitcnt vmcnt(0)
  s_nop 7
  s_nop 3
  v_cvt_pk_bf16_f32 v176, v112, v144
  v_cvt_pk_bf16_f32 v177, v113, v145
  v_cvt_pk_bf16_f32 v178, v114, v146
  v_cvt_pk_bf16_f32 v179, v115, v147
  v_cvt_pk_bf16_f32 v180, v116, v148
  v_cvt_pk_bf16_f32 v181, v117, v149
  v_cvt_pk_bf16_f32 v182, v118, v150
  v_cvt_pk_bf16_f32 v183, v119, v151
  v_cvt_pk_bf16_f32 v184, v120, v152
  v_cvt_pk_bf16_f32 v185, v121, v153
  v_cvt_pk_bf16_f32 v186, v122, v154
  v_cvt_pk_bf16_f32 v187, v123, v155
  v_cvt_pk_bf16_f32 v188, v124, v156
  v_cvt_pk_bf16_f32 v189, v125, v157
  v_cvt_pk_bf16_f32 v190, v126, v158
  v_cvt_pk_bf16_f32 v191, v127, v159
  v_cvt_pk_bf16_f32 v192, v128, v160
  v_cvt_pk_bf16_f32 v193, v129, v161
  v_cvt_pk_bf16_f32 v194, v130, v162
  v_cvt_pk_bf16_f32 v195, v131, v163
  v_cvt_pk_bf16_f32 v196, v132, v164
  v_cvt_pk_bf16_f32 v197, v133, v165
  v_cvt_pk_bf16_f32 v198, v134, v166
  v_cvt_pk_bf16_f32 v199, v135, v167
  v_cvt_pk_bf16_f32 v200, v136, v168
  v_cvt_pk_bf16_f32 v201, v137, v169
  v_cvt_pk_bf16_f32 v202, v138, v170
  v_cvt_pk_bf16_f32 v203, v139, v171
  v_cvt_pk_bf16_f32 v204, v140, v172
  v_cvt_pk_bf16_f32 v205, v141, v173
  v_cvt_pk_bf16_f32 v206, v142, v174
  v_cvt_pk_bf16_f32 v207, v143, v175
  s_mov_b32 s33, 1
  s_branch L_joinq_13
L_q:
  s_cmp_lt_u32 s2, 33
  s_cselect_b32 s40, 2, 1
  s_cmp_lt_u32 s16, 4
  s_cbranch_scc1 L_role_done
  s_sub_u32 s41, s16, 4
  s_cmp_lt_u32 s41, s40
  s_cbranch_scc0 L_role_h
  s_cmp_eq_u32 s40, 1
  s_cselect_b32 s39, 4, 8
  s_cselect_b32 s46, 192, 64
  s_cselect_b32 s48, 3, 1
  s_add_u32 s47, s41, 1
  s_cmp_eq_u32 s40, 1
  s_cselect_b32 s47, 0, s47
  s_branch L_role_done
L_role_h:
  s_mov_b32 s42, 1
  s_sub_u32 s43, s16, 2
  s_lshl_b32 s44, s41, 2
  s_add_u32 s45, s44, 4
  s_cmp_eq_u32 s40, 1
  s_cselect_b32 s43, 4, s43
  s_cselect_b32 s44, s44, 8
  s_cselect_b32 s45, s45, 16
  s_lshl_b32 s49, s2, 3
  s_add_u32 s49, s49, s43
  s_mul_i32 s49, s49, 1152
  v_and_b32 v6, 31, v0
  v_lshrrev_b32 v7, 5, v0
  v_mul_u32_u24 v252, 36, v6
  v_lshl_add_u32 v253, v7, 3, v252
  buffer_load_dwordx2 v[116:117], v253, s[8:11], s49 offen
  buffer_load_dwordx2 v[118:119], v253, s[8:11], s49 offen offset:16
  buffer_load_dword v120, v252, s[8:11], s49 offen offset:32
L_role_done:
  v_and_b32 v6, 31, v0
  v_lshrrev_b32 v7, 5, v0
  v_mul_u32_u24 v252, 36, v6
  v_lshl_add_u32 v253, v7, 3, v252
  buffer_load_dwordx2 v[76:77], v253, s[8:11], s28 offen
  buffer_load_dwordx2 v[78:79], v253, s[8:11], s28 offen offset:16
  buffer_load_dword v80, v252, s[8:11], s28 offen offset:32
  v_lshlrev_b32 v254, 2, v0
  s_mov_b32 s21, 0x270000
  buffer_load_dword v82, v254, s[8:11], s21 offen
  s_bitcmp1_b32 s16, 1
  s_cbranch_scc0 L_joinq_13
  v_lshlrev_b32 v83, 4, v0
  s_mov_b32 s34, 1
  s_and_b32 s20, s16, 1
  s_lshr_b32 s21, s16, 2
  s_lshl_b32 s21, s21, 1
  s_add_u32 s20, s20, s21
  s_lshl_b32 s21, s20, 10
  s_add_u32 s22, s21, 0
  s_mov_b32 m0, s22
  s_add_u32 s23, s22, 0x240000
  buffer_load_dwordx4 v83, s[8:11], s23 offen lds
  s_add_u32 s22, s21, 4096
  s_mov_b32 m0, s22
  s_add_u32 s23, s22, 0x240000
  buffer_load_dwordx4 v83, s[8:11], s23 offen lds
  s_add_u32 s22, s21, 8192
  s_mov_b32 m0, s22
  s_add_u32 s23, s22, 0x240000
  buffer_load_dwordx4 v83, s[8:11], s23 offen lds
  s_add_u32 s22, s21, 12288
  s_mov_b32 m0, s22
  s_add_u32 s23, s22, 0x240000
  buffer_load_dwordx4 v83, s[8:11], s23 offen lds
  s_add_u32 s22, s21, 16384
  s_mov_b32 m0, s22
  s_add_u32 s23, s22, 0x240000
  buffer_load_dwordx4 v83, s[8:11], s23 offen lds
  s_add_u32 s22, s21, 20480
  s_mov_b32 m0, s22
  s_add_u32 s23, s22, 0x240000
  buffer_load_dwordx4 v83, s[8:11], s23 offen lds
  s_add_u32 s22, s21, 24576
  s_mov_b32 m0, s22
  s_add_u32 s23, s22, 0x240000
  buffer_load_dwordx4 v83, s[8:11], s23 offen lds
  s_add_u32 s22, s21, 28672
  s_mov_b32 m0, s22
  s_add_u32 s23, s22, 0x240000
  buffer_load_dwordx4 v83, s[8:11], s23 offen lds
  s_add_u32 s22, s21, 32768
  s_mov_b32 m0, s22
  s_add_u32 s23, s22, 0x240000
  buffer_load_dwordx4 v83, s[8:11], s23 offen lds
  s_mov_b32 s22, 36864
  s_mov_b32 m0, s22
  s_add_u32 s23, s22, 0x240000
  buffer_load_dwordx4 v83, s[8:11], s23 offen lds
L_joinq_13:
  s_cmp_lt_u32 s16, 4
  s_cbranch_scc1 L_pa
  s_setprio 1
  s_branch L_pb
L_pa:
  s_setprio 2
L_pb:
  v_and_b32 v6, 31, v0
  v_lshrrev_b32 v7, 5, v0
  v_lshlrev_b32 v2, 4, v0
  v_lshlrev_b32 v3, 2, v6
  v_lshlrev_b32 v83, 4, v0
  v_cmp_lt_u32 vcc, 18, v6
  v_mov_b32 v12, v6
  v_mov_b32 v13, 18
  v_cndmask_b32 v12, v12, v13, vcc
  v_subrev_u32 v14, 20, v6
  v_cmp_gt_u32 vcc, 8, v14
  v_mov_b32 v13, 3
  s_nop 0
  v_cndmask_b32 v12, v12, v13, vcc
  v_mul_u32_u24 v13, 19, v7
  v_add_u32 v12, v12, v13
  v_lshlrev_b32 v4, 4, v12
  v_mov_b32 v93, 0x3f803f80
  v_mov_b32 v95, 0x3f803f80
  v_mov_b32 v81, 0
  v_mov_b32 v113, 2
  v_mov_b32 v48, 0
  v_mov_b32 v49, 0
  v_mov_b32 v50, 0
  v_mov_b32 v51, 0
  v_mov_b32 v52, 0
  v_mov_b32 v53, 0
  v_mov_b32 v54, 0
  v_mov_b32 v55, 0
  v_mov_b32 v56, 0
  v_mov_b32 v57, 0
  v_mov_b32 v58, 0
  v_mov_b32 v59, 0
  v_mov_b32 v60, 0
  v_mov_b32 v61, 0
  v_mov_b32 v62, 0
  v_mov_b32 v63, 0
  s_cmp_eq_u32 s33, 1
  s_cbranch_scc1 L_nowait
  s_cmp_eq_u32 s34, 1
  s_cbranch_scc1 L_bwait
  s_waitcnt vmcnt(0)
  s_branch L_nowait
L_bwait:
  s_waitcnt vmcnt(7)
  v_mov_b32 v13, 1
  ds_add_u32 v5, v13 offset:24
L_nowait:
  v_cmp_gt_u32 vcc, 32, v0
  v_mov_b32 v12, 0
  s_mov_b32 s21, 0xffff0000
  v_cndmask_b32 v80, 0, v80, vcc
  v_lshlrev_b32 v13, 16, v76
  v_and_b32 v14, s21, v76
  v_add_f32 v12, |v13|, v12
  v_add_f32 v12, |v14|, v12
  v_lshlrev_b32 v13, 16, v77
  v_and_b32 v14, s21, v77
  v_add_f32 v12, |v13|, v12
  v_add_f32 v12, |v14|, v12
  v_lshlrev_b32 v13, 16, v78
  v_and_b32 v14, s21, v78
  v_add_f32 v12, |v13|, v12
  v_add_f32 v12, |v14|, v12
  v_lshlrev_b32 v13, 16, v79
  v_and_b32 v14, s21, v79
  v_add_f32 v12, |v13|, v12
  v_add_f32 v12, |v14|, v12
  v_lshlrev_b32 v13, 16, v80
  v_and_b32 v14, s21, v80
  v_add_f32 v12, |v13|, v12
  v_add_f32 v12, |v14|, v12
  v_mov_b32 v13, v12
  v_mov_b32 v11, v82
  s_nop 0
  v_permlane32_swap_b32 v13, v12
  s_nop 1
  v_add_f32 v12, v12, v13
  s_nop 1
  v_max_f32_dpp v11, v11, v11 row_shr:1 row_mask:0xf bank_mask:0xf
  s_nop 1
  v_max_f32_dpp v11, v11, v11 row_shr:2 row_mask:0xf bank_mask:0xf
  s_nop 1
  v_max_f32_dpp v11, v11, v11 row_shr:4 row_mask:0xf bank_mask:0xf
  s_nop 1
  v_max_f32_dpp v11, v11, v11 row_shr:8 row_mask:0xf bank_mask:0xf
  s_nop 1
  v_max_f32_dpp v11, v11, v11 row_bcast:15 row_mask:0xa bank_mask:0xf
  s_nop 1
  v_max_f32_dpp v11, v11, v11 row_bcast:31 row_mask:0xc bank_mask:0xf
  s_nop 1
  v_readlane_b32 s21, v11, 63
  s_nop 1
  s_mov_b32 s38, s21
  v_mul_f32 v12, s38, v12
  v_mov_b32 v13, 0x42700000
  v_mov_b32 v14, s38
  v_cmp_nlt_f32 vcc, v12, v13
  v_mov_b32 v13, 0x4e800000
  s_nop 0
  v_cmp_nlt_f32 s[22:23], v14, v13
  s_nop 1
  s_or_b64 vcc, vcc, s[22:23]
  s_mov_b64 s[26:27], vcc
  s_cmp_eq_u64 s[26:27], 0
  s_cselect_b32 s39, s39, 99
  s_cmp_eq_u32 s42, 0
  s_cbranch_scc1 L_nohc
  v_cmp_gt_u32 vcc, 32, v0
  v_mov_b32 v12, 0
  s_mov_b32 s21, 0xffff0000
  v_cndmask_b32 v120, 0, v120, vcc
  v_lshlrev_b32 v13, 16, v116
  v_and_b32 v14, s21, v116
  v_add_f32 v12, |v13|, v12
  v_add_f32 v12, |v14|, v12
  v_lshlrev_b32 v13, 16, v117
  v_and_b32 v14, s21, v117
  v_add_f32 v12, |v13|, v12
  v_add_f32 v12, |v14|, v12
  v_lshlrev_b32 v13, 16, v118
  v_and_b32 v14, s21, v118
  v_add_f32 v12, |v13|, v12
  v_add_f32 v12, |v14|, v12
  v_lshlrev_b32 v13, 16, v119
  v_and_b32 v14, s21, v119
  v_add_f32 v12, |v13|, v12
  v_add_f32 v12, |v14|, v12
  v_lshlrev_b32 v13, 16, v120
  v_and_b32 v14, s21, v120
  v_add_f32 v12, |v13|, v12
  v_add_f32 v12, |v14|, v12
  v_mov_b32 v13, v12
  s_nop 1
  v_permlane32_swap_b32 v13, v12
  s_nop 1
  v_add_f32 v12, v12, v13
  v_mul_f32 v12, s38, v12
  v_mov_b32 v13, 0x42700000
  v_mov_b32 v14, s38
  v_cmp_nlt_f32 vcc, v12, v13
  v_mov_b32 v13, 0x4e800000
  s_nop 0
  v_cmp_nlt_f32 s[22:23], v14, v13
  s_nop 1
  s_or_b64 vcc, vcc, s[22:23]
  s_cmp_eq_u64 vcc, 0
  s_cselect_b32 s42, 1, 0
L_nohc:
L_poll_17:
  ds_read_b32 v13, v5 offset:24
  s_waitcnt lgkmcnt(0)
  v_readfirstlane_b32 s21, v13
  s_nop 0
  s_cmp_lt_u32 s21, 0x100
  s_cbranch_scc1 L_poll_17
  s_sub_u32 s30, s16, 2
  s_mul_i32 s30, s30, 19456
  s_add_u32 s29, s30, 37888
  s_cmp_eq_u64 s[26:27], 0
  s_cbranch_scc1 L_fast_16
  s_cmp_eq_u32 s34, 0
  s_cbranch_scc1 L_fbnb_20
  s_waitcnt vmcnt(0)
  v_mov_b32 v13, 1
  ds_add_u32 v5, v13
  s_mov_b32 s34, 0
L_fbnb_20:
  s_cmp_eq_u32 s18, 0
  s_cbranch_scc1 L_fbnl_18
  s_mov_b32 s24, 37888
  v_mov_b32 v13, v5
L_fbld_19:
  s_add_u32 s31, s24, 36864
  s_add_u32 s22, s29, 0
  s_mov_b32 m0, s22
  s_add_u32 s23, s22, 0x240000
  buffer_load_dwordx4 v83, s[8:11], s23 offen lds
  s_add_u32 s22, s29, 1024
  s_mov_b32 m0, s22
  s_add_u32 s23, s22, 0x240000
  buffer_load_dwordx4 v83, s[8:11], s23 offen lds
  s_add_u32 s22, s29, 2048
  s_mov_b32 m0, s22
  s_add_u32 s23, s22, 0x240000
  buffer_load_dwordx4 v83, s[8:11], s23 offen lds
  s_add_u32 s22, s29, 3072
  s_mov_b32 m0, s22
  s_add_u32 s23, s22, 0x240000
  buffer_load_dwordx4 v83, s[8:11], s23 offen lds
  s_add_u32 s22, s29, 4096
  s_mov_b32 m0, s22
  s_add_u32 s23, s22, 0x240000
  buffer_load_dwordx4 v83, s[8:11], s23 offen lds
  s_add_u32 s22, s29, 5120
  s_mov_b32 m0, s22
  s_add_u32 s23, s22, 0x240000
  buffer_load_dwordx4 v83, s[8:11], s23 offen lds
  s_add_u32 s22, s29, 6144
  s_mov_b32 m0, s22
  s_add_u32 s23, s22, 0x240000
  buffer_load_dwordx4 v83, s[8:11], s23 offen lds
  s_add_u32 s22, s29, 7168
  s_mov_b32 m0, s22
  s_add_u32 s23, s22, 0x240000
  buffer_load_dwordx4 v83, s[8:11], s23 offen lds
  s_add_u32 s22, s29, 8192
  s_mov_b32 m0, s22
  s_add_u32 s23, s22, 0x240000
  buffer_load_dwordx4 v83, s[8:11], s23 offen lds
  s_add_u32 s22, s29, 9216
  s_mov_b32 m0, s22
  s_add_u32 s23, s22, 0x240000
  buffer_load_dwordx4 v83, s[8:11], s23 offen lds
  s_add_u32 s22, s29, 10240
  s_mov_b32 m0, s22
  s_add_u32 s23, s22, 0x240000
  buffer_load_dwordx4 v83, s[8:11], s23 offen lds
  s_add_u32 s22, s29, 11264
  s_mov_b32 m0, s22
  s_add_u32 s23, s22, 0x240000
  buffer_load_dwordx4 v83, s[8:11], s23 offen lds
  s_add_u32 s22, s29, 12288
  s_mov_b32 m0, s22
  s_add_u32 s23, s22, 0x240000
  buffer_load_dwordx4 v83, s[8:11], s23 offen lds
  s_add_u32 s22, s29, 13312
  s_mov_b32 m0, s22
  s_add_u32 s23, s22, 0x240000
  buffer_load_dwordx4 v83, s[8:11], s23 offen lds
  s_add_u32 s22, s29, 14336
  s_mov_b32 m0, s22
  s_add_u32 s23, s22, 0x240000
  buffer_load_dwordx4 v83, s[8:11], s23 offen lds
  s_add_u32 s22, s29, 15360
  s_mov_b32 m0, s22
  s_add_u32 s23, s22, 0x240000
  buffer_load_dwordx4 v83, s[8:11], s23 offen lds
  s_add_u32 s22, s29, 16384
  s_mov_b32 m0, s22
  s_add_u32 s23, s22, 0x240000
  buffer_load_dwordx4 v83, s[8:11], s23 offen lds
  s_add_u32 s22, s29, 17408
  s_mov_b32 m0, s22
  s_add_u32 s23, s22, 0x240000
  buffer_load_dwordx4 v83, s[8:11], s23 offen lds
  s_add_u32 s22, s29, 18432
  s_min_u32 s22, s22, s31
  s_mov_b32 m0, s22
  s_add_u32 s23, s22, 0x240000
  buffer_load_dwordx4 v83, s[8:11], s23 offen lds
  s_waitcnt vmcnt(0)
  v_add_u32 v13, 4, v13
  s_nop 0
  ds_add_u32 v13, v113
  s_add_u32 s29, s29, 37888
  s_add_u32 s24, s24, 37888
  s_cmp_lt_u32 s24, 151552
  s_cbranch_scc1 L_fbld_19
  s_mov_b32 s18, 0
L_fbnl_18:
L_poll_21:
  ds_read_b32 v13, v5 offset:0
  s_waitcnt lgkmcnt(0)
  v_readfirstlane_b32 s21, v13
  s_nop 0
  s_cmp_lt_u32 s21, 0x100
  s_cbranch_scc1 L_poll_21
L_poll_22:
  ds_read_b32 v13, v5 offset:4
  s_waitcnt lgkmcnt(0)
  v_readfirstlane_b32 s21, v13
  s_nop 0
  s_cmp_lt_u32 s21, 0x100
  s_cbranch_scc1 L_poll_22
L_poll_23:
  ds_read_b32 v13, v5 offset:8
  s_waitcnt lgkmcnt(0)
  v_readfirstlane_b32 s21, v13
  s_nop 0
  s_cmp_lt_u32 s21, 0x100
  s_cbranch_scc1 L_poll_23
L_poll_24:
  ds_read_b32 v13, v5 offset:12
  s_waitcnt lgkmcnt(0)
  v_readfirstlane_b32 s21, v13
  s_nop 0
  s_cmp_lt_u32 s21, 0x100
  s_cbranch_scc1 L_poll_24
  v_mov_b32 v12, 0xff7fffff
  v_mov_b32 v14, v2
  v_mov_b32 v15, v3
  s_mov_b32 s20, 0
L_fbt_25:
  ds_read_b128 v[84:87], v14
  ds_read_b32 v92, v15 offset:1024
  s_waitcnt lgkmcnt(0)
  v_mfma_f32_32x32x16_bf16 v[16:31], v[84:87], v[76:79], 0
  v_mfma_f32_32x32x8bf16_1k v[16:31], v[92:93], v[80:81], v[16:31]
  v_add_u32 v14, 2368, v14
  v_add_u32 v15, 2368, v15
  s_nop 7
  s_nop 3
  v_max3_f32 v12, v16, v17, v12
  v_max3_f32 v12, v18, v19, v12
  v_max3_f32 v12, v20, v21, v12
  v_max3_f32 v12, v22, v23, v12
  v_max3_f32 v12, v24, v25, v12
  v_max3_f32 v12, v26, v27, v12
  v_max3_f32 v12, v28, v29, v12
  v_max3_f32 v12, v30, v31, v12
  s_add_u32 s20, s20, 1
  s_cmp_lt_u32 s20, 64
  s_cbranch_scc1 L_fbt_25
  v_mov_b32 v13, v12
  s_nop 1
  v_permlane32_swap_b32 v13, v12
  s_nop 1
  v_max_f32 v12, v12, v13
  v_xor_b32 v12, 0x80000000, v12
  v_and_b32 v13, 0xffff0000, v12
  v_sub_f32 v14, v12, v13
  v_lshrrev_b32 v13, 16, v13
  v_and_b32 v14, 0xffff0000, v14
  v_or_b32 v13, v13, v14
  v_cmp_gt_u32 vcc, 32, v0
  s_nop 1
  v_cndmask_b32 v81, 0, v13, vcc
L_fast_16:
  ds_read_b128 v[84:87], v2 offset:0
  ds_read_b32 v92, v3 offset:1024
  ds_read_b128 v[88:91], v2 offset:2368
  ds_read_b32 v94, v3 offset:3392
  ds_read_b128 v[96:99], v4 offset:1152
  ds_read_b128 v[100:103], v4 offset:1760
  s_cmp_lt_u32 s16, 4
  s_cselect_b64 vcc, -1, 0
  s_cmp_eq_u32 s33, 1
  s_cselect_b64 vcc, 0, vcc
  v_mov_b32 v108, 0
  v_mov_b32 v68, 0
  v_mov_b32 v109, 0
  v_mov_b32 v69, 0
  v_mov_b32 v110, 0
  v_mov_b32 v70, 0
  v_mov_b32 v111, 0
  v_mov_b32 v71, 0
  v_mov_b32 v73, 0
  v_mov_b32 v114, v5
  s_waitcnt lgkmcnt(0)
  v_mfma_f32_32x32x16_bf16 v[16:31], v[84:87], v[76:79], 0
  v_mfma_f32_32x32x8bf16_1k v[16:31], v[92:93], v[80:81], v[16:31]
  s_mov_b32 s17, 0
  s_mov_b32 s31, 74752
  v_add_u32 v5, 4, v5
  s_nop 7
  s_nop 3
L_chunk_26:
  s_cmp_eq_u32 s17, 3
  s_cselect_b32 s51, s39, 99
  s_cmp_ge_u32 s16, 4
  s_cbranch_scc1 L_pr_27
  s_cmp_lt_u32 s17, 3
  s_cbranch_scc1 L_pr_28
  s_cmp_eq_u32 s33, 0
  s_cbranch_scc1 L_pr_27
L_pr_28:
  s_setprio 2
L_pr_27:
  s_cmp_eq_u32 s18, 0
  s_cbranch_scc1 L_dm_29
  s_add_u32 s22, s29, 0
  s_mov_b32 m0, s22
  s_add_u32 s23, s22, 0x240000
  buffer_load_dwordx4 v83, s[8:11], s23 offen lds
  s_add_u32 s22, s29, 1024
  s_mov_b32 m0, s22
  s_add_u32 s23, s22, 0x240000
  buffer_load_dwordx4 v83, s[8:11], s23 offen lds
  s_add_u32 s22, s29, 2048
  s_mov_b32 m0, s22
  s_add_u32 s23, s22, 0x240000
  buffer_load_dwordx4 v83, s[8:11], s23 offen lds
  s_add_u32 s22, s29, 3072
  s_mov_b32 m0, s22
  s_add_u32 s23, s22, 0x240000
  buffer_load_dwordx4 v83, s[8:11], s23 offen lds
L_dm_29:
  v_exp_f32 v72, v16
  v_mov_b32_sdwa v71, v73 dst_sel:WORD_0 dst_unused:UNUSED_PRESERVE src0_sel:WORD_1
  v_exp_f32 v64, v17
  v_exp_f32 v73, v18
  v_mfma_f32_32x32x16_bf16 v[48:63], v[108:111], v[68:71], v[48:63]
  ds_read_b128 v[104:107], v4 offset:3520
  ds_read_b128 v[108:111], v4 offset:4128
  v_mov_b32_sdwa v64, v72 dst_sel:WORD_0 dst_unused:UNUSED_PRESERVE src0_sel:WORD_1
  v_exp_f32 v65, v19
  v_exp_f32 v72, v20
  v_mov_b32_sdwa v65, v73 dst_sel:WORD_0 dst_unused:UNUSED_PRESERVE src0_sel:WORD_1
  v_exp_f32 v66, v21
  s_waitcnt lgkmcnt(2)
  v_mfma_f32_32x32x16_bf16 v[32:47], v[88:91], v[76:79], 0
  v_exp_f32 v73, v22
  ds_read_b128 v[84:87], v2 offset:4736
  ds_read_b32 v92, v3 offset:5760
  v_mov_b32_sdwa v66, v72 dst_sel:WORD_0 dst_unused:UNUSED_PRESERVE src0_sel:WORD_1
  v_exp_f32 v67, v23
  v_exp_f32 v72, v24
  v_mov_b32_sdwa v67, v73 dst_sel:WORD_0 dst_unused:UNUSED_PRESERVE src0_sel:WORD_1
  v_exp_f32 v68, v25
  v_mfma_f32_32x32x8bf16_1k v[32:47], v[94:95], v[80:81], v[32:47]
  v_exp_f32 v73, v26
  v_mov_b32_sdwa v68, v72 dst_sel:WORD_0 dst_unused:UNUSED_PRESERVE src0_sel:WORD_1
  v_exp_f32 v69, v27
  v_exp_f32 v72, v28
  v_mov_b32_sdwa v69, v73 dst_sel:WORD_0 dst_unused:UNUSED_PRESERVE src0_sel:WORD_1
  v_exp_f32 v70, v29
  v_mfma_f32_32x32x16_bf16 v[48:63], v[96:99], v[64:67], v[48:63]
  v_exp_f32 v73, v30
  v_mov_b32_sdwa v70, v72 dst_sel:WORD_0 dst_unused:UNUSED_PRESERVE src0_sel:WORD_1
  v_exp_f32 v71, v31
  s_cmp_eq_u32 s18, 0
  s_cbranch_scc1 L_dm_30
  s_add_u32 s22, s29, 4096
  s_mov_b32 m0, s22
  s_add_u32 s23, s22, 0x240000
  buffer_load_dwordx4 v83, s[8:11], s23 offen lds
  s_add_u32 s22, s29, 5120
  s_mov_b32 m0, s22
  s_add_u32 s23, s22, 0x240000
  buffer_load_dwordx4 v83, s[8:11], s23 offen lds
  s_add_u32 s22, s29, 6144
  s_mov_b32 m0, s22
  s_add_u32 s23, s22, 0x240000
  buffer_load_dwordx4 v83, s[8:11], s23 offen lds
  s_add_u32 s22, s29, 7168
  s_mov_b32 m0, s22
  s_add_u32 s23, s22, 0x240000
  buffer_load_dwordx4 v83, s[8:11], s23 offen lds
L_dm_30:
  s_cmp_eq_u32 s34, 0
  s_cbranch_scc1 L_s0_31
  s_waitcnt vmcnt(0)
  v_mov_b32 v13, 1
  ds_add_u32 v114, v13
  s_mov_b32 s34, 0
L_s0_31:
  v_exp_f32 v72, v32
  v_mov_b32_sdwa v71, v73 dst_sel:WORD_0 dst_unused:UNUSED_PRESERVE src0_sel:WORD_1
  v_exp_f32 v64, v33
  v_exp_f32 v73, v34
  v_mfma_f32_32x32x16_bf16 v[48:63], v[100:103], v[68:71], v[48:63]
  ds_read_b128 v[96:99], v4 offset:5888
  ds_read_b128 v[100:103], v4 offset:6496
  v_mov_b32_sdwa v64, v72 dst_sel:WORD_0 dst_unused:UNUSED_PRESERVE src0_sel:WORD_1
  v_exp_f32 v65, v35
  v_exp_f32 v72, v36
  v_mov_b32_sdwa v65, v73 dst_sel:WORD_0 dst_unused:UNUSED_PRESERVE src0_sel:WORD_1
  v_exp_f32 v66, v37
  s_waitcnt lgkmcnt(2)
  v_mfma_f32_32x32x16_bf16 v[16:31], v[84:87], v[76:79], 0
  v_exp_f32 v73, v38
  ds_read_b128 v[88:91], v2 offset:7104
  ds_read_b32 v94, v3 offset:8128
  v_mov_b32_sdwa v66, v72 dst_sel:WORD_0 dst_unused:UNUSED_PRESERVE src0_sel:WORD_1
  v_exp_f32 v67, v39
  v_exp_f32 v72, v40
  v_mov_b32_sdwa v67, v73 dst_sel:WORD_0 dst_unused:UNUSED_PRESERVE src0_sel:WORD_1
  v_exp_f32 v68, v41
  v_mfma_f32_32x32x8bf16_1k v[16:31], v[92:93], v[80:81], v[16:31]
  v_exp_f32 v73, v42
  v_mov_b32_sdwa v68, v72 dst_sel:WORD_0 dst_unused:UNUSED_PRESERVE src0_sel:WORD_1
  v_exp_f32 v69, v43
  v_exp_f32 v72, v44
  v_mov_b32_sdwa v69, v73 dst_sel:WORD_0 dst_unused:UNUSED_PRESERVE src0_sel:WORD_1
  v_exp_f32 v70, v45
  v_mfma_f32_32x32x16_bf16 v[48:63], v[104:107], v[64:67], v[48:63]
  v_exp_f32 v73, v46
  v_mov_b32_sdwa v70, v72 dst_sel:WORD_0 dst_unused:UNUSED_PRESERVE src0_sel:WORD_1
  v_exp_f32 v71, v47
  s_cmp_eq_u32 s18, 0
  s_cbranch_scc1 L_dm_32
  s_add_u32 s22, s29, 8192
  s_mov_b32 m0, s22
  s_add_u32 s23, s22, 0x240000
  buffer_load_dwordx4 v83, s[8:11], s23 offen lds
  s_add_u32 s22, s29, 9216
  s_mov_b32 m0, s22
  s_add_u32 s23, s22, 0x240000
  buffer_load_dwordx4 v83, s[8:11], s23 offen lds
  s_add_u32 s22, s29, 10240
  s_mov_b32 m0, s22
  s_add_u32 s23, s22, 0x240000
  buffer_load_dwordx4 v83, s[8:11], s23 offen lds
  s_add_u32 s22, s29, 11264
  s_mov_b32 m0, s22
  s_add_u32 s23, s22, 0x240000
  buffer_load_dwordx4 v83, s[8:11], s23 offen lds
L_dm_32:
  s_cmp_eq_u32 s37, 0
  s_cbranch_scc1 L_zs_33
  buffer_store_dwordx4 v[176:179], v244, s[8:11], s35 offen
L_zs_33:
  v_exp_f32 v72, v16
  v_mov_b32_sdwa v71, v73 dst_sel:WORD_0 dst_unused:UNUSED_PRESERVE src0_sel:WORD_1
  v_exp_f32 v64, v17
  v_exp_f32 v73, v18
  v_mfma_f32_32x32x16_bf16 v[48:63], v[108:111], v[68:71], v[48:63]
  ds_read_b128 v[104:107], v4 offset:8256
  ds_read_b128 v[108:111], v4 offset:8864
  v_mov_b32_sdwa v64, v72 dst_sel:WORD_0 dst_unused:UNUSED_PRESERVE src0_sel:WORD_1
  v_exp_f32 v65, v19
  v_exp_f32 v72, v20
  v_mov_b32_sdwa v65, v73 dst_sel:WORD_0 dst_unused:UNUSED_PRESERVE src0_sel:WORD_1
  v_exp_f32 v66, v21
  s_waitcnt lgkmcnt(2)
  v_mfma_f32_32x32x16_bf16 v[32:47], v[88:91], v[76:79], 0
  v_exp_f32 v73, v22
  ds_read_b128 v[84:87], v2 offset:9472
  ds_read_b32 v92, v3 offset:10496
  ds_read_b32 v112, v114
  v_mov_b32_sdwa v66, v72 dst_sel:WORD_0 dst_unused:UNUSED_PRESERVE src0_sel:WORD_1
  v_exp_f32 v67, v23
  v_exp_f32 v72, v24
  v_mov_b32_sdwa v67, v73 dst_sel:WORD_0 dst_unused:UNUSED_PRESERVE src0_sel:WORD_1
  v_exp_f32 v68, v25
  v_mfma_f32_32x32x8bf16_1k v[32:47], v[94:95], v[80:81], v[32:47]
  v_exp_f32 v73, v26
  v_mov_b32_sdwa v68, v72 dst_sel:WORD_0 dst_unused:UNUSED_PRESERVE src0_sel:WORD_1
  v_exp_f32 v69, v27
  v_exp_f32 v72, v28
  v_mov_b32_sdwa v69, v73 dst_sel:WORD_0 dst_unused:UNUSED_PRESERVE src0_sel:WORD_1
  v_exp_f32 v70, v29
  v_mfma_f32_32x32x16_bf16 v[48:63], v[96:99], v[64:67], v[48:63]
  v_exp_f32 v73, v30
  v_mov_b32_sdwa v70, v72 dst_sel:WORD_0 dst_unused:UNUSED_PRESERVE src0_sel:WORD_1
  v_exp_f32 v71, v31
  s_cmp_eq_u32 s18, 0
  s_cbranch_scc1 L_dm_34
  s_add_u32 s22, s29, 12288
  s_mov_b32 m0, s22
  s_add_u32 s23, s22, 0x240000
  buffer_load_dwordx4 v83, s[8:11], s23 offen lds
  s_add_u32 s22, s29, 13312
  s_mov_b32 m0, s22
  s_add_u32 s23, s22, 0x240000
  buffer_load_dwordx4 v83, s[8:11], s23 offen lds
  s_add_u32 s22, s29, 14336
  s_mov_b32 m0, s22
  s_add_u32 s23, s22, 0x240000
  buffer_load_dwordx4 v83, s[8:11], s23 offen lds
  s_add_u32 s22, s29, 15360
  s_mov_b32 m0, s22
  s_add_u32 s23, s22, 0x240000
  buffer_load_dwordx4 v83, s[8:11], s23 offen lds
L_dm_34:
  s_cmp_eq_u32 s37, 0
  s_cbranch_scc1 L_zs_35
  buffer_store_dwordx4 v[180:183], v245, s[8:11], s35 offen
L_zs_35:
  v_exp_f32 v72, v32
  v_mov_b32_sdwa v71, v73 dst_sel:WORD_0 dst_unused:UNUSED_PRESERVE src0_sel:WORD_1
  v_exp_f32 v64, v33
  v_exp_f32 v73, v34
  v_mfma_f32_32x32x16_bf16 v[48:63], v[100:103], v[68:71], v[48:63]
  ds_read_b128 v[96:99], v4 offset:10624
  ds_read_b128 v[100:103], v4 offset:11232
  v_mov_b32_sdwa v64, v72 dst_sel:WORD_0 dst_unused:UNUSED_PRESERVE src0_sel:WORD_1
  v_exp_f32 v65, v35
  v_exp_f32 v72, v36
  v_mov_b32_sdwa v65, v73 dst_sel:WORD_0 dst_unused:UNUSED_PRESERVE src0_sel:WORD_1
  v_exp_f32 v66, v37
  s_waitcnt lgkmcnt(2)
  v_readfirstlane_b32 s21, v112
  s_nop 0
  s_cmp_ge_u32 s21, 0x100
  s_cbranch_scc1 L_pk_36
L_pks_37:
  ds_read_b32 v112, v114
  s_waitcnt lgkmcnt(0)
  v_readfirstlane_b32 s21, v112
  s_nop 0
  s_cmp_lt_u32 s21, 0x100
  s_cbranch_scc1 L_pks_37
L_pk_36:
  v_mfma_f32_32x32x16_bf16 v[16:31], v[84:87], v[76:79], 0
  v_exp_f32 v73, v38
  ds_read_b128 v[88:91], v2 offset:11840
  ds_read_b32 v94, v3 offset:12864
  v_mov_b32_sdwa v66, v72 dst_sel:WORD_0 dst_unused:UNUSED_PRESERVE src0_sel:WORD_1
  v_exp_f32 v67, v39
  v_exp_f32 v72, v40
  v_mov_b32_sdwa v67, v73 dst_sel:WORD_0 dst_unused:UNUSED_PRESERVE src0_sel:WORD_1
  v_exp_f32 v68, v41
  v_mfma_f32_32x32x8bf16_1k v[16:31], v[92:93], v[80:81], v[16:31]
  v_exp_f32 v73, v42
  v_mov_b32_sdwa v68, v72 dst_sel:WORD_0 dst_unused:UNUSED_PRESERVE src0_sel:WORD_1
  v_exp_f32 v69, v43
  v_exp_f32 v72, v44
  v_mov_b32_sdwa v69, v73 dst_sel:WORD_0 dst_unused:UNUSED_PRESERVE src0_sel:WORD_1
  v_exp_f32 v70, v45
  v_mfma_f32_32x32x16_bf16 v[48:63], v[104:107], v[64:67], v[48:63]
  v_exp_f32 v73, v46
  v_mov_b32_sdwa v70, v72 dst_sel:WORD_0 dst_unused:UNUSED_PRESERVE src0_sel:WORD_1
  v_exp_f32 v71, v47
L_tile_4:
  s_cmp_eq_u32 s51, 4
  s_cbranch_scc1 L_post
  s_cmp_eq_u32 s18, 0
  s_cbranch_scc1 L_dm_38
  s_add_u32 s22, s29, 16384
  s_mov_b32 m0, s22
  s_add_u32 s23, s22, 0x240000
  buffer_load_dwordx4 v83, s[8:11], s23 offen lds
  s_add_u32 s22, s29, 17408
  s_mov_b32 m0, s22
  s_add_u32 s23, s22, 0x240000
  buffer_load_dwordx4 v83, s[8:11], s23 offen lds
  s_add_u32 s22, s29, 18432
  s_min_u32 s22, s22, s31
  s_mov_b32 m0, s22
  s_add_u32 s23, s22, 0x240000
  buffer_load_dwordx4 v83, s[8:11], s23 offen lds
L_dm_38:
  s_cmp_eq_u32 s37, 0
  s_cbranch_scc1 L_zs_39
  buffer_store_dwordx4 v[184:187], v246, s[8:11], s35 offen
L_zs_39:
  v_exp_f32 v72, v16
  v_mov_b32_sdwa v71, v73 dst_sel:WORD_0 dst_unused:UNUSED_PRESERVE src0_sel:WORD_1
  v_exp_f32 v64, v17
  v_exp_f32 v73, v18
  v_mfma_f32_32x32x16_bf16 v[48:63], v[108:111], v[68:71], v[48:63]
  ds_read_b128 v[104:107], v4 offset:12992
  ds_read_b128 v[108:111], v4 offset:13600
  v_mov_b32_sdwa v64, v72 dst_sel:WORD_0 dst_unused:UNUSED_PRESERVE src0_sel:WORD_1
  v_exp_f32 v65, v19
  v_exp_f32 v72, v20
  v_mov_b32_sdwa v65, v73 dst_sel:WORD_0 dst_unused:UNUSED_PRESERVE src0_sel:WORD_1
  v_exp_f32 v66, v21
  s_waitcnt lgkmcnt(2)
  v_mfma_f32_32x32x16_bf16 v[32:47], v[88:91], v[76:79], 0
  v_exp_f32 v73, v22
  ds_read_b128 v[84:87], v2 offset:14208
  ds_read_b32 v92, v3 offset:15232
  v_mov_b32_sdwa v66, v72 dst_sel:WORD_0 dst_unused:UNUSED_PRESERVE src0_sel:WORD_1
  v_exp_f32 v67, v23
  v_exp_f32 v72, v24
  v_mov_b32_sdwa v67, v73 dst_sel:WORD_0 dst_unused:UNUSED_PRESERVE src0_sel:WORD_1
  v_exp_f32 v68, v25
  v_mfma_f32_32x32x8bf16_1k v[32:47], v[94:95], v[80:81], v[32:47]
  v_exp_f32 v73, v26
  v_mov_b32_sdwa v68, v72 dst_sel:WORD_0 dst_unused:UNUSED_PRESERVE src0_sel:WORD_1
  v_exp_f32 v69, v27
  v_exp_f32 v72, v28
  v_mov_b32_sdwa v69, v73 dst_sel:WORD_0 dst_unused:UNUSED_PRESERVE src0_sel:WORD_1
  v_exp_f32 v70, v29
  v_mfma_f32_32x32x16_bf16 v[48:63], v[96:99], v[64:67], v[48:63]
  v_exp_f32 v73, v30
  v_mov_b32_sdwa v70, v72 dst_sel:WORD_0 dst_unused:UNUSED_PRESERVE src0_sel:WORD_1
  v_exp_f32 v71, v31
  s_cmp_eq_u32 s37, 0
  s_cbranch_scc1 L_zs_40
  buffer_store_dwordx4 v[188:191], v247, s[8:11], s35 offen
L_zs_40:
  v_exp_f32 v72, v32
  v_mov_b32_sdwa v71, v73 dst_sel:WORD_0 dst_unused:UNUSED_PRESERVE src0_sel:WORD_1
  v_exp_f32 v64, v33
  v_exp_f32 v73, v34
  v_mfma_f32_32x32x16_bf16 v[48:63], v[100:103], v[68:71], v[48:63]
  ds_read_b128 v[96:99], v4 offset:15360
  ds_read_b128 v[100:103], v4 offset:15968
  v_mov_b32_sdwa v64, v72 dst_sel:WORD_0 dst_unused:UNUSED_PRESERVE src0_sel:WORD_1
  v_exp_f32 v65, v35
  v_exp_f32 v72, v36
  v_mov_b32_sdwa v65, v73 dst_sel:WORD_0 dst_unused:UNUSED_PRESERVE src0_sel:WORD_1
  v_exp_f32 v66, v37
  s_waitcnt lgkmcnt(2)
  v_mfma_f32_32x32x16_bf16 v[16:31], v[84:87], v[76:79], 0
  v_exp_f32 v73, v38
  ds_read_b128 v[88:91], v2 offset:16576
  ds_read_b32 v94, v3 offset:17600
  v_mov_b32_sdwa v66, v72 dst_sel:WORD_0 dst_unused:UNUSED_PRESERVE src0_sel:WORD_1
  v_exp_f32 v67, v39
  v_exp_f32 v72, v40
  v_mov_b32_sdwa v67, v73 dst_sel:WORD_0 dst_unused:UNUSED_PRESERVE src0_sel:WORD_1
  v_exp_f32 v68, v41
  v_mfma_f32_32x32x8bf16_1k v[16:31], v[92:93], v[80:81], v[16:31]
  v_exp_f32 v73, v42
  v_mov_b32_sdwa v68, v72 dst_sel:WORD_0 dst_unused:UNUSED_PRESERVE src0_sel:WORD_1
  v_exp_f32 v69, v43
  v_exp_f32 v72, v44
  v_mov_b32_sdwa v69, v73 dst_sel:WORD_0 dst_unused:UNUSED_PRESERVE src0_sel:WORD_1
  v_exp_f32 v70, v45
  v_mfma_f32_32x32x16_bf16 v[48:63], v[104:107], v[64:67], v[48:63]
  v_exp_f32 v73, v46
  v_mov_b32_sdwa v70, v72 dst_sel:WORD_0 dst_unused:UNUSED_PRESERVE src0_sel:WORD_1
  v_exp_f32 v71, v47
  s_cmp_eq_u32 s37, 0
  s_cbranch_scc1 L_zs_41
  buffer_store_dwordx4 v[192:195], v244, s[8:11], s36 offen
L_zs_41:
  v_exp_f32 v72, v16
  v_mov_b32_sdwa v71, v73 dst_sel:WORD_0 dst_unused:UNUSED_PRESERVE src0_sel:WORD_1
  v_exp_f32 v64, v17
  v_exp_f32 v73, v18
  v_mfma_f32_32x32x16_bf16 v[48:63], v[108:111], v[68:71], v[48:63]
  ds_read_b128 v[104:107], v4 offset:17728
  ds_read_b128 v[108:111], v4 offset:18336
  v_mov_b32_sdwa v64, v72 dst_sel:WORD_0 dst_unused:UNUSED_PRESERVE src0_sel:WORD_1
  v_exp_f32 v65, v19
  v_exp_f32 v72, v20
  v_mov_b32_sdwa v65, v73 dst_sel:WORD_0 dst_unused:UNUSED_PRESERVE src0_sel:WORD_1
  v_exp_f32 v66, v21
  s_waitcnt lgkmcnt(2)
  v_mfma_f32_32x32x16_bf16 v[32:47], v[88:91], v[76:79], 0
  v_exp_f32 v73, v22
  ds_read_b128 v[84:87], v2 offset:18944
  ds_read_b32 v92, v3 offset:19968
  v_mov_b32_sdwa v66, v72 dst_sel:WORD_0 dst_unused:UNUSED_PRESERVE src0_sel:WORD_1
  v_exp_f32 v67, v23
  v_exp_f32 v72, v24
  v_mov_b32_sdwa v67, v73 dst_sel:WORD_0 dst_unused:UNUSED_PRESERVE src0_sel:WORD_1
  v_exp_f32 v68, v25
  v_mfma_f32_32x32x8bf16_1k v[32:47], v[94:95], v[80:81], v[32:47]
  v_exp_f32 v73, v26
  v_mov_b32_sdwa v68, v72 dst_sel:WORD_0 dst_unused:UNUSED_PRESERVE src0_sel:WORD_1
  v_exp_f32 v69, v27
  v_exp_f32 v72, v28
  v_mov_b32_sdwa v69, v73 dst_sel:WORD_0 dst_unused:UNUSED_PRESERVE src0_sel:WORD_1
  v_exp_f32 v70, v29
  v_mfma_f32_32x32x16_bf16 v[48:63], v[96:99], v[64:67], v[48:63]
  v_exp_f32 v73, v30
  v_mov_b32_sdwa v70, v72 dst_sel:WORD_0 dst_unused:UNUSED_PRESERVE src0_sel:WORD_1
  v_exp_f32 v71, v31
  s_cmp_eq_u32 s37, 0
  s_cbranch_scc1 L_zs_42
  buffer_store_dwordx4 v[196:199], v245, s[8:11], s36 offen
L_zs_42:
  v_exp_f32 v72, v32
  v_mov_b32_sdwa v71, v73 dst_sel:WORD_0 dst_unused:UNUSED_PRESERVE src0_sel:WORD_1
  v_exp_f32 v64, v33
  v_exp_f32 v73, v34
  v_mfma_f32_32x32x16_bf16 v[48:63], v[100:103], v[68:71], v[48:63]
  ds_read_b128 v[96:99], v4 offset:20096
  ds_read_b128 v[100:103], v4 offset:20704
  v_mov_b32_sdwa v64, v72 dst_sel:WORD_0 dst_unused:UNUSED_PRESERVE src0_sel:WORD_1
  v_exp_f32 v65, v35
  v_exp_f32 v72, v36
  v_mov_b32_sdwa v65, v73 dst_sel:WORD_0 dst_unused:UNUSED_PRESERVE src0_sel:WORD_1
  v_exp_f32 v66, v37
  s_waitcnt lgkmcnt(2)
  v_mfma_f32_32x32x16_bf16 v[16:31], v[84:87], v[76:79], 0
  v_exp_f32 v73, v38
  ds_read_b128 v[88:91], v2 offset:21312
  ds_read_b32 v94, v3 offset:22336
  v_mov_b32_sdwa v66, v72 dst_sel:WORD_0 dst_unused:UNUSED_PRESERVE src0_sel:WORD_1
  v_exp_f32 v67, v39
  v_exp_f32 v72, v40
  v_mov_b32_sdwa v67, v73 dst_sel:WORD_0 dst_unused:UNUSED_PRESERVE src0_sel:WORD_1
  v_exp_f32 v68, v41
  v_mfma_f32_32x32x8bf16_1k v[16:31], v[92:93], v[80:81], v[16:31]
  v_exp_f32 v73, v42
  v_mov_b32_sdwa v68, v72 dst_sel:WORD_0 dst_unused:UNUSED_PRESERVE src0_sel:WORD_1
  v_exp_f32 v69, v43
  v_exp_f32 v72, v44
  v_mov_b32_sdwa v69, v73 dst_sel:WORD_0 dst_unused:UNUSED_PRESERVE src0_sel:WORD_1
  v_exp_f32 v70, v45
  v_mfma_f32_32x32x16_bf16 v[48:63], v[104:107], v[64:67], v[48:63]
  v_exp_f32 v73, v46
  v_mov_b32_sdwa v70, v72 dst_sel:WORD_0 dst_unused:UNUSED_PRESERVE src0_sel:WORD_1
  v_exp_f32 v71, v47
L_tile_8:
  s_cmp_eq_u32 s51, 8
  s_cbranch_scc1 L_post
  s_cmp_eq_u32 s37, 0
  s_cbranch_scc1 L_zs_43
  buffer_store_dwordx4 v[200:203], v246, s[8:11], s36 offen
L_zs_43:
  v_exp_f32 v72, v16
  v_mov_b32_sdwa v71, v73 dst_sel:WORD_0 dst_unused:UNUSED_PRESERVE src0_sel:WORD_1
  v_exp_f32 v64, v17
  v_exp_f32 v73, v18
  v_mfma_f32_32x32x16_bf16 v[48:63], v[108:111], v[68:71], v[48:63]
  ds_read_b128 v[104:107], v4 offset:22464
  ds_read_b128 v[108:111], v4 offset:23072
  v_mov_b32_sdwa v64, v72 dst_sel:WORD_0 dst_unused:UNUSED_PRESERVE src0_sel:WORD_1
  v_exp_f32 v65, v19
  v_exp_f32 v72, v20
  v_mov_b32_sdwa v65, v73 dst_sel:WORD_0 dst_unused:UNUSED_PRESERVE src0_sel:WORD_1
  v_exp_f32 v66, v21
  s_waitcnt lgkmcnt(2)
  v_mfma_f32_32x32x16_bf16 v[32:47], v[88:91], v[76:79], 0
  v_exp_f32 v73, v22
  ds_read_b128 v[84:87], v2 offset:23680
  ds_read_b32 v92, v3 offset:24704
  v_mov_b32_sdwa v66, v72 dst_sel:WORD_0 dst_unused:UNUSED_PRESERVE src0_sel:WORD_1
  v_exp_f32 v67, v23
  v_exp_f32 v72, v24
  v_mov_b32_sdwa v67, v73 dst_sel:WORD_0 dst_unused:UNUSED_PRESERVE src0_sel:WORD_1
  v_exp_f32 v68, v25
  v_mfma_f32_32x32x8bf16_1k v[32:47], v[94:95], v[80:81], v[32:47]
  v_exp_f32 v73, v26
  v_mov_b32_sdwa v68, v72 dst_sel:WORD_0 dst_unused:UNUSED_PRESERVE src0_sel:WORD_1
  v_exp_f32 v69, v27
  v_exp_f32 v72, v28
  v_mov_b32_sdwa v69, v73 dst_sel:WORD_0 dst_unused:UNUSED_PRESERVE src0_sel:WORD_1
  v_exp_f32 v70, v29
  v_mfma_f32_32x32x16_bf16 v[48:63], v[96:99], v[64:67], v[48:63]
  v_exp_f32 v73, v30
  v_mov_b32_sdwa v70, v72 dst_sel:WORD_0 dst_unused:UNUSED_PRESERVE src0_sel:WORD_1
  v_exp_f32 v71, v31
  s_cmp_eq_u32 s37, 0
  s_cbranch_scc1 L_zs_44
  buffer_store_dwordx4 v[204:207], v247, s[8:11], s36 offen
  s_mov_b32 s37, 0
L_zs_44:
  v_exp_f32 v72, v32
  v_mov_b32_sdwa v71, v73 dst_sel:WORD_0 dst_unused:UNUSED_PRESERVE src0_sel:WORD_1
  v_exp_f32 v64, v33
  v_exp_f32 v73, v34
  v_mfma_f32_32x32x16_bf16 v[48:63], v[100:103], v[68:71], v[48:63]
  ds_read_b128 v[96:99], v4 offset:24832
  ds_read_b128 v[100:103], v4 offset:25440
  v_mov_b32_sdwa v64, v72 dst_sel:WORD_0 dst_unused:UNUSED_PRESERVE src0_sel:WORD_1
  v_exp_f32 v65, v35
  v_exp_f32 v72, v36
  v_mov_b32_sdwa v65, v73 dst_sel:WORD_0 dst_unused:UNUSED_PRESERVE src0_sel:WORD_1
  v_exp_f32 v66, v37
  s_waitcnt lgkmcnt(2)
  v_mfma_f32_32x32x16_bf16 v[16:31], v[84:87], v[76:79], 0
  v_exp_f32 v73, v38
  ds_read_b128 v[88:91], v2 offset:26048
  ds_read_b32 v94, v3 offset:27072
  v_mov_b32_sdwa v66, v72 dst_sel:WORD_0 dst_unused:UNUSED_PRESERVE src0_sel:WORD_1
  v_exp_f32 v67, v39
  v_exp_f32 v72, v40
  v_mov_b32_sdwa v67, v73 dst_sel:WORD_0 dst_unused:UNUSED_PRESERVE src0_sel:WORD_1
  v_exp_f32 v68, v41
  v_mfma_f32_32x32x8bf16_1k v[16:31], v[92:93], v[80:81], v[16:31]
  v_exp_f32 v73, v42
  v_mov_b32_sdwa v68, v72 dst_sel:WORD_0 dst_unused:UNUSED_PRESERVE src0_sel:WORD_1
  v_exp_f32 v69, v43
  v_exp_f32 v72, v44
  v_mov_b32_sdwa v69, v73 dst_sel:WORD_0 dst_unused:UNUSED_PRESERVE src0_sel:WORD_1
  v_exp_f32 v70, v45
  v_mfma_f32_32x32x16_bf16 v[48:63], v[104:107], v[64:67], v[48:63]
  v_exp_f32 v73, v46
  v_mov_b32_sdwa v70, v72 dst_sel:WORD_0 dst_unused:UNUSED_PRESERVE src0_sel:WORD_1
  v_exp_f32 v71, v47
  v_exp_f32 v72, v16
  v_mov_b32_sdwa v71, v73 dst_sel:WORD_0 dst_unused:UNUSED_PRESERVE src0_sel:WORD_1
  v_exp_f32 v64, v17
  v_exp_f32 v73, v18
  v_mfma_f32_32x32x16_bf16 v[48:63], v[108:111], v[68:71], v[48:63]
  ds_read_b128 v[104:107], v4 offset:27200
  ds_read_b128 v[108:111], v4 offset:27808
  v_mov_b32_sdwa v64, v72 dst_sel:WORD_0 dst_unused:UNUSED_PRESERVE src0_sel:WORD_1
  v_exp_f32 v65, v19
  v_exp_f32 v72, v20
  v_mov_b32_sdwa v65, v73 dst_sel:WORD_0 dst_unused:UNUSED_PRESERVE src0_sel:WORD_1
  v_exp_f32 v66, v21
  s_waitcnt lgkmcnt(2)
  v_mfma_f32_32x32x16_bf16 v[32:47], v[88:91], v[76:79], 0
  v_exp_f32 v73, v22
  ds_read_b128 v[84:87], v2 offset:28416
  ds_read_b32 v92, v3 offset:29440
  v_mov_b32_sdwa v66, v72 dst_sel:WORD_0 dst_unused:UNUSED_PRESERVE src0_sel:WORD_1
  v_exp_f32 v67, v23
  v_exp_f32 v72, v24
  v_mov_b32_sdwa v67, v73 dst_sel:WORD_0 dst_unused:UNUSED_PRESERVE src0_sel:WORD_1
  v_exp_f32 v68, v25
  v_mfma_f32_32x32x8bf16_1k v[32:47], v[94:95], v[80:81], v[32:47]
  v_exp_f32 v73, v26
  v_mov_b32_sdwa v68, v72 dst_sel:WORD_0 dst_unused:UNUSED_PRESERVE src0_sel:WORD_1
  v_exp_f32 v69, v27
  v_exp_f32 v72, v28
  v_mov_b32_sdwa v69, v73 dst_sel:WORD_0 dst_unused:UNUSED_PRESERVE src0_sel:WORD_1
  v_exp_f32 v70, v29
  v_mfma_f32_32x32x16_bf16 v[48:63], v[96:99], v[64:67], v[48:63]
  v_exp_f32 v73, v30
  v_mov_b32_sdwa v70, v72 dst_sel:WORD_0 dst_unused:UNUSED_PRESERVE src0_sel:WORD_1
  v_exp_f32 v71, v31
  s_cmp_eq_u32 s18, 0
  s_cbranch_scc1 L_sg_45
  s_waitcnt vmcnt(0)
  ds_add_u32 v5, v113
  s_sub_u32 s18, s18, 1
  s_add_u32 s29, s29, 37888
  s_add_u32 s31, s31, 37888
L_sg_45:
  v_exp_f32 v72, v32
  v_mov_b32_sdwa v71, v73 dst_sel:WORD_0 dst_unused:UNUSED_PRESERVE src0_sel:WORD_1
  v_exp_f32 v64, v33
  v_exp_f32 v73, v34
  v_mfma_f32_32x32x16_bf16 v[48:63], v[100:103], v[68:71], v[48:63]
  ds_read_b128 v[96:99], v4 offset:29568
  ds_read_b128 v[100:103], v4 offset:30176
  v_mov_b32_sdwa v64, v72 dst_sel:WORD_0 dst_unused:UNUSED_PRESERVE src0_sel:WORD_1
  v_exp_f32 v65, v35
  v_exp_f32 v72, v36
  v_mov_b32_sdwa v65, v73 dst_sel:WORD_0 dst_unused:UNUSED_PRESERVE src0_sel:WORD_1
  v_exp_f32 v66, v37
  s_waitcnt lgkmcnt(2)
  v_mfma_f32_32x32x16_bf16 v[16:31], v[84:87], v[76:79], 0
  v_exp_f32 v73, v38
  ds_read_b128 v[88:91], v2 offset:30784
  ds_read_b32 v94, v3 offset:31808
  v_mov_b32_sdwa v66, v72 dst_sel:WORD_0 dst_unused:UNUSED_PRESERVE src0_sel:WORD_1
  v_exp_f32 v67, v39
  v_exp_f32 v72, v40
  v_mov_b32_sdwa v67, v73 dst_sel:WORD_0 dst_unused:UNUSED_PRESERVE src0_sel:WORD_1
  v_exp_f32 v68, v41
  v_mfma_f32_32x32x8bf16_1k v[16:31], v[92:93], v[80:81], v[16:31]
  v_exp_f32 v73, v42
  v_mov_b32_sdwa v68, v72 dst_sel:WORD_0 dst_unused:UNUSED_PRESERVE src0_sel:WORD_1
  v_exp_f32 v69, v43
  v_exp_f32 v72, v44
  v_mov_b32_sdwa v69, v73 dst_sel:WORD_0 dst_unused:UNUSED_PRESERVE src0_sel:WORD_1
  v_exp_f32 v70, v45
  v_mfma_f32_32x32x16_bf16 v[48:63], v[104:107], v[64:67], v[48:63]
  v_exp_f32 v73, v46
  v_mov_b32_sdwa v70, v72 dst_sel:WORD_0 dst_unused:UNUSED_PRESERVE src0_sel:WORD_1
  v_exp_f32 v71, v47
  s_cmp_eq_u32 s33, 0
  s_cbranch_scc1 L_pr_46
  s_setprio 0
L_pr_46:
L_tile_12:
  s_cmp_eq_u32 s51, 12
  s_cbranch_scc1 L_post
  s_cbranch_vccz L_pr_47
  s_setprio 0
L_pr_47:
  v_exp_f32 v72, v16
  v_mov_b32_sdwa v71, v73 dst_sel:WORD_0 dst_unused:UNUSED_PRESERVE src0_sel:WORD_1
  v_exp_f32 v64, v17
  v_exp_f32 v73, v18
  v_mfma_f32_32x32x16_bf16 v[48:63], v[108:111], v[68:71], v[48:63]
  ds_read_b128 v[104:107], v4 offset:31936
  ds_read_b128 v[108:111], v4 offset:32544
  v_mov_b32_sdwa v64, v72 dst_sel:WORD_0 dst_unused:UNUSED_PRESERVE src0_sel:WORD_1
  v_exp_f32 v65, v19
  v_exp_f32 v72, v20
  v_mov_b32_sdwa v65, v73 dst_sel:WORD_0 dst_unused:UNUSED_PRESERVE src0_sel:WORD_1
  v_exp_f32 v66, v21
  s_waitcnt lgkmcnt(2)
  v_mfma_f32_32x32x16_bf16 v[32:47], v[88:91], v[76:79], 0
  v_exp_f32 v73, v22
  ds_read_b128 v[84:87], v2 offset:33152
  ds_read_b32 v92, v3 offset:34176
  v_mov_b32_sdwa v66, v72 dst_sel:WORD_0 dst_unused:UNUSED_PRESERVE src0_sel:WORD_1
  v_exp_f32 v67, v23
  v_exp_f32 v72, v24
  v_mov_b32_sdwa v67, v73 dst_sel:WORD_0 dst_unused:UNUSED_PRESERVE src0_sel:WORD_1
  v_exp_f32 v68, v25
  v_mfma_f32_32x32x8bf16_1k v[32:47], v[94:95], v[80:81], v[32:47]
  v_exp_f32 v73, v26
  v_mov_b32_sdwa v68, v72 dst_sel:WORD_0 dst_unused:UNUSED_PRESERVE src0_sel:WORD_1
  v_exp_f32 v69, v27
  v_exp_f32 v72, v28
  v_mov_b32_sdwa v69, v73 dst_sel:WORD_0 dst_unused:UNUSED_PRESERVE src0_sel:WORD_1
  v_exp_f32 v70, v29
  v_mfma_f32_32x32x16_bf16 v[48:63], v[96:99], v[64:67], v[48:63]
  v_exp_f32 v73, v30
  v_mov_b32_sdwa v70, v72 dst_sel:WORD_0 dst_unused:UNUSED_PRESERVE src0_sel:WORD_1
  v_exp_f32 v71, v31
  v_exp_f32 v72, v32
  v_mov_b32_sdwa v71, v73 dst_sel:WORD_0 dst_unused:UNUSED_PRESERVE src0_sel:WORD_1
  v_exp_f32 v64, v33
  v_exp_f32 v73, v34
  v_mfma_f32_32x32x16_bf16 v[48:63], v[100:103], v[68:71], v[48:63]
  ds_read_b128 v[96:99], v4 offset:34304
  ds_read_b128 v[100:103], v4 offset:34912
  v_mov_b32_sdwa v64, v72 dst_sel:WORD_0 dst_unused:UNUSED_PRESERVE src0_sel:WORD_1
  v_exp_f32 v65, v35
  v_exp_f32 v72, v36
  v_mov_b32_sdwa v65, v73 dst_sel:WORD_0 dst_unused:UNUSED_PRESERVE src0_sel:WORD_1
  v_exp_f32 v66, v37
  s_waitcnt lgkmcnt(2)
  v_mfma_f32_32x32x16_bf16 v[16:31], v[84:87], v[76:79], 0
  v_exp_f32 v73, v38
  ds_read_b128 v[88:91], v2 offset:35520
  ds_read_b32 v94, v3 offset:36544
  ds_read_b32 v112, v5
  v_mov_b32_sdwa v66, v72 dst_sel:WORD_0 dst_unused:UNUSED_PRESERVE src0_sel:WORD_1
  v_exp_f32 v67, v39
  v_exp_f32 v72, v40
  v_mov_b32_sdwa v67, v73 dst_sel:WORD_0 dst_unused:UNUSED_PRESERVE src0_sel:WORD_1
  v_exp_f32 v68, v41
  v_mfma_f32_32x32x8bf16_1k v[16:31], v[92:93], v[80:81], v[16:31]
  v_exp_f32 v73, v42
  v_mov_b32_sdwa v68, v72 dst_sel:WORD_0 dst_unused:UNUSED_PRESERVE src0_sel:WORD_1
  v_exp_f32 v69, v43
  v_exp_f32 v72, v44
  v_mov_b32_sdwa v69, v73 dst_sel:WORD_0 dst_unused:UNUSED_PRESERVE src0_sel:WORD_1
  v_exp_f32 v70, v45
  v_mfma_f32_32x32x16_bf16 v[48:63], v[104:107], v[64:67], v[48:63]
  v_exp_f32 v73, v46
  v_mov_b32_sdwa v70, v72 dst_sel:WORD_0 dst_unused:UNUSED_PRESERVE src0_sel:WORD_1
  v_exp_f32 v71, v47
  v_exp_f32 v72, v16
  v_mov_b32_sdwa v71, v73 dst_sel:WORD_0 dst_unused:UNUSED_PRESERVE src0_sel:WORD_1
  v_exp_f32 v64, v17
  v_exp_f32 v73, v18
  v_mfma_f32_32x32x16_bf16 v[48:63], v[108:111], v[68:71], v[48:63]
  ds_read_b128 v[104:107], v4 offset:36672
  ds_read_b128 v[108:111], v4 offset:37280
  v_mov_b32_sdwa v64, v72 dst_sel:WORD_0 dst_unused:UNUSED_PRESERVE src0_sel:WORD_1
  v_exp_f32 v65, v19
  v_exp_f32 v72, v20
  v_mov_b32_sdwa v65, v73 dst_sel:WORD_0 dst_unused:UNUSED_PRESERVE src0_sel:WORD_1
  v_exp_f32 v66, v21
  s_waitcnt lgkmcnt(2)
  v_readfirstlane_b32 s21, v112
  s_nop 0
  s_cmp_ge_u32 s21, 0x100
  s_cbranch_scc1 L_pk_48
L_pks_49:
  ds_read_b32 v112, v5
  s_waitcnt lgkmcnt(0)
  v_readfirstlane_b32 s21, v112
  s_nop 0
  s_cmp_lt_u32 s21, 0x100
  s_cbranch_scc1 L_pks_49
L_pk_48:
  v_mfma_f32_32x32x16_bf16 v[32:47], v[88:91], v[76:79], 0
  v_exp_f32 v73, v22
  ds_read_b128 v[84:87], v2 offset:37888
  ds_read_b32 v92, v3 offset:38912
  v_mov_b32_sdwa v66, v72 dst_sel:WORD_0 dst_unused:UNUSED_PRESERVE src0_sel:WORD_1
  v_exp_f32 v67, v23
  v_exp_f32 v72, v24
  v_mov_b32_sdwa v67, v73 dst_sel:WORD_0 dst_unused:UNUSED_PRESERVE src0_sel:WORD_1
  v_exp_f32 v68, v25
  v_mfma_f32_32x32x8bf16_1k v[32:47], v[94:95], v[80:81], v[32:47]
  v_exp_f32 v73, v26
  v_mov_b32_sdwa v68, v72 dst_sel:WORD_0 dst_unused:UNUSED_PRESERVE src0_sel:WORD_1
  v_exp_f32 v69, v27
  v_exp_f32 v72, v28
  v_mov_b32_sdwa v69, v73 dst_sel:WORD_0 dst_unused:UNUSED_PRESERVE src0_sel:WORD_1
  v_exp_f32 v70, v29
  v_mfma_f32_32x32x16_bf16 v[48:63], v[96:99], v[64:67], v[48:63]
  v_exp_f32 v73, v30
  v_mov_b32_sdwa v70, v72 dst_sel:WORD_0 dst_unused:UNUSED_PRESERVE src0_sel:WORD_1
  v_exp_f32 v71, v31
  v_exp_f32 v72, v32
  v_mov_b32_sdwa v71, v73 dst_sel:WORD_0 dst_unused:UNUSED_PRESERVE src0_sel:WORD_1
  v_exp_f32 v64, v33
  v_exp_f32 v73, v34
  v_mfma_f32_32x32x16_bf16 v[48:63], v[100:103], v[68:71], v[48:63]
  ds_read_b128 v[96:99], v4 offset:39040
  ds_read_b128 v[100:103], v4 offset:39648
  v_mov_b32_sdwa v64, v72 dst_sel:WORD_0 dst_unused:UNUSED_PRESERVE src0_sel:WORD_1
  v_exp_f32 v65, v35
  v_exp_f32 v72, v36
  v_mov_b32_sdwa v65, v73 dst_sel:WORD_0 dst_unused:UNUSED_PRESERVE src0_sel:WORD_1
  v_exp_f32 v66, v37
  s_waitcnt lgkmcnt(2)
  v_mfma_f32_32x32x16_bf16 v[16:31], v[84:87], v[76:79], 0
  v_exp_f32 v73, v38
  ds_read_b128 v[88:91], v2 offset:40256
  ds_read_b32 v94, v3 offset:41280
  v_mov_b32_sdwa v66, v72 dst_sel:WORD_0 dst_unused:UNUSED_PRESERVE src0_sel:WORD_1
  v_exp_f32 v67, v39
  v_exp_f32 v72, v40
  v_mov_b32_sdwa v67, v73 dst_sel:WORD_0 dst_unused:UNUSED_PRESERVE src0_sel:WORD_1
  v_exp_f32 v68, v41
  v_mfma_f32_32x32x8bf16_1k v[16:31], v[92:93], v[80:81], v[16:31]
  v_exp_f32 v73, v42
  v_mov_b32_sdwa v68, v72 dst_sel:WORD_0 dst_unused:UNUSED_PRESERVE src0_sel:WORD_1
  v_exp_f32 v69, v43
  v_exp_f32 v72, v44
  v_mov_b32_sdwa v69, v73 dst_sel:WORD_0 dst_unused:UNUSED_PRESERVE src0_sel:WORD_1
  v_exp_f32 v70, v45
  v_mfma_f32_32x32x16_bf16 v[48:63], v[104:107], v[64:67], v[48:63]
  v_exp_f32 v73, v46
  v_mov_b32_sdwa v70, v72 dst_sel:WORD_0 dst_unused:UNUSED_PRESERVE src0_sel:WORD_1
  v_exp_f32 v71, v47
  v_add_u32 v2, 37888, v2
  v_add_u32 v3, 37888, v3
  v_add_u32 v4, 37888, v4
  v_add_u32 v5, 4, v5
  s_add_u32 s17, s17, 1
  s_cmp_lt_u32 s17, 4
  s_cbranch_scc1 L_chunk_26
L_post:
  v_mov_b32_sdwa v71, v73 dst_sel:WORD_0 dst_unused:UNUSED_PRESERVE src0_sel:WORD_1
  s_nop 1
  v_mfma_f32_32x32x16_bf16 v[48:63], v[108:111], v[68:71], v[48:63]
  s_waitcnt lgkmcnt(0)
  s_nop 7
  s_nop 7
  s_cmp_eq_u32 s50, 1
  s_cbranch_scc1 L_hepi
  s_cmp_eq_u32 s39, 99
  s_cbranch_scc1 L_noadd
  s_sub_u32 s20, s16, 4
  s_lshl_b32 s20, s20, 2
  s_add_u32 s20, s20, 151584
  v_mov_b32 v14, s20
L_hp:
  ds_read_b32 v13, v14
  s_waitcnt lgkmcnt(0)
  v_readfirstlane_b32 s21, v13
  s_nop 0
  s_cmp_lt_u32 s21, s46
  s_cbranch_scc1 L_hp
  s_mul_i32 s20, s47, 2816
  s_add_u32 s20, s20, 151616
  v_lshlrev_b32 v14, 2, v0
  v_add_u32 v14, s20, v14
L_hs:
  ds_read_b32 v16, v14 offset:0
  ds_read_b32 v17, v14 offset:256
  ds_read_b32 v18, v14 offset:512
  ds_read_b32 v19, v14 offset:768
  ds_read_b32 v20, v14 offset:1024
  ds_read_b32 v21, v14 offset:1280
  ds_read_b32 v22, v14 offset:1536
  ds_read_b32 v23, v14 offset:1792
  ds_read_b32 v24, v14 offset:2048
  ds_read_b32 v25, v14 offset:2304
  ds_read_b32 v26, v14 offset:2560
  v_add_u32 v14, 2816, v14
  s_waitcnt lgkmcnt(0)
  v_add_f32 v48, v48, v16
  v_add_f32 v49, v49, v17
  v_add_f32 v50, v50, v18
  v_add_f32 v51, v51, v19
  v_add_f32 v52, v52, v20
  v_add_f32 v53, v53, v21
  v_add_f32 v54, v54, v22
  v_add_f32 v55, v55, v23
  v_add_f32 v56, v56, v24
  v_add_f32 v57, v57, v25
  v_add_f32 v58, v58, v26
  s_sub_u32 s48, s48, 1
  s_cmp_lg_u32 s48, 0
  s_cbranch_scc1 L_hs
L_noadd:
  v_mov_b32 v12, v58
  v_mov_b32 v13, v58
  s_nop 1
  v_permlane32_swap_b32 v12, v13
  s_nop 1
  v_rcp_f32 v12, v12
  s_nop 0
  v_mul_f32 v48, v48, v12
  v_mul_f32 v49, v49, v12
  v_mul_f32 v50, v50, v12
  v_mul_f32 v51, v51, v12
  v_mul_f32 v52, v52, v12
  v_mul_f32 v53, v53, v12
  v_mul_f32 v54, v54, v12
  v_mul_f32 v55, v55, v12
  v_mul_f32 v56, v56, v12
  v_mul_f32 v57, v57, v12
  v_cvt_pk_bf16_f32 v64, v48, v49
  v_cvt_pk_bf16_f32 v65, v50, v51
  v_cvt_pk_bf16_f32 v66, v52, v53
  v_cvt_pk_bf16_f32 v67, v54, v55
  v_cvt_pk_bf16_f32 v68, v56, v57
  s_add_u32 s20, s28, 0x280000
  buffer_store_dwordx2 v[64:65], v253, s[8:11], s20 offen
  buffer_store_dwordx2 v[66:67], v253, s[8:11], s20 offen offset:16
  v_cmp_gt_u32 vcc, 32, v0
  s_and_saveexec_b64 s[22:23], vcc
  buffer_store_dword v68, v252, s[8:11], s20 offen offset:32
  s_mov_b64 exec, s[22:23]
  s_cmp_eq_u32 s42, 0
  s_cbranch_scc1 L_fin
  s_mov_b32 s50, 1
  s_mov_b32 s51, s45
  s_mov_b32 s17, 3
  s_mov_b64 vcc, 0
  v_mov_b32 v76, v116
  v_mov_b32 v77, v117
  v_mov_b32 v78, v118
  v_mov_b32 v79, v119
  v_mov_b32 v80, v120
  v_mov_b32 v81, 0
  v_subrev_u32 v2, 37888, v2
  v_subrev_u32 v3, 37888, v3
  v_subrev_u32 v4, 37888, v4
  v_subrev_u32 v5, 4, v5
  s_mul_i32 s20, s44, 2368
  v_add_u32 v12, s20, v2
  v_add_u32 v13, s20, v3
  v_add_u32 v14, s20, v4
  ds_read_b128 v[84:87], v12
  ds_read_b32 v92, v13 offset:1024
  ds_read_b128 v[88:91], v12 offset:2368
  ds_read_b32 v94, v13 offset:3392
  ds_read_b128 v[96:99], v14 offset:1152
  ds_read_b128 v[100:103], v14 offset:1760
  v_mov_b32 v48, 0
  v_mov_b32 v49, 0
  v_mov_b32 v50, 0
  v_mov_b32 v51, 0
  v_mov_b32 v52, 0
  v_mov_b32 v53, 0
  v_mov_b32 v54, 0
  v_mov_b32 v55, 0
  v_mov_b32 v56, 0
  v_mov_b32 v57, 0
  v_mov_b32 v58, 0
  v_mov_b32 v59, 0
  v_mov_b32 v60, 0
  v_mov_b32 v61, 0
  v_mov_b32 v62, 0
  v_mov_b32 v63, 0
  v_mov_b32 v108, 0
  v_mov_b32 v68, 0
  v_mov_b32 v109, 0
  v_mov_b32 v69, 0
  v_mov_b32 v110, 0
  v_mov_b32 v70, 0
  v_mov_b32 v111, 0
  v_mov_b32 v71, 0
  v_mov_b32 v73, 0
  s_waitcnt lgkmcnt(0)
  v_mfma_f32_32x32x16_bf16 v[16:31], v[84:87], v[76:79], 0
  v_mfma_f32_32x32x8bf16_1k v[16:31], v[92:93], v[80:81], v[16:31]
  s_nop 7
  s_nop 7
  s_cmp_eq_u32 s44, 4
  s_cbranch_scc1 L_tile_4
  s_cmp_eq_u32 s44, 8
  s_cbranch_scc1 L_tile_8
  s_cmp_eq_u32 s44, 8
  s_cbranch_scc1 L_tile_8
  s_branch L_tile_12
L_hepi:
  s_sub_u32 s20, s16, 5
  s_mul_i32 s20, s20, 2816
  s_add_u32 s20, s20, 151616
  v_lshlrev_b32 v14, 2, v0
  v_add_u32 v14, s20, v14
  ds_write_b32 v14, v48 offset:0
  ds_write_b32 v14, v49 offset:256
  ds_write_b32 v14, v50 offset:512
  ds_write_b32 v14, v51 offset:768
  ds_write_b32 v14, v52 offset:1024
  ds_write_b32 v14, v53 offset:1280
  ds_write_b32 v14, v54 offset:1536
  ds_write_b32 v14, v55 offset:1792
  ds_write_b32 v14, v56 offset:2048
  ds_write_b32 v14, v57 offset:2304
  ds_write_b32 v14, v58 offset:2560
  s_sub_u32 s20, s43, 4
  s_lshl_b32 s20, s20, 2
  s_add_u32 s20, s20, 151584
  v_mov_b32 v13, s20
  v_mov_b32 v12, 1
  s_waitcnt lgkmcnt(0)
  ds_add_u32 v13, v12
  s_waitcnt lgkmcnt(0)
L_fin:
L_end_10:
  s_endpgm
.section .rodata,"a"
.p2align 6
.amdhsa_kernel attn_kernel
  .amdhsa_next_free_vgpr 256
  .amdhsa_next_free_sgpr 102
  .amdhsa_accum_offset 256
  .amdhsa_group_segment_fixed_size 0
  .amdhsa_kernarg_size 88
  .amdhsa_user_sgpr_count 2
  .amdhsa_user_sgpr_kernarg_segment_ptr 1
  .amdhsa_system_sgpr_workgroup_id_x 1
  .amdhsa_float_denorm_mode_32 3
.end_amdhsa_kernel
.text
.text
.globl outp_kernel
.p2align 8
.type outp_kernel,@function
outp_kernel:
  s_cmp_ge_u32 s2, 230
  s_cbranch_scc1 L_end_50
  s_load_dwordx2 s[40:41], s[0:1], 56
  s_load_dwordx2 s[42:43], s[0:1], 64
  s_load_dwordx2 s[46:47], s[0:1], 80
  v_lshrrev_b32 v1, 6, v0
  v_and_b32 v0, 63, v0
  s_nop 0
  v_readfirstlane_b32 s16, v1
  s_waitcnt lgkmcnt(0)
  s_mov_b32 s8, s46
  s_and_b32 s9, s47, 0xffff
  s_mov_b32 s10, 0xc00000
  s_mov_b32 s11, 0x20000
  s_mov_b32 s12, s42
  s_and_b32 s13, s43, 0xffff
  s_mov_b32 s14, 0x480000
  s_mov_b32 s15, 0x20000
  s_sub_u32 s18, s2, 144
  s_cmp_lt_u32 s18, 86
  s_cbranch_scc1 L_a3_52
  s_mov_b32 s48, s40
  s_and_b32 s49, s41, 0xffff
  s_mov_b32 s50, 0xa2000
  s_mov_b32 s51, 0x20000
  s_sub_u32 s17, s2, 0
  s_and_b32 s20, s17, 7
  s_lshr_b32 s21, s17, 3
  s_and_b32 s22, s21, 1
  s_lshl_b32 s20, s20, 1
  s_add_u32 s24, s20, s22
  s_lshr_b32 s25, s17, 4
  s_mul_i32 s26, s24, 147456
  s_add_u32 s26, s26, 0x280000
  s_lshl_b32 s27, s25, 7
  s_lshl_b32 s28, s16, 12
  s_lshl_b32 s29, s16, 11
  v_lshrrev_b32 v1, 3, v0
  v_and_b32 v2, 7, v0
  v_lshrrev_b32 v3, 1, v1
  v_xor_b32 v2, v2, v3
  v_lshlrev_b32 v2, 4, v2
  s_lshl_b32 s20, s16, 5
  v_add_u32 v1, s20, v1
  s_mov_b32 s20, 1152
  v_mul_lo_u32 v1, v1, s20
  v_add_u32 v5, v1, v2
  v_xor_b32 v15, 64, v5
  v_lshrrev_b32 v1, 3, v0
  v_and_b32 v2, 7, v0
  v_lshrrev_b32 v3, 1, v1
  v_and_b32 v3, 1, v3
  v_lshlrev_b32 v3, 2, v3
  v_xor_b32 v2, v2, v3
  v_lshlrev_b32 v2, 4, v2
  s_lshl_b32 s20, s16, 4
  v_add_u32 v1, s20, v1
  s_mov_b32 s20, 1152
  v_mul_lo_u32 v1, v1, s20
  v_add_u32 v6, v1, v2
  s_add_u32 s30, s24, s25
  s_cmp_ge_u32 s30, 18
  s_cselect_b32 s20, 18, 0
  s_sub_u32 s30, s30, s20
  s_cmp_ge_u32 s30, 9
  s_cselect_b32 s20, 9, 0
  s_sub_u32 s30, s30, s20
  s_mov_b32 s30, 0
  s_lshl_b32 s31, s30, 7
  s_add_u32 s31, s31, s26
  s_mul_i32 s19, s30, 73728
  s_add_u32 s19, s19, s27
  s_add_u32 s21, s28, 0
  s_mov_b32 m0, s21
  s_add_u32 s22, s31, 0
  buffer_load_dwordx4 v5, s[8:11], s22 offen lds
  s_add_u32 s21, s28, 1024
  s_mov_b32 m0, s21
  s_add_u32 s22, s31, 9216
  buffer_load_dwordx4 v15, s[8:11], s22 offen lds
  s_add_u32 s21, s28, 2048
  s_mov_b32 m0, s21
  s_add_u32 s22, s31, 18432
  buffer_load_dwordx4 v5, s[8:11], s22 offen lds
  s_add_u32 s21, s28, 3072
  s_mov_b32 m0, s21
  s_add_u32 s22, s31, 27648
  buffer_load_dwordx4 v15, s[8:11], s22 offen lds
  s_add_u32 s21, s29, 16384
  s_mov_b32 m0, s21
  s_add_u32 s22, s19, 0
  buffer_load_dwordx4 v6, s[48:51], s22 offen lds
  s_add_u32 s21, s29, 17408
  s_mov_b32 m0, s21
  s_add_u32 s22, s19, 9216
  buffer_load_dwordx4 v6, s[48:51], s22 offen lds
  s_add_u32 s30, s30, 1
  s_cmp_eq_u32 s30, 9
  s_cselect_b32 s30, 0, s30
  s_lshl_b32 s31, s30, 7
  s_add_u32 s31, s31, s26
  s_mul_i32 s19, s30, 73728
  s_add_u32 s19, s19, s27
  s_add_u32 s21, s28, 24576
  s_mov_b32 m0, s21
  s_add_u32 s22, s31, 0
  buffer_load_dwordx4 v5, s[8:11], s22 offen lds
  s_add_u32 s21, s28, 25600
  s_mov_b32 m0, s21
  s_add_u32 s22, s31, 9216
  buffer_load_dwordx4 v15, s[8:11], s22 offen lds
  s_add_u32 s21, s28, 26624
  s_mov_b32 m0, s21
  s_add_u32 s22, s31, 18432
  buffer_load_dwordx4 v5, s[8:11], s22 offen lds
  s_add_u32 s21, s28, 27648
  s_mov_b32 m0, s21
  s_add_u32 s22, s31, 27648
  buffer_load_dwordx4 v15, s[8:11], s22 offen lds
  s_add_u32 s21, s29, 40960
  s_mov_b32 m0, s21
  s_add_u32 s22, s19, 0
  buffer_load_dwordx4 v6, s[48:51], s22 offen lds
  s_add_u32 s21, s29, 41984
  s_mov_b32 m0, s21
  s_add_u32 s22, s19, 9216
  buffer_load_dwordx4 v6, s[48:51], s22 offen lds
  s_add_u32 s30, s30, 1
  s_cmp_eq_u32 s30, 9
  s_cselect_b32 s30, 0, s30
  s_lshl_b32 s31, s30, 7
  s_add_u32 s31, s31, s26
  s_mul_i32 s19, s30, 73728
  s_add_u32 s19, s19, s27
  s_add_u32 s21, s28, 49152
  s_mov_b32 m0, s21
  s_add_u32 s22, s31, 0
  buffer_load_dwordx4 v5, s[8:11], s22 offen lds
  s_add_u32 s21, s28, 50176
  s_mov_b32 m0, s21
  s_add_u32 s22, s31, 9216
  buffer_load_dwordx4 v15, s[8:11], s22 offen lds
  s_add_u32 s21, s28, 51200
  s_mov_b32 m0, s21
  s_add_u32 s22, s31, 18432
  buffer_load_dwordx4 v5, s[8:11], s22 offen lds
  s_add_u32 s21, s28, 52224
  s_mov_b32 m0, s21
  s_add_u32 s22, s31, 27648
  buffer_load_dwordx4 v15, s[8:11], s22 offen lds
  s_add_u32 s21, s29, 65536
  s_mov_b32 m0, s21
  s_add_u32 s22, s19, 0
  buffer_load_dwordx4 v6, s[48:51], s22 offen lds
  s_add_u32 s21, s29, 66560
  s_mov_b32 m0, s21
  s_add_u32 s22, s19, 9216
  buffer_load_dwordx4 v6, s[48:51], s22 offen lds
  v_and_b32 v1, 31, v0
  v_lshrrev_b32 v2, 5, v0
  v_bfe_u32 v3, v1, 1, 3
  s_lshl_b32 s20, s16, 12
  v_lshlrev_b32 v1, 7, v1
  v_add_u32 v1, s20, v1
  v_add_u32 v4, 0, v2
  v_xor_b32 v4, v4, v3
  v_lshl_add_u32 v8, v4, 4, v1
  v_add_u32 v4, 2, v2
  v_xor_b32 v4, v4, v3
  v_lshl_add_u32 v9, v4, 4, v1
  v_add_u32 v4, 4, v2
  v_xor_b32 v4, v4, v3
  v_lshl_add_u32 v10, v4, 4, v1
  v_add_u32 v4, 6, v2
  v_xor_b32 v4, v4, v3
  v_lshl_add_u32 v11, v4, 4, v1
  v_and_b32 v1, 15, v0
  v_lshrrev_b32 v2, 2, v1
  v_and_b32 v1, 3, v1
  v_lshrrev_b32 v3, 4, v0
  v_lshrrev_b32 v4, 1, v3
  v_and_b32 v3, 1, v3
  v_lshl_add_u32 v4, v4, 3, v2
  v_lshlrev_b32 v4, 7, v4
  v_lshrrev_b32 v7, 1, v1
  v_lshl_add_u32 v7, v3, 1, v7
  v_and_b32 v1, 1, v1
  v_lshlrev_b32 v1, 3, v1
  v_lshrrev_b32 v2, 1, v2
  v_lshlrev_b32 v2, 2, v2
  v_add_u32 v4, v4, v1
  v_add_u32 v4, 16384, v4
  v_xor_b32 v3, v7, v2
  v_lshl_add_u32 v12, v3, 4, v4
  v_xor_b32 v7, 4, v7
  v_xor_b32 v3, v7, v2
  v_lshl_add_u32 v13, v3, 4, v4
  v_and_b32 v1, 31, v0
  v_lshrrev_b32 v2, 5, v0
  s_lshl_b32 s20, s16, 5
  v_add_u32 v1, s20, v1
  s_mov_b32 s20, 2304
  v_mul_lo_u32 v1, v1, s20
  v_lshl_add_u32 v14, v2, 4, v1
  v_mov_b32 v48, 0
  v_mov_b32 v49, 0
  v_mov_b32 v50, 0
  v_mov_b32 v51, 0
  v_mov_b32 v52, 0
  v_mov_b32 v53, 0
  v_mov_b32 v54, 0
  v_mov_b32 v55, 0
  v_mov_b32 v56, 0
  v_mov_b32 v57, 0
  v_mov_b32 v58, 0
  v_mov_b32 v59, 0
  v_mov_b32 v60, 0
  v_mov_b32 v61, 0
  v_mov_b32 v62, 0
  v_mov_b32 v63, 0
  v_mov_b32 v64, 0
  v_mov_b32 v65, 0
  v_mov_b32 v66, 0
  v_mov_b32 v67, 0
  v_mov_b32 v68, 0
  v_mov_b32 v69, 0
  v_mov_b32 v70, 0
  v_mov_b32 v71, 0
  v_mov_b32 v72, 0
  v_mov_b32 v73, 0
  v_mov_b32 v74, 0
  v_mov_b32 v75, 0
  v_mov_b32 v76, 0
  v_mov_b32 v77, 0
  v_mov_b32 v78, 0
  v_mov_b32 v79, 0
  s_waitcnt vmcnt(12)
  s_barrier
  ds_read_b128 v[16:19], v8 offset:0
  ds_read_b64_tr_b16 v[24:25], v12 offset:0
  ds_read_b64_tr_b16 v[26:27], v12 offset:512
  ds_read_b64_tr_b16 v[28:29], v13 offset:0
  ds_read_b64_tr_b16 v[30:31], v13 offset:512
  ds_read_b128 v[20:23], v9 offset:0
  ds_read_b64_tr_b16 v[32:33], v12 offset:2048
  ds_read_b64_tr_b16 v[34:35], v12 offset:2560
  ds_read_b64_tr_b16 v[36:37], v13 offset:2048
  ds_read_b64_tr_b16 v[38:39], v13 offset:2560
  s_waitcnt lgkmcnt(5)
  v_mfma_f32_32x32x16_bf16 v[48:63], v[24:27], v[16:19], v[48:63]
  v_mfma_f32_32x32x16_bf16 v[64:79], v[28:31], v[16:19], v[64:79]
  s_add_u32 s30, s30, 1
  s_cmp_eq_u32 s30, 9
  s_cselect_b32 s30, 0, s30
  s_lshl_b32 s31, s30, 7
  s_add_u32 s31, s31, s26
  s_mul_i32 s19, s30, 73728
  s_add_u32 s19, s19, s27
  s_add_u32 s21, s28, 73728
  s_mov_b32 m0, s21
  s_add_u32 s22, s31, 0
  buffer_load_dwordx4 v5, s[8:11], s22 offen lds
  s_add_u32 s21, s28, 74752
  s_mov_b32 m0, s21
  s_add_u32 s22, s31, 9216
  buffer_load_dwordx4 v15, s[8:11], s22 offen lds
  ds_read_b128 v[16:19], v10 offset:0
  ds_read_b64_tr_b16 v[24:25], v12 offset:4096
  ds_read_b64_tr_b16 v[26:27], v12 offset:4608
  ds_read_b64_tr_b16 v[28:29], v13 offset:4096
  ds_read_b64_tr_b16 v[30:31], v13 offset:4608
  s_waitcnt lgkmcnt(5)
  v_mfma_f32_32x32x16_bf16 v[48:63], v[32:35], v[20:23], v[48:63]
  v_mfma_f32_32x32x16_bf16 v[64:79], v[36:39], v[20:23], v[64:79]
  s_add_u32 s21, s28, 75776
  s_mov_b32 m0, s21
  s_add_u32 s22, s31, 18432
  buffer_load_dwordx4 v5, s[8:11], s22 offen lds
  s_add_u32 s21, s28, 76800
  s_mov_b32 m0, s21
  s_add_u32 s22, s31, 27648
  buffer_load_dwordx4 v15, s[8:11], s22 offen lds
  ds_read_b128 v[20:23], v11 offset:0
  ds_read_b64_tr_b16 v[32:33], v12 offset:6144
  ds_read_b64_tr_b16 v[34:35], v12 offset:6656
  ds_read_b64_tr_b16 v[36:37], v13 offset:6144
  ds_read_b64_tr_b16 v[38:39], v13 offset:6656
  s_waitcnt lgkmcnt(5)
  v_mfma_f32_32x32x16_bf16 v[48:63], v[24:27], v[16:19], v[48:63]
  v_mfma_f32_32x32x16_bf16 v[64:79], v[28:31], v[16:19], v[64:79]
  s_add_u32 s21, s29, 90112
  s_mov_b32 m0, s21
  s_add_u32 s22, s19, 0
  buffer_load_dwordx4 v6, s[48:51], s22 offen lds
  s_waitcnt lgkmcnt(0)
  v_mfma_f32_32x32x16_bf16 v[48:63], v[32:35], v[20:23], v[48:63]
  v_mfma_f32_32x32x16_bf16 v[64:79], v[36:39], v[20:23], v[64:79]
  s_add_u32 s21, s29, 91136
  s_mov_b32 m0, s21
  s_add_u32 s22, s19, 9216
  buffer_load_dwordx4 v6, s[48:51], s22 offen lds
  s_waitcnt vmcnt(12)
  s_barrier
  ds_read_b128 v[16:19], v8 offset:24576
  ds_read_b64_tr_b16 v[24:25], v12 offset:24576
  ds_read_b64_tr_b16 v[26:27], v12 offset:25088
  ds_read_b64_tr_b16 v[28:29], v13 offset:24576
  ds_read_b64_tr_b16 v[30:31], v13 offset:25088
  ds_read_b128 v[20:23], v9 offset:24576
  ds_read_b64_tr_b16 v[32:33], v12 offset:26624
  ds_read_b64_tr_b16 v[34:35], v12 offset:27136
  ds_read_b64_tr_b16 v[36:37], v13 offset:26624
  ds_read_b64_tr_b16 v[38:39], v13 offset:27136
  s_waitcnt lgkmcnt(5)
  v_mfma_f32_32x32x16_bf16 v[48:63], v[24:27], v[16:19], v[48:63]
  v_mfma_f32_32x32x16_bf16 v[64:79], v[28:31], v[16:19], v[64:79]
  s_add_u32 s30, s30, 1
  s_cmp_eq_u32 s30, 9
  s_cselect_b32 s30, 0, s30
  s_lshl_b32 s31, s30, 7
  s_add_u32 s31, s31, s26
  s_mul_i32 s19, s30, 73728
  s_add_u32 s19, s19, s27
  s_add_u32 s21, s28, 98304
  s_mov_b32 m0, s21
  s_add_u32 s22, s31, 0
  buffer_load_dwordx4 v5, s[8:11], s22 offen lds
  s_add_u32 s21, s28, 99328
  s_mov_b32 m0, s21
  s_add_u32 s22, s31, 9216
  buffer_load_dwordx4 v15, s[8:11], s22 offen lds
  ds_read_b128 v[16:19], v10 offset:24576
  ds_read_b64_tr_b16 v[24:25], v12 offset:28672
  ds_read_b64_tr_b16 v[26:27], v12 offset:29184
  ds_read_b64_tr_b16 v[28:29], v13 offset:28672
  ds_read_b64_tr_b16 v[30:31], v13 offset:29184
  s_waitcnt lgkmcnt(5)
  v_mfma_f32_32x32x16_bf16 v[48:63], v[32:35], v[20:23], v[48:63]
  v_mfma_f32_32x32x16_bf16 v[64:79], v[36:39], v[20:23], v[64:79]
  s_add_u32 s21, s28, 100352
  s_mov_b32 m0, s21
  s_add_u32 s22, s31, 18432
  buffer_load_dwordx4 v5, s[8:11], s22 offen lds
  s_add_u32 s21, s28, 101376
  s_mov_b32 m0, s21
  s_add_u32 s22, s31, 27648
  buffer_load_dwordx4 v15, s[8:11], s22 offen lds
  ds_read_b128 v[20:23], v11 offset:24576
  ds_read_b64_tr_b16 v[32:33], v12 offset:30720
  ds_read_b64_tr_b16 v[34:35], v12 offset:31232
  ds_read_b64_tr_b16 v[36:37], v13 offset:30720
  ds_read_b64_tr_b16 v[38:39], v13 offset:31232
  s_waitcnt lgkmcnt(5)
  v_mfma_f32_32x32x16_bf16 v[48:63], v[24:27], v[16:19], v[48:63]
  v_mfma_f32_32x32x16_bf16 v[64:79], v[28:31], v[16:19], v[64:79]
  s_add_u32 s21, s29, 114688
  s_mov_b32 m0, s21
  s_add_u32 s22, s19, 0
  buffer_load_dwordx4 v6, s[48:51], s22 offen lds
  s_waitcnt lgkmcnt(0)
  v_mfma_f32_32x32x16_bf16 v[48:63], v[32:35], v[20:23], v[48:63]
  v_mfma_f32_32x32x16_bf16 v[64:79], v[36:39], v[20:23], v[64:79]
  s_add_u32 s21, s29, 115712
  s_mov_b32 m0, s21
  s_add_u32 s22, s19, 9216
  buffer_load_dwordx4 v6, s[48:51], s22 offen lds
  v_add_u32 v8, 49152, v8
  v_add_u32 v9, 49152, v9
  v_add_u32 v10, 49152, v10
  v_add_u32 v11, 49152, v11
  v_add_u32 v12, 49152, v12
  v_add_u32 v13, 49152, v13
  s_waitcnt vmcnt(12)
  s_barrier
  ds_read_b128 v[16:19], v8 offset:0
  ds_read_b64_tr_b16 v[24:25], v12 offset:0
  ds_read_b64_tr_b16 v[26:27], v12 offset:512
  ds_read_b64_tr_b16 v[28:29], v13 offset:0
  ds_read_b64_tr_b16 v[30:31], v13 offset:512
  ds_read_b128 v[20:23], v9 offset:0
  ds_read_b64_tr_b16 v[32:33], v12 offset:2048
  ds_read_b64_tr_b16 v[34:35], v12 offset:2560
  ds_read_b64_tr_b16 v[36:37], v13 offset:2048
  ds_read_b64_tr_b16 v[38:39], v13 offset:2560
  s_waitcnt lgkmcnt(5)
  v_mfma_f32_32x32x16_bf16 v[48:63], v[24:27], v[16:19], v[48:63]
  v_mfma_f32_32x32x16_bf16 v[64:79], v[28:31], v[16:19], v[64:79]
  s_add_u32 s30, s30, 1
  s_cmp_eq_u32 s30, 9
  s_cselect_b32 s30, 0, s30
  s_lshl_b32 s31, s30, 7
  s_add_u32 s31, s31, s26
  s_mul_i32 s19, s30, 73728
  s_add_u32 s19, s19, s27
  s_add_u32 s21, s28, 122880
  s_mov_b32 m0, s21
  s_add_u32 s22, s31, 0
  buffer_load_dwordx4 v5, s[8:11], s22 offen lds
  s_add_u32 s21, s28, 123904
  s_mov_b32 m0, s21
  s_add_u32 s22, s31, 9216
  buffer_load_dwordx4 v15, s[8:11], s22 offen lds
  ds_read_b128 v[16:19], v10 offset:0
  ds_read_b64_tr_b16 v[24:25], v12 offset:4096
  ds_read_b64_tr_b16 v[26:27], v12 offset:4608
  ds_read_b64_tr_b16 v[28:29], v13 offset:4096
  ds_read_b64_tr_b16 v[30:31], v13 offset:4608
  s_waitcnt lgkmcnt(5)
  v_mfma_f32_32x32x16_bf16 v[48:63], v[32:35], v[20:23], v[48:63]
  v_mfma_f32_32x32x16_bf16 v[64:79], v[36:39], v[20:23], v[64:79]
  s_add_u32 s21, s28, 124928
  s_mov_b32 m0, s21
  s_add_u32 s22, s31, 18432
  buffer_load_dwordx4 v5, s[8:11], s22 offen lds
  s_add_u32 s21, s28, 125952
  s_mov_b32 m0, s21
  s_add_u32 s22, s31, 27648
  buffer_load_dwordx4 v15, s[8:11], s22 offen lds
  ds_read_b128 v[20:23], v11 offset:0
  ds_read_b64_tr_b16 v[32:33], v12 offset:6144
  ds_read_b64_tr_b16 v[34:35], v12 offset:6656
  ds_read_b64_tr_b16 v[36:37], v13 offset:6144
  ds_read_b64_tr_b16 v[38:39], v13 offset:6656
  s_waitcnt lgkmcnt(5)
  v_mfma_f32_32x32x16_bf16 v[48:63], v[24:27], v[16:19], v[48:63]
  v_mfma_f32_32x32x16_bf16 v[64:79], v[28:31], v[16:19], v[64:79]
  s_add_u32 s21, s29, 139264
  s_mov_b32 m0, s21
  s_add_u32 s22, s19, 0
  buffer_load_dwordx4 v6, s[48:51], s22 offen lds
  s_waitcnt lgkmcnt(0)
  v_mfma_f32_32x32x16_bf16 v[48:63], v[32:35], v[20:23], v[48:63]
  v_mfma_f32_32x32x16_bf16 v[64:79], v[36:39], v[20:23], v[64:79]
  s_add_u32 s21, s29, 140288
  s_mov_b32 m0, s21
  s_add_u32 s22, s19, 9216
  buffer_load_dwordx4 v6, s[48:51], s22 offen lds
  s_waitcnt vmcnt(12)
  s_barrier
  ds_read_b128 v[16:19], v8 offset:24576
  ds_read_b64_tr_b16 v[24:25], v12 offset:24576
  ds_read_b64_tr_b16 v[26:27], v12 offset:25088
  ds_read_b64_tr_b16 v[28:29], v13 offset:24576
  ds_read_b64_tr_b16 v[30:31], v13 offset:25088
  ds_read_b128 v[20:23], v9 offset:24576
  ds_read_b64_tr_b16 v[32:33], v12 offset:26624
  ds_read_b64_tr_b16 v[34:35], v12 offset:27136
  ds_read_b64_tr_b16 v[36:37], v13 offset:26624
  ds_read_b64_tr_b16 v[38:39], v13 offset:27136
  s_waitcnt lgkmcnt(5)
  v_mfma_f32_32x32x16_bf16 v[48:63], v[24:27], v[16:19], v[48:63]
  v_mfma_f32_32x32x16_bf16 v[64:79], v[28:31], v[16:19], v[64:79]
  s_add_u32 s30, s30, 1
  s_cmp_eq_u32 s30, 9
  s_cselect_b32 s30, 0, s30
  s_lshl_b32 s31, s30, 7
  s_add_u32 s31, s31, s26
  s_mul_i32 s19, s30, 73728
  s_add_u32 s19, s19, s27
  s_add_u32 s21, s28, 0
  s_mov_b32 m0, s21
  s_add_u32 s22, s31, 0
  buffer_load_dwordx4 v5, s[8:11], s22 offen lds
  s_add_u32 s21, s28, 1024
  s_mov_b32 m0, s21
  s_add_u32 s22, s31, 9216
  buffer_load_dwordx4 v15, s[8:11], s22 offen lds
  ds_read_b128 v[16:19], v10 offset:24576
  ds_read_b64_tr_b16 v[24:25], v12 offset:28672
  ds_read_b64_tr_b16 v[26:27], v12 offset:29184
  ds_read_b64_tr_b16 v[28:29], v13 offset:28672
  ds_read_b64_tr_b16 v[30:31], v13 offset:29184
  s_waitcnt lgkmcnt(5)
  v_mfma_f32_32x32x16_bf16 v[48:63], v[32:35], v[20:23], v[48:63]
  v_mfma_f32_32x32x16_bf16 v[64:79], v[36:39], v[20:23], v[64:79]
  s_add_u32 s21, s28, 2048
  s_mov_b32 m0, s21
  s_add_u32 s22, s31, 18432
  buffer_load_dwordx4 v5, s[8:11], s22 offen lds
  s_add_u32 s21, s28, 3072
  s_mov_b32 m0, s21
  s_add_u32 s22, s31, 27648
  buffer_load_dwordx4 v15, s[8:11], s22 offen lds
  ds_read_b128 v[20:23], v11 offset:24576
  ds_read_b64_tr_b16 v[32:33], v12 offset:30720
  ds_read_b64_tr_b16 v[34:35], v12 offset:31232
  ds_read_b64_tr_b16 v[36:37], v13 offset:30720
  ds_read_b64_tr_b16 v[38:39], v13 offset:31232
  s_waitcnt lgkmcnt(5)
  v_mfma_f32_32x32x16_bf16 v[48:63], v[24:27], v[16:19], v[48:63]
  v_mfma_f32_32x32x16_bf16 v[64:79], v[28:31], v[16:19], v[64:79]
  s_add_u32 s21, s29, 16384
  s_mov_b32 m0, s21
  s_add_u32 s22, s19, 0
  buffer_load_dwordx4 v6, s[48:51], s22 offen lds
  s_waitcnt lgkmcnt(0)
  v_mfma_f32_32x32x16_bf16 v[48:63], v[32:35], v[20:23], v[48:63]
  v_mfma_f32_32x32x16_bf16 v[64:79], v[36:39], v[20:23], v[64:79]
  s_add_u32 s21, s29, 17408
  s_mov_b32 m0, s21
  s_add_u32 s22, s19, 9216
  buffer_load_dwordx4 v6, s[48:51], s22 offen lds
  v_add_u32 v8, 49152, v8
  v_add_u32 v9, 49152, v9
  v_add_u32 v10, 49152, v10
  v_add_u32 v11, 49152, v11
  v_add_u32 v12, 49152, v12
  v_add_u32 v13, 49152, v13
  s_waitcnt vmcnt(12)
  s_barrier
  ds_read_b128 v[16:19], v8 offset:0
  ds_read_b64_tr_b16 v[24:25], v12 offset:0
  ds_read_b64_tr_b16 v[26:27], v12 offset:512
  ds_read_b64_tr_b16 v[28:29], v13 offset:0
  ds_read_b64_tr_b16 v[30:31], v13 offset:512
  ds_read_b128 v[20:23], v9 offset:0
  ds_read_b64_tr_b16 v[32:33], v12 offset:2048
  ds_read_b64_tr_b16 v[34:35], v12 offset:2560
  ds_read_b64_tr_b16 v[36:37], v13 offset:2048
  ds_read_b64_tr_b16 v[38:39], v13 offset:2560
  s_waitcnt lgkmcnt(5)
  v_mfma_f32_32x32x16_bf16 v[48:63], v[24:27], v[16:19], v[48:63]
  v_mfma_f32_32x32x16_bf16 v[64:79], v[28:31], v[16:19], v[64:79]
  s_add_u32 s30, s30, 1
  s_cmp_eq_u32 s30, 9
  s_cselect_b32 s30, 0, s30
  s_lshl_b32 s31, s30, 7
  s_add_u32 s31, s31, s26
  s_mul_i32 s19, s30, 73728
  s_add_u32 s19, s19, s27
  s_add_u32 s21, s28, 24576
  s_mov_b32 m0, s21
  s_add_u32 s22, s31, 0
  buffer_load_dwordx4 v5, s[8:11], s22 offen lds
  s_add_u32 s21, s28, 25600
  s_mov_b32 m0, s21
  s_add_u32 s22, s31, 9216
  buffer_load_dwordx4 v15, s[8:11], s22 offen lds
  ds_read_b128 v[16:19], v10 offset:0
  ds_read_b64_tr_b16 v[24:25], v12 offset:4096
  ds_read_b64_tr_b16 v[26:27], v12 offset:4608
  ds_read_b64_tr_b16 v[28:29], v13 offset:4096
  ds_read_b64_tr_b16 v[30:31], v13 offset:4608
  s_waitcnt lgkmcnt(5)
  v_mfma_f32_32x32x16_bf16 v[48:63], v[32:35], v[20:23], v[48:63]
  v_mfma_f32_32x32x16_bf16 v[64:79], v[36:39], v[20:23], v[64:79]
  s_add_u32 s21, s28, 26624
  s_mov_b32 m0, s21
  s_add_u32 s22, s31, 18432
  buffer_load_dwordx4 v5, s[8:11], s22 offen lds
  s_add_u32 s21, s28, 27648
  s_mov_b32 m0, s21
  s_add_u32 s22, s31, 27648
  buffer_load_dwordx4 v15, s[8:11], s22 offen lds
  ds_read_b128 v[20:23], v11 offset:0
  ds_read_b64_tr_b16 v[32:33], v12 offset:6144
  ds_read_b64_tr_b16 v[34:35], v12 offset:6656
  ds_read_b64_tr_b16 v[36:37], v13 offset:6144
  ds_read_b64_tr_b16 v[38:39], v13 offset:6656
  s_waitcnt lgkmcnt(5)
  v_mfma_f32_32x32x16_bf16 v[48:63], v[24:27], v[16:19], v[48:63]
  v_mfma_f32_32x32x16_bf16 v[64:79], v[28:31], v[16:19], v[64:79]
  s_add_u32 s21, s29, 40960
  s_mov_b32 m0, s21
  s_add_u32 s22, s19, 0
  buffer_load_dwordx4 v6, s[48:51], s22 offen lds
  s_waitcnt lgkmcnt(0)
  v_mfma_f32_32x32x16_bf16 v[48:63], v[32:35], v[20:23], v[48:63]
  v_mfma_f32_32x32x16_bf16 v[64:79], v[36:39], v[20:23], v[64:79]
  s_add_u32 s21, s29, 41984
  s_mov_b32 m0, s21
  s_add_u32 s22, s19, 9216
  buffer_load_dwordx4 v6, s[48:51], s22 offen lds
  s_waitcnt vmcnt(12)
  s_barrier
  ds_read_b128 v[16:19], v8 offset:24576
  ds_read_b64_tr_b16 v[24:25], v12 offset:24576
  ds_read_b64_tr_b16 v[26:27], v12 offset:25088
  ds_read_b64_tr_b16 v[28:29], v13 offset:24576
  ds_read_b64_tr_b16 v[30:31], v13 offset:25088
  ds_read_b128 v[20:23], v9 offset:24576
  ds_read_b64_tr_b16 v[32:33], v12 offset:26624
  ds_read_b64_tr_b16 v[34:35], v12 offset:27136
  ds_read_b64_tr_b16 v[36:37], v13 offset:26624
  ds_read_b64_tr_b16 v[38:39], v13 offset:27136
  s_waitcnt lgkmcnt(5)
  v_mfma_f32_32x32x16_bf16 v[48:63], v[24:27], v[16:19], v[48:63]
  v_mfma_f32_32x32x16_bf16 v[64:79], v[28:31], v[16:19], v[64:79]
  s_add_u32 s30, s30, 1
  s_cmp_eq_u32 s30, 9
  s_cselect_b32 s30, 0, s30
  s_lshl_b32 s31, s30, 7
  s_add_u32 s31, s31, s26
  s_mul_i32 s19, s30, 73728
  s_add_u32 s19, s19, s27
  s_add_u32 s21, s28, 49152
  s_mov_b32 m0, s21
  s_add_u32 s22, s31, 0
  buffer_load_dwordx4 v5, s[8:11], s22 offen lds
  s_add_u32 s21, s28, 50176
  s_mov_b32 m0, s21
  s_add_u32 s22, s31, 9216
  buffer_load_dwordx4 v15, s[8:11], s22 offen lds
  ds_read_b128 v[16:19], v10 offset:24576
  ds_read_b64_tr_b16 v[24:25], v12 offset:28672
  ds_read_b64_tr_b16 v[26:27], v12 offset:29184
  ds_read_b64_tr_b16 v[28:29], v13 offset:28672
  ds_read_b64_tr_b16 v[30:31], v13 offset:29184
  s_waitcnt lgkmcnt(5)
  v_mfma_f32_32x32x16_bf16 v[48:63], v[32:35], v[20:23], v[48:63]
  v_mfma_f32_32x32x16_bf16 v[64:79], v[36:39], v[20:23], v[64:79]
  s_add_u32 s21, s28, 51200
  s_mov_b32 m0, s21
  s_add_u32 s22, s31, 18432
  buffer_load_dwordx4 v5, s[8:11], s22 offen lds
  s_add_u32 s21, s28, 52224
  s_mov_b32 m0, s21
  s_add_u32 s22, s31, 27648
  buffer_load_dwordx4 v15, s[8:11], s22 offen lds
  ds_read_b128 v[20:23], v11 offset:24576
  ds_read_b64_tr_b16 v[32:33], v12 offset:30720
  ds_read_b64_tr_b16 v[34:35], v12 offset:31232
  ds_read_b64_tr_b16 v[36:37], v13 offset:30720
  ds_read_b64_tr_b16 v[38:39], v13 offset:31232
  s_waitcnt lgkmcnt(5)
  v_mfma_f32_32x32x16_bf16 v[48:63], v[24:27], v[16:19], v[48:63]
  v_mfma_f32_32x32x16_bf16 v[64:79], v[28:31], v[16:19], v[64:79]
  s_add_u32 s21, s29, 65536
  s_mov_b32 m0, s21
  s_add_u32 s22, s19, 0
  buffer_load_dwordx4 v6, s[48:51], s22 offen lds
  s_waitcnt lgkmcnt(0)
  v_mfma_f32_32x32x16_bf16 v[48:63], v[32:35], v[20:23], v[48:63]
  v_mfma_f32_32x32x16_bf16 v[64:79], v[36:39], v[20:23], v[64:79]
  s_add_u32 s21, s29, 66560
  s_mov_b32 m0, s21
  s_add_u32 s22, s19, 9216
  buffer_load_dwordx4 v6, s[48:51], s22 offen lds
  v_add_u32 v8, 0xfffe8000, v8
  v_add_u32 v9, 0xfffe8000, v9
  v_add_u32 v10, 0xfffe8000, v10
  v_add_u32 v11, 0xfffe8000, v11
  v_add_u32 v12, 0xfffe8000, v12
  v_add_u32 v13, 0xfffe8000, v13
  s_waitcnt vmcnt(12)
  s_barrier
  ds_read_b128 v[16:19], v8 offset:0
  ds_read_b64_tr_b16 v[24:25], v12 offset:0
  ds_read_b64_tr_b16 v[26:27], v12 offset:512
  ds_read_b64_tr_b16 v[28:29], v13 offset:0
  ds_read_b64_tr_b16 v[30:31], v13 offset:512
  ds_read_b128 v[20:23], v9 offset:0
  ds_read_b64_tr_b16 v[32:33], v12 offset:2048
  ds_read_b64_tr_b16 v[34:35], v12 offset:2560
  ds_read_b64_tr_b16 v[36:37], v13 offset:2048
  ds_read_b64_tr_b16 v[38:39], v13 offset:2560
  s_waitcnt lgkmcnt(5)
  v_mfma_f32_32x32x16_bf16 v[48:63], v[24:27], v[16:19], v[48:63]
  v_mfma_f32_32x32x16_bf16 v[64:79], v[28:31], v[16:19], v[64:79]
  ds_read_b128 v[16:19], v10 offset:0
  ds_read_b64_tr_b16 v[24:25], v12 offset:4096
  ds_read_b64_tr_b16 v[26:27], v12 offset:4608
  ds_read_b64_tr_b16 v[28:29], v13 offset:4096
  ds_read_b64_tr_b16 v[30:31], v13 offset:4608
  s_waitcnt lgkmcnt(5)
  v_mfma_f32_32x32x16_bf16 v[48:63], v[32:35], v[20:23], v[48:63]
  v_mfma_f32_32x32x16_bf16 v[64:79], v[36:39], v[20:23], v[64:79]
  ds_read_b128 v[20:23], v11 offset:0
  ds_read_b64_tr_b16 v[32:33], v12 offset:6144
  ds_read_b64_tr_b16 v[34:35], v12 offset:6656
  ds_read_b64_tr_b16 v[36:37], v13 offset:6144
  ds_read_b64_tr_b16 v[38:39], v13 offset:6656
  s_waitcnt lgkmcnt(5)
  v_mfma_f32_32x32x16_bf16 v[48:63], v[24:27], v[16:19], v[48:63]
  v_mfma_f32_32x32x16_bf16 v[64:79], v[28:31], v[16:19], v[64:79]
  s_waitcnt lgkmcnt(0)
  v_mfma_f32_32x32x16_bf16 v[48:63], v[32:35], v[20:23], v[48:63]
  v_mfma_f32_32x32x16_bf16 v[64:79], v[36:39], v[20:23], v[64:79]
  s_waitcnt vmcnt(6)
  s_barrier
  ds_read_b128 v[16:19], v8 offset:24576
  ds_read_b64_tr_b16 v[24:25], v12 offset:24576
  ds_read_b64_tr_b16 v[26:27], v12 offset:25088
  ds_read_b64_tr_b16 v[28:29], v13 offset:24576
  ds_read_b64_tr_b16 v[30:31], v13 offset:25088
  ds_read_b128 v[20:23], v9 offset:24576
  ds_read_b64_tr_b16 v[32:33], v12 offset:26624
  ds_read_b64_tr_b16 v[34:35], v12 offset:27136
  ds_read_b64_tr_b16 v[36:37], v13 offset:26624
  ds_read_b64_tr_b16 v[38:39], v13 offset:27136
  s_waitcnt lgkmcnt(5)
  v_mfma_f32_32x32x16_bf16 v[48:63], v[24:27], v[16:19], v[48:63]
  v_mfma_f32_32x32x16_bf16 v[64:79], v[28:31], v[16:19], v[64:79]
  ds_read_b128 v[16:19], v10 offset:24576
  ds_read_b64_tr_b16 v[24:25], v12 offset:28672
  ds_read_b64_tr_b16 v[26:27], v12 offset:29184
  ds_read_b64_tr_b16 v[28:29], v13 offset:28672
  ds_read_b64_tr_b16 v[30:31], v13 offset:29184
  s_waitcnt lgkmcnt(5)
  v_mfma_f32_32x32x16_bf16 v[48:63], v[32:35], v[20:23], v[48:63]
  v_mfma_f32_32x32x16_bf16 v[64:79], v[36:39], v[20:23], v[64:79]
  ds_read_b128 v[20:23], v11 offset:24576
  ds_read_b64_tr_b16 v[32:33], v12 offset:30720
  ds_read_b64_tr_b16 v[34:35], v12 offset:31232
  ds_read_b64_tr_b16 v[36:37], v13 offset:30720
  ds_read_b64_tr_b16 v[38:39], v13 offset:31232
  s_waitcnt lgkmcnt(5)
  v_mfma_f32_32x32x16_bf16 v[48:63], v[24:27], v[16:19], v[48:63]
  v_mfma_f32_32x32x16_bf16 v[64:79], v[28:31], v[16:19], v[64:79]
  s_waitcnt lgkmcnt(0)
  v_mfma_f32_32x32x16_bf16 v[48:63], v[32:35], v[20:23], v[48:63]
  v_mfma_f32_32x32x16_bf16 v[64:79], v[36:39], v[20:23], v[64:79]
  v_add_u32 v8, 49152, v8
  v_add_u32 v9, 49152, v9
  v_add_u32 v10, 49152, v10
  v_add_u32 v11, 49152, v11
  v_add_u32 v12, 49152, v12
  v_add_u32 v13, 49152, v13
  s_waitcnt vmcnt(0)
  s_barrier
  ds_read_b128 v[16:19], v8 offset:0
  ds_read_b64_tr_b16 v[24:25], v12 offset:0
  ds_read_b64_tr_b16 v[26:27], v12 offset:512
  ds_read_b64_tr_b16 v[28:29], v13 offset:0
  ds_read_b64_tr_b16 v[30:31], v13 offset:512
  ds_read_b128 v[20:23], v9 offset:0
  ds_read_b64_tr_b16 v[32:33], v12 offset:2048
  ds_read_b64_tr_b16 v[34:35], v12 offset:2560
  ds_read_b64_tr_b16 v[36:37], v13 offset:2048
  ds_read_b64_tr_b16 v[38:39], v13 offset:2560
  s_waitcnt lgkmcnt(5)
  v_mfma_f32_32x32x16_bf16 v[48:63], v[24:27], v[16:19], v[48:63]
  v_mfma_f32_32x32x16_bf16 v[64:79], v[28:31], v[16:19], v[64:79]
  ds_read_b128 v[16:19], v10 offset:0
  ds_read_b64_tr_b16 v[24:25], v12 offset:4096
  ds_read_b64_tr_b16 v[26:27], v12 offset:4608
  ds_read_b64_tr_b16 v[28:29], v13 offset:4096
  ds_read_b64_tr_b16 v[30:31], v13 offset:4608
  s_waitcnt lgkmcnt(5)
  v_mfma_f32_32x32x16_bf16 v[48:63], v[32:35], v[20:23], v[48:63]
  v_mfma_f32_32x32x16_bf16 v[64:79], v[36:39], v[20:23], v[64:79]
  ds_read_b128 v[20:23], v11 offset:0
  ds_read_b64_tr_b16 v[32:33], v12 offset:6144
  ds_read_b64_tr_b16 v[34:35], v12 offset:6656
  ds_read_b64_tr_b16 v[36:37], v13 offset:6144
  ds_read_b64_tr_b16 v[38:39], v13 offset:6656
  s_waitcnt lgkmcnt(5)
  v_mfma_f32_32x32x16_bf16 v[48:63], v[24:27], v[16:19], v[48:63]
  v_mfma_f32_32x32x16_bf16 v[64:79], v[28:31], v[16:19], v[64:79]
  s_waitcnt lgkmcnt(0)
  v_mfma_f32_32x32x16_bf16 v[48:63], v[32:35], v[20:23], v[48:63]
  v_mfma_f32_32x32x16_bf16 v[64:79], v[36:39], v[20:23], v[64:79]
  s_nop 7
  s_nop 7
  s_mul_i32 s23, s24, 294912
  s_add_u32 s23, s23, s27
  s_add_u32 s23, s23, 0x480
  v_cvt_pk_bf16_f32 v80, v48, v49
  v_cvt_pk_bf16_f32 v81, v50, v51
  v_cvt_pk_bf16_f32 v82, v52, v53
  v_cvt_pk_bf16_f32 v83, v54, v55
  s_nop 1
  v_permlane32_swap_b32 v80, v82
  v_permlane32_swap_b32 v81, v83
  buffer_store_dwordx4 v[80:83], v14, s[12:15], s23 offen offset:0
  v_cvt_pk_bf16_f32 v84, v56, v57
  v_cvt_pk_bf16_f32 v85, v58, v59
  v_cvt_pk_bf16_f32 v86, v60, v61
  v_cvt_pk_bf16_f32 v87, v62, v63
  s_nop 1
  v_permlane32_swap_b32 v84, v86
  v_permlane32_swap_b32 v85, v87
  buffer_store_dwordx4 v[84:87], v14, s[12:15], s23 offen offset:32
  v_cvt_pk_bf16_f32 v88, v64, v65
  v_cvt_pk_bf16_f32 v89, v66, v67
  v_cvt_pk_bf16_f32 v90, v68, v69
  v_cvt_pk_bf16_f32 v91, v70, v71
  s_nop 1
  v_permlane32_swap_b32 v88, v90
  v_permlane32_swap_b32 v89, v91
  buffer_store_dwordx4 v[88:91], v14, s[12:15], s23 offen offset:64
  v_cvt_pk_bf16_f32 v92, v72, v73
  v_cvt_pk_bf16_f32 v93, v74, v75
  v_cvt_pk_bf16_f32 v94, v76, v77
  v_cvt_pk_bf16_f32 v95, v78, v79
  s_nop 1
  v_permlane32_swap_b32 v92, v94
  v_permlane32_swap_b32 v93, v95
  buffer_store_dwordx4 v[92:95], v14, s[12:15], s23 offen offset:96
  s_branch L_fin_51
L_a3_52:
  s_getpc_b64 s[48:49]
L_pc_53:
  s_add_u32 s48, s48, tab_a3-L_pc_53
  s_addc_u32 s49, s49, 0
  s_and_b32 s49, s49, 0xffff
  s_mov_b32 s50, 0xc800
  s_mov_b32 s51, 0x20000
  s_lshl_b32 s20, s16, 6
  v_add_u32 v1, s20, v0
  v_mul_u32_u24 v2, 21846, v1
  v_lshrrev_b32 v2, 16, v2
  v_mul_u32_u24 v3, 3, v2
  v_sub_u32 v3, v1, v3
  s_mul_i32 s24, s18, 27744
  s_add_u32 s24, s24, 0x960000
  s_add_u32 s25, s24, 13872
  v_cmp_gt_u32 vcc, 73, v2
  v_lshlrev_b32 v4, 4, v3
  v_mov_b32 v7, 0x7ff00000
  v_add_u32 v6, 0, v2
  v_mad_u32_u24 v6, v6, 48, v4
  v_cndmask_b32 v8, v7, v6, vcc
  v_add_u32 v6, 144, v2
  v_mad_u32_u24 v6, v6, 48, v4
  v_cndmask_b32 v9, v7, v6, vcc
  v_sub_u32 v6, 288, v2
  v_mad_u32_u24 v6, v6, 48, v4
  v_cndmask_b32 v10, v7, v6, vcc
  v_sub_u32 v6, 144, v2
  v_mad_u32_u24 v6, v6, 48, v4
  v_cndmask_b32 v11, v7, v6, vcc
  buffer_load_dwordx4 v[16:19], v8, s[8:11], s24 offen
  buffer_load_dwordx4 v[20:23], v8, s[8:11], s25 offen
  buffer_load_dwordx4 v[24:27], v9, s[8:11], s24 offen
  buffer_load_dwordx4 v[28:31], v9, s[8:11], s25 offen
  buffer_load_dwordx4 v[32:35], v10, s[8:11], s24 offen
  buffer_load_dwordx4 v[36:39], v10, s[8:11], s25 offen
  buffer_load_dwordx4 v[40:43], v11, s[8:11], s24 offen
  buffer_load_dwordx4 v[44:47], v11, s[8:11], s25 offen
  v_lshlrev_b32 v6, 4, v0
  s_mul_i32 s20, s16, 13
  s_add_u32 s20, s20, 0
  s_min_u32 s20, s20, 49
  s_lshl_b32 s20, s20, 10
  s_add_u32 s21, s20, 40960
  s_mov_b32 m0, s21
  s_nop 0
  buffer_load_dwordx4 v6, s[48:51], s20 offen lds
  s_mul_i32 s20, s16, 13
  s_add_u32 s20, s20, 1
  s_min_u32 s20, s20, 49
  s_lshl_b32 s20, s20, 10
  s_add_u32 s21, s20, 40960
  s_mov_b32 m0, s21
  s_nop 0
  buffer_load_dwordx4 v6, s[48:51], s20 offen lds
  s_mul_i32 s20, s16, 13
  s_add_u32 s20, s20, 2
  s_min_u32 s20, s20, 49
  s_lshl_b32 s20, s20, 10
  s_add_u32 s21, s20, 40960
  s_mov_b32 m0, s21
  s_nop 0
  buffer_load_dwordx4 v6, s[48:51], s20 offen lds
  s_mul_i32 s20, s16, 13
  s_add_u32 s20, s20, 3
  s_min_u32 s20, s20, 49
  s_lshl_b32 s20, s20, 10
  s_add_u32 s21, s20, 40960
  s_mov_b32 m0, s21
  s_nop 0
  buffer_load_dwordx4 v6, s[48:51], s20 offen lds
  s_mul_i32 s20, s16, 13
  s_add_u32 s20, s20, 4
  s_min_u32 s20, s20, 49
  s_lshl_b32 s20, s20, 10
  s_add_u32 s21, s20, 40960
  s_mov_b32 m0, s21
  s_nop 0
  buffer_load_dwordx4 v6, s[48:51], s20 offen lds
  s_mul_i32 s20, s16, 13
  s_add_u32 s20, s20, 5
  s_min_u32 s20, s20, 49
  s_lshl_b32 s20, s20, 10
  s_add_u32 s21, s20, 40960
  s_mov_b32 m0, s21
  s_nop 0
  buffer_load_dwordx4 v6, s[48:51], s20 offen lds
  s_mul_i32 s20, s16, 13
  s_add_u32 s20, s20, 6
  s_min_u32 s20, s20, 49
  s_lshl_b32 s20, s20, 10
  s_add_u32 s21, s20, 40960
  s_mov_b32 m0, s21
  s_nop 0
  buffer_load_dwordx4 v6, s[48:51], s20 offen lds
  s_mul_i32 s20, s16, 13
  s_add_u32 s20, s20, 7
  s_min_u32 s20, s20, 49
  s_lshl_b32 s20, s20, 10
  s_add_u32 s21, s20, 40960
  s_mov_b32 m0, s21
  s_nop 0
  buffer_load_dwordx4 v6, s[48:51], s20 offen lds
  s_mul_i32 s20, s16, 13
  s_add_u32 s20, s20, 8
  s_min_u32 s20, s20, 49
  s_lshl_b32 s20, s20, 10
  s_add_u32 s21, s20, 40960
  s_mov_b32 m0, s21
  s_nop 0
  buffer_load_dwordx4 v6, s[48:51], s20 offen lds
  s_mul_i32 s20, s16, 13
  s_add_u32 s20, s20, 9
  s_min_u32 s20, s20, 49
  s_lshl_b32 s20, s20, 10
  s_add_u32 s21, s20, 40960
  s_mov_b32 m0, s21
  s_nop 0
  buffer_load_dwordx4 v6, s[48:51], s20 offen lds
  s_mul_i32 s20, s16, 13
  s_add_u32 s20, s20, 10
  s_min_u32 s20, s20, 49
  s_lshl_b32 s20, s20, 10
  s_add_u32 s21, s20, 40960
  s_mov_b32 m0, s21
  s_nop 0
  buffer_load_dwordx4 v6, s[48:51], s20 offen lds
  s_mul_i32 s20, s16, 13
  s_add_u32 s20, s20, 11
  s_min_u32 s20, s20, 49
  s_lshl_b32 s20, s20, 10
  s_add_u32 s21, s20, 40960
  s_mov_b32 m0, s21
  s_nop 0
  buffer_load_dwordx4 v6, s[48:51], s20 offen lds
  s_mul_i32 s20, s16, 13
  s_add_u32 s20, s20, 12
  s_min_u32 s20, s20, 49
  s_lshl_b32 s20, s20, 10
  s_add_u32 s21, s20, 40960
  s_mov_b32 m0, s21
  s_nop 0
  buffer_load_dwordx4 v6, s[48:51], s20 offen lds
  v_add_u32 v14, 40960, v6
  v_mov_b32 v48, 0
  v_mov_b32 v49, 0
  v_mov_b32 v50, 0
  v_mov_b32 v51, 0
  v_lshlrev_b32 v5, 4, v1
  v_add_u32 v5, 35040, v5
  v_min_u32 v5, 38384, v5
  ds_write_b128 v5, v[48:51]
  v_mul_u32_u24 v5, 240, v2
  v_mul_u32_u24 v6, 80, v3
  v_add_u32 v5, v5, v6
  v_mov_b32 v7, 92160
  v_cndmask_b32 v12, v7, v5, vcc
  v_cvt_f32_u32 v5, v2
  v_mul_f32 v6, 0x3ae38e39, v5
  v_cos_f32 v80, v6
  v_sin_f32 v81, v6
  v_mul_f32 v6, 0x3b638e39, v5
  v_cos_f32 v82, v6
  v_sin_f32 v83, v6
  v_mul_f32 v6, 0x3baaaaab, v5
  v_cos_f32 v84, v6
  v_sin_f32 v85, v6
  v_and_b32 v1, 15, v0
  v_lshrrev_b32 v2, 2, v1
  v_and_b32 v1, 3, v1
  v_lshrrev_b32 v3, 4, v0
  v_lshrrev_b32 v4, 1, v3
  v_and_b32 v3, 1, v3
  v_lshl_add_u32 v4, v4, 3, v2
  v_mul_u32_u24 v4, 240, v4
  v_lshl_add_u32 v4, v3, 5, v4
  v_lshl_add_u32 v13, v1, 3, v4
  s_waitcnt vmcnt(13)
  v_lshlrev_b32 v48, 16, v16
  v_and_b32 v49, 0xffff0000, v16
  v_lshlrev_b32 v50, 16, v20
  v_and_b32 v51, 0xffff0000, v20
  v_lshlrev_b32 v52, 16, v24
  v_and_b32 v53, 0xffff0000, v24
  v_lshlrev_b32 v54, 16, v28
  v_and_b32 v55, 0xffff0000, v28
  v_lshlrev_b32 v56, 16, v32
  v_and_b32 v57, 0xffff0000, v32
  v_lshlrev_b32 v58, 16, v36
  v_and_b32 v59, 0xffff0000, v36
  v_lshlrev_b32 v60, 16, v40
  v_and_b32 v61, 0xffff0000, v40
  v_lshlrev_b32 v62, 16, v44
  v_and_b32 v63, 0xffff0000, v44
  v_pk_add_f32 v[64:65], v[48:49], v[56:57]
  v_pk_add_f32 v[66:67], v[50:51], v[58:59] neg_lo:[0,1] neg_hi:[0,1]
  v_pk_add_f32 v[68:69], v[48:49], v[56:57] neg_lo:[0,1] neg_hi:[0,1]
  v_pk_add_f32 v[70:71], v[50:51], v[58:59]
  v_pk_add_f32 v[72:73], v[52:53], v[60:61]
  v_pk_add_f32 v[74:75], v[54:55], v[62:63] neg_lo:[0,1] neg_hi:[0,1]
  v_pk_add_f32 v[76:77], v[52:53], v[60:61] neg_lo:[0,1] neg_hi:[0,1]
  v_pk_add_f32 v[78:79], v[54:55], v[62:63]
  v_pk_add_f32 v[48:49], v[64:65], v[72:73]
  v_pk_add_f32 v[50:51], v[66:67], v[74:75]
  v_pk_add_f32 v[56:57], v[64:65], v[72:73] neg_lo:[0,1] neg_hi:[0,1]
  v_pk_add_f32 v[58:59], v[66:67], v[74:75] neg_lo:[0,1] neg_hi:[0,1]
  v_pk_add_f32 v[52:53], v[68:69], v[78:79] neg_lo:[0,1] neg_hi:[0,1]
  v_pk_add_f32 v[54:55], v[70:71], v[76:77]
  v_pk_add_f32 v[60:61], v[68:69], v[78:79]
  v_pk_add_f32 v[62:63], v[70:71], v[76:77] neg_lo:[0,1] neg_hi:[0,1]
  v_pk_mul_f32 v[86:87], v[54:55], v[80:81] op_sel:[0,1] op_sel_hi:[1,1]
  v_pk_mul_f32 v[88:89], v[52:53], v[80:81] op_sel:[0,1] op_sel_hi:[1,1]
  v_pk_fma_f32 v[52:53], v[52:53], v[80:81], v[86:87] op_sel:[0,0,0] op_sel_hi:[1,0,1] neg_lo:[0,0,1] neg_hi:[0,0,1]
  v_pk_fma_f32 v[54:55], v[54:55], v[80:81], v[88:89] op_sel:[0,0,0] op_sel_hi:[1,0,1]
  v_pk_mul_f32 v[86:87], v[58:59], v[82:83] op_sel:[0,1] op_sel_hi:[1,1]
  v_pk_mul_f32 v[88:89], v[56:57], v[82:83] op_sel:[0,1] op_sel_hi:[1,1]
  v_pk_fma_f32 v[56:57], v[56:57], v[82:83], v[86:87] op_sel:[0,0,0] op_sel_hi:[1,0,1] neg_lo:[0,0,1] neg_hi:[0,0,1]
  v_pk_fma_f32 v[58:59], v[58:59], v[82:83], v[88:89] op_sel:[0,0,0] op_sel_hi:[1,0,1]
  v_pk_mul_f32 v[86:87], v[62:63], v[84:85] op_sel:[0,1] op_sel_hi:[1,1]
  v_pk_mul_f32 v[88:89], v[60:61], v[84:85] op_sel:[0,1] op_sel_hi:[1,1]
  v_pk_fma_f32 v[60:61], v[60:61], v[84:85], v[86:87] op_sel:[0,0,0] op_sel_hi:[1,0,1] neg_lo:[0,0,1] neg_hi:[0,0,1]
  v_pk_fma_f32 v[62:63], v[62:63], v[84:85], v[88:89] op_sel:[0,0,0] op_sel_hi:[1,0,1]
  v_cvt_pk_bf16_f32 v90, v48, v52
  v_cvt_pk_bf16_f32 v91, v56, v60
  v_cvt_pk_bf16_f32 v92, v49, v53
  v_cvt_pk_bf16_f32 v93, v57, v61
  ds_write_b128 v12, v[90:93] offset:0
  v_cvt_pk_bf16_f32 v94, v50, v54
  v_cvt_pk_bf16_f32 v95, v58, v62
  v_cvt_pk_bf16_f32 v96, v51, v55
  v_cvt_pk_bf16_f32 v97, v59, v63
  ds_write_b128 v12, v[94:97] offset:17520
  v_lshlrev_b32 v48, 16, v17
  v_and_b32 v49, 0xffff0000, v17
  v_lshlrev_b32 v50, 16, v21
  v_and_b32 v51, 0xffff0000, v21
  v_lshlrev_b32 v52, 16, v25
  v_and_b32 v53, 0xffff0000, v25
  v_lshlrev_b32 v54, 16, v29
  v_and_b32 v55, 0xffff0000, v29
  v_lshlrev_b32 v56, 16, v33
  v_and_b32 v57, 0xffff0000, v33
  v_lshlrev_b32 v58, 16, v37
  v_and_b32 v59, 0xffff0000, v37
  v_lshlrev_b32 v60, 16, v41
  v_and_b32 v61, 0xffff0000, v41
  v_lshlrev_b32 v62, 16, v45
  v_and_b32 v63, 0xffff0000, v45
  v_pk_add_f32 v[64:65], v[48:49], v[56:57]
  v_pk_add_f32 v[66:67], v[50:51], v[58:59] neg_lo:[0,1] neg_hi:[0,1]
  v_pk_add_f32 v[68:69], v[48:49], v[56:57] neg_lo:[0,1] neg_hi:[0,1]
  v_pk_add_f32 v[70:71], v[50:51], v[58:59]
  v_pk_add_f32 v[72:73], v[52:53], v[60:61]
  v_pk_add_f32 v[74:75], v[54:55], v[62:63] neg_lo:[0,1] neg_hi:[0,1]
  v_pk_add_f32 v[76:77], v[52:53], v[60:61] neg_lo:[0,1] neg_hi:[0,1]
  v_pk_add_f32 v[78:79], v[54:55], v[62:63]
  v_pk_add_f32 v[48:49], v[64:65], v[72:73]
  v_pk_add_f32 v[50:51], v[66:67], v[74:75]
  v_pk_add_f32 v[56:57], v[64:65], v[72:73] neg_lo:[0,1] neg_hi:[0,1]
  v_pk_add_f32 v[58:59], v[66:67], v[74:75] neg_lo:[0,1] neg_hi:[0,1]
  v_pk_add_f32 v[52:53], v[68:69], v[78:79] neg_lo:[0,1] neg_hi:[0,1]
  v_pk_add_f32 v[54:55], v[70:71], v[76:77]
  v_pk_add_f32 v[60:61], v[68:69], v[78:79]
  v_pk_add_f32 v[62:63], v[70:71], v[76:77] neg_lo:[0,1] neg_hi:[0,1]
  v_pk_mul_f32 v[86:87], v[54:55], v[80:81] op_sel:[0,1] op_sel_hi:[1,1]
  v_pk_mul_f32 v[88:89], v[52:53], v[80:81] op_sel:[0,1] op_sel_hi:[1,1]
  v_pk_fma_f32 v[52:53], v[52:53], v[80:81], v[86:87] op_sel:[0,0,0] op_sel_hi:[1,0,1] neg_lo:[0,0,1] neg_hi:[0,0,1]
  v_pk_fma_f32 v[54:55], v[54:55], v[80:81], v[88:89] op_sel:[0,0,0] op_sel_hi:[1,0,1]
  v_pk_mul_f32 v[86:87], v[58:59], v[82:83] op_sel:[0,1] op_sel_hi:[1,1]
  v_pk_mul_f32 v[88:89], v[56:57], v[82:83] op_sel:[0,1] op_sel_hi:[1,1]
  v_pk_fma_f32 v[56:57], v[56:57], v[82:83], v[86:87] op_sel:[0,0,0] op_sel_hi:[1,0,1] neg_lo:[0,0,1] neg_hi:[0,0,1]
  v_pk_fma_f32 v[58:59], v[58:59], v[82:83], v[88:89] op_sel:[0,0,0] op_sel_hi:[1,0,1]
  v_pk_mul_f32 v[86:87], v[62:63], v[84:85] op_sel:[0,1] op_sel_hi:[1,1]
  v_pk_mul_f32 v[88:89], v[60:61], v[84:85] op_sel:[0,1] op_sel_hi:[1,1]
  v_pk_fma_f32 v[60:61], v[60:61], v[84:85], v[86:87] op_sel:[0,0,0] op_sel_hi:[1,0,1] neg_lo:[0,0,1] neg_hi:[0,0,1]
  v_pk_fma_f32 v[62:63], v[62:63], v[84:85], v[88:89] op_sel:[0,0,0] op_sel_hi:[1,0,1]
  v_cvt_pk_bf16_f32 v98, v48, v52
  v_cvt_pk_bf16_f32 v99, v56, v60
  v_cvt_pk_bf16_f32 v100, v49, v53
  v_cvt_pk_bf16_f32 v101, v57, v61
  ds_write_b128 v12, v[98:101] offset:16
  v_cvt_pk_bf16_f32 v102, v50, v54
  v_cvt_pk_bf16_f32 v103, v58, v62
  v_cvt_pk_bf16_f32 v104, v51, v55
  v_cvt_pk_bf16_f32 v105, v59, v63
  ds_write_b128 v12, v[102:105] offset:17536
  v_lshlrev_b32 v48, 16, v18
  v_and_b32 v49, 0xffff0000, v18
  v_lshlrev_b32 v50, 16, v22
  v_and_b32 v51, 0xffff0000, v22
  v_lshlrev_b32 v52, 16, v26
  v_and_b32 v53, 0xffff0000, v26
  v_lshlrev_b32 v54, 16, v30
  v_and_b32 v55, 0xffff0000, v30
  v_lshlrev_b32 v56, 16, v34
  v_and_b32 v57, 0xffff0000, v34
  v_lshlrev_b32 v58, 16, v38
  v_and_b32 v59, 0xffff0000, v38
  v_lshlrev_b32 v60, 16, v42
  v_and_b32 v61, 0xffff0000, v42
  v_lshlrev_b32 v62, 16, v46
  v_and_b32 v63, 0xffff0000, v46
  v_pk_add_f32 v[64:65], v[48:49], v[56:57]
  v_pk_add_f32 v[66:67], v[50:51], v[58:59] neg_lo:[0,1] neg_hi:[0,1]
  v_pk_add_f32 v[68:69], v[48:49], v[56:57] neg_lo:[0,1] neg_hi:[0,1]
  v_pk_add_f32 v[70:71], v[50:51], v[58:59]
  v_pk_add_f32 v[72:73], v[52:53], v[60:61]
  v_pk_add_f32 v[74:75], v[54:55], v[62:63] neg_lo:[0,1] neg_hi:[0,1]
  v_pk_add_f32 v[76:77], v[52:53], v[60:61] neg_lo:[0,1] neg_hi:[0,1]
  v_pk_add_f32 v[78:79], v[54:55], v[62:63]
  v_pk_add_f32 v[48:49], v[64:65], v[72:73]
  v_pk_add_f32 v[50:51], v[66:67], v[74:75]
  v_pk_add_f32 v[56:57], v[64:65], v[72:73] neg_lo:[0,1] neg_hi:[0,1]
  v_pk_add_f32 v[58:59], v[66:67], v[74:75] neg_lo:[0,1] neg_hi:[0,1]
  v_pk_add_f32 v[52:53], v[68:69], v[78:79] neg_lo:[0,1] neg_hi:[0,1]
  v_pk_add_f32 v[54:55], v[70:71], v[76:77]
  v_pk_add_f32 v[60:61], v[68:69], v[78:79]
  v_pk_add_f32 v[62:63], v[70:71], v[76:77] neg_lo:[0,1] neg_hi:[0,1]
  v_pk_mul_f32 v[86:87], v[54:55], v[80:81] op_sel:[0,1] op_sel_hi:[1,1]
  v_pk_mul_f32 v[88:89], v[52:53], v[80:81] op_sel:[0,1] op_sel_hi:[1,1]
  v_pk_fma_f32 v[52:53], v[52:53], v[80:81], v[86:87] op_sel:[0,0,0] op_sel_hi:[1,0,1] neg_lo:[0,0,1] neg_hi:[0,0,1]
  v_pk_fma_f32 v[54:55], v[54:55], v[80:81], v[88:89] op_sel:[0,0,0] op_sel_hi:[1,0,1]
  v_pk_mul_f32 v[86:87], v[58:59], v[82:83] op_sel:[0,1] op_sel_hi:[1,1]
  v_pk_mul_f32 v[88:89], v[56:57], v[82:83] op_sel:[0,1] op_sel_hi:[1,1]
  v_pk_fma_f32 v[56:57], v[56:57], v[82:83], v[86:87] op_sel:[0,0,0] op_sel_hi:[1,0,1] neg_lo:[0,0,1] neg_hi:[0,0,1]
  v_pk_fma_f32 v[58:59], v[58:59], v[82:83], v[88:89] op_sel:[0,0,0] op_sel_hi:[1,0,1]
  v_pk_mul_f32 v[86:87], v[62:63], v[84:85] op_sel:[0,1] op_sel_hi:[1,1]
  v_pk_mul_f32 v[88:89], v[60:61], v[84:85] op_sel:[0,1] op_sel_hi:[1,1]
  v_pk_fma_f32 v[60:61], v[60:61], v[84:85], v[86:87] op_sel:[0,0,0] op_sel_hi:[1,0,1] neg_lo:[0,0,1] neg_hi:[0,0,1]
  v_pk_fma_f32 v[62:63], v[62:63], v[84:85], v[88:89] op_sel:[0,0,0] op_sel_hi:[1,0,1]
  v_cvt_pk_bf16_f32 v90, v48, v52
  v_cvt_pk_bf16_f32 v91, v56, v60
  v_cvt_pk_bf16_f32 v92, v49, v53
  v_cvt_pk_bf16_f32 v93, v57, v61
  ds_write_b128 v12, v[90:93] offset:32
  v_cvt_pk_bf16_f32 v94, v50, v54
  v_cvt_pk_bf16_f32 v95, v58, v62
  v_cvt_pk_bf16_f32 v96, v51, v55
  v_cvt_pk_bf16_f32 v97, v59, v63
  ds_write_b128 v12, v[94:97] offset:17552
  v_lshlrev_b32 v48, 16, v19
  v_and_b32 v49, 0xffff0000, v19
  v_lshlrev_b32 v50, 16, v23
  v_and_b32 v51, 0xffff0000, v23
  v_lshlrev_b32 v52, 16, v27
  v_and_b32 v53, 0xffff0000, v27
  v_lshlrev_b32 v54, 16, v31
  v_and_b32 v55, 0xffff0000, v31
  v_lshlrev_b32 v56, 16, v35
  v_and_b32 v57, 0xffff0000, v35
  v_lshlrev_b32 v58, 16, v39
  v_and_b32 v59, 0xffff0000, v39
  v_lshlrev_b32 v60, 16, v43
  v_and_b32 v61, 0xffff0000, v43
  v_lshlrev_b32 v62, 16, v47
  v_and_b32 v63, 0xffff0000, v47
  v_pk_add_f32 v[64:65], v[48:49], v[56:57]
  v_pk_add_f32 v[66:67], v[50:51], v[58:59] neg_lo:[0,1] neg_hi:[0,1]
  v_pk_add_f32 v[68:69], v[48:49], v[56:57] neg_lo:[0,1] neg_hi:[0,1]
  v_pk_add_f32 v[70:71], v[50:51], v[58:59]
  v_pk_add_f32 v[72:73], v[52:53], v[60:61]
  v_pk_add_f32 v[74:75], v[54:55], v[62:63] neg_lo:[0,1] neg_hi:[0,1]
  v_pk_add_f32 v[76:77], v[52:53], v[60:61] neg_lo:[0,1] neg_hi:[0,1]
  v_pk_add_f32 v[78:79], v[54:55], v[62:63]
  v_pk_add_f32 v[48:49], v[64:65], v[72:73]
  v_pk_add_f32 v[50:51], v[66:67], v[74:75]
  v_pk_add_f32 v[56:57], v[64:65], v[72:73] neg_lo:[0,1] neg_hi:[0,1]
  v_pk_add_f32 v[58:59], v[66:67], v[74:75] neg_lo:[0,1] neg_hi:[0,1]
  v_pk_add_f32 v[52:53], v[68:69], v[78:79] neg_lo:[0,1] neg_hi:[0,1]
  v_pk_add_f32 v[54:55], v[70:71], v[76:77]
  v_pk_add_f32 v[60:61], v[68:69], v[78:79]
  v_pk_add_f32 v[62:63], v[70:71], v[76:77] neg_lo:[0,1] neg_hi:[0,1]
  v_pk_mul_f32 v[86:87], v[54:55], v[80:81] op_sel:[0,1] op_sel_hi:[1,1]
  v_pk_mul_f32 v[88:89], v[52:53], v[80:81] op_sel:[0,1] op_sel_hi:[1,1]
  v_pk_fma_f32 v[52:53], v[52:53], v[80:81], v[86:87] op_sel:[0,0,0] op_sel_hi:[1,0,1] neg_lo:[0,0,1] neg_hi:[0,0,1]
  v_pk_fma_f32 v[54:55], v[54:55], v[80:81], v[88:89] op_sel:[0,0,0] op_sel_hi:[1,0,1]
  v_pk_mul_f32 v[86:87], v[58:59], v[82:83] op_sel:[0,1] op_sel_hi:[1,1]
  v_pk_mul_f32 v[88:89], v[56:57], v[82:83] op_sel:[0,1] op_sel_hi:[1,1]
  v_pk_fma_f32 v[56:57], v[56:57], v[82:83], v[86:87] op_sel:[0,0,0] op_sel_hi:[1,0,1] neg_lo:[0,0,1] neg_hi:[0,0,1]
  v_pk_fma_f32 v[58:59], v[58:59], v[82:83], v[88:89] op_sel:[0,0,0] op_sel_hi:[1,0,1]
  v_pk_mul_f32 v[86:87], v[62:63], v[84:85] op_sel:[0,1] op_sel_hi:[1,1]
  v_pk_mul_f32 v[88:89], v[60:61], v[84:85] op_sel:[0,1] op_sel_hi:[1,1]
  v_pk_fma_f32 v[60:61], v[60:61], v[84:85], v[86:87] op_sel:[0,0,0] op_sel_hi:[1,0,1] neg_lo:[0,0,1] neg_hi:[0,0,1]
  v_pk_fma_f32 v[62:63], v[62:63], v[84:85], v[88:89] op_sel:[0,0,0] op_sel_hi:[1,0,1]
  v_cvt_pk_bf16_f32 v98, v48, v52
  v_cvt_pk_bf16_f32 v99, v56, v60
  v_cvt_pk_bf16_f32 v100, v49, v53
  v_cvt_pk_bf16_f32 v101, v57, v61
  ds_write_b128 v12, v[98:101] offset:48
  v_cvt_pk_bf16_f32 v102, v50, v54
  v_cvt_pk_bf16_f32 v103, v58, v62
  v_cvt_pk_bf16_f32 v104, v51, v55
  v_cvt_pk_bf16_f32 v105, v59, v63
  ds_write_b128 v12, v[102:105] offset:17568
  s_waitcnt vmcnt(0) lgkmcnt(0)
  s_barrier
  v_and_b32 v1, 31, v0
  v_lshrrev_b32 v2, 5, v0
  v_mul_u32_u24 v2, 2304, v2
  v_lshl_add_u32 v15, v1, 3, v2
  s_mul_i32 s26, s18, 55296
  s_cmp_eq_u32 s16, 3
  s_cbranch_scc1 L_w3_54
  s_mul_i32 s20, s16, 80
  v_add_u32 v13, s20, v13
  s_mul_i32 s21, s16, 18432
  s_add_u32 s26, s26, s21
  ds_read_b64_tr_b16 v[16:17], v13 offset:0
  ds_read_b64_tr_b16 v[18:19], v13 offset:960
  ds_read_b64_tr_b16 v[20:21], v13 offset:3840
  ds_read_b64_tr_b16 v[22:23], v13 offset:4800
  ds_read_b64_tr_b16 v[24:25], v13 offset:7680
  ds_read_b64_tr_b16 v[26:27], v13 offset:8640
  ds_read_b64_tr_b16 v[28:29], v13 offset:11520
  ds_read_b64_tr_b16 v[30:31], v13 offset:12480
  ds_read_b64_tr_b16 v[32:33], v13 offset:15360
  ds_read_b64_tr_b16 v[34:35], v13 offset:16320
  ds_read_b64_tr_b16 v[36:37], v13 offset:19200
  ds_read_b64_tr_b16 v[38:39], v13 offset:20160
  s_waitcnt lgkmcnt(0)
  ds_read_b64_tr_b16 v[40:41], v13 offset:23040
  ds_read_b64_tr_b16 v[42:43], v13 offset:24000
  ds_read_b64_tr_b16 v[44:45], v13 offset:26880
  ds_read_b64_tr_b16 v[46:47], v13 offset:27840
  ds_read_b64_tr_b16 v[48:49], v13 offset:30720
  ds_read_b64_tr_b16 v[50:51], v13 offset:31680
  ds_read_b64_tr_b16 v[52:53], v13 offset:34560
  ds_read_b64_tr_b16 v[54:55], v13 offset:35520
  s_waitcnt lgkmcnt(0)
  ds_read_b128 v[96:99], v14 offset:0
  ds_read_b128 v[100:103], v14 offset:10240
  ds_read_b128 v[104:107], v14 offset:1024
  ds_read_b128 v[108:111], v14 offset:11264
  s_waitcnt lgkmcnt(3)
  v_mfma_f32_32x32x16_bf16 v[64:79], v[16:19], v[96:99], 0
  ds_read_b128 v[96:99], v14 offset:2048
  s_waitcnt lgkmcnt(3)
  v_mfma_f32_32x32x16_bf16 v[80:95], v[16:19], v[100:103], 0
  ds_read_b128 v[100:103], v14 offset:12288
  s_waitcnt lgkmcnt(3)
  v_mfma_f32_32x32x16_bf16 v[64:79], v[20:23], v[104:107], v[64:79]
  ds_read_b128 v[104:107], v14 offset:3072
  s_waitcnt lgkmcnt(3)
  v_mfma_f32_32x32x16_bf16 v[80:95], v[20:23], v[108:111], v[80:95]
  ds_read_b128 v[108:111], v14 offset:13312
  s_waitcnt lgkmcnt(3)
  v_mfma_f32_32x32x16_bf16 v[64:79], v[24:27], v[96:99], v[64:79]
  ds_read_b128 v[96:99], v14 offset:4096
  s_waitcnt lgkmcnt(3)
  v_mfma_f32_32x32x16_bf16 v[80:95], v[24:27], v[100:103], v[80:95]
  ds_read_b128 v[100:103], v14 offset:14336
  s_waitcnt lgkmcnt(3)
  v_mfma_f32_32x32x16_bf16 v[64:79], v[28:31], v[104:107], v[64:79]
  ds_read_b128 v[104:107], v14 offset:5120
  s_waitcnt lgkmcnt(3)
  v_mfma_f32_32x32x16_bf16 v[80:95], v[28:31], v[108:111], v[80:95]
  ds_read_b128 v[108:111], v14 offset:15360
  s_waitcnt lgkmcnt(3)
  v_mfma_f32_32x32x16_bf16 v[64:79], v[32:35], v[96:99], v[64:79]
  ds_read_b128 v[96:99], v14 offset:6144
  s_waitcnt lgkmcnt(3)
  v_mfma_f32_32x32x16_bf16 v[80:95], v[32:35], v[100:103], v[80:95]
  ds_read_b128 v[100:103], v14 offset:16384
  s_waitcnt lgkmcnt(3)
  v_mfma_f32_32x32x16_bf16 v[64:79], v[36:39], v[104:107], v[64:79]
  ds_read_b128 v[104:107], v14 offset:7168
  s_waitcnt lgkmcnt(3)
  v_mfma_f32_32x32x16_bf16 v[80:95], v[36:39], v[108:111], v[80:95]
  ds_read_b128 v[108:111], v14 offset:17408
  s_waitcnt lgkmcnt(3)
  v_mfma_f32_32x32x16_bf16 v[64:79], v[40:43], v[96:99], v[64:79]
  ds_read_b128 v[96:99], v14 offset:8192
  s_waitcnt lgkmcnt(3)
  v_mfma_f32_32x32x16_bf16 v[80:95], v[40:43], v[100:103], v[80:95]
  ds_read_b128 v[100:103], v14 offset:18432
  s_waitcnt lgkmcnt(3)
  v_mfma_f32_32x32x16_bf16 v[64:79], v[44:47], v[104:107], v[64:79]
  ds_read_b128 v[104:107], v14 offset:9216
  s_waitcnt lgkmcnt(3)
  v_mfma_f32_32x32x16_bf16 v[80:95], v[44:47], v[108:111], v[80:95]
  ds_read_b128 v[108:111], v14 offset:19456
  s_waitcnt lgkmcnt(3)
  v_mfma_f32_32x32x16_bf16 v[64:79], v[48:51], v[96:99], v[64:79]
  s_waitcnt lgkmcnt(2)
  v_mfma_f32_32x32x16_bf16 v[80:95], v[48:51], v[100:103], v[80:95]
  s_waitcnt lgkmcnt(1)
  v_mfma_f32_32x32x16_bf16 v[64:79], v[52:55], v[104:107], v[64:79]
  s_waitcnt lgkmcnt(0)
  v_mfma_f32_32x32x16_bf16 v[80:95], v[52:55], v[108:111], v[80:95]
  s_nop 7
  s_nop 3
  v_cvt_pk_bf16_f32 v112, v64, v65
  v_cvt_pk_bf16_f32 v113, v66, v67
  s_add_u32 s27, s26, 0
  buffer_store_dwordx2 v[112:113], v15, s[12:15], s27 offen offset:0
  v_cvt_pk_bf16_f32 v114, v68, v69
  v_cvt_pk_bf16_f32 v115, v70, v71
  s_add_u32 s27, s26, 4608
  buffer_store_dwordx2 v[114:115], v15, s[12:15], s27 offen offset:0
  v_cvt_pk_bf16_f32 v116, v72, v73
  v_cvt_pk_bf16_f32 v117, v74, v75
  s_add_u32 s27, s26, 9216
  buffer_store_dwordx2 v[116:117], v15, s[12:15], s27 offen offset:0
  v_cvt_pk_bf16_f32 v118, v76, v77
  v_cvt_pk_bf16_f32 v119, v78, v79
  s_add_u32 s27, s26, 13824
  buffer_store_dwordx2 v[118:119], v15, s[12:15], s27 offen offset:0
  v_cvt_pk_bf16_f32 v112, v80, v81
  v_cvt_pk_bf16_f32 v113, v82, v83
  s_add_u32 s27, s26, 0
  buffer_store_dwordx2 v[112:113], v15, s[12:15], s27 offen offset:256
  v_cvt_pk_bf16_f32 v114, v84, v85
  v_cvt_pk_bf16_f32 v115, v86, v87
  s_add_u32 s27, s26, 4608
  buffer_store_dwordx2 v[114:115], v15, s[12:15], s27 offen offset:256
  v_cvt_pk_bf16_f32 v116, v88, v89
  v_cvt_pk_bf16_f32 v117, v90, v91
  s_add_u32 s27, s26, 9216
  buffer_store_dwordx2 v[116:117], v15, s[12:15], s27 offen offset:256
  v_cvt_pk_bf16_f32 v118, v92, v93
  v_cvt_pk_bf16_f32 v119, v94, v95
  s_add_u32 s27, s26, 13824
  buffer_store_dwordx2 v[118:119], v15, s[12:15], s27 offen offset:256
  s_nop 1
  ds_read_b128 v[96:99], v14 offset:20480
  ds_read_b128 v[100:103], v14 offset:30720
  ds_read_b128 v[104:107], v14 offset:21504
  ds_read_b128 v[108:111], v14 offset:31744
  s_waitcnt lgkmcnt(3)
  v_mfma_f32_32x32x16_bf16 v[64:79], v[16:19], v[96:99], 0
  ds_read_b128 v[96:99], v14 offset:22528
  s_waitcnt lgkmcnt(3)
  v_mfma_f32_32x32x16_bf16 v[80:95], v[16:19], v[100:103], 0
  ds_read_b128 v[100:103], v14 offset:32768
  s_waitcnt lgkmcnt(3)
  v_mfma_f32_32x32x16_bf16 v[64:79], v[20:23], v[104:107], v[64:79]
  ds_read_b128 v[104:107], v14 offset:23552
  s_waitcnt lgkmcnt(3)
  v_mfma_f32_32x32x16_bf16 v[80:95], v[20:23], v[108:111], v[80:95]
  ds_read_b128 v[108:111], v14 offset:33792
  s_waitcnt lgkmcnt(3)
  v_mfma_f32_32x32x16_bf16 v[64:79], v[24:27], v[96:99], v[64:79]
  ds_read_b128 v[96:99], v14 offset:24576
  s_waitcnt lgkmcnt(3)
  v_mfma_f32_32x32x16_bf16 v[80:95], v[24:27], v[100:103], v[80:95]
  ds_read_b128 v[100:103], v14 offset:34816
  s_waitcnt lgkmcnt(3)
  v_mfma_f32_32x32x16_bf16 v[64:79], v[28:31], v[104:107], v[64:79]
  ds_read_b128 v[104:107], v14 offset:25600
  s_waitcnt lgkmcnt(3)
  v_mfma_f32_32x32x16_bf16 v[80:95], v[28:31], v[108:111], v[80:95]
  ds_read_b128 v[108:111], v14 offset:35840
  s_waitcnt lgkmcnt(3)
  v_mfma_f32_32x32x16_bf16 v[64:79], v[32:35], v[96:99], v[64:79]
  ds_read_b128 v[96:99], v14 offset:26624
  s_waitcnt lgkmcnt(3)
  v_mfma_f32_32x32x16_bf16 v[80:95], v[32:35], v[100:103], v[80:95]
  ds_read_b128 v[100:103], v14 offset:36864
  s_waitcnt lgkmcnt(3)
  v_mfma_f32_32x32x16_bf16 v[64:79], v[36:39], v[104:107], v[64:79]
  ds_read_b128 v[104:107], v14 offset:27648
  s_waitcnt lgkmcnt(3)
  v_mfma_f32_32x32x16_bf16 v[80:95], v[36:39], v[108:111], v[80:95]
  ds_read_b128 v[108:111], v14 offset:37888
  s_waitcnt lgkmcnt(3)
  v_mfma_f32_32x32x16_bf16 v[64:79], v[40:43], v[96:99], v[64:79]
  ds_read_b128 v[96:99], v14 offset:28672
  s_waitcnt lgkmcnt(3)
  v_mfma_f32_32x32x16_bf16 v[80:95], v[40:43], v[100:103], v[80:95]
  ds_read_b128 v[100:103], v14 offset:38912
  s_waitcnt lgkmcnt(3)
  v_mfma_f32_32x32x16_bf16 v[64:79], v[44:47], v[104:107], v[64:79]
  ds_read_b128 v[104:107], v14 offset:29696
  s_waitcnt lgkmcnt(3)
  v_mfma_f32_32x32x16_bf16 v[80:95], v[44:47], v[108:111], v[80:95]
  ds_read_b128 v[108:111], v14 offset:39936
  s_waitcnt lgkmcnt(3)
  v_mfma_f32_32x32x16_bf16 v[64:79], v[48:51], v[96:99], v[64:79]
  s_waitcnt lgkmcnt(2)
  v_mfma_f32_32x32x16_bf16 v[80:95], v[48:51], v[100:103], v[80:95]
  s_waitcnt lgkmcnt(1)
  v_mfma_f32_32x32x16_bf16 v[64:79], v[52:55], v[104:107], v[64:79]
  s_waitcnt lgkmcnt(0)
  v_mfma_f32_32x32x16_bf16 v[80:95], v[52:55], v[108:111], v[80:95]
  s_nop 7
  s_nop 3
  v_cvt_pk_bf16_f32 v112, v64, v65
  v_cvt_pk_bf16_f32 v113, v66, v67
  s_add_u32 s27, s26, 0
  buffer_store_dwordx2 v[112:113], v15, s[12:15], s27 offen offset:512
  v_cvt_pk_bf16_f32 v114, v68, v69
  v_cvt_pk_bf16_f32 v115, v70, v71
  s_add_u32 s27, s26, 4608
  buffer_store_dwordx2 v[114:115], v15, s[12:15], s27 offen offset:512
  v_cvt_pk_bf16_f32 v116, v72, v73
  v_cvt_pk_bf16_f32 v117, v74, v75
  s_add_u32 s27, s26, 9216
  buffer_store_dwordx2 v[116:117], v15, s[12:15], s27 offen offset:512
  v_cvt_pk_bf16_f32 v118, v76, v77
  v_cvt_pk_bf16_f32 v119, v78, v79
  s_add_u32 s27, s26, 13824
  buffer_store_dwordx2 v[118:119], v15, s[12:15], s27 offen offset:512
  v_cvt_pk_bf16_f32 v112, v80, v81
  v_cvt_pk_bf16_f32 v113, v82, v83
  s_add_u32 s27, s26, 0
  buffer_store_dwordx2 v[112:113], v15, s[12:15], s27 offen offset:768
  v_cvt_pk_bf16_f32 v114, v84, v85
  v_cvt_pk_bf16_f32 v115, v86, v87
  s_add_u32 s27, s26, 4608
  buffer_store_dwordx2 v[114:115], v15, s[12:15], s27 offen offset:768
  v_cvt_pk_bf16_f32 v116, v88, v89
  v_cvt_pk_bf16_f32 v117, v90, v91
  s_add_u32 s27, s26, 9216
  buffer_store_dwordx2 v[116:117], v15, s[12:15], s27 offen offset:768
  v_cvt_pk_bf16_f32 v118, v92, v93
  v_cvt_pk_bf16_f32 v119, v94, v95
  s_add_u32 s27, s26, 13824
  buffer_store_dwordx2 v[118:119], v15, s[12:15], s27 offen offset:768
  s_nop 1
  s_branch L_a3d_55
L_w3_54:
  v_cmp_gt_u32 vcc, 16, v1
  v_mov_b32 v7, 0x7ff00000
  s_nop 0
  v_cndmask_b32 v15, v7, v15, vcc
  ds_read_b128 v[96:99], v14 offset:40960
  ds_read_b128 v[100:103], v14 offset:41984
  ds_read_b128 v[104:107], v14 offset:43008
  ds_read_b128 v[108:111], v14 offset:44032
  ds_read_b128 v[112:115], v14 offset:45056
  ds_read_b128 v[116:119], v14 offset:46080
  ds_read_b128 v[120:123], v14 offset:47104
  ds_read_b128 v[124:127], v14 offset:48128
  ds_read_b128 v[128:131], v14 offset:49152
  ds_read_b128 v[132:135], v14 offset:50176
  s_waitcnt lgkmcnt(0)
  ds_read_b64_tr_b16 v[16:17], v13 offset:0
  ds_read_b64_tr_b16 v[18:19], v13 offset:960
  ds_read_b64_tr_b16 v[20:21], v13 offset:80
  ds_read_b64_tr_b16 v[22:23], v13 offset:1040
  ds_read_b64_tr_b16 v[24:25], v13 offset:160
  ds_read_b64_tr_b16 v[26:27], v13 offset:1120
  ds_read_b64_tr_b16 v[28:29], v13 offset:3840
  ds_read_b64_tr_b16 v[30:31], v13 offset:4800
  s_waitcnt lgkmcnt(6)
  v_mfma_f32_32x32x16_bf16 v[136:151], v[16:19], v[96:99], 0
  ds_read_b64_tr_b16 v[16:17], v13 offset:3920
  ds_read_b64_tr_b16 v[18:19], v13 offset:4880
  s_waitcnt lgkmcnt(6)
  v_mfma_f32_32x32x16_bf16 v[152:167], v[20:23], v[96:99], 0
  ds_read_b64_tr_b16 v[20:21], v13 offset:4000
  ds_read_b64_tr_b16 v[22:23], v13 offset:4960
  s_waitcnt lgkmcnt(6)
  v_mfma_f32_32x32x16_bf16 v[168:183], v[24:27], v[96:99], 0
  ds_read_b64_tr_b16 v[24:25], v13 offset:7680
  ds_read_b64_tr_b16 v[26:27], v13 offset:8640
  s_waitcnt lgkmcnt(6)
  v_mfma_f32_32x32x16_bf16 v[136:151], v[28:31], v[100:103], v[136:151]
  ds_read_b64_tr_b16 v[28:29], v13 offset:7760
  ds_read_b64_tr_b16 v[30:31], v13 offset:8720
  s_waitcnt lgkmcnt(6)
  v_mfma_f32_32x32x16_bf16 v[152:167], v[16:19], v[100:103], v[152:167]
  ds_read_b64_tr_b16 v[16:17], v13 offset:7840
  ds_read_b64_tr_b16 v[18:19], v13 offset:8800
  s_waitcnt lgkmcnt(6)
  v_mfma_f32_32x32x16_bf16 v[168:183], v[20:23], v[100:103], v[168:183]
  ds_read_b64_tr_b16 v[20:21], v13 offset:11520
  ds_read_b64_tr_b16 v[22:23], v13 offset:12480
  s_waitcnt lgkmcnt(6)
  v_mfma_f32_32x32x16_bf16 v[136:151], v[24:27], v[104:107], v[136:151]
  ds_read_b64_tr_b16 v[24:25], v13 offset:11600
  ds_read_b64_tr_b16 v[26:27], v13 offset:12560
  s_waitcnt lgkmcnt(6)
  v_mfma_f32_32x32x16_bf16 v[152:167], v[28:31], v[104:107], v[152:167]
  ds_read_b64_tr_b16 v[28:29], v13 offset:11680
  ds_read_b64_tr_b16 v[30:31], v13 offset:12640
  s_waitcnt lgkmcnt(6)
  v_mfma_f32_32x32x16_bf16 v[168:183], v[16:19], v[104:107], v[168:183]
  ds_read_b64_tr_b16 v[16:17], v13 offset:15360
  ds_read_b64_tr_b16 v[18:19], v13 offset:16320
  s_waitcnt lgkmcnt(6)
  v_mfma_f32_32x32x16_bf16 v[136:151], v[20:23], v[108:111], v[136:151]
  ds_read_b64_tr_b16 v[20:21], v13 offset:15440
  ds_read_b64_tr_b16 v[22:23], v13 offset:16400
  s_waitcnt lgkmcnt(6)
  v_mfma_f32_32x32x16_bf16 v[152:167], v[24:27], v[108:111], v[152:167]
  ds_read_b64_tr_b16 v[24:25], v13 offset:15520
  ds_read_b64_tr_b16 v[26:27], v13 offset:16480
  s_waitcnt lgkmcnt(6)
  v_mfma_f32_32x32x16_bf16 v[168:183], v[28:31], v[108:111], v[168:183]
  ds_read_b64_tr_b16 v[28:29], v13 offset:19200
  ds_read_b64_tr_b16 v[30:31], v13 offset:20160
  s_waitcnt lgkmcnt(6)
  v_mfma_f32_32x32x16_bf16 v[136:151], v[16:19], v[112:115], v[136:151]
  ds_read_b64_tr_b16 v[16:17], v13 offset:19280
  ds_read_b64_tr_b16 v[18:19], v13 offset:20240
  s_waitcnt lgkmcnt(6)
  v_mfma_f32_32x32x16_bf16 v[152:167], v[20:23], v[112:115], v[152:167]
  ds_read_b64_tr_b16 v[20:21], v13 offset:19360
  ds_read_b64_tr_b16 v[22:23], v13 offset:20320
  s_waitcnt lgkmcnt(6)
  v_mfma_f32_32x32x16_bf16 v[168:183], v[24:27], v[112:115], v[168:183]
  ds_read_b64_tr_b16 v[24:25], v13 offset:23040
  ds_read_b64_tr_b16 v[26:27], v13 offset:24000
  s_waitcnt lgkmcnt(6)
  v_mfma_f32_32x32x16_bf16 v[136:151], v[28:31], v[116:119], v[136:151]
  ds_read_b64_tr_b16 v[28:29], v13 offset:23120
  ds_read_b64_tr_b16 v[30:31], v13 offset:24080
  s_waitcnt lgkmcnt(6)
  v_mfma_f32_32x32x16_bf16 v[152:167], v[16:19], v[116:119], v[152:167]
  ds_read_b64_tr_b16 v[16:17], v13 offset:23200
  ds_read_b64_tr_b16 v[18:19], v13 offset:24160
  s_waitcnt lgkmcnt(6)
  v_mfma_f32_32x32x16_bf16 v[168:183], v[20:23], v[116:119], v[168:183]
  ds_read_b64_tr_b16 v[20:21], v13 offset:26880
  ds_read_b64_tr_b16 v[22:23], v13 offset:27840
  s_waitcnt lgkmcnt(6)
  v_mfma_f32_32x32x16_bf16 v[136:151], v[24:27], v[120:123], v[136:151]
  ds_read_b64_tr_b16 v[24:25], v13 offset:26960
  ds_read_b64_tr_b16 v[26:27], v13 offset:27920
  s_waitcnt lgkmcnt(6)
  v_mfma_f32_32x32x16_bf16 v[152:167], v[28:31], v[120:123], v[152:167]
  ds_read_b64_tr_b16 v[28:29], v13 offset:27040
  ds_read_b64_tr_b16 v[30:31], v13 offset:28000
  s_waitcnt lgkmcnt(6)
  v_mfma_f32_32x32x16_bf16 v[168:183], v[16:19], v[120:123], v[168:183]
  ds_read_b64_tr_b16 v[16:17], v13 offset:30720
  ds_read_b64_tr_b16 v[18:19], v13 offset:31680
  s_waitcnt lgkmcnt(6)
  v_mfma_f32_32x32x16_bf16 v[136:151], v[20:23], v[124:127], v[136:151]
  ds_read_b64_tr_b16 v[20:21], v13 offset:30800
  ds_read_b64_tr_b16 v[22:23], v13 offset:31760
  s_waitcnt lgkmcnt(6)
  v_mfma_f32_32x32x16_bf16 v[152:167], v[24:27], v[124:127], v[152:167]
  ds_read_b64_tr_b16 v[24:25], v13 offset:30880
  ds_read_b64_tr_b16 v[26:27], v13 offset:31840
  s_waitcnt lgkmcnt(6)
  v_mfma_f32_32x32x16_bf16 v[168:183], v[28:31], v[124:127], v[168:183]
  ds_read_b64_tr_b16 v[28:29], v13 offset:34560
  ds_read_b64_tr_b16 v[30:31], v13 offset:35520
  s_waitcnt lgkmcnt(6)
  v_mfma_f32_32x32x16_bf16 v[136:151], v[16:19], v[128:131], v[136:151]
  ds_read_b64_tr_b16 v[16:17], v13 offset:34640
  ds_read_b64_tr_b16 v[18:19], v13 offset:35600
  s_waitcnt lgkmcnt(6)
  v_mfma_f32_32x32x16_bf16 v[152:167], v[20:23], v[128:131], v[152:167]
  ds_read_b64_tr_b16 v[20:21], v13 offset:34720
  ds_read_b64_tr_b16 v[22:23], v13 offset:35680
  s_waitcnt lgkmcnt(6)
  v_mfma_f32_32x32x16_bf16 v[168:183], v[24:27], v[128:131], v[168:183]
  s_waitcnt lgkmcnt(4)
  v_mfma_f32_32x32x16_bf16 v[136:151], v[28:31], v[132:135], v[136:151]
  s_waitcnt lgkmcnt(2)
  v_mfma_f32_32x32x16_bf16 v[152:167], v[16:19], v[132:135], v[152:167]
  s_waitcnt lgkmcnt(0)
  v_mfma_f32_32x32x16_bf16 v[168:183], v[20:23], v[132:135], v[168:183]
  s_nop 7
  s_nop 3
  v_cvt_pk_bf16_f32 v184, v136, v137
  v_cvt_pk_bf16_f32 v185, v138, v139
  s_add_u32 s27, s26, 0
  buffer_store_dwordx2 v[184:185], v15, s[12:15], s27 offen offset:1024
  v_cvt_pk_bf16_f32 v186, v140, v141
  v_cvt_pk_bf16_f32 v187, v142, v143
  s_add_u32 s27, s26, 4608
  buffer_store_dwordx2 v[186:187], v15, s[12:15], s27 offen offset:1024
  v_cvt_pk_bf16_f32 v188, v144, v145
  v_cvt_pk_bf16_f32 v189, v146, v147
  s_add_u32 s27, s26, 9216
  buffer_store_dwordx2 v[188:189], v15, s[12:15], s27 offen offset:1024
  v_cvt_pk_bf16_f32 v190, v148, v149
  v_cvt_pk_bf16_f32 v191, v150, v151
  s_add_u32 s27, s26, 13824
  buffer_store_dwordx2 v[190:191], v15, s[12:15], s27 offen offset:1024
  v_cvt_pk_bf16_f32 v192, v152, v153
  v_cvt_pk_bf16_f32 v193, v154, v155
  s_add_u32 s27, s26, 18432
  buffer_store_dwordx2 v[192:193], v15, s[12:15], s27 offen offset:1024
  v_cvt_pk_bf16_f32 v194, v156, v157
  v_cvt_pk_bf16_f32 v195, v158, v159
  s_add_u32 s27, s26, 23040
  buffer_store_dwordx2 v[194:195], v15, s[12:15], s27 offen offset:1024
  v_cvt_pk_bf16_f32 v196, v160, v161
  v_cvt_pk_bf16_f32 v197, v162, v163
  s_add_u32 s27, s26, 27648
  buffer_store_dwordx2 v[196:197], v15, s[12:15], s27 offen offset:1024
  v_cvt_pk_bf16_f32 v198, v164, v165
  v_cvt_pk_bf16_f32 v199, v166, v167
  s_add_u32 s27, s26, 32256
  buffer_store_dwordx2 v[198:199], v15, s[12:15], s27 offen offset:1024
  v_cvt_pk_bf16_f32 v200, v168, v169
  v_cvt_pk_bf16_f32 v201, v170, v171
  s_add_u32 s27, s26, 36864
  buffer_store_dwordx2 v[200:201], v15, s[12:15], s27 offen offset:1024
  v_cvt_pk_bf16_f32 v202, v172, v173
  v_cvt_pk_bf16_f32 v203, v174, v175
  s_add_u32 s27, s26, 41472
  buffer_store_dwordx2 v[202:203], v15, s[12:15], s27 offen offset:1024
  v_cvt_pk_bf16_f32 v204, v176, v177
  v_cvt_pk_bf16_f32 v205, v178, v179
  s_add_u32 s27, s26, 46080
  buffer_store_dwordx2 v[204:205], v15, s[12:15], s27 offen offset:1024
  v_cvt_pk_bf16_f32 v206, v180, v181
  v_cvt_pk_bf16_f32 v207, v182, v183
  s_add_u32 s27, s26, 50688
  buffer_store_dwordx2 v[206:207], v15, s[12:15], s27 offen offset:1024
L_a3d_55:
L_fin_51:
L_end_50:
  s_endpgm
.section .rodata,"a"
.p2align 6
.amdhsa_kernel outp_kernel
  .amdhsa_next_free_vgpr 256
  .amdhsa_next_free_sgpr 102
  .amdhsa_accum_offset 256
  .amdhsa_group_segment_fixed_size 0
  .amdhsa_kernarg_size 88
  .amdhsa_user_sgpr_count 2
  .amdhsa_user_sgpr_kernarg_segment_ptr 1
  .amdhsa_system_sgpr_workgroup_id_x 1
  .amdhsa_float_denorm_mode_32 3
.end_amdhsa_kernel
.text
.text
.p2align 8
.type tab_a1,@object
tab_a1:
.quad 0x3f803f803f803f80,0x3f803f803f803f80,0x3f7e3f7f3f803f80,0x3f743f773f7a3f7c,0x3f773f7c3f7f3f80,0x3f523f5e3f683f71,0x3f6d3f773f7e3f80,0x3f1c3f353f4b3f5e,0x3f5e3f713f7c3f80,0x3eaf3f003f253f44,0x3f4b3f683f7a3f80,0x3d333e853eec3f25,0x3f353f5e3f773f80,0xbe85248d3e853f00,0x3f1c3f523f743f80,0xbf0abe853d333eaf
.quad 0x3f003f443f713f80,0xbf44bf00be323e32,0x3ec43f353f6d3f80,0xbf6dbf35bec4248d,0x3e853f253f683f80,0xbf7fbf5ebf13be32,0x3e063f133f633f80,0xbf7abf77bf3dbeaf,0x248d3f003f5e3f80,0xbf5ebf80bf5ebf00,0xbe063ed83f583f80,0xbf2dbf77bf74bf25,0xbe853eaf3f523f80,0xbed8bf5ebf7fbf44,0xbec43e853f4b3f80,0xbe06bf35bf7ebf5e
.quad 0xbf003e323f443f80,0x3e32bf00bf71bf71,0xbf1c3db23f3d3f80,0x3eecbe85bf58bf7c,0xbf35248d3f353f80,0x3f35a554bf35bf80,0xbf4bbdb23f2d3f80,0x3f633e85bf0abf7c,0xbf5ebe323f253f80,0x3f7c3f00beafbf71,0xbf6dbe853f1c3f80,0x3f7e3f35be06bf5e,0xbf77beaf3f133f80,0x3f683f5e3db2bf44,0xbf7ebed83f0a3f80,0x3f3d3f773e9abf25
.quad 0xbf80bf003f003f80,0x3f003f803f00bf00,0xbf7ebf133eec3f80,0x3e5e3f773f2dbeaf,0xbf77bf253ed83f80,0xbdb23f5e3f52be32,0xbf6dbf353ec43f80,0xbec43f353f6da554,0xbf5ebf443eaf3f80,0xbf253f003f7c3e32,0xbf4bbf523e9a3f80,0xbf583e853f803eaf,0xbf35bf5e3e853f80,0xbf77248d3f773f00,0xbf1cbf683e5e3f80,0xbf80be853f633f25
.quad 0x3f803f803f803f80,0x3f803f803f803f80,0x3f633f683f6d3f71,0x3f4b3f523f583f5e,0x3f133f253f353f44,0x3e853eaf3ed83f00,0x3e063e853ec43f00,0xbec4be85be06248d,0xbeafbe32248d3e32,0xbf5ebf44bf25bf00,0xbf3dbf13bec4be32,0xbf7ebf7fbf74bf5e,0xbf77bf5ebf35bf00,0xbf35bf5ebf77bf80,0xbf7abf7fbf6dbf44,0xbe06bed8bf2dbf5e
.quad 0xbf44bf71bf80bf71,0x3f003e32be32bf00,0xbec4bf35bf6dbf80,0x3f6d3f353ec4a554,0x3db2beafbf35bf71,0x3f773f7c3f523f00,0x3f0a3db2bec4bf44,0x3f1c3f683f803f5e,0x3f5e3f00a554bf00,0x248d3f003f5e3f80,0x3f803f523ec4be32,0xbf1cbdb23eec3f5e,0x3f683f7c3f353e32,0xbf77bf25bdb23f00,0x3f1c3f773f6d3f00,0xbf6dbf77bf1c248d
.quad 0x3e323f443f803f44,0xbf00bf71bf71bf00,0xbe9a3ed83f6d3f71,0x3e06bf13bf7abf5e,0xbf35248d3f353f80,0x3f35a554bf35bf80,0xbf74bed83ec43f71,0x3f7e3f13be5ebf5e,0xbf7cbf44248d3f44,0x3f5e3f713eafbf00,0xbf4bbf77bec43f00,0x3ec43f773f4ba554,0xbed8bf7cbf353e32,0xbe853f253f7f3f00,0x3d33bf52bf6dbe32,0xbf4b3db23f633f5e
.quad 0x3f00bf00bf80bf00,0xbf80bf003f003f80,0x3f58bdb2bf6dbf44,0xbf4bbf68bd333f5e,0x3f7f3eafbf35bf71,0xbe85bf7cbf133f00,0x3f6d3f35bec4bf80,0x3ec4bf35bf6d248d,0x3f253f71a554bf71,0x3f5ebe32bf7cbf00,0x3e5e3f7f3ec4bf44,0x3f7e3ed8bf3dbf5e,0xbe853f5e3f35bf00,0x3f353f5ebe85bf80,0xbf2d3f133f6dbe32,0x3e063f7f3e9abf5e
.quad 0x3f803f803f803f80,0x3f803f803f803f80,0x3f2d3f353f3d3f44,0x3f0a3f133f1c3f25,0xbdb2248d3db23e32,0xbed8beafbe85be32,0xbf4bbf35bf1cbf00,0xbf7ebf77bf6dbf5e,0xbf7cbf80bf7cbf71,0xbf25bf44bf5ebf71,0xbf0abf35bf58bf71,0x3e9a3db2be06beaf,0x3e85a554be85bf00,0x3f773f5e3f353f00,0x3f633f353eec3e32,0x3f3d3f683f7e3f7c
.quad 0x3f713f803f713f44,0xbe323e323f003f44,0x3ec43f353f6d3f80,0xbf6dbf35bec4248d,0xbed8248d3ed83f44,0xbf52bf7cbf77bf44,0xbf74bf35be9a3e32,0x3d33bed8bf4bbf7c,0xbf5ebf80bf5ebf00,0x3f5e3f00a554bf00,0xbe5ebf35bf7abf71,0x3f633f7f3f4b3eaf,0x3f13a554bf13bf71,0x3db23f253f773f71,0x3f7e3f353e06bf00,0xbf4bbe853ec43f5e
.quad 0x3f443f803f443e32,0xbf71bf71bf003e32,0x3d333f353f803f44,0xbe5ebf52bf7ebf25,0xbf35248d3f353f80,0x3f35a554bf35bf80,0xbf80bf353d333f44,0x3f7a3f523e06bf25,0xbf25bf80bf253e32,0x3eaf3f713f5e3e32,0x3e06bf35bf7ebf00,0xbf1c3e853f6d3f5e,0x3f52a554bf52bf71,0xbf7fbf253e853f71,0x3f7a3f35be5ebf71,0xbeecbf7fbf1c3eaf
.quad 0x3f003f803f00bf00,0x3f00bf00bf80bf00,0xbe9a3f353f743e32,0x3f803ed8bf1cbf7c,0xbf68248d3f683f44,0x3f133f7c3e85bf44,0xbf6dbf353ec43f80,0xbec43f353f6da554,0xbeafbf80beaf3f44,0xbf7cbe323f5e3f44,0x3eecbf35bf633e32,0xbf2dbf683e063f7c,0x3f77a554bf77bf00,0x3e85bf5ebf353f00,0x3f583f35bf0abf71,0x3f74bdb2bf7ebeaf
.quad 0x3f803f803f803f80,0x3f803f803f803f80,0x3ec43ed83eec3f00,0x3e5e3e853e9a3eaf,0xbf35bf25bf13bf00,0xbf68bf5ebf52bf44,0xbf6dbf77bf7ebf80,0xbf1cbf35bf4bbf5e,0xa554be32beafbf00,0x3f253f003eaf3e32,0x3f6d3f523f2d3f00,0x3f633f773f803f7c,0x3f353f5e3f773f80,0xbe85248d3e853f00,0xbec4bdb23e5e3f00,0xbf80bf77bf58bf25
.quad 0xbf80bf71bf44bf00,0xbe32bf00bf44bf71,0xbec4bf35bf6dbf80,0x3f6d3f353ec4a554,0x3f353eafbdb2bf00,0x3f133f5e3f7f3f71,0x3f6d3f7f3f583f00,0xbf2dbe853e5e3f25,0x248d3f003f5e3f80,0xbf5ebf80bf5ebf00,0xbf6dbf13bd333f00,0x3e9abe85bf3dbf7c,0xbf35bf7cbf68bf00,0x3f7f3f5e3ed8be32,0x3ec4be85bf4bbf80,0x3e063f353f7e3f5e
.quad 0x3f803f443e32bf00,0xbf71bf003e323f44,0x3ec43f683f743f00,0xbf0abf77bf63beaf,0xbf35248d3f353f80,0x3f35a554bf35bf80,0xbf6dbf68be9a3f00,0x3f583f773eecbeaf,0xa554bf44bf7cbf00,0xbeaf3f003f7c3f44,0x3f6d3e85bf1cbf80,0xbf7ebf353e063f5e,0x3f353f7c3ed8bf00,0xbdb2bf5ebf68be32,0xbec43f133f803f00,0x3f743e85bf2dbf7c
.quad 0xbf80bf003f003f80,0x3f003f803f00bf00,0xbec4bf7fbf0a3f00,0xbf3d3e853f7a3f25,0x3f35beafbf7fbf00,0xbf52bf5e3db23f71,0x3f6d3f35bec4bf80,0x3ec4bf35bf6d248d,0x248d3f713f25bf00,0x3f7c3f00bf25bf71,0xbf6d3db23f7a3f00,0x3d333f773f0abf25,0xbf35bf5e3e853f80,0xbf77248d3f773f00,0x3ec4bf52bf3d3f00,0xbeecbf773d333f7c
.quad 0x3f803f803f803f80,0x3f803f803f803f80,0x3d333db23e063e32,0xbe06bdb2bd33248d,0xbf7fbf7cbf77bf71,0xbf77bf7cbf7fbf80,0xbe06be85bec4bf00,0x3ec43e853e06a554,0x3f7c3f713f5e3f44,0x3f5e3f713f7c3f80,0x3e5e3ed83f1c3f44,0xbf1cbed8be5e248d,0xbf77bf5ebf35bf00,0xbf35bf5ebf77bf80,0xbe9abf13bf4bbf71,0x3f4b3f133e9aa554
.quad 0x3f713f443f003e32,0x3f003f443f713f80,0x3ec43f353f6d3f80,0xbf6dbf35bec4248d,0xbf68bf25be853e32,0xbe85bf25bf68bf80,0xbeecbf52bf7ebf71,0x3f7e3f523eeca554,0x3f5e3f00a554bf00,0x248d3f003f5e3f80,0x3f0a3f683f7e3f44,0xbf7ebf68bf0a248d,0xbf52beaf3e853f44,0x3e85beafbf52bf80,0xbf1cbf77bf6dbf00,0x3f6d3f773f1ca554
.quad 0x3f443e32bf00bf71,0xbf003e323f443f80,0x3f2d3f7f3f4b3e32,0xbf4bbf7fbf2d248d,0xbf35248d3f353f80,0x3f35a554bf35bf80,0xbf3dbf7fbf1c3e32,0x3f1c3f7f3f3da554,0x3f25be32bf5ebf71,0xbf5ebe323f253f80,0x3f4b3f773ec4bf00,0xbec4bf77bf4b248d,0xbf133eaf3f773f44,0x3f773eafbf13bf80,0xbf58bf68be063f44,0x3e063f683f58a554
.quad 0x3f00bf00bf80bf00,0xbf80bf003f003f80,0x3f633f52be06bf71,0x3e06bf52bf63248d,0xbed83f253f773e32,0x3f773f25bed8bf80,0xbf6dbf353ec43f80,0xbec43f353f6da554,0x3eafbf44bf5e3e32,0xbf5ebf443eaf3f80,0x3f743f13bf1cbf71,0x3f1cbf13bf74248d,0xbe853f5e3f35bf00,0x3f353f5ebe85bf80,0xbf7abed83f4b3f44,0xbf4b3ed83f7aa554
.quad 0x3f803f803f803f80,0x3f803f803f803f80,0xbe9abe85be5ebe32,0xbeecbed8bec4beaf,0xbf52bf5ebf68bf71,0xbf13bf25bf35bf44,0x3f4b3f353f1c3f00,0x3f7e3f773f6d3f5e,0x3eaf3f003f253f44,0xbeafbe32248d3e32,0xbf80bf77bf63bf44,0xbf2dbf52bf6dbf7c,0x3e85a554be85bf00,0x3f773f5e3f353f00,0x3f583f773f803f71,0xbe5e3db23ec43f25
.quad 0xbf44bf00be323e32,0xbf44bf71bf80bf71,0xbec4bf35bf6dbf80,0x3f6d3f353ec4a554,0x3f7f3f5e3f133e32,0xbdb23eaf3f353f71,0xbe5e3e853f2d3f71,0xbf58bf7fbf6dbf25,0xbf5ebf80bf5ebf00,0x3f5e3f00a554bf00,0x3f3d3e85be9abf44,0x3d333f133f6d3f7c,0x3ed83f5e3f7f3f44,0xbf68bf7cbf35be32,0xbf7ebf35be063f00,0x3f4b3e85bec4bf5e
.quad 0x3e32bf00bf71bf71,0x3e323f443f803f44,0x3f633f773f0abe32,0xbf74bf68bec43eaf,0xbf35248d3f353f80,0x3f35a554bf35bf80,0xbeecbf77bf58be32,0x3e9a3f683f6d3eaf,0x3f7c3f00beafbf71,0xbf7cbf44248d3f44,0xbe063f353f7e3f00,0x3f1cbe85bf6dbf5e,0xbf68bf5ebdb23f44,0x3ed83f7c3f35be32,0x3f2dbe85bf74bf44,0xbf80bf133ec43f7c
.quad 0x3f003f803f00bf00,0x3f00bf00bf80bf00,0xbf7abe853f3d3f71,0x3f0a3f7f3ec4bf25,0x3db2bf5ebf523e32,0xbf7fbeaf3f353f71,0x3f6d3f35bec4bf80,0x3ec4bf35bf6d248d,0xbf253f003f7c3e32,0x3f253f71a554bf71,0xbf0abf77bd333f71,0xbf7abdb23f6d3f25,0x3f77a554bf77bf00,0x3e85bf5ebf353f00,0xbd333f773eecbf44,0x3f3d3f52bec4bf7c
.quad 0x3f803f803f803f80,0x3f803f803f803f80,0xbf1cbf13bf0abf00,0xbf3dbf35bf2dbf25,0xbe85beafbed8bf00,0x3db2a554bdb2be32,0x3f6d3f773f7e3f80,0x3f1c3f353f4b3f5e,0xbf5ebf44bf25bf00,0xbf7cbf80bf7cbf71,0x3e06bdb2be9abf00,0x3f583f353f0a3eaf,0x3f353f5e3f773f80,0xbe85248d3e853f00,0xbf7ebf68bf3dbf00,0xbeecbf35bf63bf7c
.quad 0x3f003e32be32bf00,0x3f713f803f713f44,0x3ec43f353f6d3f80,0xbf6dbf35bec4248d,0xbf77bf7cbf52bf00,0x3ed8a554bed8bf44,0x3f4b3ed8bd33bf00,0x3e9a3f353f743f7c,0x248d3f003f5e3f80,0xbf5ebf80bf5ebf00,0xbf4bbf7fbf63bf00,0x3f7a3f353e5ebeaf,0x3f773f253db2bf00,0xbf13248d3f133f71,0xbec43e853f4b3f80,0xbe06bf35bf7ebf5e
.quad 0xbf00bf71bf71bf00,0x3f443f803f443e32,0x3f7e3f523e5ebf00,0xbf80bf35bd333f25,0xbf35248d3f353f80,0x3f35a554bf35bf80,0xbe06bf52bf7abf00,0xbd333f353f803f25,0x3f5e3f713eafbf00,0xbf25bf80bf253e32,0xbf6dbe853f1c3f80,0x3f7e3f35be06bf5e,0x3e85bf25bf7fbf00,0xbf52248d3f523f71,0x3f1c3f7f3eecbf00,0x3e5ebf35bf7abeaf
.quad 0xbf80bf003f003f80,0x3f003f803f00bf00,0x3f1cbed8bf80bf00,0xbf74bf353e9a3f7c,0x3e853f7c3f13bf00,0x3f68a554bf68bf44,0xbf6dbf353ec43f80,0xbec43f353f6da554,0x3f5ebe32bf7cbf00,0xbeafbf80beaf3f44,0xbe063f683f2dbf00,0x3f633f35beecbf7c,0xbf35bf5e3e853f80,0xbf77248d3f773f00,0x3f7e3db2bf74bf00,0x3f0abf35bf583eaf
.quad 0x3f803f803f803f80,0x3f803f803f803f80,0xbf58bf52bf4bbf44,0xbf6dbf68bf63bf5e,0x3ed83eaf3e853e32,0x3f353f253f133f00,0x3e063e853ec43f00,0xbec4be85be06248d,0xbf25bf44bf5ebf71,0xa554be32beafbf00,0x3f743f7f3f7e3f71,0x3ec43f133f3d3f5e,0xbf77bf5ebf35bf00,0xbf35bf5ebf77bf80,0x3f2d3ed83e06be32,0x3f6d3f7f3f7a3f5e
.quad 0xbe323e323f003f44,0xbf80bf71bf44bf00,0xbec4bf35bf6dbf80,0x3f6d3f353ec4a554,0x3f523f7c3f773f44,0xbf35beaf3db23f00,0xbf80bf68bf1cbe32,0x3ec4bdb2bf0abf5e,0x3f5e3f00a554bf00,0x248d3f003f5e3f80,0xbeec3db23f1c3f71,0xbec4bf52bf80bf5e,0xbdb2bf25bf77bf71,0x3f353f7c3f683f00,0x3f1c3f773f6d3f00,0xbf6dbf77bf1c248d
.quad 0xbf71bf71bf003e32,0x3f803f443e32bf00,0x3f7a3f13be06bf44,0xbf6dbed83e9a3f5e,0xbf35248d3f353f80,0x3f35a554bf35bf80,0x3e5ebf13bf7ebf44,0xbec43ed83f743f5e,0x3eaf3f713f5e3e32,0xa554bf44bf7cbf00,0xbf4bbf77bec43f00,0x3ec43f773f4ba554,0x3f7f3f25be85bf71,0xbf35bf7cbed83f00,0xbf63bdb23f4b3f71,0x3f6d3f52bd33bf5e
.quad 0x3f00bf00bf80bf00,0xbf80bf003f003f80,0x3d333f683f4bbe32,0x3f6d3db2bf58bf5e,0xbf13bf7cbe853f44,0xbf353eaf3f7f3f00,0x3f6d3f35bec4bf80,0x3ec4bf35bf6d248d,0xbf7cbe323f5e3f44,0x248d3f713f25bf00,0x3f3dbed8bf7ebe32,0xbec4bf7fbe5e3f5e,0xbe853f5e3f35bf00,0x3f353f5ebe85bf80,0xbe9abf7fbe063f71,0xbf6dbf133f2d3f5e
.quad 0x3f803f803f803f80,0x3f803f803f803f80,0xbf7abf77bf74bf71,0xbf80bf7fbf7ebf7c,0x3f683f5e3f523f44,0x3f7f3f7c3f773f71,0xbf4bbf35bf1cbf00,0xbf7ebf77bf6dbf5e,0x3f253f003eaf3e32,0x3f7c3f713f5e3f44,0xbeecbe85bd333e32,0xbf7abf68bf4bbf25,0x3e85a554be85bf00,0x3f773f5e3f353f00,0xbd333e853f0a3f44,0xbf74bf52bf1cbeaf
.quad 0xbe32bf00bf44bf71,0x3f713f443f003e32,0x3ec43f353f6d3f80,0xbf6dbf35bec4248d,0xbf13bf5ebf7fbf71,0x3f683f253e85be32,0x3f3d3f773f7a3f44,0xbf63bf13be063eaf,0xbf5ebf80bf5ebf00,0x3f5e3f00a554bf00,0x3f743f773f2d3e32,0xbf58bed83e063f25,0xbf7fbf5ebed83e32,0x3f523eafbe85bf44,0x3f7e3f353e06bf00,0xbf4bbe853ec43f5e
.quad 0xbf71bf003e323f44,0x3f443e32bf00bf71,0x3f583e85beecbf71,0xbf3dbdb23f1c3f7c,0xbf35248d3f353f80,0x3f35a554bf35bf80,0x3f0abe85bf63bf71,0xbf2d3db23f4b3f7c,0xbeaf3f003f7c3f44,0x3f25be32bf5ebf71,0x3e06bf35bf7ebf00,0xbf1c3e853f6d3f5e,0x3db23f5e3f683e32,0x3f13beafbf77bf44,0xbe9abf77bf3d3e32,0xbf0a3ed83f7e3f25
.quad 0x3f003f803f00bf00,0x3f00bf00bf80bf00,0xbf2dbf77be5e3f44,0xbeec3f133f7e3eaf,0x3f523f5ebdb2bf71,0x3ed8bf25bf77be32,0xbf6dbf353ec43f80,0xbec43f353f6da554,0x3f7c3f00bf25bf71,0x3eafbf44bf5e3e32,0xbf80be853f583f44,0xbe9a3f523f4bbeaf,0x3f77a554bf77bf00,0x3e85bf5ebf353f00,0xbf633e853f803e32,0xbe5e3f683f1cbf25
.quad 0x3f803f803f803f80,0x3f803f803f803f80,0xbf7ebf7fbf80bf80,0xbf74bf77bf7abf7c,0x3f773f7c3f7f3f80,0x3f523f5e3f683f71,0xbf6dbf77bf7ebf80,0xbf1cbf35bf4bbf5e,0x3f5e3f713f7c3f80,0x3eaf3f003f253f44,0xbf4bbf68bf7abf80,0xbd33be85beecbf25,0x3f353f5e3f773f80,0xbe85248d3e853f00,0xbf1cbf52bf74bf80,0x3f0a3e85bd33beaf
.quad 0x3f003f443f713f80,0xbf44bf00be323e32,0xbec4bf35bf6dbf80,0x3f6d3f353ec4a554,0x3e853f253f683f80,0xbf7fbf5ebf13be32,0xbe06bf13bf63bf80,0x3f7a3f773f3d3eaf,0x248d3f003f5e3f80,0xbf5ebf80bf5ebf00,0x3e06bed8bf58bf80,0x3f2d3f773f743f25,0xbe853eaf3f523f80,0xbed8bf5ebf7fbf44,0x3ec4be85bf4bbf80,0x3e063f353f7e3f5e
.quad 0xbf003e323f443f80,0x3e32bf00bf71bf71,0x3f1cbdb2bf3dbf80,0xbeec3e853f583f7c,0xbf35248d3f353f80,0x3f35a554bf35bf80,0x3f4b3db2bf2dbf80,0xbf63be853f0a3f7c,0xbf5ebe323f253f80,0x3f7c3f00beafbf71,0x3f6d3e85bf1cbf80,0xbf7ebf353e063f5e,0xbf77beaf3f133f80,0x3f683f5e3db2bf44,0x3f7e3ed8bf0abf80,0xbf3dbf77be9a3f25
.quad 0xbf80bf003f003f80,0x3f003f803f00bf00,0x3f7e3f13beecbf80,0xbe5ebf77bf2d3eaf,0xbf77bf253ed83f80,0xbdb23f5e3f52be32,0x3f6d3f35bec4bf80,0x3ec4bf35bf6d248d,0xbf5ebf443eaf3f80,0xbf253f003f7c3e32,0x3f4b3f52be9abf80,0x3f58be85bf80beaf,0xbf35bf5e3e853f80,0xbf77248d3f773f00,0x3f1c3f68be5ebf80,0x3f803e85bf63bf25
.quad 0x3f803f803f803f80,0x3f803f803f803f80,0xbf63bf68bf6dbf71,0xbf4bbf52bf58bf5e,0x3f133f253f353f44,0x3e853eaf3ed83f00,0xbe06be85bec4bf00,0x3ec43e853e06a554,0xbeafbe32248d3e32,0xbf5ebf44bf25bf00,0x3f3d3f133ec43e32,0x3f7e3f7f3f743f5e,0xbf77bf5ebf35bf00,0xbf35bf5ebf77bf80,0x3f7a3f7f3f6d3f44,0x3e063ed83f2d3f5e
.quad 0xbf44bf71bf80bf71,0x3f003e32be32bf00,0x3ec43f353f6d3f80,0xbf6dbf35bec4248d,0x3db2beafbf35bf71,0x3f773f7c3f523f00,0xbf0abdb23ec43f44,0xbf1cbf68bf80bf5e,0x3f5e3f00a554bf00,0x248d3f003f5e3f80,0xbf80bf52bec43e32,0x3f1c3db2beecbf5e,0x3f683f7c3f353e32,0xbf77bf25bdb23f00,0xbf1cbf77bf6dbf00,0x3f6d3f773f1ca554
.quad 0x3e323f443f803f44,0xbf00bf71bf71bf00,0x3e9abed8bf6dbf71,0xbe063f133f7a3f5e,0xbf35248d3f353f80,0x3f35a554bf35bf80,0x3f743ed8bec4bf71,0xbf7ebf133e5e3f5e,0xbf7cbf44248d3f44,0x3f5e3f713eafbf00,0x3f4b3f773ec4bf00,0xbec4bf77bf4b248d,0xbed8bf7cbf353e32,0xbe853f253f7f3f00,0xbd333f523f6d3e32,0x3f4bbdb2bf63bf5e
.quad 0x3f00bf00bf80bf00,0xbf80bf003f003f80,0xbf583db23f6d3f44,0x3f4b3f683d33bf5e,0x3f7f3eafbf35bf71,0xbe85bf7cbf133f00,0xbf6dbf353ec43f80,0xbec43f353f6da554,0x3f253f71a554bf71,0x3f5ebe32bf7cbf00,0xbe5ebf7fbec43f44,0xbf7ebed83f3d3f5e,0xbe853f5e3f35bf00,0x3f353f5ebe85bf80,0x3f2dbf13bf6d3e32,0xbe06bf7fbe9a3f5e
.quad 0x3f803f803f803f80,0x3f803f803f803f80,0xbf2dbf35bf3dbf44,0xbf0abf13bf1cbf25,0xbdb2248d3db23e32,0xbed8beafbe85be32,0x3f4b3f353f1c3f00,0x3f7e3f773f6d3f5e,0xbf7cbf80bf7cbf71,0xbf25bf44bf5ebf71,0x3f0a3f353f583f71,0xbe9abdb23e063eaf,0x3e85a554be85bf00,0x3f773f5e3f353f00,0xbf63bf35beecbe32,0xbf3dbf68bf7ebf7c
.quad 0x3f713f803f713f44,0xbe323e323f003f44,0xbec4bf35bf6dbf80,0x3f6d3f353ec4a554,0xbed8248d3ed83f44,0xbf52bf7cbf77bf44,0x3f743f353e9abe32,0xbd333ed83f4b3f7c,0xbf5ebf80bf5ebf00,0x3f5e3f00a554bf00,0x3e5e3f353f7a3f71,0xbf63bf7fbf4bbeaf,0x3f13a554bf13bf71,0x3db23f253f773f71,0xbf7ebf35be063f00,0x3f4b3e85bec4bf5e
.quad 0x3f443f803f443e32,0xbf71bf71bf003e32,0xbd33bf35bf80bf44,0x3e5e3f523f7e3f25,0xbf35248d3f353f80,0x3f35a554bf35bf80,0x3f803f35bd33bf44,0xbf7abf52be063f25,0xbf25bf80bf253e32,0x3eaf3f713f5e3e32,0xbe063f353f7e3f00,0x3f1cbe85bf6dbf5e,0x3f52a554bf52bf71,0xbf7fbf253e853f71,0xbf7abf353e5e3f71,0x3eec3f7f3f1cbeaf
.quad 0x3f003f803f00bf00,0x3f00bf00bf80bf00,0x3e9abf35bf74be32,0xbf80bed83f1c3f7c,0xbf68248d3f683f44,0x3f133f7c3e85bf44,0x3f6d3f35bec4bf80,0x3ec4bf35bf6d248d,0xbeafbf80beaf3f44,0xbf7cbe323f5e3f44,0xbeec3f353f63be32,0x3f2d3f68be06bf7c,0x3f77a554bf77bf00,0x3e85bf5ebf353f00,0xbf58bf353f0a3f71,0xbf743db23f7e3eaf
.quad 0x3f803f803f803f80,0x3f803f803f803f80,0xbec4bed8beecbf00,0xbe5ebe85be9abeaf,0xbf35bf25bf13bf00,0xbf68bf5ebf52bf44,0x3f6d3f773f7e3f80,0x3f1c3f353f4b3f5e,0xa554be32beafbf00,0x3f253f003eaf3e32,0xbf6dbf52bf2dbf00,0xbf63bf77bf80bf7c,0x3f353f5e3f773f80,0xbe85248d3e853f00,0x3ec43db2be5ebf00,0x3f803f773f583f25
.quad 0xbf80bf71bf44bf00,0xbe32bf00bf44bf71,0x3ec43f353f6d3f80,0xbf6dbf35bec4248d,0x3f353eafbdb2bf00,0x3f133f5e3f7f3f71,0xbf6dbf7fbf58bf00,0x3f2d3e85be5ebf25,0x248d3f003f5e3f80,0xbf5ebf80bf5ebf00,0x3f6d3f133d33bf00,0xbe9a3e853f3d3f7c,0xbf35bf7cbf68bf00,0x3f7f3f5e3ed8be32,0xbec43e853f4b3f80,0xbe06bf35bf7ebf5e
.quad 0x3f803f443e32bf00,0xbf71bf003e323f44,0xbec4bf68bf74bf00,0x3f0a3f773f633eaf,0xbf35248d3f353f80,0x3f35a554bf35bf80,0x3f6d3f683e9abf00,0xbf58bf77beec3eaf,0xa554bf44bf7cbf00,0xbeaf3f003f7c3f44,0xbf6dbe853f1c3f80,0x3f7e3f35be06bf5e,0x3f353f7c3ed8bf00,0xbdb2bf5ebf68be32,0x3ec4bf13bf80bf00,0xbf74be853f2d3f7c
.quad 0xbf80bf003f003f80,0x3f003f803f00bf00,0x3ec43f7f3f0abf00,0x3f3dbe85bf7abf25,0x3f35beafbf7fbf00,0xbf52bf5e3db23f71,0xbf6dbf353ec43f80,0xbec43f353f6da554,0x248d3f713f25bf00,0x3f7c3f00bf25bf71,0x3f6dbdb2bf7abf00,0xbd33bf77bf0a3f25,0xbf35bf5e3e853f80,0xbf77248d3f773f00,0xbec43f523f3dbf00,0x3eec3f77bd33bf7c
.quad 0x3f803f803f803f80,0x3f803f803f803f80,0xbd33bdb2be06be32,0x3e063db23d33a554,0xbf7fbf7cbf77bf71,0xbf77bf7cbf7fbf80,0x3e063e853ec43f00,0xbec4be85be06248d,0x3f7c3f713f5e3f44,0x3f5e3f713f7c3f80,0xbe5ebed8bf1cbf44,0x3f1c3ed83e5ea554,0xbf77bf5ebf35bf00,0xbf35bf5ebf77bf80,0x3e9a3f133f4b3f71,0xbf4bbf13be9a248d
.quad 0x3f713f443f003e32,0x3f003f443f713f80,0xbec4bf35bf6dbf80,0x3f6d3f353ec4a554,0xbf68bf25be853e32,0xbe85bf25bf68bf80,0x3eec3f523f7e3f71,0xbf7ebf52beec248d,0x3f5e3f00a554bf00,0x248d3f003f5e3f80,0xbf0abf68bf7ebf44,0x3f7e3f683f0aa554,0xbf52beaf3e853f44,0x3e85beafbf52bf80,0x3f1c3f773f6d3f00,0xbf6dbf77bf1c248d
.quad 0x3f443e32bf00bf71,0xbf003e323f443f80,0xbf2dbf7fbf4bbe32,0x3f4b3f7f3f2da554,0xbf35248d3f353f80,0x3f35a554bf35bf80,0x3f3d3f7f3f1cbe32,0xbf1cbf7fbf3d248d,0x3f25be32bf5ebf71,0xbf5ebe323f253f80,0xbf4bbf77bec43f00,0x3ec43f773f4ba554,0xbf133eaf3f773f44,0x3f773eafbf13bf80,0x3f583f683e06bf44,0xbe06bf68bf58248d
.quad 0x3f00bf00bf80bf00,0xbf80bf003f003f80,0xbf63bf523e063f71,0xbe063f523f63a554,0xbed83f253f773e32,0x3f773f25bed8bf80,0x3f6d3f35bec4bf80,0x3ec4bf35bf6d248d,0x3eafbf44bf5e3e32,0xbf5ebf443eaf3f80,0xbf74bf133f1c3f71,0xbf1c3f133f74a554,0xbe853f5e3f35bf00,0x3f353f5ebe85bf80,0x3f7a3ed8bf4bbf44,0x3f4bbed8bf7a248d
.quad 0x3f803f803f803f80,0x3f803f803f803f80,0x3e9a3e853e5e3e32,0x3eec3ed83ec43eaf,0xbf52bf5ebf68bf71,0xbf13bf25bf35bf44,0xbf4bbf35bf1cbf00,0xbf7ebf77bf6dbf5e,0x3eaf3f003f253f44,0xbeafbe32248d3e32,0x3f803f773f633f44,0x3f2d3f523f6d3f7c,0x3e85a554be85bf00,0x3f773f5e3f353f00,0xbf58bf77bf80bf71,0x3e5ebdb2bec4bf25
.quad 0xbf44bf00be323e32,0xbf44bf71bf80bf71,0x3ec43f353f6d3f80,0xbf6dbf35bec4248d,0x3f7f3f5e3f133e32,0xbdb23eaf3f353f71,0x3e5ebe85bf2dbf71,0x3f583f7f3f6d3f25,0xbf5ebf80bf5ebf00,0x3f5e3f00a554bf00,0xbf3dbe853e9a3f44,0xbd33bf13bf6dbf7c,0x3ed83f5e3f7f3f44,0xbf68bf7cbf35be32,0x3f7e3f353e06bf00,0xbf4bbe853ec43f5e
.quad 0x3e32bf00bf71bf71,0x3e323f443f803f44,0xbf63bf77bf0a3e32,0x3f743f683ec4beaf,0xbf35248d3f353f80,0x3f35a554bf35bf80,0x3eec3f773f583e32,0xbe9abf68bf6dbeaf,0x3f7c3f00beafbf71,0xbf7cbf44248d3f44,0x3e06bf35bf7ebf00,0xbf1c3e853f6d3f5e,0xbf68bf5ebdb23f44,0x3ed83f7c3f35be32,0xbf2d3e853f743f44,0x3f803f13bec4bf7c
.quad 0x3f003f803f00bf00,0x3f00bf00bf80bf00,0x3f7a3e85bf3dbf71,0xbf0abf7fbec43f25,0x3db2bf5ebf523e32,0xbf7fbeaf3f353f71,0xbf6dbf353ec43f80,0xbec43f353f6da554,0xbf253f003f7c3e32,0x3f253f71a554bf71,0x3f0a3f773d33bf71,0x3f7a3db2bf6dbf25,0x3f77a554bf77bf00,0x3e85bf5ebf353f00,0x3d33bf77beec3f44,0xbf3dbf523ec43f7c
.quad 0x3f803f803f803f80,0x3f803f803f803f80,0x3f1c3f133f0a3f00,0x3f3d3f353f2d3f25,0xbe85beafbed8bf00,0x3db2a554bdb2be32,0xbf6dbf77bf7ebf80,0xbf1cbf35bf4bbf5e,0xbf5ebf44bf25bf00,0xbf7cbf80bf7cbf71,0xbe063db23e9a3f00,0xbf58bf35bf0abeaf,0x3f353f5e3f773f80,0xbe85248d3e853f00,0x3f7e3f683f3d3f00,0x3eec3f353f633f7c
.quad 0x3f003e32be32bf00,0x3f713f803f713f44,0xbec4bf35bf6dbf80,0x3f6d3f353ec4a554,0xbf77bf7cbf52bf00,0x3ed8a554bed8bf44,0xbf4bbed83d333f00,0xbe9abf35bf74bf7c,0x248d3f003f5e3f80,0xbf5ebf80bf5ebf00,0x3f4b3f7f3f633f00,0xbf7abf35be5e3eaf,0x3f773f253db2bf00,0xbf13248d3f133f71,0x3ec4be85bf4bbf80,0x3e063f353f7e3f5e
.quad 0xbf00bf71bf71bf00,0x3f443f803f443e32,0xbf7ebf52be5e3f00,0x3f803f353d33bf25,0xbf35248d3f353f80,0x3f35a554bf35bf80,0x3e063f523f7a3f00,0x3d33bf35bf80bf25,0x3f5e3f713eafbf00,0xbf25bf80bf253e32,0x3f6d3e85bf1cbf80,0xbf7ebf353e063f5e,0x3e85bf25bf7fbf00,0xbf52248d3f523f71,0xbf1cbf7fbeec3f00,0xbe5e3f353f7a3eaf
.quad 0xbf80bf003f003f80,0x3f003f803f00bf00,0xbf1c3ed83f803f00,0x3f743f35be9abf7c,0x3e853f7c3f13bf00,0x3f68a554bf68bf44,0x3f6d3f35bec4bf80,0x3ec4bf35bf6d248d,0x3f5ebe32bf7cbf00,0xbeafbf80beaf3f44,0x3e06bf68bf2d3f00,0xbf63bf353eec3f7c,0xbf35bf5e3e853f80,0xbf77248d3f773f00,0xbf7ebdb23f743f00,0xbf0a3f353f58beaf
.quad 0x3f803f803f803f80,0x3f803f803f803f80,0x3f583f523f4b3f44,0x3f6d3f683f633f5e,0x3ed83eaf3e853e32,0x3f353f253f133f00,0xbe06be85bec4bf00,0x3ec43e853e06a554,0xbf25bf44bf5ebf71,0xa554be32beafbf00,0xbf74bf7fbf7ebf71,0xbec4bf13bf3dbf5e,0xbf77bf5ebf35bf00,0xbf35bf5ebf77bf80,0xbf2dbed8be063e32,0xbf6dbf7fbf7abf5e
.quad 0xbe323e323f003f44,0xbf80bf71bf44bf00,0x3ec43f353f6d3f80,0xbf6dbf35bec4248d,0x3f523f7c3f773f44,0xbf35beaf3db23f00,0x3f803f683f1c3e32,0xbec43db23f0a3f5e,0x3f5e3f00a554bf00,0x248d3f003f5e3f80,0x3eecbdb2bf1cbf71,0x3ec43f523f803f5e,0xbdb2bf25bf77bf71,0x3f353f7c3f683f00,0xbf1cbf77bf6dbf00,0x3f6d3f773f1ca554
.quad 0xbf71bf71bf003e32,0x3f803f443e32bf00,0xbf7abf133e063f44,0x3f6d3ed8be9abf5e,0xbf35248d3f353f80,0x3f35a554bf35bf80,0xbe5e3f133f7e3f44,0x3ec4bed8bf74bf5e,0x3eaf3f713f5e3e32,0xa554bf44bf7cbf00,0x3f4b3f773ec4bf00,0xbec4bf77bf4b248d,0x3f7f3f25be85bf71,0xbf35bf7cbed83f00,0x3f633db2bf4bbf71,0xbf6dbf523d333f5e
.quad 0x3f00bf00bf80bf00,0xbf80bf003f003f80,0xbd33bf68bf4b3e32,0xbf6dbdb23f583f5e,0xbf13bf7cbe853f44,0xbf353eaf3f7f3f00,0xbf6dbf353ec43f80,0xbec43f353f6da554,0xbf7cbe323f5e3f44,0x248d3f713f25bf00,0xbf3d3ed83f7e3e32,0x3ec43f7f3e5ebf5e,0xbe853f5e3f35bf00,0x3f353f5ebe85bf80,0x3e9a3f7f3e06bf71,0x3f6d3f13bf2dbf5e
.quad 0x3f803f803f803f80,0x3f803f803f803f80,0x3f7a3f773f743f71,0x3f803f7f3f7e3f7c,0x3f683f5e3f523f44,0x3f7f3f7c3f773f71,0x3f4b3f353f1c3f00,0x3f7e3f773f6d3f5e,0x3f253f003eaf3e32,0x3f7c3f713f5e3f44,0x3eec3e853d33be32,0x3f7a3f683f4b3f25,0x3e85a554be85bf00,0x3f773f5e3f353f00,0x3d33be85bf0abf44,0x3f743f523f1c3eaf
.quad 0xbe32bf00bf44bf71,0x3f713f443f003e32,0xbec4bf35bf6dbf80,0x3f6d3f353ec4a554,0xbf13bf5ebf7fbf71,0x3f683f253e85be32,0xbf3dbf77bf7abf44,0x3f633f133e06beaf,0xbf5ebf80bf5ebf00,0x3f5e3f00a554bf00,0xbf74bf77bf2dbe32,0x3f583ed8be06bf25,0xbf7fbf5ebed83e32,0x3f523eafbe85bf44,0xbf7ebf35be063f00,0x3f4b3e85bec4bf5e
.quad 0xbf71bf003e323f44,0x3f443e32bf00bf71,0xbf58be853eec3f71,0x3f3d3db2bf1cbf7c,0xbf35248d3f353f80,0x3f35a554bf35bf80,0xbf0a3e853f633f71,0x3f2dbdb2bf4bbf7c,0xbeaf3f003f7c3f44,0x3f25be32bf5ebf71,0xbe063f353f7e3f00,0x3f1cbe85bf6dbf5e,0x3db23f5e3f683e32,0x3f13beafbf77bf44,0x3e9a3f773f3dbe32,0x3f0abed8bf7ebf25
.quad 0x3f003f803f00bf00,0x3f00bf00bf80bf00,0x3f2d3f773e5ebf44,0x3eecbf13bf7ebeaf,0x3f523f5ebdb2bf71,0x3ed8bf25bf77be32,0x3f6d3f35bec4bf80,0x3ec4bf35bf6d248d,0x3f7c3f00bf25bf71,0x3eafbf44bf5e3e32,0x3f803e85bf58bf44,0x3e9abf52bf4b3eaf,0x3f77a554bf77bf00,0x3e85bf5ebf353f00,0x3f63be85bf80be32,0x3e5ebf68bf1c3f25
.quad 0x8000800080008000,0x8000800080008000,0xbe06bdb2bd338000,0xbe9abe85be5ebe32,0xbe85be32bdb28000,0xbf13bf00bed8beaf,0xbec4be85be068000,0xbf4bbf35bf1cbf00,0xbf00beafbe328000,0xbf71bf5ebf44bf25,0xbf1cbed8be5e8000,0xbf80bf77bf63bf44,0xbf35bf00be858000,0xbf77bf80bf77bf5e,0xbf4bbf13be9a8000,0xbf58bf77bf80bf71
.quad 0xbf5ebf25beaf8000,0xbf25bf5ebf7cbf7c,0xbf6dbf35bec48000,0xbec4bf35bf6dbf80,0xbf77bf44bed88000,0xbdb2bf00bf52bf7c,0xbf7ebf52beec8000,0x3e5ebe85bf2dbf71,0xbf80bf5ebf008000,0x3f00a50dbf00bf5e,0xbf7ebf68bf0a8000,0x3f3d3e85be9abf44,0xbf77bf71bf138000,0x3f683f00bdb2bf25,0xbf6dbf77bf1c8000,0x3f7e3f353e06bf00
.quad 0xbf5ebf7cbf258000,0x3f7c3f5e3eafbeaf,0xbf4bbf7fbf2d8000,0x3f633f773f0abe32,0xbf35bf80bf358000,0x3f353f803f35a50d,0xbf1cbf7fbf3d8000,0x3eec3f773f583e32,0xbf00bf7cbf448000,0x3e323f5e3f713eaf,0xbec4bf77bf4b8000,0xbe063f353f7e3f00,0xbe85bf71bf528000,0xbed83f003f7f3f25,0xbe06bf68bf588000,0xbf2d3e853f743f44
.quad 0xa50dbf5ebf5e8000,0xbf5e80003f5e3f5e,0x3e06bf52bf638000,0xbf7abe853f3d3f71,0x3e85bf44bf688000,0xbf7fbf003f133f7c,0x3ec4bf35bf6d8000,0xbf6dbf353ec43f80,0x3f00bf25bf718000,0xbf44bf5e3e323f7c,0x3f1cbf13bf748000,0xbf0abf77bd333f71,0x3f35bf00bf778000,0xbe85bf80be853f5e,0x3f4bbed8bf7a8000,0x3d33bf77beec3f44
.quad 0x8000800080008000,0x8000800080008000,0xbeecbed8bec4beaf,0xbf1cbf13bf0abf00,0xbf52bf44bf35bf25,0xbf77bf71bf68bf5e,0xbf7ebf77bf6dbf5e,0xbf6dbf77bf7ebf80,0xbf71bf7cbf80bf7c,0xbf00bf25bf44bf5e,0xbf2dbf52bf6dbf7c,0x3e06bdb2be9abf00,0xbe85bf00bf35bf5e,0x3f353f003e85a50d,0x3e5ebdb2bec4bf25,0x3f7e3f683f3d3f00
.quad 0x3f253eafa50dbeaf,0x3f5e3f7c3f7c3f5e,0x3f6d3f353ec4a50d,0x3ec43f353f6d3f80,0x3f7f3f713f353eaf,0xbe853e323f133f5e,0x3f583f7f3f6d3f25,0xbf4bbed83d333f00,0x3f003f5e3f803f5e,0xbf80bf5ebf008000,0x3d333f133f6d3f7c,0xbf4bbf7fbf63bf00,0xbed83e323f353f7c,0xbe85bf44bf7fbf5e,0xbf4bbe853ec43f5e,0x3ec4be85bf4bbf80
.quad 0xbf7cbf2580003f25,0x3f5e3eafbeafbf5e,0xbf74bf68bec43eaf,0x3f7e3f523e5ebf00,0xbf35bf80bf358000,0x3f353f803f35a50d,0xbe9abf68bf6dbeaf,0x3e063f523f7a3f00,0x3e32bf25bf80bf25,0xbf003eaf3f713f5e,0x3f1cbe85bf6dbf5e,0xbf6dbe853f1c3f80,0x3f683e32bf35bf7c,0xbf77bf443db23f5e,0x3f803f13bec4bf7c,0xbf1cbf7fbeec3f00
.quad 0x3f5e3f5ea50dbf5e,0xa50dbf5ebf5e8000,0x3f0a3f7f3ec4bf25,0x3f1cbed8bf80bf00,0x3db23f713f35beaf,0x3f773e32bf52bf5e,0xbec43f353f6da50d,0x3f6d3f35bec4bf80,0xbf443eaf3f803eaf,0x3f003f7c3e32bf5e,0xbf7abdb23f6d3f25,0xbe063f683f2dbf00,0xbf77bf003f353f5e,0xbf353f003f77a50d,0xbf3dbf523ec43f7c,0xbf7ebdb23f743f00
.quad 0x8000800080008000,0x8000800080008000,0xbf3dbf35bf2dbf25,0xbf58bf52bf4bbf44,0xbf7fbf80bf7fbf7c,0xbf68bf71bf77bf7c,0xbf1cbf35bf4bbf5e,0xbe06be85bec4bf00,0x3e32a50dbe32beaf,0x3f443f253f003eaf,0x3f583f353f0a3eaf,0x3f743f7f3f7e3f71,0x3f773f803f773f5e,0x3e853f003f353f5e,0x3eec3f353f633f7c,0xbf2dbed8be063e32
.quad 0xbeaf80003eaf3f25,0xbf7cbf7cbf5ebf25,0xbf6dbf35bec48000,0xbec4bf35bf6dbf80,0xbf68bf80bf68bf25,0x3f133e32be85bf25,0xbe9abf35bf74bf7c,0x3f803f683f1c3e32,0x3f00a50dbf00bf5e,0x3f003f5e3f803f5e,0x3f7a3f353e5ebeaf,0xbeec3db23f1c3f71,0x3f523f803f523eaf,0xbf7fbf44be853eaf,0x3e063f353f7e3f5e,0xbf1cbf77bf6dbf00
.quad 0xbf2580003f253f7c,0x3eafbeafbf5ebf7c,0xbf80bf35bd333f25,0x3f7a3f13be06bf44,0xbf35bf80bf358000,0x3f353f803f35a50d,0x3d33bf35bf80bf25,0xbe5e3f133f7e3f44,0x3f44a50dbf44bf7c,0xbf71beaf3f003f7c,0x3f7e3f35be06bf5e,0xbf4bbf77bec43f00,0x3f133f803f13beaf,0x3db2bf44bf77beaf,0xbe5e3f353f7a3eaf,0x3f633db2bf4bbf71
.quad 0xbf5e80003f5e3f5e,0x3f5e3f5ea50dbf5e,0xbf74bf353e9a3f7c,0x3d333f683f4bbe32,0xbed8bf80bed83f25,0xbf523e323f773f25,0x3ec4bf35bf6d8000,0xbf6dbf353ec43f80,0x3f71a50dbf71bf25,0xbe32bf7cbf003f25,0x3f633f35beecbf7c,0x3f3dbed8bf7ebe32,0x3e853f803e85bf5e,0x3f773f00bf35bf5e,0xbf0a3f353f58beaf,0x3e9a3f7f3e06bf71
.quad 0x8000800080008000,0x8000800080008000,0xbf6dbf68bf63bf5e,0xbf7abf77bf74bf71,0xbf35bf44bf52bf5e,0xbed8bf00bf13bf25,0x3ec43e853e06a50d,0x3f4b3f353f1c3f00,0x3f803f7c3f713f5e,0x3f443f5e3f713f7c,0x3ec43f133f3d3f5e,0xbeecbe85bd333e32,0xbf35bf00be858000,0xbf77bf80bf77bf5e,0xbf6dbf7fbf7abf5e,0x3d33be85bf0abf44
.quad 0xa50dbeafbf25bf5e,0x3f7c3f5e3f253eaf,0x3f6d3f353ec4a50d,0x3ec43f353f6d3f80,0x3f353f713f7f3f5e,0xbf52bf00bdb23eaf,0xbec43db23f0a3f5e,0xbf3dbf77bf7abf44,0xbf80bf5ebf008000,0x3f00a50dbf00bf5e,0xbec4bf52bf80bf5e,0x3f743f773f2d3e32,0x3f353e32bed8bf5e,0xbdb23f003f683f7c,0x3f6d3f773f1ca50d,0xbf7ebf35be063f00
.quad 0x80003f253f7c3f5e,0xbeafbf5ebf7cbf25,0xbf6dbed83e9a3f5e,0x3f583e85beecbf71,0xbf35bf80bf358000,0x3f353f803f35a50d,0x3ec4bed8bf74bf5e,0xbf0a3e853f633f71,0x3f803f25be32bf5e,0xbf71bf5ebe323f25,0x3ec43f773f4ba50d,0x3e06bf35bf7ebf00,0xbf353e323f683f5e,0x3f7f3f00bed8bf7c,0xbf6dbf523d333f5e,0x3e9a3f773f3dbe32
.quad 0xa50dbf5ebf5e8000,0xbf5e80003f5e3f5e,0x3f6d3db2bf58bf5e,0xbf2dbf77be5e3f44,0x3f353f713db2bf5e,0x3f13bf00bf7fbeaf,0xbec43f353f6da50d,0x3f6d3f35bec4bf80,0xbf80beaf3f443f5e,0xbe323f5e3f44beaf,0xbec4bf7fbe5e3f5e,0xbf80be853f583f44,0x3f35bf00bf778000,0xbe85bf80be853f5e,0x3f6d3f13bf2dbf5e,0x3f63be85bf80be32
.quad 0x8000800080008000,0x8000800080008000,0xbf80bf7fbf7ebf7c,0xbf7ebf7fbf80bf80,0xbdb2be32be85beaf,0x3e853e323db2a50d,0x3f7e3f773f6d3f5e,0x3f6d3f773f7e3f80,0x3e323eaf3f003f25,0xbf00beafbe328000,0xbf7abf68bf4bbf25,0xbf4bbf68bf7abf80,0xbe85bf00bf35bf5e,0x3f353f003e85a50d,0x3f743f523f1c3eaf,0x3f1c3f523f743f80
.quad 0x3eaf3f253f5e3f7c,0xbf5ebf25beaf8000,0xbf6dbf35bec48000,0xbec4bf35bf6dbf80,0xbed8bf44bf77bf7c,0x3f773f443ed8a50d,0x3f633f133e06beaf,0x3e063f133f633f80,0x3f003f5e3f803f5e,0xbf80bf5ebf008000,0xbf58bed83e063f25,0x3e06bed8bf58bf80,0xbf13bf71bf77bf25,0x3f773f713f13a50d,0x3f4b3e85bec4bf5e,0xbec43e853f4b3f80
.quad 0x3f253f7c3f5e3eaf,0xbf5ebf7cbf258000,0xbf3dbdb23f1c3f7c,0x3f1cbdb2bf3dbf80,0xbf35bf80bf358000,0x3f353f803f35a50d,0x3f2dbdb2bf4bbf7c,0xbf4bbdb23f2d3f80,0x3f443f7c3f00beaf,0xbf00bf7cbf448000,0xbf1c3e853f6d3f5e,0x3f6d3e85bf1cbf80,0xbf52bf71be853f25,0x3e853f713f52a50d,0x3f0abed8bf7ebf25,0xbf7ebed83f0a3f80
.quad 0x3f5e3f5ea50dbf5e,0xa50dbf5ebf5e8000,0xbeec3f133f7e3eaf,0x3f7e3f13beecbf80,0xbf68bf443e853f7c,0xbe853f443f68a50d,0x3ec4bf35bf6d8000,0xbf6dbf353ec43f80,0x3f713f25bf00bf7c,0x3f00bf25bf718000,0xbe9a3f523f4bbeaf,0x3f4b3f52be9abf80,0xbf77bf003f353f5e,0xbf353f003f77a50d,0x3e5ebf68bf1c3f25,0xbf1cbf683e5e3f80
.quad 0x8000800080008000,0x8000800080008000,0xbf74bf77bf7abf7c,0xbf63bf68bf6dbf71,0x3f133f003ed83eaf,0x3f523f443f353f25,0x3f1c3f353f4b3f5e,0x3e063e853ec43f00,0xbf71bf5ebf44bf25,0xbf71bf7cbf80bf7c,0xbd33be85beecbf25,0x3f3d3f133ec43e32,0x3f773f803f773f5e,0x3e853f003f353f5e,0xbf0abe853d333eaf,0xbf7abf7fbf6dbf44
.quad 0xbf25bf5ebf7cbf7c,0x3f253eafa50dbeaf,0x3f6d3f353ec4a50d,0x3ec43f353f6d3f80,0x3db23f003f523f7c,0xbf7fbf71bf35beaf,0xbf7abf77bf3dbeaf,0x3f0a3db2bec4bf44,0x3f00a50dbf00bf5e,0x3f003f5e3f803f5e,0x3f2d3f773f743f25,0xbf80bf52bec43e32,0xbf68bf003db23f25,0x3ed8be32bf35bf7c,0xbe06bf35bf7ebf5e,0x3f1c3f773f6d3f00
.quad 0x3f7c3f5e3eafbeaf,0xbf7cbf2580003f25,0xbeec3e853f583f7c,0x3e9abed8bf6dbf71,0xbf35bf80bf358000,0x3f353f803f35a50d,0x3f633e85bf0abf7c,0xbf74bed83ec43f71,0x3e323f5e3f713eaf,0x3e32bf25bf80bf25,0xbf7ebf353e063f5e,0x3f4b3f773ec4bf00,0x3ed8bf00bf7fbf25,0xbf68be323f353f7c,0x3f3d3f773e9abf25,0x3d33bf52bf6dbe32
.quad 0xbf5e80003f5e3f5e,0x3f5e3f5ea50dbf5e,0xbe5ebf77bf2d3eaf,0xbf583db23f6d3f44,0x3f7f3f00bf13bf7c,0xbdb2bf71bf353eaf,0xbec43f353f6da50d,0x3f6d3f35bec4bf80,0xbf44bf5e3e323f7c,0xbf443eaf3f803eaf,0x3f58be85bf80beaf,0xbe5ebf7fbec43f44,0x3e853f803e85bf5e,0x3f773f00bf35bf5e,0xbf80be853f633f25,0xbf2d3f133f6dbe32
.quad 0x8000800080008000,0x8000800080008000,0xbf4bbf52bf58bf5e,0xbf2dbf35bf3dbf44,0x3f773f713f683f5e,0x3f7f3f803f7f3f7c,0xbec4be85be068000,0xbf4bbf35bf1cbf00,0xbf00bf25bf44bf5e,0x3e32a50dbe32beaf,0x3f7e3f7f3f743f5e,0x3f0a3f353f583f71,0xbf35bf00be858000,0xbf77bf80bf77bf5e,0xbe06bed8bf2dbf5e,0x3f633f353eec3e32
.quad 0x3f5e3f7c3f7c3f5e,0xbeaf80003eaf3f25,0xbf6dbf35bec48000,0xbec4bf35bf6dbf80,0x3e85be32bf13bf5e,0x3f683f803f683f25,0x3f1c3f683f803f5e,0xbf74bf35be9a3e32,0xbf80bf5ebf008000,0x3f00a50dbf00bf5e,0x3f1c3db2beecbf5e,0x3e5e3f353f7a3f71,0x3e853f443f7f3f5e,0xbf52bf80bf52beaf,0xbf6dbf77bf1c8000,0x3f7e3f353e06bf00
.quad 0x3f5e3eafbeafbf5e,0xbf2580003f253f7c,0xbe063f133f7a3f5e,0xbd33bf35bf80bf44,0xbf35bf80bf358000,0x3f353f803f35a50d,0x3f7e3f13be5ebf5e,0xbf80bf353d333f44,0xbf003eaf3f713f5e,0x3f44a50dbf44bf7c,0xbec4bf77bf4b8000,0xbe063f353f7e3f00,0x3f773f44bdb2bf5e,0xbf13bf80bf133eaf,0xbf4b3db23f633f5e,0x3f7a3f35be5ebf71
.quad 0xa50dbf5ebf5e8000,0xbf5e80003f5e3f5e,0x3f4b3f683d33bf5e,0x3e9abf35bf74be32,0xbf77be323f523f5e,0x3ed83f803ed8bf25,0x3ec4bf35bf6d8000,0xbf6dbf353ec43f80,0x3f003f7c3e32bf5e,0x3f71a50dbf71bf25,0xbf7ebed83f3d3f5e,0xbeec3f353f63be32,0x3f35bf00bf778000,0xbe85bf80be853f5e,0x3e063f7f3e9abf5e,0x3f583f35bf0abf71
.quad 0x8000800080008000,0x8000800080008000,0xbf0abf13bf1cbf25,0xbec4bed8beecbf00,0x3f683f713f773f7c,0x3f353f443f523f5e,0xbf7ebf77bf6dbf5e,0xbf6dbf77bf7ebf80,0x3f443f253f003eaf,0x3f803f7c3f713f5e,0xbe9abdb23e063eaf,0xbf6dbf52bf2dbf00,0xbe85bf00bf35bf5e,0x3f353f003e85a50d,0x3f3d3f683f7e3f7c,0xbec4bdb23e5e3f00
.quad 0xbf7cbf7cbf5ebf25,0xa50dbeafbf25bf5e,0x3f6d3f353ec4a50d,0x3ec43f353f6d3f80,0xbf13be323e853f25,0xbf35bf71bf7fbf5e,0x3d33bed8bf4bbf7c,0x3f6d3f7f3f583f00,0x3f003f5e3f803f5e,0xbf80bf5ebf008000,0xbf63bf7fbf4bbeaf,0x3f6d3f133d33bf00,0x3f7f3f443e85beaf,0xbf35be323ed83f5e,0xbf4bbe853ec43f5e,0x3ec4be85bf4bbf80
.quad 0x3eafbeafbf5ebf7c,0x80003f253f7c3f5e,0x3e5e3f523f7e3f25,0xbec4bf68bf74bf00,0xbf35bf80bf358000,0x3f353f803f35a50d,0x3f7a3f523e06bf25,0xbf6dbf68be9a3f00,0xbf71beaf3f003f7c,0x3f803f25be32bf5e,0x3f1cbe85bf6dbf5e,0xbf6dbe853f1c3f80,0xbdb23f443f773eaf,0x3f35be32bf68bf5e,0xbeecbf7fbf1c3eaf,0xbec43f133f803f00
.quad 0x3f5e3f5ea50dbf5e,0xa50dbf5ebf5e8000,0xbf80bed83f1c3f7c,0x3ec43f7f3f0abf00,0x3f52be32bf77bf25,0xbf35bf71bdb23f5e,0xbec43f353f6da50d,0x3f6d3f35bec4bf80,0xbe32bf7cbf003f25,0xbf80beaf3f443f5e,0x3f2d3f68be06bf7c,0x3f6dbdb2bf7abf00,0xbf77bf003f353f5e,0xbf353f003f77a50d,0x3f74bdb2bf7ebeaf,0x3ec4bf52bf3d3f00
.quad 0x8000800080008000,0x8000800080008000,0xbe5ebe85be9abeaf,0xbd33bdb2be06be32,0x3ed83f003f133f25,0x3db23e323e853eaf,0xbf1cbf35bf4bbf5e,0xbe06be85bec4bf00,0x3f443f5e3f713f7c,0x3e323eaf3f003f25,0xbf63bf77bf80bf7c,0xbe5ebed8bf1cbf44,0x3f773f803f773f5e,0x3e853f003f353f5e,0xbf80bf77bf58bf25,0xbe9abf13bf4bbf71
.quad 0x3f7c3f5e3f253eaf,0x3eaf3f253f5e3f7c,0xbf6dbf35bec48000,0xbec4bf35bf6dbf80,0x3f523f003db2beaf,0x3ed83f443f773f7c,0xbf2dbe853e5e3f25,0xbeecbf52bf7ebf71,0x3f00a50dbf00bf5e,0x3f003f5e3f803f5e,0xbe9a3e853f3d3f7c,0xbf0abf68bf7ebf44,0x3db2bf00bf68bf7c,0x3f133f713f773f25,0x3e063f353f7e3f5e,0xbf1cbf77bf6dbf00
.quad 0xbeafbf5ebf7cbf25,0x3f253f7c3f5e3eaf,0x3f0a3f773f633eaf,0xbf2dbf7fbf4bbe32,0xbf35bf80bf358000,0x3f353f803f35a50d,0x3f583f773eecbeaf,0xbf3dbf7fbf1c3e32,0xbf71bf5ebe323f25,0x3f443f7c3f00beaf,0x3f7e3f35be06bf5e,0xbf4bbf77bec43f00,0xbf7fbf003ed83f7c,0x3f523f713e85bf25,0x3f743e85bf2dbf7c,0xbf58bf68be063f44
.quad 0xbf5e80003f5e3f5e,0x3f5e3f5ea50dbf5e,0x3f3dbe85bf7abf25,0xbf63bf523e063f71,0xbf133f003f7f3eaf,0x3f683f44be85bf7c,0x3ec4bf35bf6d8000,0xbf6dbf353ec43f80,0xbe323f5e3f44beaf,0x3f713f25bf00bf7c,0xbd33bf77bf0a3f25,0xbf74bf133f1c3f71,0x3e853f803e85bf5e,0x3f773f00bf35bf5e,0xbeecbf773d333f7c,0xbf7abed83f4b3f44
.quad 0x8000800080008000,0x8000800080008000,0x3e063db23d33a50d,0x3e9a3e853e5e3e32,0xbe85be32bdb28000,0xbf13bf00bed8beaf,0x3ec43e853e06a50d,0x3f4b3f353f1c3f00,0xbf00beafbe328000,0xbf71bf5ebf44bf25,0x3f1c3ed83e5ea50d,0x3f803f773f633f44,0xbf35bf00be858000,0xbf77bf80bf77bf5e,0x3f4b3f133e9aa50d,0x3f583f773f803f71
.quad 0xbf5ebf25beaf8000,0xbf25bf5ebf7cbf7c,0x3f6d3f353ec4a50d,0x3ec43f353f6d3f80,0xbf77bf44bed88000,0xbdb2bf00bf52bf7c,0x3f7e3f523eeca50d,0xbe5e3e853f2d3f71,0xbf80bf5ebf008000,0x3f00a50dbf00bf5e,0x3f7e3f683f0aa50d,0xbf3dbe853e9a3f44,0xbf77bf71bf138000,0x3f683f00bdb2bf25,0x3f6d3f773f1ca50d,0xbf7ebf35be063f00
.quad 0xbf5ebf7cbf258000,0x3f7c3f5e3eafbeaf,0x3f4b3f7f3f2da50d,0xbf63bf77bf0a3e32,0xbf35bf80bf358000,0x3f353f803f35a50d,0x3f1c3f7f3f3da50d,0xbeecbf77bf58be32,0xbf00bf7cbf448000,0x3e323f5e3f713eaf,0x3ec43f773f4ba50d,0x3e06bf35bf7ebf00,0xbe85bf71bf528000,0xbed83f003f7f3f25,0x3e063f683f58a50d,0x3f2dbe85bf74bf44
.quad 0xa50dbf5ebf5e8000,0xbf5e80003f5e3f5e,0xbe063f523f63a50d,0x3f7a3e85bf3dbf71,0x3e85bf44bf688000,0xbf7fbf003f133f7c,0xbec43f353f6da50d,0x3f6d3f35bec4bf80,0x3f00bf25bf718000,0xbf44bf5e3e323f7c,0xbf1c3f133f74a50d,0x3f0a3f773d33bf71,0x3f35bf00bf778000,0xbe85bf80be853f5e,0xbf4b3ed83f7aa50d,0xbd333f773eecbf44
.quad 0x8000800080008000,0x8000800080008000,0x3eec3ed83ec43eaf,0x3f1c3f133f0a3f00,0xbf52bf44bf35bf25,0xbf77bf71bf68bf5e,0x3f7e3f773f6d3f5e,0x3f6d3f773f7e3f80,0xbf71bf7cbf80bf7c,0xbf00bf25bf44bf5e,0x3f2d3f523f6d3f7c,0xbe063db23e9a3f00,0xbe85bf00bf35bf5e,0x3f353f003e85a50d,0xbe5e3db23ec43f25,0xbf7ebf68bf3dbf00
.quad 0x3f253eafa50dbeaf,0x3f5e3f7c3f7c3f5e,0xbf6dbf35bec48000,0xbec4bf35bf6dbf80,0x3f7f3f713f353eaf,0xbe853e323f133f5e,0xbf58bf7fbf6dbf25,0x3f4b3ed8bd33bf00,0x3f003f5e3f803f5e,0xbf80bf5ebf008000,0xbd33bf13bf6dbf7c,0x3f4b3f7f3f633f00,0xbed83e323f353f7c,0xbe85bf44bf7fbf5e,0x3f4b3e85bec4bf5e,0xbec43e853f4b3f80
.quad 0xbf7cbf2580003f25,0x3f5e3eafbeafbf5e,0x3f743f683ec4beaf,0xbf7ebf52be5e3f00,0xbf35bf80bf358000,0x3f353f803f35a50d,0x3e9a3f683f6d3eaf,0xbe06bf52bf7abf00,0x3e32bf25bf80bf25,0xbf003eaf3f713f5e,0xbf1c3e853f6d3f5e,0x3f6d3e85bf1cbf80,0x3f683e32bf35bf7c,0xbf77bf443db23f5e,0xbf80bf133ec43f7c,0x3f1c3f7f3eecbf00
.quad 0x3f5e3f5ea50dbf5e,0xa50dbf5ebf5e8000,0xbf0abf7fbec43f25,0xbf1c3ed83f803f00,0x3db23f713f35beaf,0x3f773e32bf52bf5e,0x3ec4bf35bf6d8000,0xbf6dbf353ec43f80,0xbf443eaf3f803eaf,0x3f003f7c3e32bf5e,0x3f7a3db2bf6dbf25,0x3e06bf68bf2d3f00,0xbf77bf003f353f5e,0xbf353f003f77a50d,0x3f3d3f52bec4bf7c,0x3f7e3db2bf74bf00
.quad 0x8000800080008000,0x8000800080008000,0x3f3d3f353f2d3f25,0x3f583f523f4b3f44,0xbf7fbf80bf7fbf7c,0xbf68bf71bf77bf7c,0x3f1c3f353f4b3f5e,0x3e063e853ec43f00,0x3e32a50dbe32beaf,0x3f443f253f003eaf,0xbf58bf35bf0abeaf,0xbf74bf7fbf7ebf71,0x3f773f803f773f5e,0x3e853f003f353f5e,0xbeecbf35bf63bf7c,0x3f2d3ed83e06be32
.quad 0xbeaf80003eaf3f25,0xbf7cbf7cbf5ebf25,0x3f6d3f353ec4a50d,0x3ec43f353f6d3f80,0xbf68bf80bf68bf25,0x3f133e32be85bf25,0x3e9a3f353f743f7c,0xbf80bf68bf1cbe32,0x3f00a50dbf00bf5e,0x3f003f5e3f803f5e,0xbf7abf35be5e3eaf,0x3eecbdb2bf1cbf71,0x3f523f803f523eaf,0xbf7fbf44be853eaf,0xbe06bf35bf7ebf5e,0x3f1c3f773f6d3f00
.quad 0xbf2580003f253f7c,0x3eafbeafbf5ebf7c,0x3f803f353d33bf25,0xbf7abf133e063f44,0xbf35bf80bf358000,0x3f353f803f35a50d,0xbd333f353f803f25,0x3e5ebf13bf7ebf44,0x3f44a50dbf44bf7c,0xbf71beaf3f003f7c,0xbf7ebf353e063f5e,0x3f4b3f773ec4bf00,0x3f133f803f13beaf,0x3db2bf44bf77beaf,0x3e5ebf35bf7abeaf,0xbf63bdb23f4b3f71
.quad 0xbf5e80003f5e3f5e,0x3f5e3f5ea50dbf5e,0x3f743f35be9abf7c,0xbd33bf68bf4b3e32,0xbed8bf80bed83f25,0xbf523e323f773f25,0xbec43f353f6da50d,0x3f6d3f35bec4bf80,0x3f71a50dbf71bf25,0xbe32bf7cbf003f25,0xbf63bf353eec3f7c,0xbf3d3ed83f7e3e32,0x3e853f803e85bf5e,0x3f773f00bf35bf5e,0x3f0abf35bf583eaf,0xbe9abf7fbe063f71
.quad 0x8000800080008000,0x8000800080008000,0x3f6d3f683f633f5e,0x3f7a3f773f743f71,0xbf35bf44bf52bf5e,0xbed8bf00bf13bf25,0xbec4be85be068000,0xbf4bbf35bf1cbf00,0x3f803f7c3f713f5e,0x3f443f5e3f713f7c,0xbec4bf13bf3dbf5e,0x3eec3e853d33be32,0xbf35bf00be858000,0xbf77bf80bf77bf5e,0x3f6d3f7f3f7a3f5e,0xbd333e853f0a3f44
.quad 0xa50dbeafbf25bf5e,0x3f7c3f5e3f253eaf,0xbf6dbf35bec48000,0xbec4bf35bf6dbf80,0x3f353f713f7f3f5e,0xbf52bf00bdb23eaf,0x3ec4bdb2bf0abf5e,0x3f3d3f773f7a3f44,0xbf80bf5ebf008000,0x3f00a50dbf00bf5e,0x3ec43f523f803f5e,0xbf74bf77bf2dbe32,0x3f353e32bed8bf5e,0xbdb23f003f683f7c,0xbf6dbf77bf1c8000,0x3f7e3f353e06bf00
.quad 0x80003f253f7c3f5e,0xbeafbf5ebf7cbf25,0x3f6d3ed8be9abf5e,0xbf58be853eec3f71,0xbf35bf80bf358000,0x3f353f803f35a50d,0xbec43ed83f743f5e,0x3f0abe85bf63bf71,0x3f803f25be32bf5e,0xbf71bf5ebe323f25,0xbec4bf77bf4b8000,0xbe063f353f7e3f00,0xbf353e323f683f5e,0x3f7f3f00bed8bf7c,0x3f6d3f52bd33bf5e,0xbe9abf77bf3d3e32
.quad 0xa50dbf5ebf5e8000,0xbf5e80003f5e3f5e,0xbf6dbdb23f583f5e,0x3f2d3f773e5ebf44,0x3f353f713db2bf5e,0x3f13bf00bf7fbeaf,0x3ec4bf35bf6d8000,0xbf6dbf353ec43f80,0xbf80beaf3f443f5e,0xbe323f5e3f44beaf,0x3ec43f7f3e5ebf5e,0x3f803e85bf58bf44,0x3f35bf00bf778000,0xbe85bf80be853f5e,0xbf6dbf133f2d3f5e,0xbf633e853f803e32
.quad 0x8000800080008000,0x8000800080008000,0x3f803f7f3f7e3f7c,0x3f7e3f7f3f803f80,0xbdb2be32be85beaf,0x3e853e323db2a50d,0xbf7ebf77bf6dbf5e,0xbf6dbf77bf7ebf80,0x3e323eaf3f003f25,0xbf00beafbe328000,0x3f7a3f683f4b3f25,0x3f4b3f683f7a3f80,0xbe85bf00bf35bf5e,0x3f353f003e85a50d,0xbf74bf52bf1cbeaf,0xbf1cbf52bf74bf80
.quad 0x3eaf3f253f5e3f7c,0xbf5ebf25beaf8000,0x3f6d3f353ec4a50d,0x3ec43f353f6d3f80,0xbed8bf44bf77bf7c,0x3f773f443ed8a50d,0xbf63bf13be063eaf,0xbe06bf13bf63bf80,0x3f003f5e3f803f5e,0xbf80bf5ebf008000,0x3f583ed8be06bf25,0xbe063ed83f583f80,0xbf13bf71bf77bf25,0x3f773f713f13a50d,0xbf4bbe853ec43f5e,0x3ec4be85bf4bbf80
.quad 0x3f253f7c3f5e3eaf,0xbf5ebf7cbf258000,0x3f3d3db2bf1cbf7c,0xbf1c3db23f3d3f80,0xbf35bf80bf358000,0x3f353f803f35a50d,0xbf2d3db23f4b3f7c,0x3f4b3db2bf2dbf80,0x3f443f7c3f00beaf,0xbf00bf7cbf448000,0x3f1cbe85bf6dbf5e,0xbf6dbe853f1c3f80,0xbf52bf71be853f25,0x3e853f713f52a50d,0xbf0a3ed83f7e3f25,0x3f7e3ed8bf0abf80
.quad 0x3f5e3f5ea50dbf5e,0xa50dbf5ebf5e8000,0x3eecbf13bf7ebeaf,0xbf7ebf133eec3f80,0xbf68bf443e853f7c,0xbe853f443f68a50d,0xbec43f353f6da50d,0x3f6d3f35bec4bf80,0x3f713f25bf00bf7c,0x3f00bf25bf718000,0x3e9abf52bf4b3eaf,0xbf4bbf523e9a3f80,0xbf77bf003f353f5e,0xbf353f003f77a50d,0xbe5e3f683f1cbf25,0x3f1c3f68be5ebf80
.quad 0x8000800080008000,0x8000800080008000,0x3f743f773f7a3f7c,0x3f633f683f6d3f71,0x3f133f003ed83eaf,0x3f523f443f353f25,0xbf1cbf35bf4bbf5e,0xbe06be85bec4bf00,0xbf71bf5ebf44bf25,0xbf71bf7cbf80bf7c,0x3d333e853eec3f25,0xbf3dbf13bec4be32,0x3f773f803f773f5e,0x3e853f003f353f5e,0x3f0a3e85bd33beaf,0x3f7a3f7f3f6d3f44
.quad 0xbf25bf5ebf7cbf7c,0x3f253eafa50dbeaf,0xbf6dbf35bec48000,0xbec4bf35bf6dbf80,0x3db23f003f523f7c,0xbf7fbf71bf35beaf,0x3f7a3f773f3d3eaf,0xbf0abdb23ec43f44,0x3f00a50dbf00bf5e,0x3f003f5e3f803f5e,0xbf2dbf77bf74bf25,0x3f803f523ec4be32,0xbf68bf003db23f25,0x3ed8be32bf35bf7c,0x3e063f353f7e3f5e,0xbf1cbf77bf6dbf00
.quad 0x3f7c3f5e3eafbeaf,0xbf7cbf2580003f25,0x3eecbe85bf58bf7c,0xbe9a3ed83f6d3f71,0xbf35bf80bf358000,0x3f353f803f35a50d,0xbf63be853f0a3f7c,0x3f743ed8bec4bf71,0x3e323f5e3f713eaf,0x3e32bf25bf80bf25,0x3f7e3f35be06bf5e,0xbf4bbf77bec43f00,0x3ed8bf00bf7fbf25,0xbf68be323f353f7c,0xbf3dbf77be9a3f25,0xbd333f523f6d3e32
.quad 0xbf5e80003f5e3f5e,0x3f5e3f5ea50dbf5e,0x3e5e3f773f2dbeaf,0x3f58bdb2bf6dbf44,0x3f7f3f00bf13bf7c,0xbdb2bf71bf353eaf,0x3ec4bf35bf6d8000,0xbf6dbf353ec43f80,0xbf44bf5e3e323f7c,0xbf443eaf3f803eaf,0xbf583e853f803eaf,0x3e5e3f7f3ec4bf44,0x3e853f803e85bf5e,0x3f773f00bf35bf5e,0x3f803e85bf63bf25,0x3f2dbf13bf6d3e32
.quad 0x8000800080008000,0x8000800080008000,0x3f4b3f523f583f5e,0x3f2d3f353f3d3f44,0x3f773f713f683f5e,0x3f7f3f803f7f3f7c,0x3ec43e853e06a50d,0x3f4b3f353f1c3f00,0xbf00bf25bf44bf5e,0x3e32a50dbe32beaf,0xbf7ebf7fbf74bf5e,0xbf0abf35bf58bf71,0xbf35bf00be858000,0xbf77bf80bf77bf5e,0x3e063ed83f2d3f5e,0xbf63bf35beecbe32
.quad 0x3f5e3f7c3f7c3f5e,0xbeaf80003eaf3f25,0x3f6d3f353ec4a50d,0x3ec43f353f6d3f80,0x3e85be32bf13bf5e,0x3f683f803f683f25,0xbf1cbf68bf80bf5e,0x3f743f353e9abe32,0xbf80bf5ebf008000,0x3f00a50dbf00bf5e,0xbf1cbdb23eec3f5e,0xbe5ebf35bf7abf71,0x3e853f443f7f3f5e,0xbf52bf80bf52beaf,0x3f6d3f773f1ca50d,0xbf7ebf35be063f00
.quad 0x3f5e3eafbeafbf5e,0xbf2580003f253f7c,0x3e06bf13bf7abf5e,0x3d333f353f803f44,0xbf35bf80bf358000,0x3f353f803f35a50d,0xbf7ebf133e5e3f5e,0x3f803f35bd33bf44,0xbf003eaf3f713f5e,0x3f44a50dbf44bf7c,0x3ec43f773f4ba50d,0x3e06bf35bf7ebf00,0x3f773f44bdb2bf5e,0xbf13bf80bf133eaf,0x3f4bbdb2bf63bf5e,0xbf7abf353e5e3f71
.quad 0xa50dbf5ebf5e8000,0xbf5e80003f5e3f5e,0xbf4bbf68bd333f5e,0xbe9a3f353f743e32,0xbf77be323f523f5e,0x3ed83f803ed8bf25,0xbec43f353f6da50d,0x3f6d3f35bec4bf80,0x3f003f7c3e32bf5e,0x3f71a50dbf71bf25,0x3f7e3ed8bf3dbf5e,0x3eecbf35bf633e32,0x3f35bf00bf778000,0xbe85bf80be853f5e,0xbe06bf7fbe9a3f5e,0xbf58bf353f0a3f71
.quad 0x8000800080008000,0x8000800080008000,0x3f0a3f133f1c3f25,0x3ec43ed83eec3f00,0x3f683f713f773f7c,0x3f353f443f523f5e,0x3f7e3f773f6d3f5e,0x3f6d3f773f7e3f80,0x3f443f253f003eaf,0x3f803f7c3f713f5e,0x3e9a3db2be06beaf,0x3f6d3f523f2d3f00,0xbe85bf00bf35bf5e,0x3f353f003e85a50d,0xbf3dbf68bf7ebf7c,0x3ec43db2be5ebf00
.quad 0xbf7cbf7cbf5ebf25,0xa50dbeafbf25bf5e,0xbf6dbf35bec48000,0xbec4bf35bf6dbf80,0xbf13be323e853f25,0xbf35bf71bf7fbf5e,0xbd333ed83f4b3f7c,0xbf6dbf7fbf58bf00,0x3f003f5e3f803f5e,0xbf80bf5ebf008000,0x3f633f7f3f4b3eaf,0xbf6dbf13bd333f00,0x3f7f3f443e85beaf,0xbf35be323ed83f5e,0x3f4b3e85bec4bf5e,0xbec43e853f4b3f80
.quad 0x3eafbeafbf5ebf7c,0x80003f253f7c3f5e,0xbe5ebf52bf7ebf25,0x3ec43f683f743f00,0xbf35bf80bf358000,0x3f353f803f35a50d,0xbf7abf52be063f25,0x3f6d3f683e9abf00,0xbf71beaf3f003f7c,0x3f803f25be32bf5e,0xbf1c3e853f6d3f5e,0x3f6d3e85bf1cbf80,0xbdb23f443f773eaf,0x3f35be32bf68bf5e,0x3eec3f7f3f1cbeaf,0x3ec4bf13bf80bf00
.quad 0x3f5e3f5ea50dbf5e,0xa50dbf5ebf5e8000,0x3f803ed8bf1cbf7c,0xbec4bf7fbf0a3f00,0x3f52be32bf77bf25,0xbf35bf71bdb23f5e,0x3ec4bf35bf6d8000,0xbf6dbf353ec43f80,0xbe32bf7cbf003f25,0xbf80beaf3f443f5e,0xbf2dbf683e063f7c,0xbf6d3db23f7a3f00,0xbf77bf003f353f5e,0xbf353f003f77a50d,0xbf743db23f7e3eaf,0xbec43f523f3dbf00
.quad 0x8000800080008000,0x8000800080008000,0x3e5e3e853e9a3eaf,0x3d333db23e063e32,0x3ed83f003f133f25,0x3db23e323e853eaf,0x3f1c3f353f4b3f5e,0x3e063e853ec43f00,0x3f443f5e3f713f7c,0x3e323eaf3f003f25,0x3f633f773f803f7c,0x3e5e3ed83f1c3f44,0x3f773f803f773f5e,0x3e853f003f353f5e,0x3f803f773f583f25,0x3e9a3f133f4b3f71
.quad 0x3f7c3f5e3f253eaf,0x3eaf3f253f5e3f7c,0x3f6d3f353ec4a50d,0x3ec43f353f6d3f80,0x3f523f003db2beaf,0x3ed83f443f773f7c,0x3f2d3e85be5ebf25,0x3eec3f523f7e3f71,0x3f00a50dbf00bf5e,0x3f003f5e3f803f5e,0x3e9abe85bf3dbf7c,0x3f0a3f683f7e3f44,0x3db2bf00bf68bf7c,0x3f133f713f773f25,0xbe06bf35bf7ebf5e,0x3f1c3f773f6d3f00
.quad 0xbeafbf5ebf7cbf25,0x3f253f7c3f5e3eaf,0xbf0abf77bf63beaf,0x3f2d3f7f3f4b3e32,0xbf35bf80bf358000,0x3f353f803f35a50d,0xbf58bf77beec3eaf,0x3f3d3f7f3f1cbe32,0xbf71bf5ebe323f25,0x3f443f7c3f00beaf,0xbf7ebf353e063f5e,0x3f4b3f773ec4bf00,0xbf7fbf003ed83f7c,0x3f523f713e85bf25,0xbf74be853f2d3f7c,0x3f583f683e06bf44
.quad 0xbf5e80003f5e3f5e,0x3f5e3f5ea50dbf5e,0xbf3d3e853f7a3f25,0x3f633f52be06bf71,0xbf133f003f7f3eaf,0x3f683f44be85bf7c,0xbec43f353f6da50d,0x3f6d3f35bec4bf80,0xbe323f5e3f44beaf,0x3f713f25bf00bf7c,0x3d333f773f0abf25,0x3f743f13bf1cbf71,0x3e853f803e85bf5e,0x3f773f00bf35bf5e,0x3eec3f77bd33bf7c,0x3f7a3ed8bf4bbf44
.quad 0xbf00bf713e323f80,0xbf71bf003f443f44,0xbec4bf773e063f80,0xbf4bbf353f1c3f5e,0xbe85bf7c3db23f80,0xbf13bf5e3ed83f71,0xbe06bf7f3d333f80,0xbe9abf773e5e3f7c,0xa554bf80248d3f80,0xa554bf80248d3f80,0x3e06bf7fbd333f80,0x3e9abf77be5e3f7c,0x3e85bf7cbdb23f80,0x3f13bf5ebed83f71,0x3ec4bf77be063f80,0x3f4bbf35bf1c3f5e
.quad 0x3f00bf71be323f80,0x3f71bf00bf443f44,0x3f1cbf68be5e3f80,0x3f80be85bf633f25,0x3f35bf5ebe853f80,0x3f77a554bf773f00,0x3f4bbf52be9a3f80,0x3f583e85bf803eaf,0x3f5ebf44beaf3f80,0x3f253f00bf7c3e32,0x3f6dbf35bec43f80,0x3ec43f35bf6d248d,0x3f77bf25bed83f80,0x3db23f5ebf52be32,0x3f7ebf13beec3f80,0xbe5e3f77bf2dbeaf
.quad 0x3f80bf00bf003f80,0xbf003f80bf00bf00,0x3f7ebed8bf0a3f80,0xbf3d3f77be9abf25,0x3f77beafbf133f80,0xbf683f5ebdb2bf44,0x3f6dbe85bf1c3f80,0xbf7e3f353e06bf5e,0x3f5ebe32bf253f80,0xbf7c3f003eafbf71,0x3f4bbdb2bf2d3f80,0xbf633e853f0abf7c,0x3f35a554bf353f80,0xbf35248d3f35bf80,0x3f1c3db2bf3d3f80,0xbeecbe853f58bf7c
.quad 0x3f003e32bf443f80,0xbe32bf003f71bf71,0x3ec43e85bf4b3f80,0x3e06bf353f7ebf5e,0x3e853eafbf523f80,0x3ed8bf5e3f7fbf44,0x3e063ed8bf583f80,0x3f2dbf773f74bf25,0x248d3f00bf5e3f80,0x3f5ebf803f5ebf00,0xbe063f13bf633f80,0x3f7abf773f3dbeaf,0xbe853f25bf683f80,0x3f7fbf5e3f13be32,0xbec43f35bf6d3f80,0x3f6dbf353ec4a554
.quad 0xbf713e323f803e32,0xbf003f443f44bf00,0xbf7ebe853f6d3f00,0xbf6d3e853f7ea554,0xbf52bf253f353f44,0xbf77beaf3f683f00,0xbeecbf683ec43f71,0xbf1cbf523f0a3f5e,0xa554bf80248d3f80,0xa554bf80248d3f80,0x3eecbf68bec43f71,0x3f1cbf52bf0a3f5e,0x3f52bf25bf353f44,0x3f77beafbf683f00,0x3f7ebe85bf6d3f00,0x3f6d3e85bf7e248d
.quad 0x3f713e32bf803e32,0x3f003f44bf44bf00,0x3f2d3f13bf6dbe32,0xbe063f7fbe9abf5e,0x3e853f5ebf35bf00,0xbf353f5e3e85bf80,0xbe5e3f7fbec4bf44,0xbf7e3ed83f3dbf5e,0xbf253f71a554bf71,0xbf5ebe323f7cbf00,0xbf6d3f353ec4bf80,0xbec4bf353f6da554,0xbf7f3eaf3f35bf71,0x3e85bf7c3f133f00,0xbf58bdb23f6dbf44,0x3f4bbf683d333f5e
.quad 0xbf00bf003f80bf00,0x3f80bf00bf003f80,0xbd33bf523f6dbe32,0x3f4b3db2bf633f5e,0x3ed8bf7c3f353e32,0x3e853f25bf7f3f00,0x3f4bbf773ec43f00,0xbec43f77bf4b248d,0x3f7cbf44248d3f44,0xbf5e3f71beafbf00,0x3f74bed8bec43f71,0xbf7e3f133e5ebf5e,0x3f35a554bf353f80,0xbf35248d3f35bf80,0x3e9a3ed8bf6d3f71,0xbe06bf133f7abf5e
.quad 0xbe323f44bf803f44,0x3f00bf713f71bf00,0xbf1c3f77bf6d3f00,0x3f6dbf773f1ca554,0xbf683f7cbf353e32,0x3f77bf253db23f00,0xbf803f52bec4be32,0x3f1cbdb2beec3f5e,0xbf5e3f00a554bf00,0x248d3f00bf5e3f80,0xbf0a3db23ec4bf44,0xbf1c3f68bf803f5e,0xbdb2beaf3f35bf71,0xbf773f7cbf523f00,0x3ec4bf353f6dbf80,0xbf6d3f35bec4248d
.quad 0x3e323f803e32bf71,0x3f443f44bf00bf71,0xbf1c3f353f4bbf00,0xbe063f773ec4bf5e,0xbf7f248d3f7f3e32,0xbf683eaf3f77be32,0xbf3dbf353f2d3f44,0xbf58bf133f4b3f25,0xa554bf80248d3f80,0xa554bf80248d3f80,0x3f3dbf35bf2d3f44,0x3f58bf13bf4b3f25,0x3f7fa554bf7f3e32,0x3f683eafbf77be32,0x3f1c3f35bf4bbf00,0x3e063f77bec4bf5e
.quad 0xbe323f80be32bf71,0xbf443f443f00bf71,0xbf583f353f0abf71,0xbf74bdb23f7ebeaf,0xbf77248d3f77bf00,0xbe85bf5e3f353f00,0xbeecbf353f633e32,0x3f2dbf68be063f7c,0x3eafbf803eaf3f44,0x3f7cbe32bf5e3f44,0x3f6dbf35bec43f80,0x3ec43f35bf6d248d,0x3f68a554bf683f44,0xbf133f7cbe85bf44,0x3e9a3f35bf743e32,0xbf803ed83f1cbf7c
.quad 0xbf003f80bf00bf00,0xbf00bf003f80bf00,0xbf7a3f353e5ebf71,0x3eecbf7f3f1c3eaf,0xbf52248d3f52bf71,0x3f7fbf25be853f71,0xbe06bf353f7ebf00,0x3f1c3e85bf6d3f5e,0x3f25bf803f253e32,0xbeaf3f71bf5e3e32,0x3f80bf35bd333f44,0xbf7a3f52be06bf25,0x3f35a554bf353f80,0xbf35248d3f35bf80,0xbd333f35bf803f44,0x3e5ebf523f7ebf25
.quad 0xbf443f80bf443e32,0x3f71bf713f003e32,0xbf7e3f35be06bf00,0x3f4bbe85bec43f5e,0xbf13248d3f13bf71,0xbdb23f25bf773f71,0x3e5ebf353f7abf71,0xbf633f7fbf4b3eaf,0x3f5ebf803f5ebf00,0xbf5e3f00a554bf00,0x3f74bf353e9a3e32,0xbd33bed83f4bbf7c,0x3ed8a554bed83f44,0x3f52bf7c3f77bf44,0xbec43f35bf6d3f80,0x3f6dbf353ec4a554
.quad 0x3f803e32bf71bf00,0x3f44bf00bf713e32,0x3ec43f77be06bf80,0x3f4b3f35bf1cbf5e,0xbf353f253f52bf00,0xbed83f5e3f13bf44,0xbf6dbed83f633f00,0xbf7abe853f743eaf,0xa554bf80248d3f80,0xa554bf80248d3f80,0x3f6dbed8bf633f00,0x3f7abe85bf743eaf,0x3f353f25bf52bf00,0x3ed83f5ebf13bf44,0xbec43f773e06bf80,0xbf4b3f353f1cbf5e
.quad 0xbf803e323f71bf00,0xbf44bf003f713e32,0xbec4bf523f3d3f00,0x3eecbf77bd333f7c,0x3f35bf5ebe853f80,0x3f77a554bf773f00,0x3f6d3db2bf7a3f00,0xbd333f77bf0abf25,0x248d3f71bf25bf00,0xbf7c3f003f25bf71,0xbf6d3f353ec4bf80,0xbec4bf353f6da554,0xbf35beaf3f7fbf00,0x3f52bf5ebdb23f71,0x3ec4bf7f3f0a3f00,0x3f3d3e85bf7a3f25
.quad 0x3f80bf00bf003f80,0xbf003f80bf00bf00,0x3ec43f13bf803f00,0xbf743e853f2dbf7c,0xbf353f7cbed8bf00,0x3db2bf5e3f68be32,0xbf6d3e853f1cbf80,0x3f7ebf35be063f5e,0xa554bf443f7cbf00,0x3eaf3f00bf7c3f44,0x3f6dbf683e9a3f00,0xbf583f77beecbeaf,0x3f35a554bf353f80,0xbf35248d3f35bf80,0xbec43f68bf743f00,0x3f0abf773f63beaf
.quad 0xbf803f44be32bf00,0x3f71bf00be323f44,0xbec4be853f4bbf80,0xbe063f35bf7e3f5e,0x3f35bf7c3f68bf00,0xbf7f3f5ebed8be32,0x3f6dbf133d333f00,0xbe9abe853f3dbf7c,0x248d3f00bf5e3f80,0x3f5ebf803f5ebf00,0xbf6d3f7fbf583f00,0x3f2dbe85be5e3f25,0xbf353eaf3db2bf00,0xbf133f5ebf7f3f71,0x3ec4bf353f6dbf80,0xbf6d3f35bec4248d
.quad 0x3e32bf71bf003f44,0xbf00bf713e323f80,0x3f7e3e85bf6dbf00,0x3f6dbe85bf7e248d,0xbdb23f7c3e85bf71,0x3e853f7cbdb2bf80,0xbf80bdb23f7e3e32,0xbf7e3db23f80a554,0xa554bf80248d3f80,0xa554bf80248d3f80,0x3f80bdb2bf7e3e32,0x3f7e3db2bf80248d,0x3db23f7cbe85bf71,0xbe853f7c3db2bf80,0xbf7e3e853f6dbf00,0xbf6dbe853f7ea554
.quad 0xbe32bf713f003f44,0x3f00bf71be323f80,0x3f7abed8bf4b3f44,0x3f4b3ed8bf7a248d,0x3e853f5ebf35bf00,0xbf353f5e3e85bf80,0xbf743f133f1cbf71,0xbf1cbf133f74a554,0xbeafbf443f5e3e32,0x3f5ebf44beaf3f80,0x3f6dbf35bec43f80,0x3ec43f35bf6d248d,0x3ed83f25bf773e32,0xbf773f253ed8bf80,0xbf633f523e06bf71,0xbe06bf523f63a554
.quad 0xbf00bf003f80bf00,0x3f80bf00bf003f80,0x3f58bf683e063f44,0xbe063f68bf58248d,0x3f133eafbf773f44,0xbf773eaf3f13bf80,0xbf4b3f77bec4bf00,0x3ec4bf773f4ba554,0xbf25be323f5ebf71,0x3f5ebe32bf253f80,0x3f3dbf7f3f1c3e32,0xbf1c3f7fbf3d248d,0x3f35a554bf353f80,0xbf35248d3f35bf80,0xbf2d3f7fbf4b3e32,0x3f4bbf7f3f2da554
.quad 0xbf443e323f00bf71,0x3f003e32bf443f80,0x3f1cbf773f6dbf00,0xbf6d3f77bf1c248d,0x3f52beafbe853f44,0xbe85beaf3f52bf80,0xbf0a3f68bf7e3f44,0x3f7ebf683f0aa554,0xbf5e3f00a554bf00,0x248d3f00bf5e3f80,0x3eecbf523f7ebf71,0xbf7e3f52beec248d,0x3f68bf253e853e32,0x3e85bf253f68bf80,0xbec43f35bf6d3f80,0x3f6dbf353ec4a554
.quad 0xbf71bf003f443f44,0xbf713e323f803e32,0x3f1cbf35bf4b3f00,0x3e06bf77bec43f5e,0x3f133f5ebed8bf71,0x3f523f25bf35bf44,0xbf743e853f7abe32,0xbf633ed83f6dbeaf,0xa554bf80248d3f80,0xa554bf80248d3f80,0x3f743e85bf7abe32,0x3f633ed8bf6dbeaf,0xbf133f5e3ed8bf71,0xbf523f253f35bf44,0xbf1cbf353f4b3f00,0xbe06bf773ec43f5e
.quad 0x3f71bf00bf443f44,0x3f713e32bf803e32,0x3d333f77beecbf44,0xbf3d3f523ec4bf7c,0xbf77248d3f77bf00,0xbe85bf5e3f353f00,0x3f0abf773d333f71,0x3f7abdb2bf6d3f25,0x3f253f00bf7c3e32,0xbf253f71a554bf71,0xbf6d3f353ec4bf80,0xbec4bf353f6da554,0xbdb2bf5e3f523e32,0x3f7fbeafbf353f71,0x3f7abe85bf3d3f71,0xbf0a3f7fbec4bf25
.quad 0xbf003f80bf00bf00,0xbf00bf003f80bf00,0xbf2dbe853f74bf44,0x3f80bf13bec43f7c,0x3f68bf5e3db23f44,0xbed83f7cbf35be32,0x3e063f35bf7e3f00,0xbf1cbe853f6dbf5e,0xbf7c3f003eafbf71,0x3f7cbf44248d3f44,0x3eecbf773f58be32,0xbe9a3f68bf6d3eaf,0x3f35a554bf353f80,0xbf35248d3f35bf80,0xbf633f77bf0abe32,0x3f74bf683ec43eaf
.quad 0xbe32bf003f71bf71,0xbe323f44bf803f44,0x3f7ebf353e063f00,0xbf4b3e853ec4bf5e,0xbed83f5ebf7f3f44,0x3f68bf7c3f35be32,0xbf3d3e853e9abf44,0xbd333f13bf6d3f7c,0x3f5ebf803f5ebf00,0xbf5e3f00a554bf00,0x3e5e3e85bf2d3f71,0x3f58bf7f3f6dbf25,0xbf7f3f5ebf133e32,0x3db23eafbf353f71,0x3ec4bf353f6dbf80,0xbf6d3f35bec4248d
.quad 0xbf003f443f44bf00,0x3e323f803e32bf71,0xbec4bf773e063f80,0xbf4bbf353f1c3f5e,0x3f773eafbf68bf00,0x3f7fa554bf7fbe32,0xbf4b3f133f58bf00,0xbf2d3f353f3dbf25,0xa554bf80248d3f80,0xa554bf80248d3f80,0x3f4b3f13bf58bf00,0x3f2d3f35bf3dbf25,0xbf773eaf3f68bf00,0xbf7f248d3f7fbe32,0x3ec4bf77be063f80,0x3f4bbf35bf1c3f5e
.quad 0x3f003f44bf44bf00,0xbe323f80be32bf71,0xbf7e3db23f74bf00,0xbf0abf353f583eaf,0x3f35bf5ebe853f80,0x3f77a554bf773f00,0x3e063f68bf2dbf00,0xbf633f353eecbf7c,0xbf5ebe323f7cbf00,0x3eafbf803eaf3f44,0x3f6dbf35bec43f80,0x3ec43f35bf6d248d,0xbe853f7cbf13bf00,0xbf68248d3f68bf44,0xbf1cbed83f80bf00,0x3f74bf35be9a3f7c
.quad 0x3f80bf00bf003f80,0xbf003f80bf00bf00,0xbf1c3f7fbeecbf00,0xbe5ebf353f7abeaf,0xbe85bf253f7fbf00,0x3f52a554bf523f71,0x3f6dbe85bf1c3f80,0xbf7e3f353e06bf5e,0xbf5e3f71beafbf00,0x3f25bf803f253e32,0x3e06bf523f7abf00,0x3d333f35bf803f25,0x3f35a554bf353f80,0xbf35248d3f35bf80,0xbf7e3f52be5ebf00,0x3f80bf353d333f25
.quad 0x3f00bf713f71bf00,0xbf443f80bf443e32,0x3ec43e85bf4b3f80,0x3e06bf353f7ebf5e,0xbf773f25bdb2bf00,0x3f13a554bf133f71,0x3f4bbf7f3f63bf00,0xbf7a3f35be5ebeaf,0x248d3f00bf5e3f80,0x3f5ebf803f5ebf00,0xbf4b3ed83d33bf00,0xbe9a3f35bf743f7c,0x3f77bf7c3f52bf00,0xbed8248d3ed8bf44,0xbec43f35bf6d3f80,0x3f6dbf353ec4a554
.quad 0x3f443f44bf00bf71,0x3f803e32bf71bf00,0xbf7ebe853f6d3f00,0xbf6d3e853f7ea554,0x3f68beafbf773e32,0x3f35bf25bf523f00,0xbf0a3f523f1cbf44,0xbec43f683eecbf5e,0xa554bf80248d3f80,0xa554bf80248d3f80,0x3f0a3f52bf1cbf44,0x3ec43f68beecbf5e,0xbf68beaf3f773e32,0xbf35bf253f523f00,0x3f7ebe85bf6d3f00,0x3f6d3e85bf7e248d
.quad 0xbf443f443f00bf71,0xbf803e323f71bf00,0x3e9abf7f3e063f71,0x3f6dbf13bf2d3f5e,0x3e853f5ebf35bf00,0xbf353f5e3e85bf80,0xbf3dbed83f7ebe32,0x3ec4bf7f3e5e3f5e,0x3f7cbe32bf5e3f44,0x248d3f71bf25bf00,0xbf6d3f353ec4bf80,0xbec4bf353f6da554,0x3f13bf7c3e853f44,0x3f353eafbf7f3f00,0xbd333f68bf4bbe32,0xbf6d3db23f58bf5e
.quad 0xbf00bf003f80bf00,0x3f80bf00bf003f80,0x3f63bdb2bf4b3f71,0xbf6d3f523d33bf5e,0xbf7f3f253e85bf71,0x3f35bf7c3ed83f00,0x3f4bbf773ec43f00,0xbec43f77bf4b248d,0xbeaf3f71bf5e3e32,0xa554bf443f7cbf00,0xbe5ebf133f7ebf44,0x3ec43ed8bf743f5e,0x3f35a554bf353f80,0xbf35248d3f35bf80,0xbf7a3f133e06bf44,0x3f6dbed8be9a3f5e
.quad 0x3f71bf713f003e32,0xbf803f44be32bf00,0xbf1c3f77bf6d3f00,0x3f6dbf773f1ca554,0x3db2bf253f77bf71,0xbf353f7cbf683f00,0x3eec3db2bf1c3f71,0x3ec4bf523f80bf5e,0xbf5e3f00a554bf00,0x248d3f00bf5e3f80,0x3f80bf683f1cbe32,0xbec4bdb23f0abf5e,0xbf523f7cbf773f44,0x3f35beafbdb23f00,0x3ec4bf353f6dbf80,0xbf6d3f35bec4248d
.quad 0x3f44bf00bf713e32,0x3e32bf71bf003f44,0xbf1c3f353f4bbf00,0xbe063f773ec4bf5e,0x3ed8bf5ebf133f44,0x3db2bf7cbe853f71,0xbe5e3f773e9abf71,0xbd333f7f3e06bf7c,0xa554bf80248d3f80,0xa554bf80248d3f80,0x3e5e3f77be9abf71,0x3d333f7fbe06bf7c,0xbed8bf5e3f133f44,0xbdb2bf7c3e853f71,0x3f1c3f35bf4bbf00,0x3e063f77bec4bf5e
.quad 0xbf44bf003f713e32,0xbe32bf713f003f44,0x3f633e85bf803e32,0x3e5e3f68bf1cbf25,0xbf77248d3f77bf00,0xbe85bf5e3f353f00,0x3f80be85bf583f44,0x3e9a3f52bf4bbeaf,0xbf7c3f003f25bf71,0xbeafbf443f5e3e32,0x3f6dbf35bec43f80,0x3ec43f35bf6d248d,0xbf523f5e3db2bf71,0xbed8bf253f77be32,0x3f2dbf773e5e3f44,0x3eec3f13bf7e3eaf
.quad 0xbf003f80bf00bf00,0xbf00bf003f80bf00,0x3e9abf773f3d3e32,0x3f0a3ed8bf7e3f25,0xbdb23f5ebf683e32,0xbf13beaf3f77bf44,0xbe06bf353f7ebf00,0x3f1c3e85bf6d3f5e,0x3eaf3f00bf7c3f44,0xbf25be323f5ebf71,0xbf0abe853f63bf71,0x3f2d3db2bf4b3f7c,0x3f35a554bf353f80,0xbf35248d3f35bf80,0xbf583e853eecbf71,0x3f3dbdb2bf1c3f7c
.quad 0x3f71bf00be323f44,0xbf443e323f00bf71,0xbf7e3f35be06bf00,0x3f4bbe85bec43f5e,0x3f7fbf5e3ed83e32,0xbf523eaf3e85bf44,0xbf743f77bf2d3e32,0x3f58bed8be063f25,0x3f5ebf803f5ebf00,0xbf5e3f00a554bf00,0xbf3d3f77bf7a3f44,0x3f63bf133e063eaf,0x3f13bf5e3f7fbf71,0xbf683f25be85be32,0xbec43f35bf6d3f80,0x3f6dbf353ec4a554
.quad 0xbf00bf713e323f80,0xbf71bf003f443f44,0x3ec43f77be06bf80,0x3f4b3f35bf1cbf5e,0xbe85bf7c3db23f80,0xbf13bf5e3ed83f71,0x3e063f7fbd33bf80,0x3e9a3f77be5ebf7c,0xa554bf80248d3f80,0xa554bf80248d3f80,0xbe063f7f3d33bf80,0xbe9a3f773e5ebf7c,0x3e85bf7cbdb23f80,0x3f13bf5ebed83f71,0xbec43f773e06bf80,0xbf4b3f353f1cbf5e
.quad 0x3f00bf71be323f80,0x3f71bf00bf443f44,0xbf1c3f683e5ebf80,0xbf803e853f63bf25,0x3f35bf5ebe853f80,0x3f77a554bf773f00,0xbf4b3f523e9abf80,0xbf58be853f80beaf,0x3f5ebf44beaf3f80,0x3f253f00bf7c3e32,0xbf6d3f353ec4bf80,0xbec4bf353f6da554,0x3f77bf25bed83f80,0x3db23f5ebf52be32,0xbf7e3f133eecbf80,0x3e5ebf773f2d3eaf
.quad 0x3f80bf00bf003f80,0xbf003f80bf00bf00,0xbf7e3ed83f0abf80,0x3f3dbf773e9a3f25,0x3f77beafbf133f80,0xbf683f5ebdb2bf44,0xbf6d3e853f1cbf80,0x3f7ebf35be063f5e,0x3f5ebe32bf253f80,0xbf7c3f003eafbf71,0xbf4b3db23f2dbf80,0x3f63be85bf0a3f7c,0x3f35a554bf353f80,0xbf35248d3f35bf80,0xbf1cbdb23f3dbf80,0x3eec3e85bf583f7c
.quad 0x3f003e32bf443f80,0xbe32bf003f71bf71,0xbec4be853f4bbf80,0xbe063f35bf7e3f5e,0x3e853eafbf523f80,0x3ed8bf5e3f7fbf44,0xbe06bed83f58bf80,0xbf2d3f77bf743f25,0x248d3f00bf5e3f80,0x3f5ebf803f5ebf00,0x3e06bf133f63bf80,0xbf7a3f77bf3d3eaf,0xbe853f25bf683f80,0x3f7fbf5e3f13be32,0x3ec4bf353f6dbf80,0xbf6d3f35bec4248d
.quad 0xbf713e323f803e32,0xbf003f443f44bf00,0x3f7e3e85bf6dbf00,0x3f6dbe85bf7e248d,0xbf52bf253f353f44,0xbf77beaf3f683f00,0x3eec3f68bec4bf71,0x3f1c3f52bf0abf5e,0xa554bf80248d3f80,0xa554bf80248d3f80,0xbeec3f683ec4bf71,0xbf1c3f523f0abf5e,0x3f52bf25bf353f44,0x3f77beafbf683f00,0xbf7e3e853f6dbf00,0xbf6dbe853f7ea554
.quad 0x3f713e32bf803e32,0x3f003f44bf44bf00,0xbf2dbf133f6d3e32,0x3e06bf7f3e9a3f5e,0x3e853f5ebf35bf00,0xbf353f5e3e85bf80,0x3e5ebf7f3ec43f44,0x3f7ebed8bf3d3f5e,0xbf253f71a554bf71,0xbf5ebe323f7cbf00,0x3f6dbf35bec43f80,0x3ec43f35bf6d248d,0xbf7f3eaf3f35bf71,0x3e85bf7c3f133f00,0x3f583db2bf6d3f44,0xbf4b3f68bd33bf5e
.quad 0xbf00bf003f80bf00,0x3f80bf00bf003f80,0x3d333f52bf6d3e32,0xbf4bbdb23f63bf5e,0x3ed8bf7c3f353e32,0x3e853f25bf7f3f00,0xbf4b3f77bec4bf00,0x3ec4bf773f4ba554,0x3f7cbf44248d3f44,0xbf5e3f71beafbf00,0xbf743ed83ec4bf71,0x3f7ebf13be5e3f5e,0x3f35a554bf353f80,0xbf35248d3f35bf80,0xbe9abed83f6dbf71,0x3e063f13bf7a3f5e
.quad 0xbe323f44bf803f44,0x3f00bf713f71bf00,0x3f1cbf773f6dbf00,0xbf6d3f77bf1c248d,0xbf683f7cbf353e32,0x3f77bf253db23f00,0x3f80bf523ec43e32,0xbf1c3db23eecbf5e,0xbf5e3f00a554bf00,0x248d3f00bf5e3f80,0x3f0abdb2bec43f44,0x3f1cbf683f80bf5e,0xbdb2beaf3f35bf71,0xbf773f7cbf523f00,0xbec43f35bf6d3f80,0x3f6dbf353ec4a554
.quad 0x3e323f803e32bf71,0x3f443f44bf00bf71,0x3f1cbf35bf4b3f00,0x3e06bf77bec43f5e,0xbf7f248d3f7f3e32,0xbf683eaf3f77be32,0x3f3d3f35bf2dbf44,0x3f583f13bf4bbf25,0xa554bf80248d3f80,0xa554bf80248d3f80,0xbf3d3f353f2dbf44,0xbf583f133f4bbf25,0x3f7fa554bf7f3e32,0x3f683eafbf77be32,0xbf1cbf353f4b3f00,0xbe06bf773ec43f5e
.quad 0xbe323f80be32bf71,0xbf443f443f00bf71,0x3f58bf35bf0a3f71,0x3f743db2bf7e3eaf,0xbf77248d3f77bf00,0xbe85bf5e3f353f00,0x3eec3f35bf63be32,0xbf2d3f683e06bf7c,0x3eafbf803eaf3f44,0x3f7cbe32bf5e3f44,0xbf6d3f353ec4bf80,0xbec4bf353f6da554,0x3f68a554bf683f44,0xbf133f7cbe85bf44,0xbe9abf353f74be32,0x3f80bed8bf1c3f7c
.quad 0xbf003f80bf00bf00,0xbf00bf003f80bf00,0x3f7abf35be5e3f71,0xbeec3f7fbf1cbeaf,0xbf52248d3f52bf71,0x3f7fbf25be853f71,0x3e063f35bf7e3f00,0xbf1cbe853f6dbf5e,0x3f25bf803f253e32,0xbeaf3f71bf5e3e32,0xbf803f353d33bf44,0x3f7abf523e063f25,0x3f35a554bf353f80,0xbf35248d3f35bf80,0x3d33bf353f80bf44,0xbe5e3f52bf7e3f25
.quad 0xbf443f80bf443e32,0x3f71bf713f003e32,0x3f7ebf353e063f00,0xbf4b3e853ec4bf5e,0xbf13248d3f13bf71,0xbdb23f25bf773f71,0xbe5e3f35bf7a3f71,0x3f63bf7f3f4bbeaf,0x3f5ebf803f5ebf00,0xbf5e3f00a554bf00,0xbf743f35be9abe32,0x3d333ed8bf4b3f7c,0x3ed8a554bed83f44,0x3f52bf7c3f77bf44,0x3ec4bf353f6dbf80,0xbf6d3f35bec4248d
.quad 0x3f803e32bf71bf00,0x3f44bf00bf713e32,0xbec4bf773e063f80,0xbf4bbf353f1c3f5e,0xbf353f253f52bf00,0xbed83f5e3f13bf44,0x3f6d3ed8bf63bf00,0x3f7a3e85bf74beaf,0xa554bf80248d3f80,0xa554bf80248d3f80,0xbf6d3ed83f63bf00,0xbf7a3e853f74beaf,0x3f353f25bf52bf00,0x3ed83f5ebf13bf44,0x3ec4bf77be063f80,0x3f4bbf35bf1c3f5e
.quad 0xbf803e323f71bf00,0xbf44bf003f713e32,0x3ec43f52bf3dbf00,0xbeec3f773d33bf7c,0x3f35bf5ebe853f80,0x3f77a554bf773f00,0xbf6dbdb23f7abf00,0x3d33bf773f0a3f25,0x248d3f71bf25bf00,0xbf7c3f003f25bf71,0x3f6dbf35bec43f80,0x3ec43f35bf6d248d,0xbf35beaf3f7fbf00,0x3f52bf5ebdb23f71,0xbec43f7fbf0abf00,0xbf3dbe853f7abf25
.quad 0x3f80bf00bf003f80,0xbf003f80bf00bf00,0xbec4bf133f80bf00,0x3f74be85bf2d3f7c,0xbf353f7cbed8bf00,0x3db2bf5e3f68be32,0x3f6dbe85bf1c3f80,0xbf7e3f353e06bf5e,0xa554bf443f7cbf00,0x3eaf3f00bf7c3f44,0xbf6d3f68be9abf00,0x3f58bf773eec3eaf,0x3f35a554bf353f80,0xbf35248d3f35bf80,0x3ec4bf683f74bf00,0xbf0a3f77bf633eaf
.quad 0xbf803f44be32bf00,0x3f71bf00be323f44,0x3ec43e85bf4b3f80,0x3e06bf353f7ebf5e,0x3f35bf7c3f68bf00,0xbf7f3f5ebed8be32,0xbf6d3f13bd33bf00,0x3e9a3e85bf3d3f7c,0x248d3f00bf5e3f80,0x3f5ebf803f5ebf00,0x3f6dbf7f3f58bf00,0xbf2d3e853e5ebf25,0xbf353eaf3db2bf00,0xbf133f5ebf7f3f71,0xbec43f35bf6d3f80,0x3f6dbf353ec4a554
.quad 0x3e32bf71bf003f44,0xbf00bf713e323f80,0xbf7ebe853f6d3f00,0xbf6d3e853f7ea554,0xbdb23f7c3e85bf71,0x3e853f7cbdb2bf80,0x3f803db2bf7ebe32,0x3f7ebdb2bf80248d,0xa554bf80248d3f80,0xa554bf80248d3f80,0xbf803db23f7ebe32,0xbf7ebdb23f80a554,0x3db23f7cbe85bf71,0xbe853f7c3db2bf80,0x3f7ebe85bf6d3f00,0x3f6d3e85bf7e248d
.quad 0xbe32bf713f003f44,0x3f00bf71be323f80,0xbf7a3ed83f4bbf44,0xbf4bbed83f7aa554,0x3e853f5ebf35bf00,0xbf353f5e3e85bf80,0x3f74bf13bf1c3f71,0x3f1c3f13bf74248d,0xbeafbf443f5e3e32,0x3f5ebf44beaf3f80,0xbf6d3f353ec4bf80,0xbec4bf353f6da554,0x3ed83f25bf773e32,0xbf773f253ed8bf80,0x3f63bf52be063f71,0x3e063f52bf63248d
.quad 0xbf00bf003f80bf00,0x3f80bf00bf003f80,0xbf583f68be06bf44,0x3e06bf683f58a554,0x3f133eafbf773f44,0xbf773eaf3f13bf80,0x3f4bbf773ec43f00,0xbec43f77bf4b248d,0xbf25be323f5ebf71,0x3f5ebe32bf253f80,0xbf3d3f7fbf1cbe32,0x3f1cbf7f3f3da554,0x3f35a554bf353f80,0xbf35248d3f35bf80,0x3f2dbf7f3f4bbe32,0xbf4b3f7fbf2d248d
.quad 0xbf443e323f00bf71,0x3f003e32bf443f80,0xbf1c3f77bf6d3f00,0x3f6dbf773f1ca554,0x3f52beafbe853f44,0xbe85beaf3f52bf80,0x3f0abf683f7ebf44,0xbf7e3f68bf0a248d,0xbf5e3f00a554bf00,0x248d3f00bf5e3f80,0xbeec3f52bf7e3f71,0x3f7ebf523eeca554,0x3f68bf253e853e32,0x3e85bf253f68bf80,0x3ec4bf353f6dbf80,0xbf6d3f35bec4248d
.quad 0xbf71bf003f443f44,0xbf713e323f803e32,0xbf1c3f353f4bbf00,0xbe063f773ec4bf5e,0x3f133f5ebed8bf71,0x3f523f25bf35bf44,0x3f74be85bf7a3e32,0x3f63bed8bf6d3eaf,0xa554bf80248d3f80,0xa554bf80248d3f80,0xbf74be853f7a3e32,0xbf63bed83f6d3eaf,0xbf133f5e3ed8bf71,0xbf523f253f35bf44,0x3f1c3f35bf4bbf00,0x3e063f77bec4bf5e
.quad 0x3f71bf00bf443f44,0x3f713e32bf803e32,0xbd33bf773eec3f44,0x3f3dbf52bec43f7c,0xbf77248d3f77bf00,0xbe85bf5e3f353f00,0xbf0a3f77bd33bf71,0xbf7a3db23f6dbf25,0x3f253f00bf7c3e32,0xbf253f71a554bf71,0x3f6dbf35bec43f80,0x3ec43f35bf6d248d,0xbdb2bf5e3f523e32,0x3f7fbeafbf353f71,0xbf7a3e853f3dbf71,0x3f0abf7f3ec43f25
.quad 0xbf003f80bf00bf00,0xbf00bf003f80bf00,0x3f2d3e85bf743f44,0xbf803f133ec4bf7c,0x3f68bf5e3db23f44,0xbed83f7cbf35be32,0xbe06bf353f7ebf00,0x3f1c3e85bf6d3f5e,0xbf7c3f003eafbf71,0x3f7cbf44248d3f44,0xbeec3f77bf583e32,0x3e9abf683f6dbeaf,0x3f35a554bf353f80,0xbf35248d3f35bf80,0x3f63bf773f0a3e32,0xbf743f68bec4beaf
.quad 0xbe32bf003f71bf71,0xbe323f44bf803f44,0xbf7e3f35be06bf00,0x3f4bbe85bec43f5e,0xbed83f5ebf7f3f44,0x3f68bf7c3f35be32,0x3f3dbe85be9a3f44,0x3d33bf133f6dbf7c,0x3f5ebf803f5ebf00,0xbf5e3f00a554bf00,0xbe5ebe853f2dbf71,0xbf583f7fbf6d3f25,0xbf7f3f5ebf133e32,0x3db23eafbf353f71,0xbec43f35bf6d3f80,0x3f6dbf353ec4a554
.quad 0xbf003f443f44bf00,0x3e323f803e32bf71,0x3ec43f77be06bf80,0x3f4b3f35bf1cbf5e,0x3f773eafbf68bf00,0x3f7fa554bf7fbe32,0x3f4bbf13bf583f00,0x3f2dbf35bf3d3f25,0xa554bf80248d3f80,0xa554bf80248d3f80,0xbf4bbf133f583f00,0xbf2dbf353f3d3f25,0xbf773eaf3f68bf00,0xbf7f248d3f7fbe32,0xbec43f773e06bf80,0xbf4b3f353f1cbf5e
.quad 0x3f003f44bf44bf00,0xbe323f80be32bf71,0x3f7ebdb2bf743f00,0x3f0a3f35bf58beaf,0x3f35bf5ebe853f80,0x3f77a554bf773f00,0xbe06bf683f2d3f00,0x3f63bf35beec3f7c,0xbf5ebe323f7cbf00,0x3eafbf803eaf3f44,0xbf6d3f353ec4bf80,0xbec4bf353f6da554,0xbe853f7cbf13bf00,0xbf68248d3f68bf44,0x3f1c3ed8bf803f00,0xbf743f353e9abf7c
.quad 0x3f80bf00bf003f80,0xbf003f80bf00bf00,0x3f1cbf7f3eec3f00,0x3e5e3f35bf7a3eaf,0xbe85bf253f7fbf00,0x3f52a554bf523f71,0xbf6d3e853f1cbf80,0x3f7ebf35be063f5e,0xbf5e3f71beafbf00,0x3f25bf803f253e32,0xbe063f52bf7a3f00,0xbd33bf353f80bf25,0x3f35a554bf353f80,0xbf35248d3f35bf80,0x3f7ebf523e5e3f00,0xbf803f35bd33bf25
.quad 0x3f00bf713f71bf00,0xbf443f80bf443e32,0xbec4be853f4bbf80,0xbe063f35bf7e3f5e,0xbf773f25bdb2bf00,0x3f13a554bf133f71,0xbf4b3f7fbf633f00,0x3f7abf353e5e3eaf,0x248d3f00bf5e3f80,0x3f5ebf803f5ebf00,0x3f4bbed8bd333f00,0x3e9abf353f74bf7c,0x3f77bf7c3f52bf00,0xbed8248d3ed8bf44,0x3ec4bf353f6dbf80,0xbf6d3f35bec4248d
.quad 0x3f443f44bf00bf71,0x3f803e32bf71bf00,0x3f7e3e85bf6dbf00,0x3f6dbe85bf7e248d,0x3f68beafbf773e32,0x3f35bf25bf523f00,0x3f0abf52bf1c3f44,0x3ec4bf68beec3f5e,0xa554bf80248d3f80,0xa554bf80248d3f80,0xbf0abf523f1c3f44,0xbec4bf683eec3f5e,0xbf68beaf3f773e32,0xbf35bf253f523f00,0xbf7e3e853f6dbf00,0xbf6dbe853f7ea554
.quad 0xbf443f443f00bf71,0xbf803e323f71bf00,0xbe9a3f7fbe06bf71,0xbf6d3f133f2dbf5e,0x3e853f5ebf35bf00,0xbf353f5e3e85bf80,0x3f3d3ed8bf7e3e32,0xbec43f7fbe5ebf5e,0x3f7cbe32bf5e3f44,0x248d3f71bf25bf00,0x3f6dbf35bec43f80,0x3ec43f35bf6d248d,0x3f13bf7c3e853f44,0x3f353eafbf7f3f00,0x3d33bf683f4b3e32,0x3f6dbdb2bf583f5e
.quad 0xbf00bf003f80bf00,0x3f80bf00bf003f80,0xbf633db23f4bbf71,0x3f6dbf52bd333f5e,0xbf7f3f253e85bf71,0x3f35bf7c3ed83f00,0xbf4b3f77bec4bf00,0x3ec4bf773f4ba554,0xbeaf3f71bf5e3e32,0xa554bf443f7cbf00,0x3e5e3f13bf7e3f44,0xbec4bed83f74bf5e,0x3f35a554bf353f80,0xbf35248d3f35bf80,0x3f7abf13be063f44,0xbf6d3ed83e9abf5e
.quad 0x3f71bf713f003e32,0xbf803f44be32bf00,0x3f1cbf773f6dbf00,0xbf6d3f77bf1c248d,0x3db2bf253f77bf71,0xbf353f7cbf683f00,0xbeecbdb23f1cbf71,0xbec43f52bf803f5e,0xbf5e3f00a554bf00,0x248d3f00bf5e3f80,0xbf803f68bf1c3e32,0x3ec43db2bf0a3f5e,0xbf523f7cbf773f44,0x3f35beafbdb23f00,0xbec43f35bf6d3f80,0x3f6dbf353ec4a554
.quad 0x3f44bf00bf713e32,0x3e32bf71bf003f44,0x3f1cbf35bf4b3f00,0x3e06bf77bec43f5e,0x3ed8bf5ebf133f44,0x3db2bf7cbe853f71,0x3e5ebf77be9a3f71,0x3d33bf7fbe063f7c,0xa554bf80248d3f80,0xa554bf80248d3f80,0xbe5ebf773e9a3f71,0xbd33bf7f3e063f7c,0xbed8bf5e3f133f44,0xbdb2bf7c3e853f71,0xbf1cbf353f4b3f00,0xbe06bf773ec43f5e
.quad 0xbf44bf003f713e32,0xbe32bf713f003f44,0xbf63be853f80be32,0xbe5ebf683f1c3f25,0xbf77248d3f77bf00,0xbe85bf5e3f353f00,0xbf803e853f58bf44,0xbe9abf523f4b3eaf,0xbf7c3f003f25bf71,0xbeafbf443f5e3e32,0xbf6d3f353ec4bf80,0xbec4bf353f6da554,0xbf523f5e3db2bf71,0xbed8bf253f77be32,0xbf2d3f77be5ebf44,0xbeecbf133f7ebeaf
.quad 0xbf003f80bf00bf00,0xbf00bf003f80bf00,0xbe9a3f77bf3dbe32,0xbf0abed83f7ebf25,0xbdb23f5ebf683e32,0xbf13beaf3f77bf44,0x3e063f35bf7e3f00,0xbf1cbe853f6dbf5e,0x3eaf3f00bf7c3f44,0xbf25be323f5ebf71,0x3f0a3e85bf633f71,0xbf2dbdb23f4bbf7c,0x3f35a554bf353f80,0xbf35248d3f35bf80,0x3f58be85beec3f71,0xbf3d3db23f1cbf7c
.quad 0x3f71bf00be323f44,0xbf443e323f00bf71,0x3f7ebf353e063f00,0xbf4b3e853ec4bf5e,0x3f7fbf5e3ed83e32,0xbf523eaf3e85bf44,0x3f74bf773f2dbe32,0xbf583ed83e06bf25,0x3f5ebf803f5ebf00,0xbf5e3f00a554bf00,0x3f3dbf773f7abf44,0xbf633f13be06beaf,0x3f13bf5e3f7fbf71,0xbf683f25be85be32,0x3ec4bf353f6dbf80,0xbf6d3f35bec4248d
.quad 0x3f5ebeafbf7c8000,0x3eafbf5ebf253f25,0x3f6dbe85bf7e8000,0x3f1cbf35bf4b3f00,0x3f77be32bf7f8000,0x3f52bf00bf683eaf,0x3f7ebdb2bf808000,0x3f74be85bf7a3e32,0x3f80a50dbf808000,0x3f80a50dbf808000,0x3f7e3db2bf808000,0x3f743e85bf7abe32,0x3f773e32bf7f8000,0x3f523f00bf68beaf,0x3f6d3e85bf7e8000,0x3f1c3f35bf4bbf00
.quad 0x3f5e3eafbf7c8000,0x3eaf3f5ebf25bf25,0x3f4b3ed8bf7a8000,0x3d333f77beecbf44,0x3f353f00bf778000,0xbe853f80be85bf5e,0x3f1c3f13bf748000,0xbf0a3f77bd33bf71,0x3f003f25bf718000,0xbf443f5e3e32bf7c,0x3ec43f35bf6d8000,0xbf6d3f353ec4bf80,0x3e853f44bf688000,0xbf7f3f003f13bf7c,0x3e063f52bf638000,0xbf7a3e853f3dbf71
.quad 0x80003f5ebf5e8000,0xbf5e80003f5ebf5e,0xbe063f68bf588000,0xbf2dbe853f74bf44,0xbe853f71bf528000,0xbed8bf003f7fbf25,0xbec43f77bf4b8000,0xbe06bf353f7ebf00,0xbf003f7cbf448000,0x3e32bf5e3f71beaf,0xbf1c3f7fbf3d8000,0x3eecbf773f58be32,0xbf353f80bf358000,0x3f35bf803f35a50d,0xbf4b3f7fbf2d8000,0x3f63bf773f0a3e32
.quad 0xbf5e3f7cbf258000,0x3f7cbf5e3eaf3eaf,0xbf6d3f77bf1c8000,0x3f7ebf353e063f00,0xbf773f71bf138000,0x3f68bf00bdb23f25,0xbf7e3f68bf0a8000,0x3f3dbe85be9a3f44,0xbf803f5ebf008000,0x3f00a50dbf003f5e,0xbf7e3f52beec8000,0x3e5e3e85bf2d3f71,0xbf773f44bed88000,0xbdb23f00bf523f7c,0xbf6d3f35bec48000,0xbec43f35bf6d3f80
.quad 0xbeafbf7c80003f7c,0xbf5ebf253f253f5e,0x3e06bf77bec43f5e,0xbec4bf773e063f80,0x3f13bf44bf353f25,0x3e85bf71bed83f5e,0x3f63bed8bf6d3eaf,0x3f4bbf13bf583f00,0x3f80a50dbf808000,0x3f80a50dbf808000,0x3f633ed8bf6dbeaf,0x3f4b3f13bf58bf00,0x3f133f44bf35bf25,0x3e853f71bed8bf5e,0x3e063f77bec4bf5e,0xbec43f773e06bf80
.quad 0xbeaf3f7ca50dbf7c,0xbf5e3f253f25bf5e,0xbf3d3f523ec4bf7c,0xbf7e3db23f74bf00,0xbf773f003f35bf5e,0xbf35bf003f77a50d,0xbf7a3db23f6dbf25,0xbe06bf683f2d3f00,0xbf44beaf3f80beaf,0x3f00bf7c3e323f5e,0xbec4bf353f6da50d,0x3f6dbf35bec43f80,0x3db2bf713f353eaf,0x3f77be32bf523f5e,0x3f0abf7f3ec43f25,0x3f1c3ed8bf803f00
.quad 0x3f5ebf5e80003f5e,0x80003f5ebf5e8000,0x3f80bf13bec43f7c,0xbf1c3f7fbeecbf00,0x3f68be32bf353f7c,0xbf773f443db2bf5e,0x3f1c3e85bf6d3f5e,0xbf6d3e853f1cbf80,0x3e323f25bf803f25,0xbf00beaf3f71bf5e,0xbe9a3f68bf6d3eaf,0x3e06bf523f7abf00,0xbf353f80bf358000,0x3f35bf803f35a50d,0xbf743f68bec4beaf,0x3f7ebf523e5e3f00
.quad 0xbf7c3f25a50dbf25,0x3f5ebeafbeaf3f5e,0xbf4b3e853ec4bf5e,0x3ec43e85bf4b3f80,0xbed8be323f35bf7c,0xbe853f44bf7f3f5e,0x3d33bf133f6dbf7c,0xbf4b3f7fbf633f00,0x3f00bf5e3f80bf5e,0xbf803f5ebf008000,0x3f58bf7f3f6dbf25,0xbf4b3ed83d33bf00,0x3f7fbf713f35beaf,0xbe85be323f13bf5e,0x3f6dbf353ec4a50d,0x3ec4bf353f6dbf80
.quad 0xbf7c80003f7c3eaf,0xbf253f253f5ebeaf,0xbf4bbf353f1c3f5e,0xbf7ebe853f6d3f00,0xbdb2bf80bdb23f7c,0xbed8bf713e853f7c,0x3f2dbf35bf3d3f25,0x3f0abf52bf1c3f44,0x3f80a50dbf808000,0x3f80a50dbf808000,0x3f2d3f35bf3dbf25,0x3f0a3f52bf1cbf44,0xbdb23f80bdb2bf7c,0xbed83f713e85bf7c,0xbf4b3f353f1cbf5e,0xbf7e3e853f6dbf00
.quad 0xbf7c80003f7cbeaf,0xbf25bf253f5e3eaf,0xbf0abf353f583eaf,0x3e9abf7f3e063f71,0x3e85bf803e853f5e,0x3f77bf00bf353f5e,0x3f63bf35beec3f7c,0x3f3d3ed8bf7e3e32,0x3f71a50dbf713f25,0xbe323f7cbf00bf25,0x3ec43f35bf6d8000,0xbf6d3f353ec4bf80,0xbed83f80bed8bf25,0xbf52be323f77bf25,0xbf743f353e9abf7c,0x3d33bf683f4b3e32
.quad 0xbf5e80003f5ebf5e,0x3f5ebf5e80003f5e,0xbe5ebf353f7abeaf,0x3f63bdb2bf4b3f71,0x3f13bf803f133eaf,0x3db23f44bf773eaf,0x3f7ebf35be063f5e,0xbf4b3f77bec4bf00,0x3f44a50dbf443f7c,0xbf713eaf3f00bf7c,0x3d333f35bf803f25,0xbe5ebf133f7ebf44,0xbf353f80bf358000,0x3f35bf803f35a50d,0xbf803f35bd33bf25,0x3f7abf13be063f44
.quad 0xbf2580003f25bf7c,0x3eaf3eafbf5e3f7c,0x3e06bf353f7ebf5e,0xbf1c3f77bf6d3f00,0x3f52bf803f52beaf,0xbf7f3f44be85beaf,0x3f7abf353e5e3eaf,0xbeecbdb23f1cbf71,0x3f00a50dbf003f5e,0x3f00bf5e3f80bf5e,0xbe9a3f35bf743f7c,0x3f80bf683f1cbe32,0xbf683f80bf683f25,0x3f13be32be853f25,0xbf6d3f35bec48000,0xbec43f35bf6d3f80
.quad 0x80003f7c3eafbf5e,0x3f253f5ebeafbf7c,0xbf6d3e853f7ea50d,0xbf1c3f353f4bbf00,0xbf35bf443f133f5e,0xbf68bf003f523f25,0x3ec4bf68beec3f5e,0x3e5ebf77be9a3f71,0x3f80a50dbf808000,0x3f80a50dbf808000,0x3ec43f68beecbf5e,0x3e5e3f77be9abf71,0xbf353f443f13bf5e,0xbf683f003f52bf25,0xbf6dbe853f7ea50d,0xbf1cbf353f4b3f00
.quad 0xa50dbf7c3eaf3f5e,0x3f25bf5ebeaf3f7c,0x3f6dbf13bf2d3f5e,0x3f633e85bf803e32,0x3f353f00bf778000,0xbe853f80be85bf5e,0xbec43f7fbe5ebf5e,0xbf803e853f58bf44,0xbf803eaf3f44bf5e,0xbe32bf5e3f443eaf,0xbec4bf353f6da50d,0x3f6dbf35bec43f80,0x3f35bf713db23f5e,0x3f133f00bf7f3eaf,0x3f6dbdb2bf583f5e,0xbf2d3f77be5ebf44
.quad 0x80003f5ebf5e8000,0xbf5e80003f5ebf5e,0xbf6d3f523d33bf5e,0x3e9abf773f3d3e32,0xbf35be323f68bf5e,0x3f7fbf00bed83f7c,0x3ec4bf773f4ba50d,0x3e063f35bf7e3f00,0x3f80bf25be323f5e,0xbf713f5ebe32bf25,0x3ec43ed8bf743f5e,0xbf0abe853f63bf71,0xbf353f80bf358000,0x3f35bf803f35a50d,0xbf6d3ed83e9abf5e,0x3f58be85beec3f71
.quad 0xa50dbf253f7cbf5e,0xbeaf3f5ebf7c3f25,0x3f6dbf773f1ca50d,0xbf7e3f35be06bf00,0x3f35be32bed83f5e,0xbdb2bf003f68bf7c,0xbec43f52bf803f5e,0x3f74bf773f2dbe32,0xbf803f5ebf008000,0x3f00a50dbf003f5e,0xbec4bdb23f0abf5e,0xbf3d3f77bf7a3f44,0x3f35bf713f7fbf5e,0xbf523f00bdb2beaf,0x3f6dbf353ec4a50d,0x3ec4bf353f6dbf80
.quad 0x3f7c3eafbf5ebf25,0x3f5ebeafbf7c8000,0xbe063f773ec4bf5e,0x3ec43f77be06bf80,0xbf7fbe323f773eaf,0xbf773e323f7fa50d,0x3d33bf7fbe063f7c,0xbe06bf7f3d333f80,0x3f80a50dbf808000,0x3f80a50dbf808000,0x3d333f7fbe06bf7c,0xbe063f7f3d33bf80,0xbf7f3e323f77beaf,0xbf77be323f7fa50d,0xbe06bf773ec43f5e,0x3ec4bf77be063f80
.quad 0x3f7cbeafbf5e3f25,0x3f5e3eafbf7c8000,0x3e5e3f68bf1cbf25,0xbf1c3f683e5ebf80,0xbf773f003f35bf5e,0xbf35bf003f77a50d,0xbe9abf523f4b3eaf,0x3f4bbf52be9a3f80,0x3f71bf25bf003f7c,0x3f003f25bf718000,0x3ec43f35bf6d8000,0xbf6d3f353ec4bf80,0xbf683f443e85bf7c,0xbe85bf443f68a50d,0xbeecbf133f7ebeaf,0x3f7ebf13beec3f80
.quad 0x3f5ebf5e80003f5e,0x80003f5ebf5e8000,0x3f0a3ed8bf7e3f25,0xbf7e3ed83f0abf80,0xbf523f71be85bf25,0x3e85bf713f52a50d,0xbf1cbe853f6dbf5e,0x3f6dbe85bf1c3f80,0x3f44bf7c3f003eaf,0xbf003f7cbf448000,0x3f2d3db2bf4b3f7c,0xbf4b3db23f2dbf80,0xbf353f80bf358000,0x3f35bf803f35a50d,0xbf3d3db23f1cbf7c,0x3f1c3db2bf3d3f80
.quad 0x3f25bf7c3f5ebeaf,0xbf5e3f7cbf258000,0x3f4bbe85bec43f5e,0xbec4be853f4bbf80,0xbf133f71bf773f25,0x3f77bf713f13a50d,0xbf583ed83e06bf25,0x3e063ed8bf583f80,0x3f00bf5e3f80bf5e,0xbf803f5ebf008000,0x3f63bf133e063eaf,0x3e06bf133f63bf80,0xbed83f44bf773f7c,0x3f77bf443ed8a50d,0xbf6d3f35bec48000,0xbec43f35bf6d3f80
.quad 0x3eafbf5ebf253f25,0xbeafbf7c80003f7c,0x3f4b3f35bf1cbf5e,0x3f7e3e85bf6dbf00,0xbf523f003f68beaf,0xbf133f443f35bf25,0xbe9abf773e5e3f7c,0xbeecbf683ec43f71,0x3f80a50dbf808000,0x3f80a50dbf808000,0xbe9a3f773e5ebf7c,0xbeec3f683ec4bf71,0xbf52bf003f683eaf,0xbf13bf443f353f25,0x3f4bbf35bf1c3f5e,0x3f7ebe85bf6d3f00
.quad 0x3eaf3f5ebf25bf25,0xbeaf3f7ca50dbf7c,0xbf803e853f63bf25,0xbf2dbf133f6d3e32,0x3e85bf803e853f5e,0x3f77bf00bf353f5e,0x3f583e85bf803eaf,0xbe5e3f7fbec4bf44,0xbf443f5e3e32bf7c,0xbf44beaf3f80beaf,0xbec4bf353f6da50d,0x3f6dbf35bec43f80,0x3f7fbf00bf133f7c,0xbdb23f71bf35beaf,0xbe5e3f77bf2dbeaf,0xbf58bdb23f6dbf44
.quad 0xbf5e80003f5ebf5e,0x3f5ebf5e80003f5e,0x3f3dbf773e9a3f25,0x3d333f52bf6d3e32,0x3ed83f00bf7f3f25,0xbf683e323f35bf7c,0xbf7e3f353e06bf5e,0x3f4bbf773ec43f00,0x3e32bf5e3f71beaf,0x3e323f25bf803f25,0x3f63be85bf0a3f7c,0xbf743ed83ec4bf71,0xbf353f80bf358000,0x3f35bf803f35a50d,0xbeecbe853f58bf7c,0x3e9a3ed8bf6d3f71
.quad 0x3f7cbf5e3eaf3eaf,0xbf7c3f25a50dbf25,0xbe063f35bf7e3f5e,0x3f1cbf773f6dbf00,0xbf683f003db2bf25,0x3ed83e32bf353f7c,0x3f2dbf773f74bf25,0xbf803f52bec4be32,0x3f00a50dbf003f5e,0x3f00bf5e3f80bf5e,0xbf7a3f77bf3d3eaf,0x3f0abdb2bec43f44,0x3db2bf003f52bf7c,0xbf7f3f71bf353eaf,0x3f6dbf353ec4a50d,0x3ec4bf353f6dbf80
.quad 0xbf5ebf253f253f5e,0xbf7c80003f7c3eaf,0x3f6dbe85bf7e8000,0x3f1cbf35bf4b3f00,0xbe853f713ed8bf5e,0x3db23f803db2bf7c,0xbf1cbf523f0a3f5e,0xbf3dbf353f2d3f44,0x3f80a50dbf808000,0x3f80a50dbf808000,0xbf1c3f523f0abf5e,0xbf3d3f353f2dbf44,0xbe85bf713ed83f5e,0x3db2bf803db23f7c,0x3f6d3e85bf7e8000,0x3f1c3f35bf4bbf00
.quad 0xbf5e3f253f25bf5e,0xbf7c80003f7cbeaf,0x3e06bf7f3e9a3f5e,0x3f58bf35bf0a3f71,0x3f353f00bf778000,0xbe853f80be85bf5e,0xbf7e3ed83f3dbf5e,0xbeecbf353f633e32,0x3f00bf7c3e323f5e,0x3f71a50dbf713f25,0x3ec43f35bf6d8000,0xbf6d3f353ec4bf80,0xbf773e323f52bf5e,0x3ed8bf803ed83f25,0x3f4bbf683d333f5e,0x3e9a3f35bf743e32
.quad 0x80003f5ebf5e8000,0xbf5e80003f5ebf5e,0xbf4bbdb23f63bf5e,0x3f7abf35be5e3f71,0x3f77bf44bdb23f5e,0xbf133f80bf13beaf,0xbec43f77bf4b8000,0xbe06bf353f7ebf00,0xbf00beaf3f71bf5e,0x3f44a50dbf443f7c,0x3f7ebf13be5e3f5e,0xbf803f353d33bf44,0xbf353f80bf358000,0x3f35bf803f35a50d,0xbe06bf133f7abf5e,0xbd333f35bf803f44
.quad 0x3f5ebeafbeaf3f5e,0xbf2580003f25bf7c,0xbf6d3f77bf1c8000,0x3f7ebf353e063f00,0x3e85bf443f7fbf5e,0xbf523f80bf523eaf,0x3f1cbdb2beec3f5e,0x3e5ebf353f7abf71,0xbf803f5ebf008000,0x3f00a50dbf003f5e,0x3f1cbf683f80bf5e,0xbf743f35be9abe32,0x3e853e32bf133f5e,0x3f68bf803f68bf25,0xbf6d3f35bec48000,0xbec43f35bf6d3f80
.quad 0xbf253f253f5ebeaf,0x80003f7c3eafbf5e,0x3e06bf77bec43f5e,0xbec4bf773e063f80,0x3ed83f71be85bf7c,0x3f353f44bf13bf5e,0xbf58bf133f4b3f25,0xbf6dbed83f633f00,0x3f80a50dbf808000,0x3f80a50dbf808000,0xbf583f133f4bbf25,0xbf6d3ed83f63bf00,0x3ed8bf71be853f7c,0x3f35bf44bf133f5e,0x3e063f77bec4bf5e,0xbec43f773e06bf80
.quad 0xbf25bf253f5e3eaf,0xa50dbf7c3eaf3f5e,0x3f743db2bf7e3eaf,0x3ec43f52bf3dbf00,0xbf773f003f35bf5e,0xbf35bf003f77a50d,0x3f2dbf68be063f7c,0x3f6d3db2bf7a3f00,0xbe323f7cbf00bf25,0xbf803eaf3f44bf5e,0xbec4bf353f6da50d,0x3f6dbf35bec43f80,0x3f523e32bf773f25,0xbf353f71bdb2bf5e,0xbf803ed83f1cbf7c,0x3ec4bf7f3f0a3f00
.quad 0x3f5ebf5e80003f5e,0x80003f5ebf5e8000,0xbeec3f7fbf1cbeaf,0xbec4bf133f80bf00,0xbdb2bf443f77beaf,0x3f353e32bf683f5e,0x3f1c3e85bf6d3f5e,0xbf6d3e853f1cbf80,0xbf713eaf3f00bf7c,0x3f80bf25be323f5e,0x3f7abf523e063f25,0xbf6d3f68be9abf00,0xbf353f80bf358000,0x3f35bf803f35a50d,0x3e5ebf523f7ebf25,0xbec43f68bf743f00
.quad 0x3eaf3eafbf5e3f7c,0xa50dbf253f7cbf5e,0xbf4b3e853ec4bf5e,0x3ec43e85bf4b3f80,0x3f7fbf443e853eaf,0xbf353e323ed8bf5e,0xbf633f7fbf4b3eaf,0x3f6dbf133d333f00,0x3f00bf5e3f80bf5e,0xbf803f5ebf008000,0x3d333ed8bf4b3f7c,0x3f6dbf7f3f58bf00,0xbf133e323e85bf25,0xbf353f71bf7f3f5e,0x3f6dbf353ec4a50d,0x3ec4bf353f6dbf80
.quad 0x3f253f5ebeafbf7c,0x3f7c3eafbf5ebf25,0xbf4bbf353f1c3f5e,0xbf7ebe853f6d3f00,0x3f683f00bf52bf25,0x3f7f3e32bf77beaf,0xbf7abe853f743eaf,0xbf80bdb23f7e3e32,0x3f80a50dbf808000,0x3f80a50dbf808000,0xbf7a3e853f74beaf,0xbf803db23f7ebe32,0x3f68bf00bf523f25,0x3f7fbe32bf773eaf,0xbf4b3f353f1cbf5e,0xbf7e3e853f6dbf00
.quad 0x3f25bf5ebeaf3f7c,0x3f7cbeafbf5e3f25,0xbeec3f773d33bf7c,0xbf7a3ed83f4bbf44,0x3e85bf803e853f5e,0x3f77bf00bf353f5e,0xbd333f77bf0abf25,0xbf743f133f1cbf71,0xbe32bf5e3f443eaf,0x3f71bf25bf003f7c,0x3ec43f35bf6d8000,0xbf6d3f353ec4bf80,0xbf13bf003f7fbeaf,0x3f68bf44be853f7c,0x3f3d3e85bf7a3f25,0xbf633f523e06bf71
.quad 0xbf5e80003f5ebf5e,0x3f5ebf5e80003f5e,0x3f74be85bf2d3f7c,0xbf583f68be06bf44,0xbf7f3f003ed8bf7c,0x3f52bf713e853f25,0x3f7ebf35be063f5e,0xbf4b3f77bec4bf00,0xbf713f5ebe32bf25,0x3f44bf7c3f003eaf,0x3f58bf773eec3eaf,0xbf3d3f7fbf1cbe32,0xbf353f80bf358000,0x3f35bf803f35a50d,0x3f0abf773f63beaf,0xbf2d3f7fbf4b3e32
.quad 0xbeaf3f5ebf7c3f25,0x3f25bf7c3f5ebeaf,0x3e06bf353f7ebf5e,0xbf1c3f77bf6d3f00,0x3db23f00bf683f7c,0x3f13bf713f77bf25,0xbe9abe853f3dbf7c,0xbf0a3f68bf7e3f44,0x3f00a50dbf003f5e,0x3f00bf5e3f80bf5e,0xbf2d3e853e5ebf25,0xbeec3f52bf7e3f71,0x3f52bf003db23eaf,0x3ed8bf443f77bf7c,0xbf6d3f35bec48000,0xbec43f35bf6d3f80
.quad 0x3f5ebeafbf7c8000,0x3eafbf5ebf253f25,0xbf6d3e853f7ea50d,0xbf1c3f353f4bbf00,0x3f77be32bf7f8000,0x3f52bf00bf683eaf,0xbf7e3db23f80a50d,0xbf743e853f7abe32,0x3f80a50dbf808000,0x3f80a50dbf808000,0xbf7ebdb23f80a50d,0xbf74be853f7a3e32,0x3f773e32bf7f8000,0x3f523f00bf68beaf,0xbf6dbe853f7ea50d,0xbf1cbf353f4b3f00
.quad 0x3f5e3eafbf7c8000,0x3eaf3f5ebf25bf25,0xbf4bbed83f7aa50d,0xbd33bf773eec3f44,0x3f353f00bf778000,0xbe853f80be85bf5e,0xbf1cbf133f74a50d,0x3f0abf773d333f71,0x3f003f25bf718000,0xbf443f5e3e32bf7c,0xbec4bf353f6da50d,0x3f6dbf35bec43f80,0x3e853f44bf688000,0xbf7f3f003f13bf7c,0xbe06bf523f63a50d,0x3f7abe85bf3d3f71
.quad 0x80003f5ebf5e8000,0xbf5e80003f5ebf5e,0x3e06bf683f58a50d,0x3f2d3e85bf743f44,0xbe853f71bf528000,0xbed8bf003f7fbf25,0x3ec4bf773f4ba50d,0x3e063f35bf7e3f00,0xbf003f7cbf448000,0x3e32bf5e3f71beaf,0x3f1cbf7f3f3da50d,0xbeec3f77bf583e32,0xbf353f80bf358000,0x3f35bf803f35a50d,0x3f4bbf7f3f2da50d,0xbf633f77bf0abe32
.quad 0xbf5e3f7cbf258000,0x3f7cbf5e3eaf3eaf,0x3f6dbf773f1ca50d,0xbf7e3f35be06bf00,0xbf773f71bf138000,0x3f68bf00bdb23f25,0x3f7ebf683f0aa50d,0xbf3d3e853e9abf44,0xbf803f5ebf008000,0x3f00a50dbf003f5e,0x3f7ebf523eeca50d,0xbe5ebe853f2dbf71,0xbf773f44bed88000,0xbdb23f00bf523f7c,0x3f6dbf353ec4a50d,0x3ec4bf353f6dbf80
.quad 0xbeafbf7c80003f7c,0xbf5ebf253f253f5e,0xbe063f773ec4bf5e,0x3ec43f77be06bf80,0x3f13bf44bf353f25,0x3e85bf71bed83f5e,0xbf633ed83f6dbeaf,0xbf4b3f133f58bf00,0x3f80a50dbf808000,0x3f80a50dbf808000,0xbf63bed83f6d3eaf,0xbf4bbf133f583f00,0x3f133f44bf35bf25,0x3e853f71bed8bf5e,0xbe06bf773ec43f5e,0x3ec4bf77be063f80
.quad 0xbeaf3f7ca50dbf7c,0xbf5e3f253f25bf5e,0x3f3dbf52bec43f7c,0x3f7ebdb2bf743f00,0xbf773f003f35bf5e,0xbf35bf003f77a50d,0x3f7abdb2bf6d3f25,0x3e063f68bf2dbf00,0xbf44beaf3f80beaf,0x3f00bf7c3e323f5e,0x3ec43f35bf6d8000,0xbf6d3f353ec4bf80,0x3db2bf713f353eaf,0x3f77be32bf523f5e,0xbf0a3f7fbec4bf25,0xbf1cbed83f80bf00
.quad 0x3f5ebf5e80003f5e,0x80003f5ebf5e8000,0xbf803f133ec4bf7c,0x3f1cbf7f3eec3f00,0x3f68be32bf353f7c,0xbf773f443db2bf5e,0xbf1cbe853f6dbf5e,0x3f6dbe85bf1c3f80,0x3e323f25bf803f25,0xbf00beaf3f71bf5e,0x3e9abf683f6dbeaf,0xbe063f52bf7a3f00,0xbf353f80bf358000,0x3f35bf803f35a50d,0x3f74bf683ec43eaf,0xbf7e3f52be5ebf00
.quad 0xbf7c3f25a50dbf25,0x3f5ebeafbeaf3f5e,0x3f4bbe85bec43f5e,0xbec4be853f4bbf80,0xbed8be323f35bf7c,0xbe853f44bf7f3f5e,0xbd333f13bf6d3f7c,0x3f4bbf7f3f63bf00,0x3f00bf5e3f80bf5e,0xbf803f5ebf008000,0xbf583f7fbf6d3f25,0x3f4bbed8bd333f00,0x3f7fbf713f35beaf,0xbe85be323f13bf5e,0xbf6d3f35bec48000,0xbec43f35bf6d3f80
.quad 0xbf7c80003f7c3eaf,0xbf253f253f5ebeaf,0x3f4b3f35bf1cbf5e,0x3f7e3e85bf6dbf00,0xbdb2bf80bdb23f7c,0xbed8bf713e853f7c,0xbf2d3f353f3dbf25,0xbf0a3f523f1cbf44,0x3f80a50dbf808000,0x3f80a50dbf808000,0xbf2dbf353f3d3f25,0xbf0abf523f1c3f44,0xbdb23f80bdb2bf7c,0xbed83f713e85bf7c,0x3f4bbf35bf1c3f5e,0x3f7ebe85bf6d3f00
.quad 0xbf7c80003f7cbeaf,0xbf25bf253f5e3eaf,0x3f0a3f35bf58beaf,0xbe9a3f7fbe06bf71,0x3e85bf803e853f5e,0x3f77bf00bf353f5e,0xbf633f353eecbf7c,0xbf3dbed83f7ebe32,0x3f71a50dbf713f25,0xbe323f7cbf00bf25,0xbec4bf353f6da50d,0x3f6dbf35bec43f80,0xbed83f80bed8bf25,0xbf52be323f77bf25,0x3f74bf35be9a3f7c,0xbd333f68bf4bbe32
.quad 0xbf5e80003f5ebf5e,0x3f5ebf5e80003f5e,0x3e5e3f35bf7a3eaf,0xbf633db23f4bbf71,0x3f13bf803f133eaf,0x3db23f44bf773eaf,0xbf7e3f353e06bf5e,0x3f4bbf773ec43f00,0x3f44a50dbf443f7c,0xbf713eaf3f00bf7c,0xbd33bf353f80bf25,0x3e5e3f13bf7e3f44,0xbf353f80bf358000,0x3f35bf803f35a50d,0x3f80bf353d333f25,0xbf7a3f133e06bf44
.quad 0xbf2580003f25bf7c,0x3eaf3eafbf5e3f7c,0xbe063f35bf7e3f5e,0x3f1cbf773f6dbf00,0x3f52bf803f52beaf,0xbf7f3f44be85beaf,0xbf7a3f35be5ebeaf,0x3eec3db2bf1c3f71,0x3f00a50dbf003f5e,0x3f00bf5e3f80bf5e,0x3e9abf353f74bf7c,0xbf803f68bf1c3e32,0xbf683f80bf683f25,0x3f13be32be853f25,0x3f6dbf353ec4a50d,0x3ec4bf353f6dbf80
.quad 0x80003f7c3eafbf5e,0x3f253f5ebeafbf7c,0x3f6dbe85bf7e8000,0x3f1cbf35bf4b3f00,0xbf35bf443f133f5e,0xbf68bf003f523f25,0xbec43f683eecbf5e,0xbe5e3f773e9abf71,0x3f80a50dbf808000,0x3f80a50dbf808000,0xbec4bf683eec3f5e,0xbe5ebf773e9a3f71,0xbf353f443f13bf5e,0xbf683f003f52bf25,0x3f6d3e85bf7e8000,0x3f1c3f35bf4bbf00
.quad 0xa50dbf7c3eaf3f5e,0x3f25bf5ebeaf3f7c,0xbf6d3f133f2dbf5e,0xbf63be853f80be32,0x3f353f00bf778000,0xbe853f80be85bf5e,0x3ec4bf7f3e5e3f5e,0x3f80be85bf583f44,0xbf803eaf3f44bf5e,0xbe32bf5e3f443eaf,0x3ec43f35bf6d8000,0xbf6d3f353ec4bf80,0x3f35bf713db23f5e,0x3f133f00bf7f3eaf,0xbf6d3db23f58bf5e,0x3f2dbf773e5e3f44
.quad 0x80003f5ebf5e8000,0xbf5e80003f5ebf5e,0x3f6dbf52bd333f5e,0xbe9a3f77bf3dbe32,0xbf35be323f68bf5e,0x3f7fbf00bed83f7c,0xbec43f77bf4b8000,0xbe06bf353f7ebf00,0x3f80bf25be323f5e,0xbf713f5ebe32bf25,0xbec4bed83f74bf5e,0x3f0a3e85bf633f71,0xbf353f80bf358000,0x3f35bf803f35a50d,0x3f6dbed8be9a3f5e,0xbf583e853eecbf71
.quad 0xa50dbf253f7cbf5e,0xbeaf3f5ebf7c3f25,0xbf6d3f77bf1c8000,0x3f7ebf353e063f00,0x3f35be32bed83f5e,0xbdb2bf003f68bf7c,0x3ec4bf523f80bf5e,0xbf743f77bf2d3e32,0xbf803f5ebf008000,0x3f00a50dbf003f5e,0x3ec43db2bf0a3f5e,0x3f3dbf773f7abf44,0x3f35bf713f7fbf5e,0xbf523f00bdb2beaf,0xbf6d3f35bec48000,0xbec43f35bf6d3f80
.quad 0x3f7c3eafbf5ebf25,0x3f5ebeafbf7c8000,0x3e06bf77bec43f5e,0xbec4bf773e063f80,0xbf7fbe323f773eaf,0xbf773e323f7fa50d,0xbd333f7f3e06bf7c,0x3e063f7fbd33bf80,0x3f80a50dbf808000,0x3f80a50dbf808000,0xbd33bf7f3e063f7c,0x3e06bf7fbd333f80,0xbf7f3e323f77beaf,0xbf77be323f7fa50d,0x3e063f77bec4bf5e,0xbec43f773e06bf80
.quad 0x3f7cbeafbf5e3f25,0x3f5e3eafbf7c8000,0xbe5ebf683f1c3f25,0x3f1cbf68be5e3f80,0xbf773f003f35bf5e,0xbf35bf003f77a50d,0x3e9a3f52bf4bbeaf,0xbf4b3f523e9abf80,0x3f71bf25bf003f7c,0x3f003f25bf718000,0xbec4bf353f6da50d,0x3f6dbf35bec43f80,0xbf683f443e85bf7c,0xbe85bf443f68a50d,0x3eec3f13bf7e3eaf,0xbf7e3f133eecbf80
.quad 0x3f5ebf5e80003f5e,0x80003f5ebf5e8000,0xbf0abed83f7ebf25,0x3f7ebed8bf0a3f80,0xbf523f71be85bf25,0x3e85bf713f52a50d,0x3f1c3e85bf6d3f5e,0xbf6d3e853f1cbf80,0x3f44bf7c3f003eaf,0xbf003f7cbf448000,0xbf2dbdb23f4bbf7c,0x3f4bbdb2bf2d3f80,0xbf353f80bf358000,0x3f35bf803f35a50d,0x3f3dbdb2bf1c3f7c,0xbf1cbdb23f3dbf80
.quad 0x3f25bf7c3f5ebeaf,0xbf5e3f7cbf258000,0xbf4b3e853ec4bf5e,0x3ec43e85bf4b3f80,0xbf133f71bf773f25,0x3f77bf713f13a50d,0x3f58bed8be063f25,0xbe06bed83f58bf80,0x3f00bf5e3f80bf5e,0xbf803f5ebf008000,0xbf633f13be06beaf,0xbe063f13bf633f80,0xbed83f44bf773f7c,0x3f77bf443ed8a50d,0x3f6dbf353ec4a50d,0x3ec4bf353f6dbf80
.quad 0x3eafbf5ebf253f25,0xbeafbf7c80003f7c,0xbf4bbf353f1c3f5e,0xbf7ebe853f6d3f00,0xbf523f003f68beaf,0xbf133f443f35bf25,0x3e9a3f77be5ebf7c,0x3eec3f68bec4bf71,0x3f80a50dbf808000,0x3f80a50dbf808000,0x3e9abf77be5e3f7c,0x3eecbf68bec43f71,0xbf52bf003f683eaf,0xbf13bf443f353f25,0xbf4b3f353f1cbf5e,0xbf7e3e853f6dbf00
.quad 0x3eaf3f5ebf25bf25,0xbeaf3f7ca50dbf7c,0x3f80be85bf633f25,0x3f2d3f13bf6dbe32,0x3e85bf803e853f5e,0x3f77bf00bf353f5e,0xbf58be853f80beaf,0x3e5ebf7f3ec43f44,0xbf443f5e3e32bf7c,0xbf44beaf3f80beaf,0x3ec43f35bf6d8000,0xbf6d3f353ec4bf80,0x3f7fbf00bf133f7c,0xbdb23f71bf35beaf,0x3e5ebf773f2d3eaf,0x3f583db2bf6d3f44
.quad 0xbf5e80003f5ebf5e,0x3f5ebf5e80003f5e,0xbf3d3f77be9abf25,0xbd33bf523f6dbe32,0x3ed83f00bf7f3f25,0xbf683e323f35bf7c,0x3f7ebf35be063f5e,0xbf4b3f77bec4bf00,0x3e32bf5e3f71beaf,0x3e323f25bf803f25,0xbf633e853f0abf7c,0x3f74bed8bec43f71,0xbf353f80bf358000,0x3f35bf803f35a50d,0x3eec3e85bf583f7c,0xbe9abed83f6dbf71
.quad 0x3f7cbf5e3eaf3eaf,0xbf7c3f25a50dbf25,0x3e06bf353f7ebf5e,0xbf1c3f77bf6d3f00,0xbf683f003db2bf25,0x3ed83e32bf353f7c,0xbf2d3f77bf743f25,0x3f80bf523ec43e32,0x3f00a50dbf003f5e,0x3f00bf5e3f80bf5e,0x3f7abf773f3dbeaf,0xbf0a3db23ec4bf44,0x3db2bf003f52bf7c,0xbf7f3f71bf353eaf,0xbf6d3f35bec48000,0xbec43f35bf6d3f80
.quad 0xbf5ebf253f253f5e,0xbf7c80003f7c3eaf,0xbf6d3e853f7ea50d,0xbf1c3f353f4bbf00,0xbe853f713ed8bf5e,0x3db23f803db2bf7c,0x3f1c3f52bf0abf5e,0x3f3d3f35bf2dbf44,0x3f80a50dbf808000,0x3f80a50dbf808000,0x3f1cbf52bf0a3f5e,0x3f3dbf35bf2d3f44,0xbe85bf713ed83f5e,0x3db2bf803db23f7c,0xbf6dbe853f7ea50d,0xbf1cbf353f4b3f00
.quad 0xbf5e3f253f25bf5e,0xbf7c80003f7cbeaf,0xbe063f7fbe9abf5e,0xbf583f353f0abf71,0x3f353f00bf778000,0xbe853f80be85bf5e,0x3f7ebed8bf3d3f5e,0x3eec3f35bf63be32,0x3f00bf7c3e323f5e,0x3f71a50dbf713f25,0xbec4bf353f6da50d,0x3f6dbf35bec43f80,0xbf773e323f52bf5e,0x3ed8bf803ed83f25,0xbf4b3f68bd33bf5e,0xbe9abf353f74be32
.quad 0x80003f5ebf5e8000,0xbf5e80003f5ebf5e,0x3f4b3db2bf633f5e,0xbf7a3f353e5ebf71,0x3f77bf44bdb23f5e,0xbf133f80bf13beaf,0x3ec4bf773f4ba50d,0x3e063f35bf7e3f00,0xbf00beaf3f71bf5e,0x3f44a50dbf443f7c,0xbf7e3f133e5ebf5e,0x3f80bf35bd333f44,0xbf353f80bf358000,0x3f35bf803f35a50d,0x3e063f13bf7a3f5e,0x3d33bf353f80bf44
.quad 0x3f5ebeafbeaf3f5e,0xbf2580003f25bf7c,0x3f6dbf773f1ca50d,0xbf7e3f35be06bf00,0x3e85bf443f7fbf5e,0xbf523f80bf523eaf,0xbf1c3db23eecbf5e,0xbe5e3f35bf7a3f71,0xbf803f5ebf008000,0x3f00a50dbf003f5e,0xbf1c3f68bf803f5e,0x3f74bf353e9a3e32,0x3e853e32bf133f5e,0x3f68bf803f68bf25,0x3f6dbf353ec4a50d,0x3ec4bf353f6dbf80
.quad 0xbf253f253f5ebeaf,0x80003f7c3eafbf5e,0xbe063f773ec4bf5e,0x3ec43f77be06bf80,0x3ed83f71be85bf7c,0x3f353f44bf13bf5e,0x3f583f13bf4bbf25,0x3f6d3ed8bf63bf00,0x3f80a50dbf808000,0x3f80a50dbf808000,0x3f58bf13bf4b3f25,0x3f6dbed8bf633f00,0x3ed8bf71be853f7c,0x3f35bf44bf133f5e,0xbe06bf773ec43f5e,0x3ec4bf77be063f80
.quad 0xbf25bf253f5e3eaf,0xa50dbf7c3eaf3f5e,0xbf74bdb23f7ebeaf,0xbec4bf523f3d3f00,0xbf773f003f35bf5e,0xbf35bf003f77a50d,0xbf2d3f683e06bf7c,0xbf6dbdb23f7abf00,0xbe323f7cbf00bf25,0xbf803eaf3f44bf5e,0x3ec43f35bf6d8000,0xbf6d3f353ec4bf80,0x3f523e32bf773f25,0xbf353f71bdb2bf5e,0x3f80bed8bf1c3f7c,0xbec43f7fbf0abf00
.quad 0x3f5ebf5e80003f5e,0x80003f5ebf5e8000,0x3eecbf7f3f1c3eaf,0x3ec43f13bf803f00,0xbdb2bf443f77beaf,0x3f353e32bf683f5e,0xbf1cbe853f6dbf5e,0x3f6dbe85bf1c3f80,0xbf713eaf3f00bf7c,0x3f80bf25be323f5e,0xbf7a3f52be06bf25,0x3f6dbf683e9a3f00,0xbf353f80bf358000,0x3f35bf803f35a50d,0xbe5e3f52bf7e3f25,0x3ec4bf683f74bf00
.quad 0x3eaf3eafbf5e3f7c,0xa50dbf253f7cbf5e,0x3f4bbe85bec43f5e,0xbec4be853f4bbf80,0x3f7fbf443e853eaf,0xbf353e323ed8bf5e,0x3f63bf7f3f4bbeaf,0xbf6d3f13bd33bf00,0x3f00bf5e3f80bf5e,0xbf803f5ebf008000,0xbd33bed83f4bbf7c,0xbf6d3f7fbf583f00,0xbf133e323e85bf25,0xbf353f71bf7f3f5e,0xbf6d3f35bec48000,0xbec43f35bf6d3f80
.quad 0x3f253f5ebeafbf7c,0x3f7c3eafbf5ebf25,0x3f4b3f35bf1cbf5e,0x3f7e3e85bf6dbf00,0x3f683f00bf52bf25,0x3f7f3e32bf77beaf,0x3f7a3e85bf74beaf,0x3f803db2bf7ebe32,0x3f80a50dbf808000,0x3f80a50dbf808000,0x3f7abe85bf743eaf,0x3f80bdb2bf7e3e32,0x3f68bf00bf523f25,0x3f7fbe32bf773eaf,0x3f4bbf35bf1c3f5e,0x3f7ebe85bf6d3f00
.quad 0x3f25bf5ebeaf3f7c,0x3f7cbeafbf5e3f25,0x3eecbf77bd333f7c,0x3f7abed8bf4b3f44,0x3e85bf803e853f5e,0x3f77bf00bf353f5e,0x3d33bf773f0a3f25,0x3f74bf13bf1c3f71,0xbe32bf5e3f443eaf,0x3f71bf25bf003f7c,0xbec4bf353f6da50d,0x3f6dbf35bec43f80,0xbf13bf003f7fbeaf,0x3f68bf44be853f7c,0xbf3dbe853f7abf25,0x3f63bf52be063f71
.quad 0xbf5e80003f5ebf5e,0x3f5ebf5e80003f5e,0xbf743e853f2dbf7c,0x3f58bf683e063f44,0xbf7f3f003ed8bf7c,0x3f52bf713e853f25,0xbf7e3f353e06bf5e,0x3f4bbf773ec43f00,0xbf713f5ebe32bf25,0x3f44bf7c3f003eaf,0xbf583f77beecbeaf,0x3f3dbf7f3f1c3e32,0xbf353f80bf358000,0x3f35bf803f35a50d,0xbf0a3f77bf633eaf,0x3f2dbf7f3f4bbe32
.quad 0xbeaf3f5ebf7c3f25,0x3f25bf7c3f5ebeaf,0xbe063f35bf7e3f5e,0x3f1cbf773f6dbf00,0x3db23f00bf683f7c,0x3f13bf713f77bf25,0x3e9a3e85bf3d3f7c,0x3f0abf683f7ebf44,0x3f00a50dbf003f5e,0x3f00bf5e3f80bf5e,0x3f2dbe85be5e3f25,0x3eecbf523f7ebf71,0x3f52bf003db23eaf,0x3ed8bf443f77bf7c,0x3f6dbf353ec4a50d,0x3ec4bf353f6dbf80
.quad 0xbf003f44bf713f80,0x3f44bf003e323e32,0xbf1c3f52bf743f80,0x3f0abe85bd333eaf,0xbf353f5ebf773f80,0x3e85a554be853f00,0xbf4b3f68bf7a3f80,0xbd333e85beec3f25,0xbf5e3f71bf7c3f80,0xbeaf3f00bf253f44,0xbf6d3f77bf7e3f80,0xbf1c3f35bf4b3f5e,0xbf773f7cbf7f3f80,0xbf523f5ebf683f71,0xbf7e3f7fbf803f80,0xbf743f77bf7a3f7c
.quad 0xbf803f80bf803f80,0xbf803f80bf803f80,0xbf7e3f7fbf803f80,0xbf743f77bf7a3f7c,0xbf773f7cbf7f3f80,0xbf523f5ebf683f71,0xbf6d3f77bf7e3f80,0xbf1c3f35bf4b3f5e,0xbf5e3f71bf7c3f80,0xbeaf3f00bf253f44,0xbf4b3f68bf7a3f80,0xbd333e85beec3f25,0xbf353f5ebf773f80,0x3e85248dbe853f00,0xbf1c3f52bf743f80,0x3f0abe85bd333eaf
.quad 0xbf003f44bf713f80,0x3f44bf003e323e32,0xbec43f35bf6d3f80,0x3f6dbf353ec4248d,0xbe853f25bf683f80,0x3f7fbf5e3f13be32,0xbe063f13bf633f80,0x3f7abf773f3dbeaf,0xa5543f00bf5e3f80,0x3f5ebf803f5ebf00,0x3e063ed8bf583f80,0x3f2dbf773f74bf25,0x3e853eafbf523f80,0x3ed8bf5e3f7fbf44,0x3ec43e85bf4b3f80,0x3e06bf353f7ebf5e
.quad 0x3f003e32bf443f80,0xbe32bf003f71bf71,0x3f1c3db2bf3d3f80,0xbeecbe853f58bf7c,0x3f35248dbf353f80,0xbf35a5543f35bf80,0x3f4bbdb2bf2d3f80,0xbf633e853f0abf7c,0x3f5ebe32bf253f80,0xbf7c3f003eafbf71,0x3f6dbe85bf1c3f80,0xbf7e3f353e06bf5e,0x3f77beafbf133f80,0xbf683f5ebdb2bf44,0x3f7ebed8bf0a3f80,0xbf3d3f77be9abf25
.quad 0x3f44bf713f80bf71,0xbf003e323e32bf00,0x3f7abf7f3f6dbf44,0x3e06bed83f2dbf5e,0x3f77bf5e3f35bf00,0x3f35bf5e3f77bf80,0x3f3dbf133ec4be32,0x3f7ebf7f3f74bf5e,0x3eafbe32248d3e32,0x3f5ebf443f25bf00,0xbe063e85bec43f00,0x3ec4be853e06a554,0xbf133f25bf353f44,0xbe853eafbed83f00,0xbf633f68bf6d3f71,0xbf4b3f52bf583f5e
.quad 0xbf803f80bf803f80,0xbf803f80bf803f80,0xbf633f68bf6d3f71,0xbf4b3f52bf583f5e,0xbf133f25bf353f44,0xbe853eafbed83f00,0xbe063e85bec43f00,0x3ec4be853e06248d,0x3eafbe32a5543e32,0x3f5ebf443f25bf00,0x3f3dbf133ec4be32,0x3f7ebf7f3f74bf5e,0x3f77bf5e3f35bf00,0x3f35bf5e3f77bf80,0x3f7abf7f3f6dbf44,0x3e06bed83f2dbf5e
.quad 0x3f44bf713f80bf71,0xbf003e323e32bf00,0x3ec4bf353f6dbf80,0xbf6d3f35bec4a554,0xbdb2beaf3f35bf71,0xbf773f7cbf523f00,0xbf0a3db23ec4bf44,0xbf1c3f68bf803f5e,0xbf5e3f00248dbf00,0xa5543f00bf5e3f80,0xbf803f52bec4be32,0x3f1cbdb2beec3f5e,0xbf683f7cbf353e32,0x3f77bf253db23f00,0xbf1c3f77bf6d3f00,0x3f6dbf773f1c248d
.quad 0xbe323f44bf803f44,0x3f00bf713f71bf00,0x3e9a3ed8bf6d3f71,0xbe06bf133f7abf5e,0x3f35248dbf353f80,0xbf35a5543f35bf80,0x3f74bed8bec43f71,0xbf7e3f133e5ebf5e,0x3f7cbf44a5543f44,0xbf5e3f71beafbf00,0x3f4bbf773ec43f00,0xbec43f77bf4ba554,0x3ed8bf7c3f353e32,0x3e853f25bf7f3f00,0xbd33bf523f6dbe32,0x3f4b3db2bf633f5e
.quad 0xbf713f80bf713f44,0x3e323e32bf003f44,0xbf633f35beec3e32,0xbf3d3f68bf7e3f7c,0xbe85248d3e85bf00,0xbf773f5ebf353f00,0x3f0abf353f58bf71,0xbe9a3db23e06beaf,0x3f7cbf803f7cbf71,0x3f25bf443f5ebf71,0x3f4bbf353f1cbf00,0x3f7ebf773f6dbf5e,0x3db2a554bdb23e32,0x3ed8beaf3e85be32,0xbf2d3f35bf3d3f44,0xbf0a3f13bf1c3f25
.quad 0xbf803f80bf803f80,0xbf803f80bf803f80,0xbf2d3f35bf3d3f44,0xbf0a3f13bf1c3f25,0x3db2248dbdb23e32,0x3ed8beaf3e85be32,0x3f4bbf353f1cbf00,0x3f7ebf773f6dbf5e,0x3f7cbf803f7cbf71,0x3f25bf443f5ebf71,0x3f0abf353f58bf71,0xbe9a3db23e06beaf,0xbe85a5543e85bf00,0xbf773f5ebf353f00,0xbf633f35beec3e32,0xbf3d3f68bf7e3f7c
.quad 0xbf713f80bf713f44,0x3e323e32bf003f44,0xbec43f35bf6d3f80,0x3f6dbf353ec4248d,0x3ed8248dbed83f44,0x3f52bf7c3f77bf44,0x3f74bf353e9a3e32,0xbd33bed83f4bbf7c,0x3f5ebf803f5ebf00,0xbf5e3f00248dbf00,0x3e5ebf353f7abf71,0xbf633f7fbf4b3eaf,0xbf13a5543f13bf71,0xbdb23f25bf773f71,0xbf7e3f35be06bf00,0x3f4bbe85bec43f5e
.quad 0xbf443f80bf443e32,0x3f71bf713f003e32,0xbd333f35bf803f44,0x3e5ebf523f7ebf25,0x3f35248dbf353f80,0xbf35a5543f35bf80,0x3f80bf35bd333f44,0xbf7a3f52be06bf25,0x3f25bf803f253e32,0xbeaf3f71bf5e3e32,0xbe06bf353f7ebf00,0x3f1c3e85bf6d3f5e,0xbf52a5543f52bf71,0x3f7fbf25be853f71,0xbf7a3f353e5ebf71,0x3eecbf7f3f1c3eaf
.quad 0x3f80bf713f44bf00,0x3e32bf003f44bf71,0x3ec4bdb2be5e3f00,0x3f80bf773f58bf25,0xbf353f5ebf773f80,0x3e85a554be853f00,0xbf6d3f52bf2d3f00,0xbf633f77bf803f7c,0xa554be323eafbf00,0xbf253f00beaf3e32,0x3f6dbf773f7ebf80,0x3f1cbf353f4bbf5e,0x3f35bf253f13bf00,0x3f68bf5e3f52bf44,0xbec43ed8beec3f00,0xbe5e3e85be9a3eaf
.quad 0xbf803f80bf803f80,0xbf803f80bf803f80,0xbec43ed8beec3f00,0xbe5e3e85be9a3eaf,0x3f35bf253f13bf00,0x3f68bf5e3f52bf44,0x3f6dbf773f7ebf80,0x3f1cbf353f4bbf5e,0x248dbe323eafbf00,0xbf253f00beaf3e32,0xbf6d3f52bf2d3f00,0xbf633f77bf803f7c,0xbf353f5ebf773f80,0x3e85248dbe853f00,0x3ec4bdb2be5e3f00,0x3f80bf773f58bf25
.quad 0x3f80bf713f44bf00,0x3e32bf003f44bf71,0x3ec4bf353f6dbf80,0xbf6d3f35bec4a554,0xbf353eaf3db2bf00,0xbf133f5ebf7f3f71,0xbf6d3f7fbf583f00,0x3f2dbe85be5e3f25,0xa5543f00bf5e3f80,0x3f5ebf803f5ebf00,0x3f6dbf133d333f00,0xbe9abe853f3dbf7c,0x3f35bf7c3f68bf00,0xbf7f3f5ebed8be32,0xbec4be853f4bbf80,0xbe063f35bf7e3f5e
.quad 0xbf803f44be32bf00,0x3f71bf00be323f44,0xbec43f68bf743f00,0x3f0abf773f63beaf,0x3f35248dbf353f80,0xbf35a5543f35bf80,0x3f6dbf683e9a3f00,0xbf583f77beecbeaf,0x248dbf443f7cbf00,0x3eaf3f00bf7c3f44,0xbf6d3e853f1cbf80,0x3f7ebf35be063f5e,0xbf353f7cbed8bf00,0x3db2bf5e3f68be32,0x3ec43f13bf803f00,0xbf743e853f2dbf7c
.quad 0xbf713f44bf003e32,0xbf003f44bf713f80,0x3e9abf133f4bbf71,0xbf4b3f13be9a248d,0x3f77bf5e3f35bf00,0x3f35bf5e3f77bf80,0xbe5e3ed8bf1c3f44,0x3f1cbed83e5ea554,0xbf7c3f71bf5e3f44,0xbf5e3f71bf7c3f80,0x3e06be853ec4bf00,0xbec43e85be06248d,0x3f7fbf7c3f77bf71,0x3f77bf7c3f7fbf80,0xbd333db2be063e32,0x3e06bdb23d33a554
.quad 0xbf803f80bf803f80,0xbf803f80bf803f80,0xbd333db2be063e32,0x3e06bdb23d33248d,0x3f7fbf7c3f77bf71,0x3f77bf7c3f7fbf80,0x3e06be853ec4bf00,0xbec43e85be06a554,0xbf7c3f71bf5e3f44,0xbf5e3f71bf7c3f80,0xbe5e3ed8bf1c3f44,0x3f1cbed83e5e248d,0x3f77bf5e3f35bf00,0x3f35bf5e3f77bf80,0x3e9abf133f4bbf71,0xbf4b3f13be9aa554
.quad 0xbf713f44bf003e32,0xbf003f44bf713f80,0xbec43f35bf6d3f80,0x3f6dbf353ec4248d,0x3f68bf253e853e32,0x3e85bf253f68bf80,0x3eecbf523f7ebf71,0xbf7e3f52beeca554,0xbf5e3f00248dbf00,0xa5543f00bf5e3f80,0xbf0a3f68bf7e3f44,0x3f7ebf683f0a248d,0x3f52beafbe853f44,0xbe85beaf3f52bf80,0x3f1cbf773f6dbf00,0xbf6d3f77bf1ca554
.quad 0xbf443e323f00bf71,0x3f003e32bf443f80,0xbf2d3f7fbf4b3e32,0x3f4bbf7f3f2d248d,0x3f35248dbf353f80,0xbf35a5543f35bf80,0x3f3dbf7f3f1c3e32,0xbf1c3f7fbf3da554,0xbf25be323f5ebf71,0x3f5ebe32bf253f80,0xbf4b3f77bec4bf00,0x3ec4bf773f4b248d,0x3f133eafbf773f44,0xbf773eaf3f13bf80,0x3f58bf683e063f44,0xbe063f68bf58a554
.quad 0x3f44bf003e323e32,0x3f44bf713f80bf71,0xbf583f77bf803f71,0x3e5e3db2bec43f25,0xbe85248d3e85bf00,0xbf773f5ebf353f00,0x3f80bf773f63bf44,0x3f2dbf523f6dbf7c,0xbeaf3f00bf253f44,0x3eafbe32248d3e32,0xbf4b3f35bf1c3f00,0xbf7e3f77bf6d3f5e,0x3f52bf5e3f68bf71,0x3f13bf253f35bf44,0x3e9abe853e5ebe32,0x3eecbed83ec4beaf
.quad 0xbf803f80bf803f80,0xbf803f80bf803f80,0x3e9abe853e5ebe32,0x3eecbed83ec4beaf,0x3f52bf5e3f68bf71,0x3f13bf253f35bf44,0xbf4b3f35bf1c3f00,0xbf7e3f77bf6d3f5e,0xbeaf3f00bf253f44,0x3eafbe32a5543e32,0x3f80bf773f63bf44,0x3f2dbf523f6dbf7c,0xbe85a5543e85bf00,0xbf773f5ebf353f00,0xbf583f77bf803f71,0x3e5e3db2bec43f25
.quad 0x3f44bf003e323e32,0x3f44bf713f80bf71,0x3ec4bf353f6dbf80,0xbf6d3f35bec4a554,0xbf7f3f5ebf133e32,0x3db23eafbf353f71,0x3e5e3e85bf2d3f71,0x3f58bf7f3f6dbf25,0x3f5ebf803f5ebf00,0xbf5e3f00248dbf00,0xbf3d3e853e9abf44,0xbd333f13bf6d3f7c,0xbed83f5ebf7f3f44,0x3f68bf7c3f35be32,0x3f7ebf353e063f00,0xbf4b3e853ec4bf5e
.quad 0xbe32bf003f71bf71,0xbe323f44bf803f44,0xbf633f77bf0abe32,0x3f74bf683ec43eaf,0x3f35248dbf353f80,0xbf35a5543f35bf80,0x3eecbf773f58be32,0xbe9a3f68bf6d3eaf,0xbf7c3f003eafbf71,0x3f7cbf44a5543f44,0x3e063f35bf7e3f00,0xbf1cbe853f6dbf5e,0x3f68bf5e3db23f44,0xbed83f7cbf35be32,0xbf2dbe853f74bf44,0x3f80bf13bec43f7c
.quad 0xbf003e323e32bf00,0xbf713f80bf713f44,0x3f7ebf683f3dbf00,0x3eecbf353f63bf7c,0xbf353f5ebf773f80,0x3e85a554be853f00,0xbe06bdb23e9abf00,0xbf583f35bf0a3eaf,0x3f5ebf443f25bf00,0x3f7cbf803f7cbf71,0xbf6d3f77bf7e3f80,0xbf1c3f35bf4b3f5e,0x3e85beaf3ed8bf00,0xbdb2248d3db2be32,0x3f1cbf133f0abf00,0x3f3dbf353f2dbf25
.quad 0xbf803f80bf803f80,0xbf803f80bf803f80,0x3f1cbf133f0abf00,0x3f3dbf353f2dbf25,0x3e85beaf3ed8bf00,0xbdb2a5543db2be32,0xbf6d3f77bf7e3f80,0xbf1c3f35bf4b3f5e,0x3f5ebf443f25bf00,0x3f7cbf803f7cbf71,0xbe06bdb23e9abf00,0xbf583f35bf0a3eaf,0xbf353f5ebf773f80,0x3e85248dbe853f00,0x3f7ebf683f3dbf00,0x3eecbf353f63bf7c
.quad 0xbf003e323e32bf00,0xbf713f80bf713f44,0xbec43f35bf6d3f80,0x3f6dbf353ec4248d,0x3f77bf7c3f52bf00,0xbed8a5543ed8bf44,0xbf4b3ed83d33bf00,0xbe9a3f35bf743f7c,0xa5543f00bf5e3f80,0x3f5ebf803f5ebf00,0x3f4bbf7f3f63bf00,0xbf7a3f35be5ebeaf,0xbf773f25bdb2bf00,0x3f13248dbf133f71,0x3ec43e85bf4b3f80,0x3e06bf353f7ebf5e
.quad 0x3f00bf713f71bf00,0xbf443f80bf443e32,0xbf7e3f52be5ebf00,0x3f80bf353d333f25,0x3f35248dbf353f80,0xbf35a5543f35bf80,0x3e06bf523f7abf00,0x3d333f35bf803f25,0xbf5e3f71beafbf00,0x3f25bf803f253e32,0x3f6dbe85bf1c3f80,0xbf7e3f353e06bf5e,0xbe85bf253f7fbf00,0x3f52248dbf523f71,0xbf1c3f7fbeecbf00,0xbe5ebf353f7abeaf
.quad 0x3e323e32bf003f44,0x3f80bf713f44bf00,0xbf2d3ed8be06be32,0xbf6d3f7fbf7a3f5e,0x3f77bf5e3f35bf00,0x3f35bf5e3f77bf80,0xbf743f7fbf7e3f71,0xbec43f13bf3d3f5e,0x3f25bf443f5ebf71,0xa554be323eafbf00,0xbe063e85bec43f00,0x3ec4be853e06a554,0xbed83eafbe853e32,0xbf353f25bf133f00,0x3f58bf523f4bbf44,0x3f6dbf683f63bf5e
.quad 0xbf803f80bf803f80,0xbf803f80bf803f80,0x3f58bf523f4bbf44,0x3f6dbf683f63bf5e,0xbed83eafbe853e32,0xbf353f25bf133f00,0xbe063e85bec43f00,0x3ec4be853e06248d,0x3f25bf443f5ebf71,0x248dbe323eafbf00,0xbf743f7fbf7e3f71,0xbec43f13bf3d3f5e,0x3f77bf5e3f35bf00,0x3f35bf5e3f77bf80,0xbf2d3ed8be06be32,0xbf6d3f7fbf7a3f5e
.quad 0x3e323e32bf003f44,0x3f80bf713f44bf00,0x3ec4bf353f6dbf80,0xbf6d3f35bec4a554,0xbf523f7cbf773f44,0x3f35beafbdb23f00,0x3f80bf683f1cbe32,0xbec4bdb23f0abf5e,0xbf5e3f00248dbf00,0xa5543f00bf5e3f80,0x3eec3db2bf1c3f71,0x3ec4bf523f80bf5e,0x3db2bf253f77bf71,0xbf353f7cbf683f00,0xbf1c3f77bf6d3f00,0x3f6dbf773f1c248d
.quad 0x3f71bf713f003e32,0xbf803f44be32bf00,0xbf7a3f133e06bf44,0x3f6dbed8be9a3f5e,0x3f35248dbf353f80,0xbf35a5543f35bf80,0xbe5ebf133f7ebf44,0x3ec43ed8bf743f5e,0xbeaf3f71bf5e3e32,0x248dbf443f7cbf00,0x3f4bbf773ec43f00,0xbec43f77bf4ba554,0xbf7f3f253e85bf71,0x3f35bf7c3ed83f00,0x3f63bdb2bf4b3f71,0xbf6d3f523d33bf5e
.quad 0x3e32bf003f44bf71,0xbf713f44bf003e32,0x3d333e85bf0a3f44,0x3f74bf523f1cbeaf,0xbe85248d3e85bf00,0xbf773f5ebf353f00,0x3eecbe853d333e32,0x3f7abf683f4bbf25,0xbf253f00beaf3e32,0xbf7c3f71bf5e3f44,0x3f4bbf353f1cbf00,0x3f7ebf773f6dbf5e,0xbf683f5ebf523f44,0xbf7f3f7cbf773f71,0x3f7abf773f74bf71,0x3f80bf7f3f7ebf7c
.quad 0xbf803f80bf803f80,0xbf803f80bf803f80,0x3f7abf773f74bf71,0x3f80bf7f3f7ebf7c,0xbf683f5ebf523f44,0xbf7f3f7cbf773f71,0x3f4bbf353f1cbf00,0x3f7ebf773f6dbf5e,0xbf253f00beaf3e32,0xbf7c3f71bf5e3f44,0x3eecbe853d333e32,0x3f7abf683f4bbf25,0xbe85a5543e85bf00,0xbf773f5ebf353f00,0x3d333e85bf0a3f44,0x3f74bf523f1cbeaf
.quad 0x3e32bf003f44bf71,0xbf713f44bf003e32,0xbec43f35bf6d3f80,0x3f6dbf353ec4248d,0x3f13bf5e3f7fbf71,0xbf683f25be85be32,0xbf3d3f77bf7a3f44,0x3f63bf133e063eaf,0x3f5ebf803f5ebf00,0xbf5e3f00248dbf00,0xbf743f77bf2d3e32,0x3f58bed8be063f25,0x3f7fbf5e3ed83e32,0xbf523eaf3e85bf44,0xbf7e3f35be06bf00,0x3f4bbe85bec43f5e
.quad 0x3f71bf00be323f44,0xbf443e323f00bf71,0xbf583e853eecbf71,0x3f3dbdb2bf1c3f7c,0x3f35248dbf353f80,0xbf35a5543f35bf80,0xbf0abe853f63bf71,0x3f2d3db2bf4b3f7c,0x3eaf3f00bf7c3f44,0xbf25be323f5ebf71,0xbe06bf353f7ebf00,0x3f1c3e85bf6d3f5e,0xbdb23f5ebf683e32,0xbf13beaf3f77bf44,0x3e9abf773f3d3e32,0x3f0a3ed8bf7e3f25
.quad 0xbf003f44bf713f80,0x3f44bf003e323e32,0x3f1cbf523f74bf80,0xbf0a3e853d33beaf,0xbf353f5ebf773f80,0x3e85a554be853f00,0x3f4bbf683f7abf80,0x3d33be853eecbf25,0xbf5e3f71bf7c3f80,0xbeaf3f00bf253f44,0x3f6dbf773f7ebf80,0x3f1cbf353f4bbf5e,0xbf773f7cbf7f3f80,0xbf523f5ebf683f71,0x3f7ebf7f3f80bf80,0x3f74bf773f7abf7c
.quad 0xbf803f80bf803f80,0xbf803f80bf803f80,0x3f7ebf7f3f80bf80,0x3f74bf773f7abf7c,0xbf773f7cbf7f3f80,0xbf523f5ebf683f71,0x3f6dbf773f7ebf80,0x3f1cbf353f4bbf5e,0xbf5e3f71bf7c3f80,0xbeaf3f00bf253f44,0x3f4bbf683f7abf80,0x3d33be853eecbf25,0xbf353f5ebf773f80,0x3e85248dbe853f00,0x3f1cbf523f74bf80,0xbf0a3e853d33beaf
.quad 0xbf003f44bf713f80,0x3f44bf003e323e32,0x3ec4bf353f6dbf80,0xbf6d3f35bec4a554,0xbe853f25bf683f80,0x3f7fbf5e3f13be32,0x3e06bf133f63bf80,0xbf7a3f77bf3d3eaf,0xa5543f00bf5e3f80,0x3f5ebf803f5ebf00,0xbe06bed83f58bf80,0xbf2d3f77bf743f25,0x3e853eafbf523f80,0x3ed8bf5e3f7fbf44,0xbec4be853f4bbf80,0xbe063f35bf7e3f5e
.quad 0x3f003e32bf443f80,0xbe32bf003f71bf71,0xbf1cbdb23f3dbf80,0x3eec3e85bf583f7c,0x3f35248dbf353f80,0xbf35a5543f35bf80,0xbf4b3db23f2dbf80,0x3f63be85bf0a3f7c,0x3f5ebe32bf253f80,0xbf7c3f003eafbf71,0xbf6d3e853f1cbf80,0x3f7ebf35be063f5e,0x3f77beafbf133f80,0xbf683f5ebdb2bf44,0xbf7e3ed83f0abf80,0x3f3dbf773e9a3f25
.quad 0x3f44bf713f80bf71,0xbf003e323e32bf00,0xbf7a3f7fbf6d3f44,0xbe063ed8bf2d3f5e,0x3f77bf5e3f35bf00,0x3f35bf5e3f77bf80,0xbf3d3f13bec43e32,0xbf7e3f7fbf743f5e,0x3eafbe32248d3e32,0x3f5ebf443f25bf00,0x3e06be853ec4bf00,0xbec43e85be06248d,0xbf133f25bf353f44,0xbe853eafbed83f00,0x3f63bf683f6dbf71,0x3f4bbf523f58bf5e
.quad 0xbf803f80bf803f80,0xbf803f80bf803f80,0x3f63bf683f6dbf71,0x3f4bbf523f58bf5e,0xbf133f25bf353f44,0xbe853eafbed83f00,0x3e06be853ec4bf00,0xbec43e85be06a554,0x3eafbe32a5543e32,0x3f5ebf443f25bf00,0xbf3d3f13bec43e32,0xbf7e3f7fbf743f5e,0x3f77bf5e3f35bf00,0x3f35bf5e3f77bf80,0xbf7a3f7fbf6d3f44,0xbe063ed8bf2d3f5e
.quad 0x3f44bf713f80bf71,0xbf003e323e32bf00,0xbec43f35bf6d3f80,0x3f6dbf353ec4248d,0xbdb2beaf3f35bf71,0xbf773f7cbf523f00,0x3f0abdb2bec43f44,0x3f1cbf683f80bf5e,0xbf5e3f00248dbf00,0xa5543f00bf5e3f80,0x3f80bf523ec43e32,0xbf1c3db23eecbf5e,0xbf683f7cbf353e32,0x3f77bf253db23f00,0x3f1cbf773f6dbf00,0xbf6d3f77bf1ca554
.quad 0xbe323f44bf803f44,0x3f00bf713f71bf00,0xbe9abed83f6dbf71,0x3e063f13bf7a3f5e,0x3f35248dbf353f80,0xbf35a5543f35bf80,0xbf743ed83ec4bf71,0x3f7ebf13be5e3f5e,0x3f7cbf44a5543f44,0xbf5e3f71beafbf00,0xbf4b3f77bec4bf00,0x3ec4bf773f4b248d,0x3ed8bf7c3f353e32,0x3e853f25bf7f3f00,0x3d333f52bf6d3e32,0xbf4bbdb23f63bf5e
.quad 0xbf713f80bf713f44,0x3e323e32bf003f44,0x3f63bf353eecbe32,0x3f3dbf683f7ebf7c,0xbe85248d3e85bf00,0xbf773f5ebf353f00,0xbf0a3f35bf583f71,0x3e9abdb2be063eaf,0x3f7cbf803f7cbf71,0x3f25bf443f5ebf71,0xbf4b3f35bf1c3f00,0xbf7e3f77bf6d3f5e,0x3db2a554bdb23e32,0x3ed8beaf3e85be32,0x3f2dbf353f3dbf44,0x3f0abf133f1cbf25
.quad 0xbf803f80bf803f80,0xbf803f80bf803f80,0x3f2dbf353f3dbf44,0x3f0abf133f1cbf25,0x3db2248dbdb23e32,0x3ed8beaf3e85be32,0xbf4b3f35bf1c3f00,0xbf7e3f77bf6d3f5e,0x3f7cbf803f7cbf71,0x3f25bf443f5ebf71,0xbf0a3f35bf583f71,0x3e9abdb2be063eaf,0xbe85a5543e85bf00,0xbf773f5ebf353f00,0x3f63bf353eecbe32,0x3f3dbf683f7ebf7c
.quad 0xbf713f80bf713f44,0x3e323e32bf003f44,0x3ec4bf353f6dbf80,0xbf6d3f35bec4a554,0x3ed8248dbed83f44,0x3f52bf7c3f77bf44,0xbf743f35be9abe32,0x3d333ed8bf4b3f7c,0x3f5ebf803f5ebf00,0xbf5e3f00248dbf00,0xbe5e3f35bf7a3f71,0x3f63bf7f3f4bbeaf,0xbf13a5543f13bf71,0xbdb23f25bf773f71,0x3f7ebf353e063f00,0xbf4b3e853ec4bf5e
.quad 0xbf443f80bf443e32,0x3f71bf713f003e32,0x3d33bf353f80bf44,0xbe5e3f52bf7e3f25,0x3f35248dbf353f80,0xbf35a5543f35bf80,0xbf803f353d33bf44,0x3f7abf523e063f25,0x3f25bf803f253e32,0xbeaf3f71bf5e3e32,0x3e063f35bf7e3f00,0xbf1cbe853f6dbf5e,0xbf52a5543f52bf71,0x3f7fbf25be853f71,0x3f7abf35be5e3f71,0xbeec3f7fbf1cbeaf
.quad 0x3f80bf713f44bf00,0x3e32bf003f44bf71,0xbec43db23e5ebf00,0xbf803f77bf583f25,0xbf353f5ebf773f80,0x3e85a554be853f00,0x3f6dbf523f2dbf00,0x3f63bf773f80bf7c,0xa554be323eafbf00,0xbf253f00beaf3e32,0xbf6d3f77bf7e3f80,0xbf1c3f35bf4b3f5e,0x3f35bf253f13bf00,0x3f68bf5e3f52bf44,0x3ec4bed83eecbf00,0x3e5ebe853e9abeaf
.quad 0xbf803f80bf803f80,0xbf803f80bf803f80,0x3ec4bed83eecbf00,0x3e5ebe853e9abeaf,0x3f35bf253f13bf00,0x3f68bf5e3f52bf44,0xbf6d3f77bf7e3f80,0xbf1c3f35bf4b3f5e,0x248dbe323eafbf00,0xbf253f00beaf3e32,0x3f6dbf523f2dbf00,0x3f63bf773f80bf7c,0xbf353f5ebf773f80,0x3e85248dbe853f00,0xbec43db23e5ebf00,0xbf803f77bf583f25
.quad 0x3f80bf713f44bf00,0x3e32bf003f44bf71,0xbec43f35bf6d3f80,0x3f6dbf353ec4248d,0xbf353eaf3db2bf00,0xbf133f5ebf7f3f71,0x3f6dbf7f3f58bf00,0xbf2d3e853e5ebf25,0xa5543f00bf5e3f80,0x3f5ebf803f5ebf00,0xbf6d3f13bd33bf00,0x3e9a3e85bf3d3f7c,0x3f35bf7c3f68bf00,0xbf7f3f5ebed8be32,0x3ec43e85bf4b3f80,0x3e06bf353f7ebf5e
.quad 0xbf803f44be32bf00,0x3f71bf00be323f44,0x3ec4bf683f74bf00,0xbf0a3f77bf633eaf,0x3f35248dbf353f80,0xbf35a5543f35bf80,0xbf6d3f68be9abf00,0x3f58bf773eec3eaf,0x248dbf443f7cbf00,0x3eaf3f00bf7c3f44,0x3f6dbe85bf1c3f80,0xbf7e3f353e06bf5e,0xbf353f7cbed8bf00,0x3db2bf5e3f68be32,0xbec4bf133f80bf00,0x3f74be85bf2d3f7c
.quad 0xbf713f44bf003e32,0xbf003f44bf713f80,0xbe9a3f13bf4b3f71,0x3f4bbf133e9aa554,0x3f77bf5e3f35bf00,0x3f35bf5e3f77bf80,0x3e5ebed83f1cbf44,0xbf1c3ed8be5e248d,0xbf7c3f71bf5e3f44,0xbf5e3f71bf7c3f80,0xbe063e85bec43f00,0x3ec4be853e06a554,0x3f7fbf7c3f77bf71,0x3f77bf7c3f7fbf80,0x3d33bdb23e06be32,0xbe063db2bd33248d
.quad 0xbf803f80bf803f80,0xbf803f80bf803f80,0x3d33bdb23e06be32,0xbe063db2bd33a554,0x3f7fbf7c3f77bf71,0x3f77bf7c3f7fbf80,0xbe063e85bec43f00,0x3ec4be853e06248d,0xbf7c3f71bf5e3f44,0xbf5e3f71bf7c3f80,0x3e5ebed83f1cbf44,0xbf1c3ed8be5ea554,0x3f77bf5e3f35bf00,0x3f35bf5e3f77bf80,0xbe9a3f13bf4b3f71,0x3f4bbf133e9a248d
.quad 0xbf713f44bf003e32,0xbf003f44bf713f80,0x3ec4bf353f6dbf80,0xbf6d3f35bec4a554,0x3f68bf253e853e32,0x3e85bf253f68bf80,0xbeec3f52bf7e3f71,0x3f7ebf523eec248d,0xbf5e3f00248dbf00,0xa5543f00bf5e3f80,0x3f0abf683f7ebf44,0xbf7e3f68bf0aa554,0x3f52beafbe853f44,0xbe85beaf3f52bf80,0xbf1c3f77bf6d3f00,0x3f6dbf773f1c248d
.quad 0xbf443e323f00bf71,0x3f003e32bf443f80,0x3f2dbf7f3f4bbe32,0xbf4b3f7fbf2da554,0x3f35248dbf353f80,0xbf35a5543f35bf80,0xbf3d3f7fbf1cbe32,0x3f1cbf7f3f3d248d,0xbf25be323f5ebf71,0x3f5ebe32bf253f80,0x3f4bbf773ec43f00,0xbec43f77bf4ba554,0x3f133eafbf773f44,0xbf773eaf3f13bf80,0xbf583f68be06bf44,0x3e06bf683f58248d
.quad 0x3f44bf003e323e32,0x3f44bf713f80bf71,0x3f58bf773f80bf71,0xbe5ebdb23ec4bf25,0xbe85248d3e85bf00,0xbf773f5ebf353f00,0xbf803f77bf633f44,0xbf2d3f52bf6d3f7c,0xbeaf3f00bf253f44,0x3eafbe32248d3e32,0x3f4bbf353f1cbf00,0x3f7ebf773f6dbf5e,0x3f52bf5e3f68bf71,0x3f13bf253f35bf44,0xbe9a3e85be5e3e32,0xbeec3ed8bec43eaf
.quad 0xbf803f80bf803f80,0xbf803f80bf803f80,0xbe9a3e85be5e3e32,0xbeec3ed8bec43eaf,0x3f52bf5e3f68bf71,0x3f13bf253f35bf44,0x3f4bbf353f1cbf00,0x3f7ebf773f6dbf5e,0xbeaf3f00bf253f44,0x3eafbe32a5543e32,0xbf803f77bf633f44,0xbf2d3f52bf6d3f7c,0xbe85a5543e85bf00,0xbf773f5ebf353f00,0x3f58bf773f80bf71,0xbe5ebdb23ec4bf25
.quad 0x3f44bf003e323e32,0x3f44bf713f80bf71,0xbec43f35bf6d3f80,0x3f6dbf353ec4248d,0xbf7f3f5ebf133e32,0x3db23eafbf353f71,0xbe5ebe853f2dbf71,0xbf583f7fbf6d3f25,0x3f5ebf803f5ebf00,0xbf5e3f00248dbf00,0x3f3dbe85be9a3f44,0x3d33bf133f6dbf7c,0xbed83f5ebf7f3f44,0x3f68bf7c3f35be32,0xbf7e3f35be06bf00,0x3f4bbe85bec43f5e
.quad 0xbe32bf003f71bf71,0xbe323f44bf803f44,0x3f63bf773f0a3e32,0xbf743f68bec4beaf,0x3f35248dbf353f80,0xbf35a5543f35bf80,0xbeec3f77bf583e32,0x3e9abf683f6dbeaf,0xbf7c3f003eafbf71,0x3f7cbf44a5543f44,0xbe06bf353f7ebf00,0x3f1c3e85bf6d3f5e,0x3f68bf5e3db23f44,0xbed83f7cbf35be32,0x3f2d3e85bf743f44,0xbf803f133ec4bf7c
.quad 0xbf003e323e32bf00,0xbf713f80bf713f44,0xbf7e3f68bf3d3f00,0xbeec3f35bf633f7c,0xbf353f5ebf773f80,0x3e85a554be853f00,0x3e063db2be9a3f00,0x3f58bf353f0abeaf,0x3f5ebf443f25bf00,0x3f7cbf803f7cbf71,0x3f6dbf773f7ebf80,0x3f1cbf353f4bbf5e,0x3e85beaf3ed8bf00,0xbdb2248d3db2be32,0xbf1c3f13bf0a3f00,0xbf3d3f35bf2d3f25
.quad 0xbf803f80bf803f80,0xbf803f80bf803f80,0xbf1c3f13bf0a3f00,0xbf3d3f35bf2d3f25,0x3e85beaf3ed8bf00,0xbdb2a5543db2be32,0x3f6dbf773f7ebf80,0x3f1cbf353f4bbf5e,0x3f5ebf443f25bf00,0x3f7cbf803f7cbf71,0x3e063db2be9a3f00,0x3f58bf353f0abeaf,0xbf353f5ebf773f80,0x3e85248dbe853f00,0xbf7e3f68bf3d3f00,0xbeec3f35bf633f7c
.quad 0xbf003e323e32bf00,0xbf713f80bf713f44,0x3ec4bf353f6dbf80,0xbf6d3f35bec4a554,0x3f77bf7c3f52bf00,0xbed8a5543ed8bf44,0x3f4bbed8bd333f00,0x3e9abf353f74bf7c,0xa5543f00bf5e3f80,0x3f5ebf803f5ebf00,0xbf4b3f7fbf633f00,0x3f7abf353e5e3eaf,0xbf773f25bdb2bf00,0x3f13248dbf133f71,0xbec4be853f4bbf80,0xbe063f35bf7e3f5e
.quad 0x3f00bf713f71bf00,0xbf443f80bf443e32,0x3f7ebf523e5e3f00,0xbf803f35bd33bf25,0x3f35248dbf353f80,0xbf35a5543f35bf80,0xbe063f52bf7a3f00,0xbd33bf353f80bf25,0xbf5e3f71beafbf00,0x3f25bf803f253e32,0xbf6d3e853f1cbf80,0x3f7ebf35be063f5e,0xbe85bf253f7fbf00,0x3f52248dbf523f71,0x3f1cbf7f3eec3f00,0x3e5e3f35bf7a3eaf
.quad 0x3e323e32bf003f44,0x3f80bf713f44bf00,0x3f2dbed83e063e32,0x3f6dbf7f3f7abf5e,0x3f77bf5e3f35bf00,0x3f35bf5e3f77bf80,0x3f74bf7f3f7ebf71,0x3ec4bf133f3dbf5e,0x3f25bf443f5ebf71,0xa554be323eafbf00,0x3e06be853ec4bf00,0xbec43e85be06248d,0xbed83eafbe853e32,0xbf353f25bf133f00,0xbf583f52bf4b3f44,0xbf6d3f68bf633f5e
.quad 0xbf803f80bf803f80,0xbf803f80bf803f80,0xbf583f52bf4b3f44,0xbf6d3f68bf633f5e,0xbed83eafbe853e32,0xbf353f25bf133f00,0x3e06be853ec4bf00,0xbec43e85be06a554,0x3f25bf443f5ebf71,0x248dbe323eafbf00,0x3f74bf7f3f7ebf71,0x3ec4bf133f3dbf5e,0x3f77bf5e3f35bf00,0x3f35bf5e3f77bf80,0x3f2dbed83e063e32,0x3f6dbf7f3f7abf5e
.quad 0x3e323e32bf003f44,0x3f80bf713f44bf00,0xbec43f35bf6d3f80,0x3f6dbf353ec4248d,0xbf523f7cbf773f44,0x3f35beafbdb23f00,0xbf803f68bf1c3e32,0x3ec43db2bf0a3f5e,0xbf5e3f00248dbf00,0xa5543f00bf5e3f80,0xbeecbdb23f1cbf71,0xbec43f52bf803f5e,0x3db2bf253f77bf71,0xbf353f7cbf683f00,0x3f1cbf773f6dbf00,0xbf6d3f77bf1ca554
.quad 0x3f71bf713f003e32,0xbf803f44be32bf00,0x3f7abf13be063f44,0xbf6d3ed83e9abf5e,0x3f35248dbf353f80,0xbf35a5543f35bf80,0x3e5e3f13bf7e3f44,0xbec4bed83f74bf5e,0xbeaf3f71bf5e3e32,0x248dbf443f7cbf00,0xbf4b3f77bec4bf00,0x3ec4bf773f4b248d,0xbf7f3f253e85bf71,0x3f35bf7c3ed83f00,0xbf633db23f4bbf71,0x3f6dbf52bd333f5e
.quad 0x3e32bf003f44bf71,0xbf713f44bf003e32,0xbd33be853f0abf44,0xbf743f52bf1c3eaf,0xbe85248d3e85bf00,0xbf773f5ebf353f00,0xbeec3e85bd33be32,0xbf7a3f68bf4b3f25,0xbf253f00beaf3e32,0xbf7c3f71bf5e3f44,0xbf4b3f35bf1c3f00,0xbf7e3f77bf6d3f5e,0xbf683f5ebf523f44,0xbf7f3f7cbf773f71,0xbf7a3f77bf743f71,0xbf803f7fbf7e3f7c
.quad 0xbf803f80bf803f80,0xbf803f80bf803f80,0xbf7a3f77bf743f71,0xbf803f7fbf7e3f7c,0xbf683f5ebf523f44,0xbf7f3f7cbf773f71,0xbf4b3f35bf1c3f00,0xbf7e3f77bf6d3f5e,0xbf253f00beaf3e32,0xbf7c3f71bf5e3f44,0xbeec3e85bd33be32,0xbf7a3f68bf4b3f25,0xbe85a5543e85bf00,0xbf773f5ebf353f00,0xbd33be853f0abf44,0xbf743f52bf1c3eaf
.quad 0x3e32bf003f44bf71,0xbf713f44bf003e32,0x3ec4bf353f6dbf80,0xbf6d3f35bec4a554,0x3f13bf5e3f7fbf71,0xbf683f25be85be32,0x3f3dbf773f7abf44,0xbf633f13be06beaf,0x3f5ebf803f5ebf00,0xbf5e3f00248dbf00,0x3f74bf773f2dbe32,0xbf583ed83e06bf25,0x3f7fbf5e3ed83e32,0xbf523eaf3e85bf44,0x3f7ebf353e063f00,0xbf4b3e853ec4bf5e
.quad 0x3f71bf00be323f44,0xbf443e323f00bf71,0x3f58be85beec3f71,0xbf3d3db23f1cbf7c,0x3f35248dbf353f80,0xbf35a5543f35bf80,0x3f0a3e85bf633f71,0xbf2dbdb23f4bbf7c,0x3eaf3f00bf7c3f44,0xbf25be323f5ebf71,0x3e063f35bf7e3f00,0xbf1cbe853f6dbf5e,0xbdb23f5ebf683e32,0xbf13beaf3f77bf44,0xbe9a3f77bf3dbe32,0xbf0abed83f7ebf25
.quad 0xbf5e3f25beaf8000,0xbf253f5ebf7c3f7c,0xbf4b3f13be9a8000,0xbf583f77bf803f71,0xbf353f00be858000,0xbf773f80bf773f5e,0xbf1c3ed8be5e8000,0xbf803f77bf633f44,0xbf003eafbe328000,0xbf713f5ebf443f25,0xbec43e85be068000,0xbf4b3f35bf1c3f00,0xbe853e32bdb28000,0xbf133f00bed83eaf,0xbe063db2bd338000,0xbe9a3e85be5e3e32
.quad 0xa50d8000a50d8000,0xa50d8000a50d8000,0x3e06bdb23d338000,0x3e9abe853e5ebe32,0x3e85be323db28000,0x3f13bf003ed8beaf,0x3ec4be853e068000,0x3f4bbf353f1cbf00,0x3f00beaf3e328000,0x3f71bf5e3f44bf25,0x3f1cbed83e5e8000,0x3f80bf773f63bf44,0x3f35bf003e858000,0x3f77bf803f77bf5e,0x3f4bbf133e9a8000,0x3f58bf773f80bf71
.quad 0x3f5ebf253eaf8000,0x3f25bf5e3f7cbf7c,0x3f6dbf353ec48000,0x3ec4bf353f6dbf80,0x3f77bf443ed88000,0x3db2bf003f52bf7c,0x3f7ebf523eec8000,0xbe5ebe853f2dbf71,0x3f80bf5e3f008000,0xbf00a50d3f00bf5e,0x3f7ebf683f0a8000,0xbf3d3e853e9abf44,0x3f77bf713f138000,0xbf683f003db2bf25,0x3f6dbf773f1c8000,0xbf7e3f35be06bf00
.quad 0x3f5ebf7c3f258000,0xbf7c3f5ebeafbeaf,0x3f4bbf7f3f2d8000,0xbf633f77bf0abe32,0x3f35bf803f358000,0xbf353f80bf35a50d,0x3f1cbf7f3f3d8000,0xbeec3f77bf583e32,0x3f00bf7c3f448000,0xbe323f5ebf713eaf,0x3ec4bf773f4b8000,0x3e063f35bf7e3f00,0x3e85bf713f528000,0x3ed83f00bf7f3f25,0x3e06bf683f588000,0x3f2d3e85bf743f44
.quad 0x3f25beaf80003eaf,0x3f5ebf7c3f7cbf5e,0x3e5e3db2bec43f25,0x3f7ebf683f3dbf00,0xbe853f00bf353f5e,0x3f35bf003e85a50d,0xbf2d3f52bf6d3f7c,0x3e063db2be9a3f00,0xbf713f7cbf803f7c,0xbf003f25bf443f5e,0xbf7e3f77bf6d3f5e,0xbf6d3f77bf7e3f80,0xbf523f44bf353f25,0xbf773f71bf683f5e,0xbeec3ed8bec43eaf,0xbf1c3f13bf0a3f00
.quad 0xa50d8000a50d8000,0xa50d8000a50d8000,0x3eecbed83ec4beaf,0x3f1cbf133f0abf00,0x3f52bf443f35bf25,0x3f77bf713f68bf5e,0x3f7ebf773f6dbf5e,0x3f6dbf773f7ebf80,0x3f71bf7c3f80bf7c,0x3f00bf253f44bf5e,0x3f2dbf523f6dbf7c,0xbe06bdb23e9abf00,0x3e85bf003f35bf5e,0xbf353f00be85a50d,0xbe5ebdb23ec4bf25,0xbf7e3f68bf3d3f00
.quad 0xbf253eaf8000beaf,0xbf5e3f7cbf7c3f5e,0xbf6d3f35bec4a50d,0xbec43f35bf6d3f80,0xbf7f3f71bf353eaf,0x3e853e32bf133f5e,0xbf583f7fbf6d3f25,0x3f4bbed8bd333f00,0xbf003f5ebf803f5e,0x3f80bf5e3f008000,0xbd333f13bf6d3f7c,0x3f4bbf7f3f63bf00,0x3ed83e32bf353f7c,0x3e85bf443f7fbf5e,0x3f4bbe85bec43f5e,0xbec4be853f4bbf80
.quad 0x3f7cbf25a50d3f25,0xbf5e3eaf3eafbf5e,0x3f74bf683ec43eaf,0xbf7e3f52be5ebf00,0x3f35bf803f358000,0xbf353f80bf35a50d,0x3e9abf683f6dbeaf,0xbe063f52bf7a3f00,0xbe32bf253f80bf25,0x3f003eafbf713f5e,0xbf1cbe853f6dbf5e,0x3f6dbe85bf1c3f80,0xbf683e323f35bf7c,0x3f77bf44bdb23f5e,0xbf803f133ec4bf7c,0x3f1cbf7f3eec3f00
.quad 0xbeaf80003eafbf25,0xbf7c3f7cbf5e3f25,0x3eecbf353f63bf7c,0xbf2d3ed8be06be32,0x3f77bf803f77bf5e,0x3e85bf003f35bf5e,0x3f58bf353f0abeaf,0x3f74bf7f3f7ebf71,0x3e32a50dbe323eaf,0x3f44bf253f00beaf,0xbf1c3f35bf4b3f5e,0xbe063e85bec43f00,0xbf7f3f80bf7f3f7c,0xbf683f71bf773f7c,0xbf3d3f35bf2d3f25,0xbf583f52bf4b3f44
.quad 0xa50d8000a50d8000,0xa50d8000a50d8000,0x3f3dbf353f2dbf25,0x3f58bf523f4bbf44,0x3f7fbf803f7fbf7c,0x3f68bf713f77bf7c,0x3f1cbf353f4bbf5e,0x3e06be853ec4bf00,0xbe32a50d3e32beaf,0xbf443f25bf003eaf,0xbf583f35bf0a3eaf,0xbf743f7fbf7e3f71,0xbf773f80bf773f5e,0xbe853f00bf353f5e,0xbeec3f35bf633f7c,0x3f2dbed83e063e32
.quad 0x3eaf8000beaf3f25,0x3f7cbf7c3f5ebf25,0x3f6dbf353ec48000,0x3ec4bf353f6dbf80,0x3f68bf803f68bf25,0xbf133e323e85bf25,0x3e9abf353f74bf7c,0xbf803f68bf1c3e32,0xbf00a50d3f00bf5e,0xbf003f5ebf803f5e,0xbf7a3f35be5ebeaf,0x3eec3db2bf1c3f71,0xbf523f80bf523eaf,0x3f7fbf443e853eaf,0xbe063f35bf7e3f5e,0x3f1cbf773f6dbf00
.quad 0x3f258000bf253f7c,0xbeafbeaf3f5ebf7c,0x3f80bf353d333f25,0xbf7a3f133e06bf44,0x3f35bf803f358000,0xbf353f80bf35a50d,0xbd33bf353f80bf25,0x3e5e3f13bf7e3f44,0xbf44a50d3f44bf7c,0x3f71beafbf003f7c,0xbf7e3f353e06bf5e,0x3f4bbf773ec43f00,0xbf133f80bf13beaf,0xbdb2bf443f77beaf,0x3e5e3f35bf7a3eaf,0xbf633db23f4bbf71
.quad 0x80003eafbf253f5e,0x3f7cbf5e3f25beaf,0xbf6d3f7fbf7a3f5e,0x3d333e85bf0a3f44,0xbf353f00be858000,0xbf773f80bf773f5e,0x3ec4bf133f3dbf5e,0xbeec3e85bd33be32,0x3f80bf7c3f71bf5e,0x3f44bf5e3f71bf7c,0x3ec4be853e06a50d,0x3f4bbf353f1cbf00,0xbf353f44bf523f5e,0xbed83f00bf133f25,0xbf6d3f68bf633f5e,0xbf7a3f77bf743f71
.quad 0xa50d8000a50d8000,0xa50d8000a50d8000,0x3f6dbf683f63bf5e,0x3f7abf773f74bf71,0x3f35bf443f52bf5e,0x3ed8bf003f13bf25,0xbec43e85be06a50d,0xbf4b3f35bf1c3f00,0xbf803f7cbf713f5e,0xbf443f5ebf713f7c,0xbec43f13bf3d3f5e,0x3eecbe853d333e32,0x3f35bf003e858000,0x3f77bf803f77bf5e,0x3f6dbf7f3f7abf5e,0xbd33be853f0abf44
.quad 0x8000beaf3f25bf5e,0xbf7c3f5ebf253eaf,0xbf6d3f35bec4a50d,0xbec43f35bf6d3f80,0xbf353f71bf7f3f5e,0x3f52bf003db23eaf,0x3ec43db2bf0a3f5e,0x3f3dbf773f7abf44,0x3f80bf5e3f008000,0xbf00a50d3f00bf5e,0x3ec4bf523f80bf5e,0xbf743f77bf2d3e32,0xbf353e323ed8bf5e,0x3db23f00bf683f7c,0xbf6d3f77bf1ca50d,0x3f7ebf353e063f00
.quad 0xa50d3f25bf7c3f5e,0x3eafbf5e3f7cbf25,0x3f6dbed8be9a3f5e,0xbf583e853eecbf71,0x3f35bf803f358000,0xbf353f80bf35a50d,0xbec4bed83f74bf5e,0x3f0a3e85bf633f71,0xbf803f253e32bf5e,0x3f71bf5e3e323f25,0xbec43f77bf4ba50d,0xbe06bf353f7ebf00,0x3f353e32bf683f5e,0xbf7f3f003ed8bf7c,0x3f6dbf52bd333f5e,0xbe9a3f77bf3dbe32
.quad 0x3eafbf253f5ebf7c,0xbf5e3f25beaf8000,0x3f74bf523f1cbeaf,0x3f1cbf523f74bf80,0xbe853f00bf353f5e,0x3f35bf003e85a50d,0xbf7a3f68bf4b3f25,0xbf4b3f68bf7a3f80,0x3e32beaf3f00bf25,0xbf003eafbe328000,0x3f7ebf773f6dbf5e,0x3f6dbf773f7ebf80,0xbdb23e32be853eaf,0x3e85be323db2a50d,0xbf803f7fbf7e3f7c,0xbf7e3f7fbf803f80
.quad 0xa50d8000a50d8000,0xa50d8000a50d8000,0x3f80bf7f3f7ebf7c,0x3f7ebf7f3f80bf80,0x3db2be323e85beaf,0xbe853e32bdb2a50d,0xbf7e3f77bf6d3f5e,0xbf6d3f77bf7e3f80,0xbe323eafbf003f25,0x3f00beaf3e328000,0x3f7abf683f4bbf25,0x3f4bbf683f7abf80,0x3e85bf003f35bf5e,0xbf353f00be85a50d,0xbf743f52bf1c3eaf,0xbf1c3f52bf743f80
.quad 0xbeaf3f25bf5e3f7c,0x3f5ebf253eaf8000,0x3f6dbf353ec48000,0x3ec4bf353f6dbf80,0x3ed8bf443f77bf7c,0xbf773f44bed8a50d,0xbf633f13be06beaf,0xbe063f13bf633f80,0xbf003f5ebf803f5e,0x3f80bf5e3f008000,0x3f58bed8be063f25,0xbe06bed83f58bf80,0x3f13bf713f77bf25,0xbf773f71bf13a50d,0xbf4b3e853ec4bf5e,0x3ec43e85bf4b3f80
.quad 0xbf253f7cbf5e3eaf,0x3f5ebf7c3f258000,0x3f3dbdb2bf1c3f7c,0xbf1cbdb23f3dbf80,0x3f35bf803f358000,0xbf353f80bf35a50d,0xbf2dbdb23f4bbf7c,0x3f4bbdb2bf2d3f80,0xbf443f7cbf00beaf,0x3f00bf7c3f448000,0x3f1c3e85bf6d3f5e,0xbf6d3e853f1cbf80,0x3f52bf713e853f25,0xbe853f71bf52a50d,0xbf0abed83f7ebf25,0x3f7ebed8bf0a3f80
.quad 0xbf253f5ebf7c3f7c,0x3f25beaf80003eaf,0xbf0a3e853d33beaf,0xbf7a3f7fbf6d3f44,0x3f77bf803f77bf5e,0x3e85bf003f35bf5e,0xbd333e85beec3f25,0x3f3dbf133ec4be32,0xbf713f5ebf443f25,0xbf713f7cbf803f7c,0x3f1cbf353f4bbf5e,0x3e06be853ec4bf00,0x3f13bf003ed8beaf,0x3f52bf443f35bf25,0xbf743f77bf7a3f7c,0xbf633f68bf6d3f71
.quad 0xa50d8000a50d8000,0xa50d8000a50d8000,0x3f74bf773f7abf7c,0x3f63bf683f6dbf71,0xbf133f00bed83eaf,0xbf523f44bf353f25,0xbf1c3f35bf4b3f5e,0xbe063e85bec43f00,0x3f71bf5e3f44bf25,0x3f71bf7c3f80bf7c,0x3d33be853eecbf25,0xbf3d3f13bec43e32,0xbf773f80bf773f5e,0xbe853f00bf353f5e,0x3f0abe85bd333eaf,0x3f7abf7f3f6dbf44
.quad 0x3f25bf5e3f7cbf7c,0xbf253eaf8000beaf,0xbf6d3f35bec4a50d,0xbec43f35bf6d3f80,0xbdb23f00bf523f7c,0x3f7fbf713f35beaf,0x3f7abf773f3dbeaf,0xbf0a3db23ec4bf44,0xbf00a50d3f00bf5e,0xbf003f5ebf803f5e,0xbf2d3f77bf743f25,0x3f80bf523ec43e32,0x3f68bf00bdb23f25,0xbed8be323f35bf7c,0x3e06bf353f7ebf5e,0xbf1c3f77bf6d3f00
.quad 0xbf7c3f5ebeafbeaf,0x3f7cbf25a50d3f25,0x3eec3e85bf583f7c,0xbe9abed83f6dbf71,0x3f35bf803f358000,0xbf353f80bf35a50d,0xbf633e853f0abf7c,0x3f74bed8bec43f71,0xbe323f5ebf713eaf,0xbe32bf253f80bf25,0x3f7ebf35be063f5e,0xbf4b3f77bec4bf00,0xbed8bf003f7fbf25,0x3f68be32bf353f7c,0xbf3d3f77be9abf25,0xbd33bf523f6dbe32
.quad 0x3f5ebf7c3f7cbf5e,0xbeaf80003eafbf25,0xbe063ed8bf2d3f5e,0x3f63bf353eecbe32,0xbf353f00be858000,0xbf773f80bf773f5e,0x3f7ebf7f3f74bf5e,0x3f0abf353f58bf71,0xbf003f25bf443f5e,0x3e32a50dbe323eaf,0xbec43e85be068000,0xbf4b3f35bf1c3f00,0x3f77bf713f68bf5e,0x3f7fbf803f7fbf7c,0xbf4b3f52bf583f5e,0xbf2d3f35bf3d3f44
.quad 0xa50d8000a50d8000,0xa50d8000a50d8000,0x3f4bbf523f58bf5e,0x3f2dbf353f3dbf44,0xbf773f71bf683f5e,0xbf7f3f80bf7f3f7c,0x3ec4be853e068000,0x3f4bbf353f1cbf00,0x3f00bf253f44bf5e,0xbe32a50d3e32beaf,0xbf7e3f7fbf743f5e,0xbf0a3f35bf583f71,0x3f35bf003e858000,0x3f77bf803f77bf5e,0x3e06bed83f2dbf5e,0xbf633f35beec3e32
.quad 0xbf5e3f7cbf7c3f5e,0x3eaf8000beaf3f25,0x3f6dbf353ec48000,0x3ec4bf353f6dbf80,0xbe85be323f13bf5e,0xbf683f80bf683f25,0xbf1c3f68bf803f5e,0x3f74bf353e9a3e32,0x3f80bf5e3f008000,0xbf00a50d3f00bf5e,0xbf1c3db23eecbf5e,0xbe5e3f35bf7a3f71,0xbe853f44bf7f3f5e,0x3f52bf803f52beaf,0x3f6dbf773f1c8000,0xbf7e3f35be06bf00
.quad 0xbf5e3eaf3eafbf5e,0x3f258000bf253f7c,0x3e063f13bf7a3f5e,0x3d33bf353f80bf44,0x3f35bf803f358000,0xbf353f80bf35a50d,0xbf7e3f133e5ebf5e,0x3f80bf35bd333f44,0x3f003eafbf713f5e,0xbf44a50d3f44bf7c,0x3ec4bf773f4b8000,0x3e063f35bf7e3f00,0xbf773f443db2bf5e,0x3f13bf803f133eaf,0x3f4b3db2bf633f5e,0xbf7a3f353e5ebf71
.quad 0xbf7c3f7cbf5e3f25,0x80003eafbf253f5e,0x3f3dbf683f7ebf7c,0xbec43db23e5ebf00,0xbe853f00bf353f5e,0x3f35bf003e85a50d,0xbe9a3db23e06beaf,0xbf6d3f52bf2d3f00,0x3f44bf253f00beaf,0x3f80bf7c3f71bf5e,0xbf7e3f77bf6d3f5e,0xbf6d3f77bf7e3f80,0x3f68bf713f77bf7c,0x3f35bf443f52bf5e,0xbf0a3f13bf1c3f25,0xbec43ed8beec3f00
.quad 0xa50d8000a50d8000,0xa50d8000a50d8000,0x3f0abf133f1cbf25,0x3ec4bed83eecbf00,0xbf683f71bf773f7c,0xbf353f44bf523f5e,0x3f7ebf773f6dbf5e,0x3f6dbf773f7ebf80,0xbf443f25bf003eaf,0xbf803f7cbf713f5e,0x3e9abdb2be063eaf,0x3f6dbf523f2dbf00,0x3e85bf003f35bf5e,0xbf353f00be85a50d,0xbf3d3f68bf7e3f7c,0x3ec4bdb2be5e3f00
.quad 0x3f7cbf7c3f5ebf25,0x8000beaf3f25bf5e,0xbf6d3f35bec4a50d,0xbec43f35bf6d3f80,0x3f13be32be853f25,0x3f35bf713f7fbf5e,0xbd33bed83f4bbf7c,0xbf6d3f7fbf583f00,0xbf003f5ebf803f5e,0x3f80bf5e3f008000,0x3f63bf7f3f4bbeaf,0xbf6d3f13bd33bf00,0xbf7f3f44be85beaf,0x3f35be32bed83f5e,0x3f4bbe85bec43f5e,0xbec4be853f4bbf80
.quad 0xbeafbeaf3f5ebf7c,0xa50d3f25bf7c3f5e,0xbe5e3f52bf7e3f25,0x3ec4bf683f74bf00,0x3f35bf803f358000,0xbf353f80bf35a50d,0xbf7a3f52be06bf25,0x3f6dbf683e9a3f00,0x3f71beafbf003f7c,0xbf803f253e32bf5e,0xbf1cbe853f6dbf5e,0x3f6dbe85bf1c3f80,0x3db23f44bf773eaf,0xbf35be323f68bf5e,0x3eecbf7f3f1c3eaf,0x3ec43f13bf803f00
.quad 0x3f7cbf5e3f25beaf,0x3eafbf253f5ebf7c,0xbf803f77bf583f25,0xbe9a3f13bf4b3f71,0x3f77bf803f77bf5e,0x3e85bf003f35bf5e,0xbf633f77bf803f7c,0xbe5e3ed8bf1c3f44,0x3f44bf5e3f71bf7c,0x3e32beaf3f00bf25,0xbf1c3f35bf4b3f5e,0xbe063e85bec43f00,0x3ed8bf003f13bf25,0x3db2be323e85beaf,0xbe5e3e85be9a3eaf,0xbd333db2be063e32
.quad 0xa50d8000a50d8000,0xa50d8000a50d8000,0x3e5ebe853e9abeaf,0x3d33bdb23e06be32,0xbed83f00bf133f25,0xbdb23e32be853eaf,0x3f1cbf353f4bbf5e,0x3e06be853ec4bf00,0xbf443f5ebf713f7c,0xbe323eafbf003f25,0x3f63bf773f80bf7c,0x3e5ebed83f1cbf44,0xbf773f80bf773f5e,0xbe853f00bf353f5e,0x3f80bf773f58bf25,0x3e9abf133f4bbf71
.quad 0xbf7c3f5ebf253eaf,0xbeaf3f25bf5e3f7c,0x3f6dbf353ec48000,0x3ec4bf353f6dbf80,0xbf523f00bdb2beaf,0xbed83f44bf773f7c,0x3f2dbe85be5e3f25,0x3eecbf523f7ebf71,0xbf00a50d3f00bf5e,0xbf003f5ebf803f5e,0x3e9a3e85bf3d3f7c,0x3f0abf683f7ebf44,0xbdb2bf003f68bf7c,0xbf133f71bf773f25,0xbe063f35bf7e3f5e,0x3f1cbf773f6dbf00
.quad 0x3eafbf5e3f7cbf25,0xbf253f7cbf5e3eaf,0xbf0a3f77bf633eaf,0x3f2dbf7f3f4bbe32,0x3f35bf803f358000,0xbf353f80bf35a50d,0xbf583f77beecbeaf,0x3f3dbf7f3f1c3e32,0x3f71bf5e3e323f25,0xbf443f7cbf00beaf,0xbf7e3f353e06bf5e,0x3f4bbf773ec43f00,0x3f7fbf00bed83f7c,0xbf523f71be85bf25,0xbf743e853f2dbf7c,0x3f58bf683e063f44
.quad 0xbf5e3f25beaf8000,0xbf253f5ebf7c3f7c,0x3f4bbf133e9aa50d,0x3f58bf773f80bf71,0xbf353f00be858000,0xbf773f80bf773f5e,0x3f1cbed83e5ea50d,0x3f80bf773f63bf44,0xbf003eafbe328000,0xbf713f5ebf443f25,0x3ec4be853e06a50d,0x3f4bbf353f1cbf00,0xbe853e32bdb28000,0xbf133f00bed83eaf,0x3e06bdb23d33a50d,0x3e9abe853e5ebe32
.quad 0xa50d8000a50d8000,0xa50d8000a50d8000,0xbe063db2bd33a50d,0xbe9a3e85be5e3e32,0x3e85be323db28000,0x3f13bf003ed8beaf,0xbec43e85be06a50d,0xbf4b3f35bf1c3f00,0x3f00beaf3e328000,0x3f71bf5e3f44bf25,0xbf1c3ed8be5ea50d,0xbf803f77bf633f44,0x3f35bf003e858000,0x3f77bf803f77bf5e,0xbf4b3f13be9aa50d,0xbf583f77bf803f71
.quad 0x3f5ebf253eaf8000,0x3f25bf5e3f7cbf7c,0xbf6d3f35bec4a50d,0xbec43f35bf6d3f80,0x3f77bf443ed88000,0x3db2bf003f52bf7c,0xbf7e3f52beeca50d,0x3e5e3e85bf2d3f71,0x3f80bf5e3f008000,0xbf00a50d3f00bf5e,0xbf7e3f68bf0aa50d,0x3f3dbe85be9a3f44,0x3f77bf713f138000,0xbf683f003db2bf25,0xbf6d3f77bf1ca50d,0x3f7ebf353e063f00
.quad 0x3f5ebf7c3f258000,0xbf7c3f5ebeafbeaf,0xbf4b3f7fbf2da50d,0x3f63bf773f0a3e32,0x3f35bf803f358000,0xbf353f80bf35a50d,0xbf1c3f7fbf3da50d,0x3eecbf773f58be32,0x3f00bf7c3f448000,0xbe323f5ebf713eaf,0xbec43f77bf4ba50d,0xbe06bf353f7ebf00,0x3e85bf713f528000,0x3ed83f00bf7f3f25,0xbe063f68bf58a50d,0xbf2dbe853f74bf44
.quad 0x3f25beaf80003eaf,0x3f5ebf7c3f7cbf5e,0xbe5ebdb23ec4bf25,0xbf7e3f68bf3d3f00,0xbe853f00bf353f5e,0x3f35bf003e85a50d,0x3f2dbf523f6dbf7c,0xbe06bdb23e9abf00,0xbf713f7cbf803f7c,0xbf003f25bf443f5e,0x3f7ebf773f6dbf5e,0x3f6dbf773f7ebf80,0xbf523f44bf353f25,0xbf773f71bf683f5e,0x3eecbed83ec4beaf,0x3f1cbf133f0abf00
.quad 0xa50d8000a50d8000,0xa50d8000a50d8000,0xbeec3ed8bec43eaf,0xbf1c3f13bf0a3f00,0x3f52bf443f35bf25,0x3f77bf713f68bf5e,0xbf7e3f77bf6d3f5e,0xbf6d3f77bf7e3f80,0x3f71bf7c3f80bf7c,0x3f00bf253f44bf5e,0xbf2d3f52bf6d3f7c,0x3e063db2be9a3f00,0x3e85bf003f35bf5e,0xbf353f00be85a50d,0x3e5e3db2bec43f25,0x3f7ebf683f3dbf00
.quad 0xbf253eaf8000beaf,0xbf5e3f7cbf7c3f5e,0x3f6dbf353ec48000,0x3ec4bf353f6dbf80,0xbf7f3f71bf353eaf,0x3e853e32bf133f5e,0x3f58bf7f3f6dbf25,0xbf4b3ed83d33bf00,0xbf003f5ebf803f5e,0x3f80bf5e3f008000,0x3d33bf133f6dbf7c,0xbf4b3f7fbf633f00,0x3ed83e32bf353f7c,0x3e85bf443f7fbf5e,0xbf4b3e853ec4bf5e,0x3ec43e85bf4b3f80
.quad 0x3f7cbf25a50d3f25,0xbf5e3eaf3eafbf5e,0xbf743f68bec4beaf,0x3f7ebf523e5e3f00,0x3f35bf803f358000,0xbf353f80bf35a50d,0xbe9a3f68bf6d3eaf,0x3e06bf523f7abf00,0xbe32bf253f80bf25,0x3f003eafbf713f5e,0x3f1c3e85bf6d3f5e,0xbf6d3e853f1cbf80,0xbf683e323f35bf7c,0x3f77bf44bdb23f5e,0x3f80bf13bec43f7c,0xbf1c3f7fbeecbf00
.quad 0xbeaf80003eafbf25,0xbf7c3f7cbf5e3f25,0xbeec3f35bf633f7c,0x3f2dbed83e063e32,0x3f77bf803f77bf5e,0x3e85bf003f35bf5e,0xbf583f35bf0a3eaf,0xbf743f7fbf7e3f71,0x3e32a50dbe323eaf,0x3f44bf253f00beaf,0x3f1cbf353f4bbf5e,0x3e06be853ec4bf00,0xbf7f3f80bf7f3f7c,0xbf683f71bf773f7c,0x3f3dbf353f2dbf25,0x3f58bf523f4bbf44
.quad 0xa50d8000a50d8000,0xa50d8000a50d8000,0xbf3d3f35bf2d3f25,0xbf583f52bf4b3f44,0x3f7fbf803f7fbf7c,0x3f68bf713f77bf7c,0xbf1c3f35bf4b3f5e,0xbe063e85bec43f00,0xbe32a50d3e32beaf,0xbf443f25bf003eaf,0x3f58bf353f0abeaf,0x3f74bf7f3f7ebf71,0xbf773f80bf773f5e,0xbe853f00bf353f5e,0x3eecbf353f63bf7c,0xbf2d3ed8be06be32
.quad 0x3eaf8000beaf3f25,0x3f7cbf7c3f5ebf25,0xbf6d3f35bec4a50d,0xbec43f35bf6d3f80,0x3f68bf803f68bf25,0xbf133e323e85bf25,0xbe9a3f35bf743f7c,0x3f80bf683f1cbe32,0xbf00a50d3f00bf5e,0xbf003f5ebf803f5e,0x3f7abf353e5e3eaf,0xbeecbdb23f1cbf71,0xbf523f80bf523eaf,0x3f7fbf443e853eaf,0x3e06bf353f7ebf5e,0xbf1c3f77bf6d3f00
.quad 0x3f258000bf253f7c,0xbeafbeaf3f5ebf7c,0xbf803f35bd33bf25,0x3f7abf13be063f44,0x3f35bf803f358000,0xbf353f80bf35a50d,0x3d333f35bf803f25,0xbe5ebf133f7ebf44,0xbf44a50d3f44bf7c,0x3f71beafbf003f7c,0x3f7ebf35be063f5e,0xbf4b3f77bec4bf00,0xbf133f80bf13beaf,0xbdb2bf443f77beaf,0xbe5ebf353f7abeaf,0x3f63bdb2bf4b3f71
.quad 0x80003eafbf253f5e,0x3f7cbf5e3f25beaf,0x3f6dbf7f3f7abf5e,0xbd33be853f0abf44,0xbf353f00be858000,0xbf773f80bf773f5e,0xbec43f13bf3d3f5e,0x3eecbe853d333e32,0x3f80bf7c3f71bf5e,0x3f44bf5e3f71bf7c,0xbec43e85be068000,0xbf4b3f35bf1c3f00,0xbf353f44bf523f5e,0xbed83f00bf133f25,0x3f6dbf683f63bf5e,0x3f7abf773f74bf71
.quad 0xa50d8000a50d8000,0xa50d8000a50d8000,0xbf6d3f68bf633f5e,0xbf7a3f77bf743f71,0x3f35bf443f52bf5e,0x3ed8bf003f13bf25,0x3ec4be853e068000,0x3f4bbf353f1cbf00,0xbf803f7cbf713f5e,0xbf443f5ebf713f7c,0x3ec4bf133f3dbf5e,0xbeec3e85bd33be32,0x3f35bf003e858000,0x3f77bf803f77bf5e,0xbf6d3f7fbf7a3f5e,0x3d333e85bf0a3f44
.quad 0x8000beaf3f25bf5e,0xbf7c3f5ebf253eaf,0x3f6dbf353ec48000,0x3ec4bf353f6dbf80,0xbf353f71bf7f3f5e,0x3f52bf003db23eaf,0xbec4bdb23f0abf5e,0xbf3d3f77bf7a3f44,0x3f80bf5e3f008000,0xbf00a50d3f00bf5e,0xbec43f52bf803f5e,0x3f74bf773f2dbe32,0xbf353e323ed8bf5e,0x3db23f00bf683f7c,0x3f6dbf773f1c8000,0xbf7e3f35be06bf00
.quad 0xa50d3f25bf7c3f5e,0x3eafbf5e3f7cbf25,0xbf6d3ed83e9abf5e,0x3f58be85beec3f71,0x3f35bf803f358000,0xbf353f80bf35a50d,0x3ec43ed8bf743f5e,0xbf0abe853f63bf71,0xbf803f253e32bf5e,0x3f71bf5e3e323f25,0x3ec4bf773f4b8000,0x3e063f35bf7e3f00,0x3f353e32bf683f5e,0xbf7f3f003ed8bf7c,0xbf6d3f523d33bf5e,0x3e9abf773f3d3e32
.quad 0x3eafbf253f5ebf7c,0xbf5e3f25beaf8000,0xbf743f52bf1c3eaf,0xbf1c3f52bf743f80,0xbe853f00bf353f5e,0x3f35bf003e85a50d,0x3f7abf683f4bbf25,0x3f4bbf683f7abf80,0x3e32beaf3f00bf25,0xbf003eafbe328000,0xbf7e3f77bf6d3f5e,0xbf6d3f77bf7e3f80,0xbdb23e32be853eaf,0x3e85be323db2a50d,0x3f80bf7f3f7ebf7c,0x3f7ebf7f3f80bf80
.quad 0xa50d8000a50d8000,0xa50d8000a50d8000,0xbf803f7fbf7e3f7c,0xbf7e3f7fbf803f80,0x3db2be323e85beaf,0xbe853e32bdb2a50d,0x3f7ebf773f6dbf5e,0x3f6dbf773f7ebf80,0xbe323eafbf003f25,0x3f00beaf3e328000,0xbf7a3f68bf4b3f25,0xbf4b3f68bf7a3f80,0x3e85bf003f35bf5e,0xbf353f00be85a50d,0x3f74bf523f1cbeaf,0x3f1cbf523f74bf80
.quad 0xbeaf3f25bf5e3f7c,0x3f5ebf253eaf8000,0xbf6d3f35bec4a50d,0xbec43f35bf6d3f80,0x3ed8bf443f77bf7c,0xbf773f44bed8a50d,0x3f63bf133e063eaf,0x3e06bf133f63bf80,0xbf003f5ebf803f5e,0x3f80bf5e3f008000,0xbf583ed83e06bf25,0x3e063ed8bf583f80,0x3f13bf713f77bf25,0xbf773f71bf13a50d,0x3f4bbe85bec43f5e,0xbec4be853f4bbf80
.quad 0xbf253f7cbf5e3eaf,0x3f5ebf7c3f258000,0xbf3d3db23f1cbf7c,0x3f1c3db2bf3d3f80,0x3f35bf803f358000,0xbf353f80bf35a50d,0x3f2d3db2bf4b3f7c,0xbf4b3db23f2dbf80,0xbf443f7cbf00beaf,0x3f00bf7c3f448000,0xbf1cbe853f6dbf5e,0x3f6dbe85bf1c3f80,0x3f52bf713e853f25,0xbe853f71bf52a50d,0x3f0a3ed8bf7e3f25,0xbf7e3ed83f0abf80
.quad 0xbf253f5ebf7c3f7c,0x3f25beaf80003eaf,0x3f0abe85bd333eaf,0x3f7abf7f3f6dbf44,0x3f77bf803f77bf5e,0x3e85bf003f35bf5e,0x3d33be853eecbf25,0xbf3d3f13bec43e32,0xbf713f5ebf443f25,0xbf713f7cbf803f7c,0xbf1c3f35bf4b3f5e,0xbe063e85bec43f00,0x3f13bf003ed8beaf,0x3f52bf443f35bf25,0x3f74bf773f7abf7c,0x3f63bf683f6dbf71
.quad 0xa50d8000a50d8000,0xa50d8000a50d8000,0xbf743f77bf7a3f7c,0xbf633f68bf6d3f71,0xbf133f00bed83eaf,0xbf523f44bf353f25,0x3f1cbf353f4bbf5e,0x3e06be853ec4bf00,0x3f71bf5e3f44bf25,0x3f71bf7c3f80bf7c,0xbd333e85beec3f25,0x3f3dbf133ec4be32,0xbf773f80bf773f5e,0xbe853f00bf353f5e,0xbf0a3e853d33beaf,0xbf7a3f7fbf6d3f44
.quad 0x3f25bf5e3f7cbf7c,0xbf253eaf8000beaf,0x3f6dbf353ec48000,0x3ec4bf353f6dbf80,0xbdb23f00bf523f7c,0x3f7fbf713f35beaf,0xbf7a3f77bf3d3eaf,0x3f0abdb2bec43f44,0xbf00a50d3f00bf5e,0xbf003f5ebf803f5e,0x3f2dbf773f74bf25,0xbf803f52bec4be32,0x3f68bf00bdb23f25,0xbed8be323f35bf7c,0xbe063f35bf7e3f5e,0x3f1cbf773f6dbf00
.quad 0xbf7c3f5ebeafbeaf,0x3f7cbf25a50d3f25,0xbeecbe853f58bf7c,0x3e9a3ed8bf6d3f71,0x3f35bf803f358000,0xbf353f80bf35a50d,0x3f63be85bf0a3f7c,0xbf743ed83ec4bf71,0xbe323f5ebf713eaf,0xbe32bf253f80bf25,0xbf7e3f353e06bf5e,0x3f4bbf773ec43f00,0xbed8bf003f7fbf25,0x3f68be32bf353f7c,0x3f3dbf773e9a3f25,0x3d333f52bf6d3e32
.quad 0x3f5ebf7c3f7cbf5e,0xbeaf80003eafbf25,0x3e06bed83f2dbf5e,0xbf633f35beec3e32,0xbf353f00be858000,0xbf773f80bf773f5e,0xbf7e3f7fbf743f5e,0xbf0a3f35bf583f71,0xbf003f25bf443f5e,0x3e32a50dbe323eaf,0x3ec4be853e06a50d,0x3f4bbf353f1cbf00,0x3f77bf713f68bf5e,0x3f7fbf803f7fbf7c,0x3f4bbf523f58bf5e,0x3f2dbf353f3dbf44
.quad 0xa50d8000a50d8000,0xa50d8000a50d8000,0xbf4b3f52bf583f5e,0xbf2d3f35bf3d3f44,0xbf773f71bf683f5e,0xbf7f3f80bf7f3f7c,0xbec43e85be06a50d,0xbf4b3f35bf1c3f00,0x3f00bf253f44bf5e,0xbe32a50d3e32beaf,0x3f7ebf7f3f74bf5e,0x3f0abf353f58bf71,0x3f35bf003e858000,0x3f77bf803f77bf5e,0xbe063ed8bf2d3f5e,0x3f63bf353eecbe32
.quad 0xbf5e3f7cbf7c3f5e,0x3eaf8000beaf3f25,0xbf6d3f35bec4a50d,0xbec43f35bf6d3f80,0xbe85be323f13bf5e,0xbf683f80bf683f25,0x3f1cbf683f80bf5e,0xbf743f35be9abe32,0x3f80bf5e3f008000,0xbf00a50d3f00bf5e,0x3f1cbdb2beec3f5e,0x3e5ebf353f7abf71,0xbe853f44bf7f3f5e,0x3f52bf803f52beaf,0xbf6d3f77bf1ca50d,0x3f7ebf353e063f00
.quad 0xbf5e3eaf3eafbf5e,0x3f258000bf253f7c,0xbe06bf133f7abf5e,0xbd333f35bf803f44,0x3f35bf803f358000,0xbf353f80bf35a50d,0x3f7ebf13be5e3f5e,0xbf803f353d33bf44,0x3f003eafbf713f5e,0xbf44a50d3f44bf7c,0xbec43f77bf4ba50d,0xbe06bf353f7ebf00,0xbf773f443db2bf5e,0x3f13bf803f133eaf,0xbf4bbdb23f63bf5e,0x3f7abf35be5e3f71
.quad 0xbf7c3f7cbf5e3f25,0x80003eafbf253f5e,0xbf3d3f68bf7e3f7c,0x3ec4bdb2be5e3f00,0xbe853f00bf353f5e,0x3f35bf003e85a50d,0x3e9abdb2be063eaf,0x3f6dbf523f2dbf00,0x3f44bf253f00beaf,0x3f80bf7c3f71bf5e,0x3f7ebf773f6dbf5e,0x3f6dbf773f7ebf80,0x3f68bf713f77bf7c,0x3f35bf443f52bf5e,0x3f0abf133f1cbf25,0x3ec4bed83eecbf00
.quad 0xa50d8000a50d8000,0xa50d8000a50d8000,0xbf0a3f13bf1c3f25,0xbec43ed8beec3f00,0xbf683f71bf773f7c,0xbf353f44bf523f5e,0xbf7e3f77bf6d3f5e,0xbf6d3f77bf7e3f80,0xbf443f25bf003eaf,0xbf803f7cbf713f5e,0xbe9a3db23e06beaf,0xbf6d3f52bf2d3f00,0x3e85bf003f35bf5e,0xbf353f00be85a50d,0x3f3dbf683f7ebf7c,0xbec43db23e5ebf00
.quad 0x3f7cbf7c3f5ebf25,0x8000beaf3f25bf5e,0x3f6dbf353ec48000,0x3ec4bf353f6dbf80,0x3f13be32be853f25,0x3f35bf713f7fbf5e,0x3d333ed8bf4b3f7c,0x3f6dbf7f3f58bf00,0xbf003f5ebf803f5e,0x3f80bf5e3f008000,0xbf633f7fbf4b3eaf,0x3f6dbf133d333f00,0xbf7f3f44be85beaf,0x3f35be32bed83f5e,0xbf4b3e853ec4bf5e,0x3ec43e85bf4b3f80
.quad 0xbeafbeaf3f5ebf7c,0xa50d3f25bf7c3f5e,0x3e5ebf523f7ebf25,0xbec43f68bf743f00,0x3f35bf803f358000,0xbf353f80bf35a50d,0x3f7abf523e063f25,0xbf6d3f68be9abf00,0x3f71beafbf003f7c,0xbf803f253e32bf5e,0x3f1c3e85bf6d3f5e,0xbf6d3e853f1cbf80,0x3db23f44bf773eaf,0xbf35be323f68bf5e,0xbeec3f7fbf1cbeaf,0xbec4bf133f80bf00
.quad 0x3f7cbf5e3f25beaf,0x3eafbf253f5ebf7c,0x3f80bf773f58bf25,0x3e9abf133f4bbf71,0x3f77bf803f77bf5e,0x3e85bf003f35bf5e,0x3f63bf773f80bf7c,0x3e5ebed83f1cbf44,0x3f44bf5e3f71bf7c,0x3e32beaf3f00bf25,0x3f1cbf353f4bbf5e,0x3e06be853ec4bf00,0x3ed8bf003f13bf25,0x3db2be323e85beaf,0x3e5ebe853e9abeaf,0x3d33bdb23e06be32
.quad 0xa50d8000a50d8000,0xa50d8000a50d8000,0xbe5e3e85be9a3eaf,0xbd333db2be063e32,0xbed83f00bf133f25,0xbdb23e32be853eaf,0xbf1c3f35bf4b3f5e,0xbe063e85bec43f00,0xbf443f5ebf713f7c,0xbe323eafbf003f25,0xbf633f77bf803f7c,0xbe5e3ed8bf1c3f44,0xbf773f80bf773f5e,0xbe853f00bf353f5e,0xbf803f77bf583f25,0xbe9a3f13bf4b3f71
.quad 0xbf7c3f5ebf253eaf,0xbeaf3f25bf5e3f7c,0xbf6d3f35bec4a50d,0xbec43f35bf6d3f80,0xbf523f00bdb2beaf,0xbed83f44bf773f7c,0xbf2d3e853e5ebf25,0xbeec3f52bf7e3f71,0xbf00a50d3f00bf5e,0xbf003f5ebf803f5e,0xbe9abe853f3dbf7c,0xbf0a3f68bf7e3f44,0xbdb2bf003f68bf7c,0xbf133f71bf773f25,0x3e06bf353f7ebf5e,0xbf1c3f77bf6d3f00
.quad 0x3eafbf5e3f7cbf25,0xbf253f7cbf5e3eaf,0x3f0abf773f63beaf,0xbf2d3f7fbf4b3e32,0x3f35bf803f358000,0xbf353f80bf35a50d,0x3f58bf773eec3eaf,0xbf3d3f7fbf1cbe32,0x3f71bf5e3e323f25,0xbf443f7cbf00beaf,0x3f7ebf35be063f5e,0xbf4b3f77bec4bf00,0x3f7fbf00bed83f7c,0xbf523f71be85bf25,0x3f74be85bf2d3f7c,0xbf583f68be06bf44
.size tab_a1, 55296
.p2align 8
.type tab_a2,@object
tab_a2:
.quad 0x3f803f803f803f80,0x3f803f803f803f80,0x3f553f6d3f7b3f80,0xbf0ebec4be48248d,0x3ec43f353f6d3f80,0xbec4bf35bf6dbf80,0xbe483ec43f553f80,0x3f7b3f6d3f0ea554,0xbf35248d3f353f80,0xbf3525b03f353f80,0xbf7bbec43f0e3f80,0xbe48bf6dbf5525b0,0xbf6dbf353ec43f80,0x3f6d3f35bec4bf80,0xbf0ebf6d3e483f80,0xbf553ec43f7ba5f7
.quad 0xa554bf80248d3f80,0xa731bf80261f3f80,0x3f0ebf6dbe483f80,0x3f553ec4bf7b261f,0x3f6dbf35bec43f80,0xbf6d3f353ec4bf80,0x3f7bbec4bf0e3f80,0x3e48bf6d3f55a731,0x3f35a554bf353f80,0x3f35a742bf353f80,0x3e483ec4bf553f80,0xbf7b3f6dbf0ea68d,0xbec43f35bf6d3f80,0x3ec4bf353f6dbf80,0xbf553f6dbf7b3f80,0x3f0ebec43e48a742
.quad 0xbf803f80bf803f80,0xbf803f80bf803f80,0xbf553f6dbf7b3f80,0x3f0ebec43e48a654,0xbec43f35bf6d3f80,0x3ec4bf353f6dbf80,0x3e483ec4bf553f80,0xbf7b3f6dbf0ea754,0x3f3525b0bf353f80,0x3f35a58ebf353f80,0x3f7bbec4bf0e3f80,0x3e48bf6d3f55a60d,0x3f6dbf35bec43f80,0xbf6d3f353ec4bf80,0x3f0ebf6dbe483f80,0x3f553ec4bf7ba765
.quad 0x261fbf80a5543f80,0x258dbf80a7773f80,0xbf0ebf6d3e483f80,0xbf553ec43f7ba58e,0xbf6dbf353ec43f80,0x3f6d3f35bec4bf80,0xbf7bbec43f0e3f80,0xbe48bf6dbf55a777,0xbf35a5f73f353f80,0xbf35a78d3f353f80,0xbe483ec43f553f80,0x3f7b3f6d3f0ea137,0x3ec43f353f6d3f80,0xbec4bf35bf6dbf80,0x3f553f6d3f7b3f80,0xbf0ebec4be48a784
.quad 0x3f803f803f803f80,0x3f803f803f803f80,0x3e483ec43f0e3f35,0xbf7bbf6dbf55bf35,0xbf6dbf35bec4248d,0x3f6d3f353ec4a554,0xbf0ebf6dbf7bbf35,0xbf55bec43e483f35,0x3f35a554bf35bf80,0x3f35a5f7bf35bf80,0x3f553f6d3e48bf35,0xbf0e3ec43f7b3f35,0xbec43f353f6da554,0x3ec4bf35bf6d261f,0xbf7bbec43f553f35,0xbe483f6d3f0ebf35
.quad 0xa5f7bf8025b03f80,0xa742bf80a68d3f80,0x3f7bbec4bf553f35,0x3e483f6dbf0ebf35,0x3ec43f35bf6d25b0,0xbec4bf353f6da742,0xbf553f6dbe48bf35,0x3f0e3ec4bf7b3f35,0xbf35261f3f35bf80,0xbf35a60d3f35bf80,0x3f0ebf6d3f7bbf35,0x3f55bec4be483f35,0x3f6dbf353ec4a5f7,0xbf6d3f35bec4a60d,0xbe483ec4bf0e3f35,0x3f7bbf6d3f55bf35
.quad 0xbf803f80bf803f80,0xbf803f80bf803f80,0xbe483ec4bf0e3f35,0x3f7bbf6d3f55bf35,0x3f6dbf353ec4261f,0xbf6d3f35bec4a777,0x3f0ebf6d3f7bbf35,0x3f55bec4be483f35,0xbf35a7423f35bf80,0xbf35a78d3f35bf80,0xbf553f6dbe48bf35,0x3f0e3ec4bf7b3f35,0x3ec43f35bf6da731,0xbec4bf353f6d2804,0x3f7bbec4bf553f35,0x3e483f6dbf0ebf35
.quad 0xa60dbf80a7423f80,0x268dbf80a7963f80,0xbf7bbec43f553f35,0xbe483f6d3f0ebf35,0xbec43f353f6da68d,0x3ec4bf35bf6d2754,0x3f553f6d3e48bf35,0xbf0e3ec43f7b3f35,0x3f35a60dbf35bf80,0x3f352816bf35bf80,0xbf0ebf6dbf7bbf35,0xbf55bec43e483f35,0xbf6dbf35bec4a742,0x3f6d3f353ec42889,0x3e483ec43f0e3f35,0xbf7bbf6dbf55bf35
.quad 0x3f803f803f803f80,0x3f803f803f803f80,0xbf55bf6dbf7bbf80,0x3f0e3ec43e48a554,0x3ec43f353f6d3f80,0xbec4bf35bf6dbf80,0x3e48bec4bf55bf80,0xbf7bbf6dbf0e261f,0xbf35261f3f353f80,0xbf35a68d3f353f80,0x3f7b3ec4bf0ebf80,0x3e483f6d3f55a742,0xbf6dbf353ec43f80,0x3f6d3f35bec4bf80,0x3f0e3f6dbe48bf80,0x3f55bec4bf7ba60d
.quad 0xa754bf80a6543f80,0xa777bf80a58e3f80,0xbf0e3f6d3e48bf80,0xbf55bec43f7ba777,0x3f6dbf35bec43f80,0xbf6d3f353ec4bf80,0xbf7b3ec43f0ebf80,0xbe483f6dbf552804,0x3f35a777bf353f80,0x3f35a796bf353f80,0xbe48bec43f55bf80,0x3f7bbf6d3f0e2754,0xbec43f35bf6d3f80,0x3ec4bf353f6dbf80,0x3f55bf6d3f7bbf80,0xbf0e3ec4be482889
.quad 0xbf803f80bf803f80,0xbf803f80bf803f80,0x3f55bf6d3f7bbf80,0xbf0e3ec4be482828,0xbec43f35bf6d3f80,0x3ec4bf353f6dbf80,0xbe48bec43f55bf80,0x3f7bbf6d3f0e281f,0x3f35268dbf353f80,0x3f352828bf353f80,0xbf7b3ec43f0ebf80,0xbe483f6dbf5526d4,0x3f6dbf35bec43f80,0xbf6d3f353ec4bf80,0xbf0e3f6d3e48bf80,0xbf55bec43f7b2730
.quad 0x281fbf80a7b13f80,0x2839bf80a7e53f80,0x3f0e3f6dbe48bf80,0x3f55bec4bf7ba7e5,0xbf6dbf353ec43f80,0x3f6d3f35bec4bf80,0x3f7b3ec4bf0ebf80,0x3e483f6d3f552839,0xbf3526d43f353f80,0xbf35a8043f353f80,0x3e48bec4bf55bf80,0xbf7bbf6dbf0ea880,0x3ec43f353f6d3f80,0xbec4bf35bf6dbf80,0xbf55bf6dbf7bbf80,0x3f0e3ec43e4828a3
.quad 0x3f803f803f803f80,0x3f803f803f803f80,0xbe48bec4bf0ebf35,0x3f7b3f6d3f553f35,0xbf6dbf35bec425b0,0x3f6d3f353ec4a5f7,0x3f0e3f6d3f7b3f35,0x3f553ec4be48bf35,0x3f35a731bf35bf80,0x3f35a742bf35bf80,0xbf55bf6dbe483f35,0x3f0ebec4bf7bbf35,0xbec43f353f6da742,0x3ec4bf35bf6da60d,0x3f7b3ec4bf55bf35,0x3e48bf6dbf0e3f35
.quad 0xa765bf80a60d3f80,0xa784bf80a1373f80,0xbf7b3ec43f55bf35,0xbe48bf6d3f0e3f35,0x3ec43f35bf6da58e,0xbec4bf353f6da78d,0x3f55bf6d3e483f35,0xbf0ebec43f7bbf35,0xbf35258d3f35bf80,0xbf35268d3f35bf80,0xbf0e3f6dbf7b3f35,0xbf553ec43e48bf35,0x3f6dbf353ec4a78d,0xbf6d3f35bec42816,0x3e48bec43f0ebf35,0xbf7b3f6dbf553f35
.quad 0xbf803f80bf803f80,0xbf803f80bf803f80,0x3e48bec43f0ebf35,0xbf7b3f6dbf553f35,0x3f6dbf353ec4268d,0xbf6d3f35bec426d4,0xbf0e3f6dbf7b3f35,0xbf553ec43e48bf35,0xbf35270d3f35bf80,0xbf35a7e53f35bf80,0x3f55bf6d3e483f35,0xbf0ebec43f7bbf35,0x3ec43f35bf6da85d,0xbec4bf353f6d289a,0xbf7b3ec43f55bf35,0xbe48bf6d3f0e3f35
.quad 0x2730bf8026d43f80,0x28a3bf80a8803f80,0x3f7b3ec4bf55bf35,0x3e48bf6dbf0e3f35,0xbec43f353f6da7b1,0x3ec4bf35bf6d28be,0xbf55bf6dbe483f35,0x3f0ebec4bf7bbf35,0x3f352754bf35bf80,0x3f35a731bf35bf80,0x3f0e3f6d3f7b3f35,0x3f553ec4be48bf35,0xbf6dbf35bec4a7e5,0x3f6d3f353ec428ea,0xbe48bec4bf0ebf35,0x3f7b3f6d3f553f35
.quad 0x0,0x0,0x3f0e3ec43e480000,0x3f553f6d3f7b3f80,0x3f6d3f353ec40000,0xbf6dbf35bec4250d,0x3f7b3f6d3f0e0000,0x3e48bec4bf55bf80,0x3f353f803f350000,0x3f353f803f35a58d,0x3e483f6d3f550000,0xbf7bbec43f0e3f80,0xbec43f353f6d0000,0x3ec4bf35bf6d25d4,0xbf553ec43f7b0000,0x3f0e3f6dbe48bf80
.quad 0xbf80250d3f800000,0xbf8026303f80a60d,0xbf55bec43f7b0000,0x3f0ebf6dbe483f80,0xbec4bf353f6d0000,0x3ec43f35bf6d2630,0x3e48bf6d3f550000,0xbf7b3ec43f0ebf80,0x3f35bf803f350000,0x3f35bf803f35a654,0x3f7bbf6d3f0e0000,0x3e483ec4bf553f80,0x3f6dbf353ec40000,0xbf6d3f35bec42677,0x3f0ebec43e480000,0x3f55bf6d3f7bbf80
.quad 0x25d4a58d250d0000,0x27b1a6b0269fa68d,0xbf0e3ec4be480000,0xbf553f6dbf7b3f80,0xbf6d3f35bec40000,0x3f6dbf353ec4269f,0xbf7b3f6dbf0e0000,0xbe48bec43f55bf80,0xbf353f80bf350000,0xbf353f80bf35a6b0,0xbe483f6dbf550000,0x3f7bbec4bf0e3f80,0x3ec43f35bf6d0000,0xbec4bf353f6d27b1,0x3f553ec4bf7b0000,0xbf0e3f6d3e48bf80
.quad 0x3f8025d4bf800000,0x3f8027c2bf80a6d4,0x3f55bec4bf7b0000,0xbf0ebf6d3e483f80,0x3ec4bf35bf6d0000,0xbec43f353f6da70d,0xbe48bf6dbf550000,0x3f7b3ec4bf0ebf80,0xbf35bf80bf350000,0xbf35bf80bf35a6f7,0xbf7bbf6dbf0e0000,0xbe483ec43f553f80,0xbf6dbf35bec40000,0x3f6d3f353ec427c2,0xbf0ebec4be480000,0xbf55bf6dbf7bbf80
.quad 0x0,0x0,0x3f7b3f6d3f553f35,0x3e483ec43f0e3f35,0x3ec43f353f6d3f80,0xbec4bf35bf6dbf80,0xbf55bec43e483f35,0x3f0e3f6d3f7b3f35,0xbf35bf80bf35250d,0xbf35bf80bf3525d4,0x3f0ebec4bf7bbf35,0x3f553f6d3e48bf35,0x3f6d3f35bec4bf80,0xbf6dbf353ec43f80,0xbe483f6d3f0ebf35,0x3f7b3ec4bf55bf35
.quad 0xbf8025d43f80a58d,0xbf8026773f80a654,0xbe48bf6d3f0e3f35,0x3f7bbec4bf553f35,0x3f6dbf35bec43f80,0xbf6d3f353ec4bf80,0x3f0e3ec4bf7b3f35,0x3f55bf6d3e483f35,0xbf353f80bf3525d4,0xbf353f80bf35269f,0xbf553ec43e48bf35,0x3f0ebf6d3f7bbf35,0x3ec4bf353f6dbf80,0xbec43f35bf6d3f80,0x3f7bbf6d3f55bf35,0x3e48bec43f0ebf35
.quad 0x2677a6542630a60d,0x27c2a6f7a70da6d4,0xbf7b3f6dbf553f35,0xbe483ec4bf0e3f35,0xbec43f35bf6d3f80,0x3ec4bf353f6dbf80,0x3f55bec4be483f35,0xbf0e3f6dbf7b3f35,0x3f35bf803f352630,0x3f35bf803f3527c2,0xbf0ebec43f7bbf35,0xbf553f6dbe48bf35,0xbf6d3f353ec4bf80,0x3f6dbf35bec43f80,0x3e483f6dbf0ebf35,0xbf7b3ec43f55bf35
.quad 0x3f80269fbf80a654,0x3f80a68dbf80a71f,0x3e48bf6dbf0e3f35,0xbf7bbec43f553f35,0xbf6dbf353ec43f80,0x3f6d3f35bec4bf80,0xbf0e3ec43f7b3f35,0xbf55bf6dbe483f35,0x3f353f803f352677,0x3f353f803f35a68d,0x3f553ec4be48bf35,0xbf0ebf6dbf7bbf35,0xbec4bf35bf6dbf80,0x3ec43f353f6d3f80,0xbf7bbf6dbf55bf35,0xbe48bec4bf0ebf35
.quad 0x0,0x0,0xbf0ebec4be48250d,0xbf55bf6dbf7bbf80,0x3f6d3f353ec4a58d,0xbf6dbf35bec425d4,0xbf7bbf6dbf0e25d4,0xbe483ec43f553f80,0x3f353f803f35a60d,0x3f353f803f35a654,0xbe48bf6dbf552630,0x3f7b3ec4bf0ebf80,0xbec43f353f6da654,0x3ec4bf35bf6d269f,0x3f55bec4bf7b2677,0xbf0ebf6d3e483f80
.quad 0xbf80269f3f80a68d,0xbf80a70d3f80a6d4,0x3f553ec4bf7b269f,0xbf0e3f6d3e48bf80,0xbec4bf353f6da6b0,0x3ec43f35bf6d27c2,0xbe483f6dbf5527b1,0x3f7bbec4bf0e3f80,0x3f35bf803f35a6d4,0x3f35bf803f35a71f,0xbf7b3f6dbf0ea70d,0xbe48bec43f55bf80,0x3f6dbf353ec4a6f7,0xbf6d3f35bec4a68d,0xbf0e3ec4be4827c2,0xbf553f6dbf7b3f80
.quad 0x27d4a71fa6d4a70d,0x27f7278da60ea754,0x3f0ebec43e48a6d4,0x3f55bf6d3f7bbf80,0xbf6d3f35bec4a71f,0x3f6dbf353ec427f7,0x3f7bbf6d3f0e27d4,0x3e483ec4bf553f80,0xbf353f80bf35a730,0xbf353f80bf35a842,0x3e48bf6d3f55a68d,0xbf7b3ec43f0ebf80,0x3ec43f35bf6da831,0xbec4bf353f6d2884,0xbf55bec43f7b27e5,0x3f0ebf6dbe483f80
.quad 0x3f8027f7bf80a754,0x3f802816bf80a79f,0xbf553ec43f7ba60e,0x3f0e3f6dbe48bf80,0x3ec4bf35bf6d278d,0xbec43f353f6da7d4,0x3e483f6d3f5527f7,0xbf7bbec43f0e3f80,0xbf35bf80bf35a777,0xbf35bf80bf35270d,0x3f7b3f6d3f0ea1b7,0x3e48bec4bf55bf80,0xbf6dbf35bec4a842,0x3f6d3f353ec42909,0x3f0e3ec43e482804,0x3f553f6d3f7b3f80
.quad 0x0,0x0,0xbf7bbf6dbf55bf35,0xbe48bec4bf0ebf35,0x3ec43f353f6d3f80,0xbec4bf35bf6dbf80,0x3f553ec4be48bf35,0xbf0ebf6dbf7bbf35,0xbf35bf80bf352630,0xbf35bf80bf352677,0xbf0e3ec43f7b3f35,0xbf55bf6dbe483f35,0x3f6d3f35bec4bf80,0xbf6dbf353ec43f80,0x3e48bf6dbf0e3f35,0xbf7bbec43f553f35
.quad 0xbf8027b13f80a6b0,0xbf8027c23f80a6f7,0x3e483f6dbf0ebf35,0xbf7b3ec43f55bf35,0x3f6dbf35bec43f80,0xbf6d3f353ec4bf80,0xbf0ebec43f7bbf35,0xbf553f6dbe48bf35,0xbf353f80bf3527c2,0xbf353f80bf35a68d,0x3f55bec4be483f35,0xbf0e3f6dbf7b3f35,0x3ec4bf353f6dbf80,0xbec43f35bf6d3f80,0xbf7b3f6dbf553f35,0xbe483ec4bf0e3f35
.quad 0x27e5a831a68da730,0x2804a842a1b7a777,0x3f7bbf6d3f55bf35,0x3e48bec43f0ebf35,0xbec43f35bf6d3f80,0x3ec4bf353f6dbf80,0xbf553ec43e48bf35,0x3f0ebf6d3f7bbf35,0x3f35bf803f35a60e,0x3f35bf803f35280d,0x3f0e3ec4bf7b3f35,0x3f55bf6d3e483f35,0xbf6d3f353ec4bf80,0x3f6dbf35bec43f80,0xbe48bf6d3f0e3f35,0x3f7bbec4bf553f35
.quad 0x3f80260dbf80a842,0x3f80270dbf80270d,0xbe483f6d3f0ebf35,0x3f7b3ec4bf55bf35,0xbf6dbf353ec43f80,0x3f6d3f35bec4bf80,0x3f0ebec4bf7bbf35,0x3f553f6d3e48bf35,0x3f353f803f35280d,0x3f353f803f352896,0xbf55bec43e483f35,0x3f0e3f6d3f7b3f35,0xbec4bf35bf6dbf80,0x3ec43f353f6d3f80,0x3f7b3f6d3f553f35,0x3e483ec43f0e3f35
.quad 0x8000800080008000,0x8000800080008000,0xbf0ebec4be488000,0xbf55bf6dbf7bbf80,0xbf6dbf35bec48000,0x3f6d3f353ec4a50d,0xbf7bbf6dbf0e8000,0xbe483ec43f553f80,0xbf35bf80bf358000,0xbf35bf80bf35258d,0xbe48bf6dbf558000,0x3f7b3ec4bf0ebf80,0x3ec4bf35bf6d8000,0xbec43f353f6da5d4,0x3f55bec4bf7b8000,0xbf0ebf6d3e483f80
.quad 0x3f80a50dbf808000,0x3f80a630bf80260d,0x3f553ec4bf7b8000,0xbf0e3f6d3e48bf80,0x3ec43f35bf6d8000,0xbec4bf353f6da630,0xbe483f6dbf558000,0x3f7bbec4bf0e3f80,0xbf353f80bf358000,0xbf353f80bf352654,0xbf7b3f6dbf0e8000,0xbe48bec43f55bf80,0xbf6d3f35bec48000,0x3f6dbf353ec4a677,0xbf0e3ec4be488000,0xbf553f6dbf7b3f80
.quad 0xa5d4258da50d8000,0xa7b126b0a69f268d,0x3f0ebec43e488000,0x3f55bf6d3f7bbf80,0x3f6dbf353ec48000,0xbf6d3f35bec4a69f,0x3f7bbf6d3f0e8000,0x3e483ec4bf553f80,0x3f35bf803f358000,0x3f35bf803f3526b0,0x3e48bf6d3f558000,0xbf7b3ec43f0ebf80,0xbec4bf353f6d8000,0x3ec43f35bf6da7b1,0xbf55bec43f7b8000,0x3f0ebf6dbe483f80
.quad 0xbf80a5d43f808000,0xbf80a7c23f8026d4,0xbf553ec43f7b8000,0x3f0e3f6dbe48bf80,0xbec43f353f6d8000,0x3ec4bf35bf6d270d,0x3e483f6d3f558000,0xbf7bbec43f0e3f80,0x3f353f803f358000,0x3f353f803f3526f7,0x3f7b3f6d3f0e8000,0x3e48bec4bf55bf80,0x3f6d3f353ec48000,0xbf6dbf35bec4a7c2,0x3f0e3ec43e488000,0x3f553f6d3f7b3f80
.quad 0x8000800080008000,0x8000800080008000,0xbf7bbf6dbf55bf35,0xbe48bec4bf0ebf35,0xbec4bf35bf6dbf80,0x3ec43f353f6d3f80,0x3f553ec4be48bf35,0xbf0ebf6dbf7bbf35,0x3f353f803f35a50d,0x3f353f803f35a5d4,0xbf0e3ec43f7b3f35,0xbf55bf6dbe483f35,0xbf6dbf353ec43f80,0x3f6d3f35bec4bf80,0x3e48bf6dbf0e3f35,0xbf7bbec43f553f35
.quad 0x3f80a5d4bf80258d,0x3f80a677bf802654,0x3e483f6dbf0ebf35,0xbf7b3ec43f55bf35,0xbf6d3f353ec4bf80,0x3f6dbf35bec43f80,0xbf0ebec43f7bbf35,0xbf553f6dbe48bf35,0x3f35bf803f35a5d4,0x3f35bf803f35a69f,0x3f55bec4be483f35,0xbf0e3f6dbf7b3f35,0xbec43f35bf6d3f80,0x3ec4bf353f6dbf80,0xbf7b3f6dbf553f35,0xbe483ec4bf0e3f35
.quad 0xa6772654a630260d,0xa7c226f7270d26d4,0x3f7bbf6d3f55bf35,0x3e48bec43f0ebf35,0x3ec4bf353f6dbf80,0xbec43f35bf6d3f80,0xbf553ec43e48bf35,0x3f0ebf6d3f7bbf35,0xbf353f80bf35a630,0xbf353f80bf35a7c2,0x3f0e3ec4bf7b3f35,0x3f55bf6d3e483f35,0x3f6dbf35bec43f80,0xbf6d3f353ec4bf80,0xbe48bf6d3f0e3f35,0x3f7bbec4bf553f35
.quad 0xbf80a69f3f802654,0xbf80268d3f80271f,0xbe483f6d3f0ebf35,0x3f7b3ec4bf55bf35,0x3f6d3f35bec4bf80,0xbf6dbf353ec43f80,0x3f0ebec4bf7bbf35,0x3f553f6d3e48bf35,0xbf35bf80bf35a677,0xbf35bf80bf35268d,0xbf55bec43e483f35,0x3f0e3f6d3f7b3f35,0x3ec43f353f6d3f80,0xbec4bf35bf6dbf80,0x3f7b3f6d3f553f35,0x3e483ec43f0e3f35
.quad 0x8000800080008000,0x8000800080008000,0x3f0e3ec43e48a50d,0x3f553f6d3f7b3f80,0xbf6dbf35bec4258d,0x3f6d3f353ec4a5d4,0x3f7b3f6d3f0ea5d4,0x3e48bec4bf55bf80,0xbf35bf80bf35260d,0xbf35bf80bf352654,0x3e483f6d3f55a630,0xbf7bbec43f0e3f80,0x3ec4bf35bf6d2654,0xbec43f353f6da69f,0xbf553ec43f7ba677,0x3f0e3f6dbe48bf80
.quad 0x3f80a69fbf80268d,0x3f80270dbf8026d4,0xbf55bec43f7ba69f,0x3f0ebf6dbe483f80,0x3ec43f35bf6d26b0,0xbec4bf353f6da7c2,0x3e48bf6d3f55a7b1,0xbf7b3ec43f0ebf80,0xbf353f80bf3526d4,0xbf353f80bf35271f,0x3f7bbf6d3f0e270d,0x3e483ec4bf553f80,0xbf6d3f35bec426f7,0x3f6dbf353ec4268d,0x3f0ebec43e48a7c2,0x3f55bf6d3f7bbf80
.quad 0xa7d4271f26d4270d,0xa7f7a78d260e2754,0xbf0e3ec4be4826d4,0xbf553f6dbf7b3f80,0x3f6dbf353ec4271f,0xbf6d3f35bec4a7f7,0xbf7b3f6dbf0ea7d4,0xbe48bec43f55bf80,0x3f35bf803f352730,0x3f35bf803f352842,0xbe483f6dbf55268d,0x3f7bbec4bf0e3f80,0xbec4bf353f6d2831,0x3ec43f35bf6da884,0x3f553ec4bf7ba7e5,0xbf0e3f6d3e48bf80
.quad 0xbf80a7f73f802754,0xbf80a8163f80279f,0x3f55bec4bf7b260e,0xbf0ebf6d3e483f80,0xbec43f353f6da78d,0x3ec4bf35bf6d27d4,0xbe48bf6dbf55a7f7,0x3f7b3ec4bf0ebf80,0x3f353f803f352777,0x3f353f803f35a70d,0xbf7bbf6dbf0e21b7,0xbe483ec43f553f80,0x3f6d3f353ec42842,0xbf6dbf35bec4a909,0xbf0ebec4be48a804,0xbf55bf6dbf7bbf80
.quad 0x8000800080008000,0x8000800080008000,0x3f7b3f6d3f553f35,0x3e483ec43f0e3f35,0xbec4bf35bf6dbf80,0x3ec43f353f6d3f80,0xbf55bec43e483f35,0x3f0e3f6d3f7b3f35,0x3f353f803f35a630,0x3f353f803f35a677,0x3f0ebec4bf7bbf35,0x3f553f6d3e48bf35,0xbf6dbf353ec43f80,0x3f6d3f35bec4bf80,0xbe483f6d3f0ebf35,0x3f7b3ec4bf55bf35
.quad 0x3f80a7b1bf8026b0,0x3f80a7c2bf8026f7,0xbe48bf6d3f0e3f35,0x3f7bbec4bf553f35,0xbf6d3f353ec4bf80,0x3f6dbf35bec43f80,0x3f0e3ec4bf7b3f35,0x3f55bf6d3e483f35,0x3f35bf803f35a7c2,0x3f35bf803f35268d,0xbf553ec43e48bf35,0x3f0ebf6d3f7bbf35,0xbec43f35bf6d3f80,0x3ec4bf353f6dbf80,0x3f7bbf6d3f55bf35,0x3e48bec43f0ebf35
.quad 0xa7e52831268d2730,0xa804284221b72777,0xbf7b3f6dbf553f35,0xbe483ec4bf0e3f35,0x3ec4bf353f6dbf80,0xbec43f35bf6d3f80,0x3f55bec4be483f35,0xbf0e3f6dbf7b3f35,0xbf353f80bf35260e,0xbf353f80bf35a80d,0xbf0ebec43f7bbf35,0xbf553f6dbe48bf35,0x3f6dbf35bec43f80,0xbf6d3f353ec4bf80,0x3e483f6dbf0ebf35,0xbf7b3ec43f55bf35
.quad 0xbf80a60d3f802842,0xbf80a70d3f80a70d,0x3e48bf6dbf0e3f35,0xbf7bbec43f553f35,0x3f6d3f35bec4bf80,0xbf6dbf353ec43f80,0xbf0e3ec43f7b3f35,0xbf55bf6dbe483f35,0xbf35bf80bf35a80d,0xbf35bf80bf35a896,0x3f553ec4be48bf35,0xbf0ebf6dbf7bbf35,0x3ec43f353f6d3f80,0xbec4bf35bf6dbf80,0xbf7bbf6dbf55bf35,0xbe48bec4bf0ebf35
.quad 0x3f803f803f803f80,0x3f803f803f803f80,0x3f463f623f753f7f,0xbf22bef1be95bdc9,0x3e483f0e3f553f7b,0xbe48bf0ebf55bf7b,0xbef13dc93f223f75,0x3f623f7f3f463e95,0xbf6dbec43ec43f6d,0xbf6dbec43ec43f6d,0xbf75bf463dc93f62,0x3e95bf22bf7fbef1,0xbf0ebf7bbe483f55,0x3f0e3f7b3e48bf55,0x3dc9bf75bef13f46,0xbf7fbe953f623f22
.quad 0x3f35bf35bf353f35,0x3f35bf35bf353f35,0x3f7fbe95bf623f22,0x3dc93f75bef1bf46,0x3f553e48bf7b3f0e,0xbf55be483f7bbf0e,0x3e953f22bf7f3ef1,0x3f75bf46bdc93f62,0xbec43f6dbf6d3ec4,0xbec43f6dbf6d3ec4,0xbf623f7fbf463e95,0xbef1bdc93f22bf75,0xbf7b3f55bf0e3e48,0x3f7bbf553f0ebe48,0xbf223ef1be953dc9,0xbf463f62bf753f7f
.quad 0xa5f725b0a554248d,0xa765a60da754a654,0x3f22bef13e95bdc9,0x3f46bf623f75bf7f,0x3f7bbf553f0ebe48,0xbf7b3f55bf0e3e48,0x3f62bf7f3f46be95,0x3ef13dc9bf223f75,0x3ec4bf6d3f6dbec4,0x3ec4bf6d3f6dbec4,0xbe95bf223f7fbef1,0xbf753f463dc9bf62,0xbf55be483f7bbf0e,0x3f553e48bf7b3f0e,0xbf7f3e953f62bf22,0xbdc9bf753ef13f46
.quad 0xbf353f353f35bf35,0xbf353f353f35bf35,0xbdc93f753ef1bf46,0x3f7f3e95bf62bf22,0x3f0e3f7b3e48bf55,0xbf0ebf7bbe483f55,0x3f753f46bdc9bf62,0xbe953f223f7f3ef1,0x3f6d3ec4bec4bf6d,0x3f6d3ec4bec4bf6d,0x3ef1bdc9bf22bf75,0xbf62bf7fbf46be95,0xbe48bf0ebf55bf7b,0x3e483f0e3f553f7b,0xbf46bf62bf75bf7f,0x3f223ef13e953dc9
.quad 0x3f803f803f803f80,0x3f803f803f803f80,0x3dc93e953ef13f22,0xbf7fbf75bf62bf46,0xbf7bbf55bf0ebe48,0x3f7b3f553f0e3e48,0xbe95bf46bf7fbf62,0xbf75bf22bdc93ef1,0x3f6d3ec4bec4bf6d,0x3f6d3ec4bec4bf6d,0x3ef13f7f3f22be95,0xbf62bdc93f463f75,0xbf553e483f7b3f0e,0x3f55be48bf7bbf0e,0xbf22bf623e953f7f,0xbf463ef13f75bdc9
.quad 0x3f35bf35bf353f35,0x3f35bf35bf353f35,0x3f463ef1bf75bdc9,0xbf223f623e95bf7f,0xbf0e3f7bbe48bf55,0x3f0ebf7b3e483f55,0xbf623dc93f46bf75,0xbef13f7fbf22be95,0x3ec4bf6d3f6dbec4,0x3ec4bf6d3f6dbec4,0x3f75bf223dc93ef1,0xbe953f46bf7f3f62,0xbe483f0ebf553f7b,0x3e48bf0e3f55bf7b,0xbf7f3f75bf623f46,0xbdc93e95bef13f22
.quad 0xa742a68da731261f,0xa784a137a777a58e,0x3f7fbf753f62bf46,0x3dc9be953ef1bf22,0x3e48bf0e3f55bf7b,0xbe483f0ebf553f7b,0xbf753f22bdc9bef1,0x3e95bf463f7fbf62,0xbec43f6dbf6d3ec4,0xbec43f6dbf6d3ec4,0x3f62bdc9bf463f75,0x3ef1bf7f3f223e95,0x3f0ebf7b3e483f55,0xbf0e3f7bbe48bf55,0xbf46bef13f753dc9,0x3f22bf62be953f7f
.quad 0xbf353f353f35bf35,0xbf353f353f35bf35,0x3f223f62be95bf7f,0x3f46bef1bf753dc9,0x3f55be48bf7bbf0e,0xbf553e483f7b3f0e,0xbef1bf7fbf223e95,0x3f623dc9bf46bf75,0xbf6dbec43ec43f6d,0xbf6dbec43ec43f6d,0x3e953f463f7f3f62,0x3f753f223dc9bef1,0x3f7b3f553f0e3e48,0xbf7bbf55bf0ebe48,0xbdc9be95bef1bf22,0x3f7f3f753f623f46
.quad 0x3f803f803f803f80,0x3f803f803f803f80,0xbf46bf62bf75bf7f,0x3f223ef13e953dc9,0x3e483f0e3f553f7b,0xbe48bf0ebf55bf7b,0x3ef1bdc9bf22bf75,0xbf62bf7fbf46be95,0xbf6dbec43ec43f6d,0xbf6dbec43ec43f6d,0x3f753f46bdc9bf62,0xbe953f223f7f3ef1,0xbf0ebf7bbe483f55,0x3f0e3f7b3e48bf55,0xbdc93f753ef1bf46,0x3f7f3e95bf62bf22
.quad 0x3f35bf35bf353f35,0x3f35bf35bf353f35,0xbf7f3e953f62bf22,0xbdc9bf753ef13f46,0x3f553e48bf7b3f0e,0xbf55be483f7bbf0e,0xbe95bf223f7fbef1,0xbf753f463dc9bf62,0xbec43f6dbf6d3ec4,0xbec43f6dbf6d3ec4,0x3f62bf7f3f46be95,0x3ef13dc9bf223f75,0xbf7b3f55bf0e3e48,0x3f7bbf553f0ebe48,0x3f22bef13e95bdc9,0x3f46bf623f75bf7f
.quad 0xa796260da78d258d,0x270d26d4a7b12816,0xbf223ef1be953dc9,0xbf463f62bf753f7f,0x3f7bbf553f0ebe48,0xbf7b3f55bf0e3e48,0xbf623f7fbf463e95,0xbef1bdc93f22bf75,0x3ec4bf6d3f6dbec4,0x3ec4bf6d3f6dbec4,0x3e953f22bf7f3ef1,0x3f75bf46bdc93f62,0xbf55be483f7bbf0e,0x3f553e48bf7b3f0e,0x3f7fbe95bf623f22,0x3dc93f75bef1bf46
.quad 0xbf353f353f35bf35,0xbf353f353f35bf35,0x3dc9bf75bef13f46,0xbf7fbe953f623f22,0x3f0e3f7b3e48bf55,0xbf0ebf7bbe483f55,0xbf75bf463dc93f62,0x3e95bf22bf7fbef1,0x3f6d3ec4bec4bf6d,0x3f6d3ec4bec4bf6d,0xbef13dc93f223f75,0x3f623f7f3f463e95,0xbe48bf0ebf55bf7b,0x3e483f0e3f553f7b,0x3f463f623f753f7f,0xbf22bef1be95bdc9
.quad 0x3f803f803f803f80,0x3f803f803f803f80,0xbdc9be95bef1bf22,0x3f7f3f753f623f46,0xbf7bbf55bf0ebe48,0x3f7b3f553f0e3e48,0x3e953f463f7f3f62,0x3f753f223dc9bef1,0x3f6d3ec4bec4bf6d,0x3f6d3ec4bec4bf6d,0xbef1bf7fbf223e95,0x3f623dc9bf46bf75,0xbf553e483f7b3f0e,0x3f55be48bf7bbf0e,0x3f223f62be95bf7f,0x3f46bef1bf753dc9
.quad 0x3f35bf35bf353f35,0x3f35bf35bf353f35,0xbf46bef13f753dc9,0x3f22bf62be953f7f,0xbf0e3f7bbe48bf55,0x3f0ebf7b3e483f55,0x3f62bdc9bf463f75,0x3ef1bf7f3f223e95,0x3ec4bf6d3f6dbec4,0x3ec4bf6d3f6dbec4,0xbf753f22bdc9bef1,0x3e95bf463f7fbf62,0xbe483f0ebf553f7b,0x3e48bf0e3f55bf7b,0x3f7fbf753f62bf46,0x3dc9be953ef1bf22
.quad 0x2731268da79f280d,0x26d4270da7c2281f,0xbf7f3f75bf623f46,0xbdc93e95bef13f22,0x3e48bf0e3f55bf7b,0xbe483f0ebf553f7b,0x3f75bf223dc93ef1,0xbe953f46bf7f3f62,0xbec43f6dbf6d3ec4,0xbec43f6dbf6d3ec4,0xbf623dc93f46bf75,0xbef13f7fbf22be95,0x3f0ebf7b3e483f55,0xbf0e3f7bbe48bf55,0x3f463ef1bf75bdc9,0xbf223f623e95bf7f
.quad 0xbf353f353f35bf35,0xbf353f353f35bf35,0xbf22bf623e953f7f,0xbf463ef13f75bdc9,0x3f55be48bf7bbf0e,0xbf553e483f7b3f0e,0x3ef13f7f3f22be95,0xbf62bdc93f463f75,0xbf6dbec43ec43f6d,0xbf6dbec43ec43f6d,0xbe95bf46bf7fbf62,0xbf75bf22bdc93ef1,0x3f7b3f553f0e3e48,0xbf7bbf55bf0ebe48,0x3dc93e953ef13f22,0xbf7fbf75bf62bf46
.quad 0x0,0x0,0x3f223ef13e953dc9,0x3f463f623f753f7f,0x3f7b3f553f0e3e48,0xbf7bbf55bf0ebe48,0x3f623f7f3f463e95,0x3ef1bdc9bf22bf75,0x3ec43f6d3f6d3ec4,0x3ec43f6d3f6d3ec4,0xbe953f223f7f3ef1,0xbf75bf463dc93f62,0xbf553e483f7b3f0e,0x3f55be48bf7bbf0e,0xbf7fbe953f623f22,0xbdc93f753ef1bf46
.quad 0xbf35bf353f353f35,0xbf35bf353f353f35,0xbdc9bf753ef13f46,0x3f7fbe95bf623f22,0x3f0ebf7b3e483f55,0xbf0e3f7bbe48bf55,0x3f75bf46bdc93f62,0xbe95bf223f7fbef1,0x3f6dbec4bec43f6d,0x3f6dbec4bec43f6d,0x3ef13dc9bf223f75,0xbf623f7fbf463e95,0xbe483f0ebf553f7b,0x3e48bf0e3f55bf7b,0xbf463f62bf753f7f,0x3f22bef13e95bdc9
.quad 0xbf803f80bf803f80,0xbf803f80bf803f80,0xbf463f62bf753f7f,0x3f22bef13e95bdc9,0xbe483f0ebf553f7b,0x3e48bf0e3f55bf7b,0x3ef13dc9bf223f75,0xbf623f7fbf463e95,0x3f6dbec4bec43f6d,0x3f6dbec4bec43f6d,0x3f75bf46bdc93f62,0xbe95bf223f7fbef1,0x3f0ebf7b3e483f55,0xbf0e3f7bbe48bf55,0xbdc9bf753ef13f46,0x3f7fbe95bf623f22
.quad 0xbf35bf353f353f35,0xbf35bf353f353f35,0xbf7fbe953f623f22,0xbdc93f753ef1bf46,0xbf553e483f7b3f0e,0x3f55be48bf7bbf0e,0xbe953f223f7f3ef1,0xbf75bf463dc93f62,0x3ec43f6d3f6d3ec4,0x3ec43f6d3f6d3ec4,0x3f623f7f3f463e95,0x3ef1bdc9bf22bf75,0x3f7b3f553f0e3e48,0xbf7bbf55bf0ebe48,0x3f223ef13e953dc9,0x3f463f623f753f7f
.quad 0x0,0x0,0x3f7f3f753f623f46,0x3dc93e953ef13f22,0x3e483f0e3f553f7b,0xbe48bf0ebf55bf7b,0xbf75bf22bdc93ef1,0x3e953f463f7f3f62,0xbec4bf6dbf6dbec4,0xbec4bf6dbf6dbec4,0x3f623dc9bf46bf75,0x3ef13f7f3f22be95,0x3f0e3f7b3e48bf55,0xbf0ebf7bbe483f55,0xbf463ef13f75bdc9,0x3f223f62be95bf7f
.quad 0xbf35bf353f353f35,0xbf35bf353f353f35,0x3f22bf62be953f7f,0x3f463ef1bf75bdc9,0x3f553e48bf7b3f0e,0xbf55be483f7bbf0e,0xbef13f7fbf22be95,0x3f62bdc9bf463f75,0xbf6d3ec43ec4bf6d,0xbf6d3ec43ec4bf6d,0x3e95bf463f7fbf62,0x3f75bf223dc93ef1,0x3f7bbf553f0ebe48,0xbf7b3f55bf0e3e48,0xbdc93e95bef13f22,0x3f7fbf753f62bf46
.quad 0xbf803f80bf803f80,0xbf803f80bf803f80,0xbdc93e95bef13f22,0x3f7fbf753f62bf46,0x3f7bbf553f0ebe48,0xbf7b3f55bf0e3e48,0x3e95bf463f7fbf62,0x3f75bf223dc93ef1,0xbf6d3ec43ec4bf6d,0xbf6d3ec43ec4bf6d,0xbef13f7fbf22be95,0x3f62bdc9bf463f75,0x3f553e48bf7b3f0e,0xbf55be483f7bbf0e,0x3f22bf62be953f7f,0x3f463ef1bf75bdc9
.quad 0xbf35bf353f353f35,0xbf35bf353f353f35,0xbf463ef13f75bdc9,0x3f223f62be95bf7f,0x3f0e3f7b3e48bf55,0xbf0ebf7bbe483f55,0x3f623dc9bf46bf75,0x3ef13f7f3f22be95,0xbec4bf6dbf6dbec4,0xbec4bf6dbf6dbec4,0xbf75bf22bdc93ef1,0x3e953f463f7f3f62,0x3e483f0e3f553f7b,0xbe48bf0ebf55bf7b,0x3f7f3f753f623f46,0x3dc93e953ef13f22
.quad 0x0,0x0,0xbf22bef1be95bdc9,0xbf46bf62bf75bf7f,0x3f7b3f553f0e3e48,0xbf7bbf55bf0ebe48,0xbf62bf7fbf46be95,0xbef13dc93f223f75,0x3ec43f6d3f6d3ec4,0x3ec43f6d3f6d3ec4,0x3e95bf22bf7fbef1,0x3f753f46bdc9bf62,0xbf553e483f7b3f0e,0x3f55be48bf7bbf0e,0x3f7f3e95bf62bf22,0x3dc9bf75bef13f46
.quad 0xbf35bf353f353f35,0xbf35bf353f353f35,0x3dc93f75bef1bf46,0xbf7f3e953f62bf22,0x3f0ebf7b3e483f55,0xbf0e3f7bbe48bf55,0xbf753f463dc9bf62,0x3e953f22bf7f3ef1,0x3f6dbec4bec43f6d,0x3f6dbec4bec43f6d,0xbef1bdc93f22bf75,0x3f62bf7f3f46be95,0xbe483f0ebf553f7b,0x3e48bf0e3f55bf7b,0x3f46bf623f75bf7f,0xbf223ef1be953dc9
.quad 0xbf803f80bf803f80,0xbf803f80bf803f80,0x3f46bf623f75bf7f,0xbf223ef1be953dc9,0xbe483f0ebf553f7b,0x3e48bf0e3f55bf7b,0xbef1bdc93f22bf75,0x3f62bf7f3f46be95,0x3f6dbec4bec43f6d,0x3f6dbec4bec43f6d,0xbf753f463dc9bf62,0x3e953f22bf7f3ef1,0x3f0ebf7b3e483f55,0xbf0e3f7bbe48bf55,0x3dc93f75bef1bf46,0xbf7f3e953f62bf22
.quad 0xbf35bf353f353f35,0xbf35bf353f353f35,0x3f7f3e95bf62bf22,0x3dc9bf75bef13f46,0xbf553e483f7b3f0e,0x3f55be48bf7bbf0e,0x3e95bf22bf7fbef1,0x3f753f46bdc9bf62,0x3ec43f6d3f6d3ec4,0x3ec43f6d3f6d3ec4,0xbf62bf7fbf46be95,0xbef13dc93f223f75,0x3f7b3f553f0e3e48,0xbf7bbf55bf0ebe48,0xbf22bef1be95bdc9,0xbf46bf62bf75bf7f
.quad 0x0,0x0,0xbf7fbf75bf62bf46,0xbdc9be95bef1bf22,0x3e483f0e3f553f7b,0xbe48bf0ebf55bf7b,0x3f753f223dc9bef1,0xbe95bf46bf7fbf62,0xbec4bf6dbf6dbec4,0xbec4bf6dbf6dbec4,0xbf62bdc93f463f75,0xbef1bf7fbf223e95,0x3f0e3f7b3e48bf55,0xbf0ebf7bbe483f55,0x3f46bef1bf753dc9,0xbf22bf623e953f7f
.quad 0xbf35bf353f353f35,0xbf35bf353f353f35,0xbf223f623e95bf7f,0xbf46bef13f753dc9,0x3f553e48bf7b3f0e,0xbf55be483f7bbf0e,0x3ef1bf7f3f223e95,0xbf623dc93f46bf75,0xbf6d3ec43ec4bf6d,0xbf6d3ec43ec4bf6d,0xbe953f46bf7f3f62,0xbf753f22bdc9bef1,0x3f7bbf553f0ebe48,0xbf7b3f55bf0e3e48,0x3dc9be953ef1bf22,0xbf7f3f75bf623f46
.quad 0xbf803f80bf803f80,0xbf803f80bf803f80,0x3dc9be953ef1bf22,0xbf7f3f75bf623f46,0x3f7bbf553f0ebe48,0xbf7b3f55bf0e3e48,0xbe953f46bf7f3f62,0xbf753f22bdc9bef1,0xbf6d3ec43ec4bf6d,0xbf6d3ec43ec4bf6d,0x3ef1bf7f3f223e95,0xbf623dc93f46bf75,0x3f553e48bf7b3f0e,0xbf55be483f7bbf0e,0xbf223f623e95bf7f,0xbf46bef13f753dc9
.quad 0xbf35bf353f353f35,0xbf35bf353f353f35,0x3f46bef1bf753dc9,0xbf22bf623e953f7f,0x3f0e3f7b3e48bf55,0xbf0ebf7bbe483f55,0xbf62bdc93f463f75,0xbef1bf7fbf223e95,0xbec4bf6dbf6dbec4,0xbec4bf6dbf6dbec4,0x3f753f223dc9bef1,0xbe95bf46bf7fbf62,0x3e483f0e3f553f7b,0xbe48bf0ebf55bf7b,0xbf7fbf75bf62bf46,0xbdc9be95bef1bf22
.quad 0x8000800080008000,0x8000800080008000,0xbf22bef1be95bdc9,0xbf46bf62bf75bf7f,0xbf7bbf55bf0ebe48,0x3f7b3f553f0e3e48,0xbf62bf7fbf46be95,0xbef13dc93f223f75,0xbec4bf6dbf6dbec4,0xbec4bf6dbf6dbec4,0x3e95bf22bf7fbef1,0x3f753f46bdc9bf62,0x3f55be48bf7bbf0e,0xbf553e483f7b3f0e,0x3f7f3e95bf62bf22,0x3dc9bf75bef13f46
.quad 0x3f353f35bf35bf35,0x3f353f35bf35bf35,0x3dc93f75bef1bf46,0xbf7f3e953f62bf22,0xbf0e3f7bbe48bf55,0x3f0ebf7b3e483f55,0xbf753f463dc9bf62,0x3e953f22bf7f3ef1,0xbf6d3ec43ec4bf6d,0xbf6d3ec43ec4bf6d,0xbef1bdc93f22bf75,0x3f62bf7f3f46be95,0x3e48bf0e3f55bf7b,0xbe483f0ebf553f7b,0x3f46bf623f75bf7f,0xbf223ef1be953dc9
.quad 0x3f80bf803f80bf80,0x3f80bf803f80bf80,0x3f46bf623f75bf7f,0xbf223ef1be953dc9,0x3e48bf0e3f55bf7b,0xbe483f0ebf553f7b,0xbef1bdc93f22bf75,0x3f62bf7f3f46be95,0xbf6d3ec43ec4bf6d,0xbf6d3ec43ec4bf6d,0xbf753f463dc9bf62,0x3e953f22bf7f3ef1,0xbf0e3f7bbe48bf55,0x3f0ebf7b3e483f55,0x3dc93f75bef1bf46,0xbf7f3e953f62bf22
.quad 0x3f353f35bf35bf35,0x3f353f35bf35bf35,0x3f7f3e95bf62bf22,0x3dc9bf75bef13f46,0x3f55be48bf7bbf0e,0xbf553e483f7b3f0e,0x3e95bf22bf7fbef1,0x3f753f46bdc9bf62,0xbec4bf6dbf6dbec4,0xbec4bf6dbf6dbec4,0xbf62bf7fbf46be95,0xbef13dc93f223f75,0xbf7bbf55bf0ebe48,0x3f7b3f553f0e3e48,0xbf22bef1be95bdc9,0xbf46bf62bf75bf7f
.quad 0x8000800080008000,0x8000800080008000,0xbf7fbf75bf62bf46,0xbdc9be95bef1bf22,0xbe48bf0ebf55bf7b,0x3e483f0e3f553f7b,0x3f753f223dc9bef1,0xbe95bf46bf7fbf62,0x3ec43f6d3f6d3ec4,0x3ec43f6d3f6d3ec4,0xbf62bdc93f463f75,0xbef1bf7fbf223e95,0xbf0ebf7bbe483f55,0x3f0e3f7b3e48bf55,0x3f46bef1bf753dc9,0xbf22bf623e953f7f
.quad 0x3f353f35bf35bf35,0x3f353f35bf35bf35,0xbf223f623e95bf7f,0xbf46bef13f753dc9,0xbf55be483f7bbf0e,0x3f553e48bf7b3f0e,0x3ef1bf7f3f223e95,0xbf623dc93f46bf75,0x3f6dbec4bec43f6d,0x3f6dbec4bec43f6d,0xbe953f46bf7f3f62,0xbf753f22bdc9bef1,0xbf7b3f55bf0e3e48,0x3f7bbf553f0ebe48,0x3dc9be953ef1bf22,0xbf7f3f75bf623f46
.quad 0x3f80bf803f80bf80,0x3f80bf803f80bf80,0x3dc9be953ef1bf22,0xbf7f3f75bf623f46,0xbf7b3f55bf0e3e48,0x3f7bbf553f0ebe48,0xbe953f46bf7f3f62,0xbf753f22bdc9bef1,0x3f6dbec4bec43f6d,0x3f6dbec4bec43f6d,0x3ef1bf7f3f223e95,0xbf623dc93f46bf75,0xbf55be483f7bbf0e,0x3f553e48bf7b3f0e,0xbf223f623e95bf7f,0xbf46bef13f753dc9
.quad 0x3f353f35bf35bf35,0x3f353f35bf35bf35,0x3f46bef1bf753dc9,0xbf22bf623e953f7f,0xbf0ebf7bbe483f55,0x3f0e3f7b3e48bf55,0xbf62bdc93f463f75,0xbef1bf7fbf223e95,0x3ec43f6d3f6d3ec4,0x3ec43f6d3f6d3ec4,0x3f753f223dc9bef1,0xbe95bf46bf7fbf62,0xbe48bf0ebf55bf7b,0x3e483f0e3f553f7b,0xbf7fbf75bf62bf46,0xbdc9be95bef1bf22
.quad 0x8000800080008000,0x8000800080008000,0x3f223ef13e953dc9,0x3f463f623f753f7f,0xbf7bbf55bf0ebe48,0x3f7b3f553f0e3e48,0x3f623f7f3f463e95,0x3ef1bdc9bf22bf75,0xbec4bf6dbf6dbec4,0xbec4bf6dbf6dbec4,0xbe953f223f7f3ef1,0xbf75bf463dc93f62,0x3f55be48bf7bbf0e,0xbf553e483f7b3f0e,0xbf7fbe953f623f22,0xbdc93f753ef1bf46
.quad 0x3f353f35bf35bf35,0x3f353f35bf35bf35,0xbdc9bf753ef13f46,0x3f7fbe95bf623f22,0xbf0e3f7bbe48bf55,0x3f0ebf7b3e483f55,0x3f75bf46bdc93f62,0xbe95bf223f7fbef1,0xbf6d3ec43ec4bf6d,0xbf6d3ec43ec4bf6d,0x3ef13dc9bf223f75,0xbf623f7fbf463e95,0x3e48bf0e3f55bf7b,0xbe483f0ebf553f7b,0xbf463f62bf753f7f,0x3f22bef13e95bdc9
.quad 0x3f80bf803f80bf80,0x3f80bf803f80bf80,0xbf463f62bf753f7f,0x3f22bef13e95bdc9,0x3e48bf0e3f55bf7b,0xbe483f0ebf553f7b,0x3ef13dc9bf223f75,0xbf623f7fbf463e95,0xbf6d3ec43ec4bf6d,0xbf6d3ec43ec4bf6d,0x3f75bf46bdc93f62,0xbe95bf223f7fbef1,0xbf0e3f7bbe48bf55,0x3f0ebf7b3e483f55,0xbdc9bf753ef13f46,0x3f7fbe95bf623f22
.quad 0x3f353f35bf35bf35,0x3f353f35bf35bf35,0xbf7fbe953f623f22,0xbdc93f753ef1bf46,0x3f55be48bf7bbf0e,0xbf553e483f7b3f0e,0xbe953f223f7f3ef1,0xbf75bf463dc93f62,0xbec4bf6dbf6dbec4,0xbec4bf6dbf6dbec4,0x3f623f7f3f463e95,0x3ef1bdc9bf22bf75,0xbf7bbf55bf0ebe48,0x3f7b3f553f0e3e48,0x3f223ef13e953dc9,0x3f463f623f753f7f
.quad 0x8000800080008000,0x8000800080008000,0x3f7f3f753f623f46,0x3dc93e953ef13f22,0xbe48bf0ebf55bf7b,0x3e483f0e3f553f7b,0xbf75bf22bdc93ef1,0x3e953f463f7f3f62,0x3ec43f6d3f6d3ec4,0x3ec43f6d3f6d3ec4,0x3f623dc9bf46bf75,0x3ef13f7f3f22be95,0xbf0ebf7bbe483f55,0x3f0e3f7b3e48bf55,0xbf463ef13f75bdc9,0x3f223f62be95bf7f
.quad 0x3f353f35bf35bf35,0x3f353f35bf35bf35,0x3f22bf62be953f7f,0x3f463ef1bf75bdc9,0xbf55be483f7bbf0e,0x3f553e48bf7b3f0e,0xbef13f7fbf22be95,0x3f62bdc9bf463f75,0x3f6dbec4bec43f6d,0x3f6dbec4bec43f6d,0x3e95bf463f7fbf62,0x3f75bf223dc93ef1,0xbf7b3f55bf0e3e48,0x3f7bbf553f0ebe48,0xbdc93e95bef13f22,0x3f7fbf753f62bf46
.quad 0x3f80bf803f80bf80,0x3f80bf803f80bf80,0xbdc93e95bef13f22,0x3f7fbf753f62bf46,0xbf7b3f55bf0e3e48,0x3f7bbf553f0ebe48,0x3e95bf463f7fbf62,0x3f75bf223dc93ef1,0x3f6dbec4bec43f6d,0x3f6dbec4bec43f6d,0xbef13f7fbf22be95,0x3f62bdc9bf463f75,0xbf55be483f7bbf0e,0x3f553e48bf7b3f0e,0x3f22bf62be953f7f,0x3f463ef1bf75bdc9
.quad 0x3f353f35bf35bf35,0x3f353f35bf35bf35,0xbf463ef13f75bdc9,0x3f223f62be95bf7f,0xbf0ebf7bbe483f55,0x3f0e3f7b3e48bf55,0x3f623dc9bf46bf75,0x3ef13f7f3f22be95,0x3ec43f6d3f6d3ec4,0x3ec43f6d3f6d3ec4,0xbf75bf22bdc93ef1,0x3e953f463f7f3f62,0xbe48bf0ebf55bf7b,0x3e483f0e3f553f7b,0x3f7f3f753f623f46,0x3dc93e953ef13f22
.quad 0x3f753f7b3f7f3f80,0x3ef13f0e3f223f35,0x3f223f553f753f80,0xbf7fbf7bbf62bf35,0x3dc93f0e3f623f80,0x3f223e48be95bf35,0xbef13e483f463f80,0x3e953f553f7f3f35,0xbf62be483f223f80,0xbf75bf55bdc93f35,0xbf7fbf0e3ef13f80,0x3f46be48bf75bf35,0xbf46bf553e953f80,0x3dc93f7b3ef1bf35,0xbe95bf7b3dc93f80,0xbf62bf0e3f463f35
.quad 0x3e95bf7bbdc93f80,0x3f62bf0ebf463f35,0x3f46bf55be953f80,0xbdc93f7bbef1bf35,0x3f7fbf0ebef13f80,0xbf46be483f75bf35,0x3f62be48bf223f80,0x3f75bf553dc93f35,0x3ef13e48bf463f80,0xbe953f55bf7f3f35,0xbdc93f0ebf623f80,0xbf223e483e95bf35,0xbf223f55bf753f80,0x3f7fbf7b3f62bf35,0xbf753f7bbf7f3f80,0xbef13f0ebf223f35
.quad 0xbf753f7bbf7f3f80,0xbef13f0ebf223f35,0xbf223f55bf753f80,0x3f7fbf7b3f62bf35,0xbdc93f0ebf623f80,0xbf223e483e95bf35,0x3ef13e48bf463f80,0xbe953f55bf7f3f35,0x3f62be48bf223f80,0x3f75bf553dc93f35,0x3f7fbf0ebef13f80,0xbf46be483f75bf35,0x3f46bf55be953f80,0xbdc93f7bbef1bf35,0x3e95bf7bbdc93f80,0x3f62bf0ebf463f35
.quad 0xbe95bf7b3dc93f80,0xbf62bf0e3f463f35,0xbf46bf553e953f80,0x3dc93f7b3ef1bf35,0xbf7fbf0e3ef13f80,0x3f46be48bf75bf35,0xbf62be483f223f80,0xbf75bf55bdc93f35,0xbef13e483f463f80,0x3e953f553f7f3f35,0x3dc93f0e3f623f80,0x3f223e48be95bf35,0x3f223f553f753f80,0xbf7fbf7bbf62bf35,0x3f753f7b3f7f3f80,0x3ef13f0e3f223f35
.quad 0x3f463f553f623f6d,0x3dc93e483e953ec4,0xbef1be483dc93ec4,0xbe95bf0ebf46bf6d,0xbf75bf7bbf46bec4,0x3ef13f553f7f3f6d,0x3dc9bf0ebf75bf6d,0xbf22bf7bbf62bec4,0x3f7f3f0ebe95bf6d,0x3f463f7b3ef1bec4,0x3e953f7b3f22bec4,0xbf62bf553dc93f6d,0xbf623e483f7f3ec4,0x3f753f0ebf22bf6d,0xbf22bf553ef13f6d,0xbf7fbe483f753ec4
.quad 0x3f22bf55bef13f6d,0x3f7fbe48bf753ec4,0x3f623e48bf7f3ec4,0xbf753f0e3f22bf6d,0xbe953f7bbf22bec4,0x3f62bf55bdc93f6d,0xbf7f3f0e3e95bf6d,0xbf463f7bbef1bec4,0xbdc9bf0e3f75bf6d,0x3f22bf7b3f62bec4,0x3f75bf7b3f46bec4,0xbef13f55bf7f3f6d,0x3ef1be48bdc93ec4,0x3e95bf0e3f46bf6d,0xbf463f55bf623f6d,0xbdc93e48be953ec4
.quad 0xbf463f55bf623f6d,0xbdc93e48be953ec4,0x3ef1be48bdc93ec4,0x3e95bf0e3f46bf6d,0x3f75bf7b3f46bec4,0xbef13f55bf7f3f6d,0xbdc9bf0e3f75bf6d,0x3f22bf7b3f62bec4,0xbf7f3f0e3e95bf6d,0xbf463f7bbef1bec4,0xbe953f7bbf22bec4,0x3f62bf55bdc93f6d,0x3f623e48bf7f3ec4,0xbf753f0e3f22bf6d,0x3f22bf55bef13f6d,0x3f7fbe48bf753ec4
.quad 0xbf22bf553ef13f6d,0xbf7fbe483f753ec4,0xbf623e483f7f3ec4,0x3f753f0ebf22bf6d,0x3e953f7b3f22bec4,0xbf62bf553dc93f6d,0x3f7f3f0ebe95bf6d,0x3f463f7b3ef1bec4,0x3dc9bf0ebf75bf6d,0xbf22bf7bbf62bec4,0xbf75bf7bbf46bec4,0x3ef13f553f7f3f6d,0xbef1be483dc93ec4,0xbe95bf0ebf46bf6d,0x3f463f553f623f6d,0x3dc93e483e953ec4
.quad 0xbe95be48bdc9248d,0xbf62bf55bf46bf35,0x3f463f0e3e95a554,0xbdc93e483ef13f35,0xbf7fbf55bef125b0,0x3f463f7b3f753f35,0x3f623f7b3f22a5f7,0x3f753f0ebdc9bf35,0xbef1bf7bbf46261f,0x3e95bf0ebf7fbf35,0xbdc93f553f62a731,0xbf22bf7bbe953f35,0x3f22bf0ebf75a68d,0xbf7fbe483f623f35,0xbf753e483f7fa742,0xbef13f553f22bf35
.quad 0x3f753e48bf7fa654,0x3ef13f55bf22bf35,0xbf22bf0e3f75a754,0x3f7fbe48bf623f35,0x3dc93f55bf62a60d,0x3f22bf7b3e953f35,0x3ef1bf7b3f46a765,0xbe95bf0e3f7fbf35,0xbf623f7bbf22a58e,0xbf753f0e3dc9bf35,0x3f7fbf553ef1a777,0xbf463f7bbf753f35,0xbf463f0ebe95a137,0x3dc93e48bef13f35,0x3e95be483dc9a784,0x3f62bf553f46bf35
.quad 0x3e95be483dc9258d,0x3f62bf553f46bf35,0xbf463f0ebe95a78d,0x3dc93e48bef13f35,0x3f7fbf553ef1260d,0xbf463f7bbf753f35,0xbf623f7bbf22a796,0xbf753f0e3dc9bf35,0x3ef1bf7b3f46280d,0xbe95bf0e3f7fbf35,0x3dc93f55bf62a79f,0x3f22bf7b3e953f35,0xbf22bf0e3f75268d,0x3f7fbe48bf623f35,0x3f753e48bf7f2731,0x3ef13f55bf22bf35
.quad 0xbf753e483f7f2816,0xbef13f553f22bf35,0x3f22bf0ebf75a7b1,0xbf7fbe483f623f35,0xbdc93f553f6226d4,0xbf22bf7bbe953f35,0xbef1bf7bbf46270d,0x3e95bf0ebf7fbf35,0x3f623f7b3f22281f,0x3f753f0ebdc9bf35,0xbf7fbf55bef1a7c2,0x3f463f7b3f753f35,0x3f463f0e3e95270d,0xbdc93e483ef13f35,0xbe95be48bdc926d4,0xbf62bf55bf46bf35
.quad 0xbf22bf0ebef1bec4,0xbf7fbf7bbf75bf6d,0x3f623f7b3f7f3f6d,0xbf75bf55bf22bec4,0x3e95be48bf22bf6d,0xbf62bf0ebdc93ec4,0xbf7fbf55be953ec4,0xbf46be483ef13f6d,0x3dc93f553f753ec4,0xbf223e483f623f6d,0x3f753e48bf46bf6d,0xbef13f0e3f7f3ec4,0xbef1bf7bbdc93f6d,0xbe953f553f46bec4,0xbf463f0e3f62bec4,0xbdc93f7b3e95bf6d
.quad 0x3f463f0ebf62bec4,0x3dc93f7bbe95bf6d,0x3ef1bf7b3dc93f6d,0x3e953f55bf46bec4,0xbf753e483f46bf6d,0x3ef13f0ebf7f3ec4,0xbdc93f55bf753ec4,0x3f223e48bf623f6d,0x3f7fbf553e953ec4,0x3f46be48bef13f6d,0xbe95be483f22bf6d,0x3f62bf0e3dc93ec4,0xbf623f7bbf7f3f6d,0x3f75bf553f22bec4,0x3f22bf0e3ef1bec4,0x3f7fbf7b3f75bf6d
.quad 0x3f22bf0e3ef1bec4,0x3f7fbf7b3f75bf6d,0xbf623f7bbf7f3f6d,0x3f75bf553f22bec4,0xbe95be483f22bf6d,0x3f62bf0e3dc93ec4,0x3f7fbf553e953ec4,0x3f46be48bef13f6d,0xbdc93f55bf753ec4,0x3f223e48bf623f6d,0xbf753e483f46bf6d,0x3ef13f0ebf7f3ec4,0x3ef1bf7b3dc93f6d,0x3e953f55bf46bec4,0x3f463f0ebf62bec4,0x3dc93f7bbe95bf6d
.quad 0xbf463f0e3f62bec4,0xbdc93f7b3e95bf6d,0xbef1bf7bbdc93f6d,0xbe953f553f46bec4,0x3f753e48bf46bf6d,0xbef13f0e3f7f3ec4,0x3dc93f553f753ec4,0xbf223e483f623f6d,0xbf7fbf55be953ec4,0xbf46be483ef13f6d,0x3e95be48bf22bf6d,0xbf62bf0ebdc93ec4,0x3f623f7b3f7f3f6d,0xbf75bf55bf22bec4,0xbf22bf0ebef1bec4,0xbf7fbf7bbf75bf6d
.quad 0x3e953e483dc90000,0x3f623f553f463f35,0x3f463f0e3e950000,0xbdc93e483ef13f35,0x3f7f3f553ef10000,0xbf46bf7bbf75bf35,0x3f623f7b3f220000,0x3f753f0ebdc9bf35,0x3ef13f7b3f460000,0xbe953f0e3f7f3f35,0xbdc93f553f620000,0xbf22bf7bbe953f35,0xbf223f0e3f750000,0x3f7f3e48bf62bf35,0xbf753e483f7f0000,0xbef13f553f22bf35
.quad 0xbf75be483f7f0000,0xbef1bf553f223f35,0xbf22bf0e3f750000,0x3f7fbe48bf623f35,0xbdc9bf553f620000,0xbf223f7bbe95bf35,0x3ef1bf7b3f460000,0xbe95bf0e3f7fbf35,0x3f62bf7b3f220000,0x3f75bf0ebdc93f35,0x3f7fbf553ef10000,0xbf463f7bbf753f35,0x3f46bf0e3e950000,0xbdc9be483ef1bf35,0x3e95be483dc90000,0x3f62bf553f46bf35
.quad 0xbe953e48bdc90000,0xbf623f55bf463f35,0xbf463f0ebe950000,0x3dc93e48bef13f35,0xbf7f3f55bef10000,0x3f46bf7b3f75bf35,0xbf623f7bbf220000,0xbf753f0e3dc9bf35,0xbef13f7bbf460000,0x3e953f0ebf7f3f35,0x3dc93f55bf620000,0x3f22bf7b3e953f35,0x3f223f0ebf750000,0xbf7f3e483f62bf35,0x3f753e48bf7f0000,0x3ef13f55bf22bf35
.quad 0x3f75be48bf7f0000,0x3ef1bf55bf223f35,0x3f22bf0ebf750000,0xbf7fbe483f623f35,0x3dc9bf55bf620000,0x3f223f7b3e95bf35,0xbef1bf7bbf460000,0x3e95bf0ebf7fbf35,0xbf62bf7bbf220000,0xbf75bf0e3dc93f35,0xbf7fbf55bef10000,0x3f463f7b3f753f35,0xbf46bf0ebe950000,0x3dc9be48bef1bf35,0xbe95be48bdc90000,0xbf62bf55bf46bf35
.quad 0x3f223f0e3ef13ec4,0x3f7f3f7b3f753f6d,0x3f623f7b3f7f3f6d,0xbf75bf55bf22bec4,0xbe953e483f223f6d,0x3f623f0e3dc9bec4,0xbf7fbf55be953ec4,0xbf46be483ef13f6d,0xbdc9bf55bf75bec4,0x3f22be48bf62bf6d,0x3f753e48bf46bf6d,0xbef13f0e3f7f3ec4,0x3ef13f7b3dc9bf6d,0x3e95bf55bf463ec4,0xbf463f0e3f62bec4,0xbdc93f7b3e95bf6d
.quad 0xbf46bf0e3f623ec4,0xbdc9bf7b3e953f6d,0x3ef1bf7b3dc93f6d,0x3e953f55bf46bec4,0x3f75be48bf463f6d,0xbef1bf0e3f7fbec4,0xbdc93f55bf753ec4,0x3f223e48bf623f6d,0xbf7f3f55be95bec4,0xbf463e483ef1bf6d,0xbe95be483f22bf6d,0x3f62bf0e3dc93ec4,0x3f62bf7b3f7fbf6d,0xbf753f55bf223ec4,0x3f22bf0e3ef1bec4,0x3f7fbf7b3f75bf6d
.quad 0xbf223f0ebef13ec4,0xbf7f3f7bbf753f6d,0xbf623f7bbf7f3f6d,0x3f75bf553f22bec4,0x3e953e48bf223f6d,0xbf623f0ebdc9bec4,0x3f7fbf553e953ec4,0x3f46be48bef13f6d,0x3dc9bf553f75bec4,0xbf22be483f62bf6d,0xbf753e483f46bf6d,0x3ef13f0ebf7f3ec4,0xbef13f7bbdc9bf6d,0xbe95bf553f463ec4,0x3f463f0ebf62bec4,0x3dc93f7bbe95bf6d
.quad 0x3f46bf0ebf623ec4,0x3dc9bf7bbe953f6d,0xbef1bf7bbdc93f6d,0xbe953f553f46bec4,0xbf75be483f463f6d,0x3ef1bf0ebf7fbec4,0x3dc93f553f753ec4,0xbf223e483f623f6d,0x3f7f3f553e95bec4,0x3f463e48bef1bf6d,0x3e95be48bf22bf6d,0xbf62bf0ebdc93ec4,0xbf62bf7bbf7fbf6d,0x3f753f553f223ec4,0xbf22bf0ebef1bec4,0xbf7fbf7bbf75bf6d
.quad 0x3f753f7b3f7f3f80,0x3ef13f0e3f223f35,0xbf22bf55bf75bf80,0x3f7f3f7b3f623f35,0x3dc93f0e3f623f80,0x3f223e48be95bf35,0x3ef1be48bf46bf80,0xbe95bf55bf7fbf35,0xbf62be483f223f80,0xbf75bf55bdc93f35,0x3f7f3f0ebef1bf80,0xbf463e483f753f35,0xbf46bf553e953f80,0x3dc93f7b3ef1bf35,0x3e953f7bbdc9bf80,0x3f623f0ebf46bf35
.quad 0x3e95bf7bbdc93f80,0x3f62bf0ebf463f35,0xbf463f553e95bf80,0x3dc9bf7b3ef13f35,0x3f7fbf0ebef13f80,0xbf46be483f75bf35,0xbf623e483f22bf80,0xbf753f55bdc9bf35,0x3ef13e48bf463f80,0xbe953f55bf7f3f35,0x3dc9bf0e3f62bf80,0x3f22be48be953f35,0xbf223f55bf753f80,0x3f7fbf7b3f62bf35,0x3f75bf7b3f7fbf80,0x3ef1bf0e3f22bf35
.quad 0xbf753f7bbf7f3f80,0xbef13f0ebf223f35,0x3f22bf553f75bf80,0xbf7f3f7bbf623f35,0xbdc93f0ebf623f80,0xbf223e483e95bf35,0xbef1be483f46bf80,0x3e95bf553f7fbf35,0x3f62be48bf223f80,0x3f75bf553dc93f35,0xbf7f3f0e3ef1bf80,0x3f463e48bf753f35,0x3f46bf55be953f80,0xbdc93f7bbef1bf35,0xbe953f7b3dc9bf80,0xbf623f0e3f46bf35
.quad 0xbe95bf7b3dc93f80,0xbf62bf0e3f463f35,0x3f463f55be95bf80,0xbdc9bf7bbef13f35,0xbf7fbf0e3ef13f80,0x3f46be48bf75bf35,0x3f623e48bf22bf80,0x3f753f553dc9bf35,0xbef13e483f463f80,0x3e953f553f7f3f35,0xbdc9bf0ebf62bf80,0xbf22be483e953f35,0x3f223f553f753f80,0xbf7fbf7bbf62bf35,0xbf75bf7bbf7fbf80,0xbef1bf0ebf22bf35
.quad 0x3f463f553f623f6d,0x3dc93e483e953ec4,0x3ef13e48bdc9bec4,0x3e953f0e3f463f6d,0xbf75bf7bbf46bec4,0x3ef13f553f7f3f6d,0xbdc93f0e3f753f6d,0x3f223f7b3f623ec4,0x3f7f3f0ebe95bf6d,0x3f463f7b3ef1bec4,0xbe95bf7bbf223ec4,0x3f623f55bdc9bf6d,0xbf623e483f7f3ec4,0x3f753f0ebf22bf6d,0x3f223f55bef1bf6d,0x3f7f3e48bf75bec4
.quad 0x3f22bf55bef13f6d,0x3f7fbe48bf753ec4,0xbf62be483f7fbec4,0x3f75bf0ebf223f6d,0xbe953f7bbf22bec4,0x3f62bf55bdc93f6d,0x3f7fbf0ebe953f6d,0x3f46bf7b3ef13ec4,0xbdc9bf0e3f75bf6d,0x3f22bf7b3f62bec4,0xbf753f7bbf463ec4,0x3ef1bf553f7fbf6d,0x3ef1be48bdc93ec4,0x3e95bf0e3f46bf6d,0x3f46bf553f62bf6d,0x3dc9be483e95bec4
.quad 0xbf463f55bf623f6d,0xbdc93e48be953ec4,0xbef13e483dc9bec4,0xbe953f0ebf463f6d,0x3f75bf7b3f46bec4,0xbef13f55bf7f3f6d,0x3dc93f0ebf753f6d,0xbf223f7bbf623ec4,0xbf7f3f0e3e95bf6d,0xbf463f7bbef1bec4,0x3e95bf7b3f223ec4,0xbf623f553dc9bf6d,0x3f623e48bf7f3ec4,0xbf753f0e3f22bf6d,0xbf223f553ef1bf6d,0xbf7f3e483f75bec4
.quad 0xbf22bf553ef13f6d,0xbf7fbe483f753ec4,0x3f62be48bf7fbec4,0xbf75bf0e3f223f6d,0x3e953f7b3f22bec4,0xbf62bf553dc93f6d,0xbf7fbf0e3e953f6d,0xbf46bf7bbef13ec4,0x3dc9bf0ebf75bf6d,0xbf22bf7bbf62bec4,0x3f753f7b3f463ec4,0xbef1bf55bf7fbf6d,0xbef1be483dc93ec4,0xbe95bf0ebf46bf6d,0xbf46bf55bf62bf6d,0xbdc9be48be95bec4
.quad 0xbe95be48bdc98000,0xbf62bf55bf46bf35,0xbf46bf0ebe958000,0x3dc9be48bef1bf35,0xbf7fbf55bef18000,0x3f463f7b3f753f35,0xbf62bf7bbf228000,0xbf75bf0e3dc93f35,0xbef1bf7bbf468000,0x3e95bf0ebf7fbf35,0x3dc9bf55bf628000,0x3f223f7b3e95bf35,0x3f22bf0ebf758000,0xbf7fbe483f623f35,0x3f75be48bf7f8000,0x3ef1bf55bf223f35
.quad 0x3f753e48bf7f8000,0x3ef13f55bf22bf35,0x3f223f0ebf758000,0xbf7f3e483f62bf35,0x3dc93f55bf628000,0x3f22bf7b3e953f35,0xbef13f7bbf468000,0x3e953f0ebf7f3f35,0xbf623f7bbf228000,0xbf753f0e3dc9bf35,0xbf7f3f55bef18000,0x3f46bf7b3f75bf35,0xbf463f0ebe958000,0x3dc93e48bef13f35,0xbe953e48bdc98000,0xbf623f55bf463f35
.quad 0x3e95be483dc98000,0x3f62bf553f46bf35,0x3f46bf0e3e958000,0xbdc9be483ef1bf35,0x3f7fbf553ef18000,0xbf463f7bbf753f35,0x3f62bf7b3f228000,0x3f75bf0ebdc93f35,0x3ef1bf7b3f468000,0xbe95bf0e3f7fbf35,0xbdc9bf553f628000,0xbf223f7bbe95bf35,0xbf22bf0e3f758000,0x3f7fbe48bf623f35,0xbf75be483f7f8000,0xbef1bf553f223f35
.quad 0xbf753e483f7f8000,0xbef13f553f22bf35,0xbf223f0e3f758000,0x3f7f3e48bf62bf35,0xbdc93f553f628000,0xbf22bf7bbe953f35,0x3ef13f7b3f468000,0xbe953f0e3f7f3f35,0x3f623f7b3f228000,0x3f753f0ebdc9bf35,0x3f7f3f553ef18000,0xbf46bf7bbf75bf35,0x3f463f0e3e958000,0xbdc93e483ef13f35,0x3e953e483dc98000,0x3f623f553f463f35
.quad 0xbf22bf0ebef1bec4,0xbf7fbf7bbf75bf6d,0xbf62bf7bbf7fbf6d,0x3f753f553f223ec4,0x3e95be48bf22bf6d,0xbf62bf0ebdc93ec4,0x3f7f3f553e95bec4,0x3f463e48bef1bf6d,0x3dc93f553f753ec4,0xbf223e483f623f6d,0xbf75be483f463f6d,0x3ef1bf0ebf7fbec4,0xbef1bf7bbdc93f6d,0xbe953f553f46bec4,0x3f46bf0ebf623ec4,0x3dc9bf7bbe953f6d
.quad 0x3f463f0ebf62bec4,0x3dc93f7bbe95bf6d,0xbef13f7bbdc9bf6d,0xbe95bf553f463ec4,0xbf753e483f46bf6d,0x3ef13f0ebf7f3ec4,0x3dc9bf553f75bec4,0xbf22be483f62bf6d,0x3f7fbf553e953ec4,0x3f46be48bef13f6d,0x3e953e48bf223f6d,0xbf623f0ebdc9bec4,0xbf623f7bbf7f3f6d,0x3f75bf553f22bec4,0xbf223f0ebef13ec4,0xbf7f3f7bbf753f6d
.quad 0x3f22bf0e3ef1bec4,0x3f7fbf7b3f75bf6d,0x3f62bf7b3f7fbf6d,0xbf753f55bf223ec4,0xbe95be483f22bf6d,0x3f62bf0e3dc93ec4,0xbf7f3f55be95bec4,0xbf463e483ef1bf6d,0xbdc93f55bf753ec4,0x3f223e48bf623f6d,0x3f75be48bf463f6d,0xbef1bf0e3f7fbec4,0x3ef1bf7b3dc93f6d,0x3e953f55bf46bec4,0xbf46bf0e3f623ec4,0xbdc9bf7b3e953f6d
.quad 0xbf463f0e3f62bec4,0xbdc93f7b3e95bf6d,0x3ef13f7b3dc9bf6d,0x3e95bf55bf463ec4,0x3f753e48bf46bf6d,0xbef13f0e3f7f3ec4,0xbdc9bf55bf75bec4,0x3f22be48bf62bf6d,0xbf7fbf55be953ec4,0xbf46be483ef13f6d,0xbe953e483f223f6d,0x3f623f0e3dc9bec4,0x3f623f7b3f7f3f6d,0xbf75bf55bf22bec4,0x3f223f0e3ef13ec4,0x3f7f3f7b3f753f6d
.quad 0xbf75bf7bbf7fbf80,0xbef1bf0ebf22bf35,0x3f223f553f753f80,0xbf7fbf7bbf62bf35,0xbdc9bf0ebf62bf80,0xbf22be483e953f35,0xbef13e483f463f80,0x3e953f553f7f3f35,0x3f623e48bf22bf80,0x3f753f553dc9bf35,0xbf7fbf0e3ef13f80,0x3f46be48bf75bf35,0x3f463f55be95bf80,0xbdc9bf7bbef13f35,0xbe95bf7b3dc93f80,0xbf62bf0e3f463f35
.quad 0xbe953f7b3dc9bf80,0xbf623f0e3f46bf35,0x3f46bf55be953f80,0xbdc93f7bbef1bf35,0xbf7f3f0e3ef1bf80,0x3f463e48bf753f35,0x3f62be48bf223f80,0x3f75bf553dc93f35,0xbef1be483f46bf80,0x3e95bf553f7fbf35,0xbdc93f0ebf623f80,0xbf223e483e95bf35,0x3f22bf553f75bf80,0xbf7f3f7bbf623f35,0xbf753f7bbf7f3f80,0xbef13f0ebf223f35
.quad 0x3f75bf7b3f7fbf80,0x3ef1bf0e3f22bf35,0xbf223f55bf753f80,0x3f7fbf7b3f62bf35,0x3dc9bf0e3f62bf80,0x3f22be48be953f35,0x3ef13e48bf463f80,0xbe953f55bf7f3f35,0xbf623e483f22bf80,0xbf753f55bdc9bf35,0x3f7fbf0ebef13f80,0xbf46be483f75bf35,0xbf463f553e95bf80,0x3dc9bf7b3ef13f35,0x3e95bf7bbdc93f80,0x3f62bf0ebf463f35
.quad 0x3e953f7bbdc9bf80,0x3f623f0ebf46bf35,0xbf46bf553e953f80,0x3dc93f7b3ef1bf35,0x3f7f3f0ebef1bf80,0xbf463e483f753f35,0xbf62be483f223f80,0xbf75bf55bdc93f35,0x3ef1be48bf46bf80,0xbe95bf55bf7fbf35,0x3dc93f0e3f623f80,0x3f223e48be95bf35,0xbf22bf55bf75bf80,0x3f7f3f7b3f623f35,0x3f753f7b3f7f3f80,0x3ef13f0e3f223f35
.quad 0xbf46bf55bf62bf6d,0xbdc9be48be95bec4,0xbef1be483dc93ec4,0xbe95bf0ebf46bf6d,0x3f753f7b3f463ec4,0xbef1bf55bf7fbf6d,0x3dc9bf0ebf75bf6d,0xbf22bf7bbf62bec4,0xbf7fbf0e3e953f6d,0xbf46bf7bbef13ec4,0x3e953f7b3f22bec4,0xbf62bf553dc93f6d,0x3f62be48bf7fbec4,0xbf75bf0e3f223f6d,0xbf22bf553ef13f6d,0xbf7fbe483f753ec4
.quad 0xbf223f553ef1bf6d,0xbf7f3e483f75bec4,0x3f623e48bf7f3ec4,0xbf753f0e3f22bf6d,0x3e95bf7b3f223ec4,0xbf623f553dc9bf6d,0xbf7f3f0e3e95bf6d,0xbf463f7bbef1bec4,0x3dc93f0ebf753f6d,0xbf223f7bbf623ec4,0x3f75bf7b3f46bec4,0xbef13f55bf7f3f6d,0xbef13e483dc9bec4,0xbe953f0ebf463f6d,0xbf463f55bf623f6d,0xbdc93e48be953ec4
.quad 0x3f46bf553f62bf6d,0x3dc9be483e95bec4,0x3ef1be48bdc93ec4,0x3e95bf0e3f46bf6d,0xbf753f7bbf463ec4,0x3ef1bf553f7fbf6d,0xbdc9bf0e3f75bf6d,0x3f22bf7b3f62bec4,0x3f7fbf0ebe953f6d,0x3f46bf7b3ef13ec4,0xbe953f7bbf22bec4,0x3f62bf55bdc93f6d,0xbf62be483f7fbec4,0x3f75bf0ebf223f6d,0x3f22bf55bef13f6d,0x3f7fbe48bf753ec4
.quad 0x3f223f55bef1bf6d,0x3f7f3e48bf75bec4,0xbf623e483f7f3ec4,0x3f753f0ebf22bf6d,0xbe95bf7bbf223ec4,0x3f623f55bdc9bf6d,0x3f7f3f0ebe95bf6d,0x3f463f7b3ef1bec4,0xbdc93f0e3f753f6d,0x3f223f7b3f623ec4,0xbf75bf7bbf46bec4,0x3ef13f553f7f3f6d,0x3ef13e48bdc9bec4,0x3e953f0e3f463f6d,0x3f463f553f623f6d,0x3dc93e483e953ec4
.quad 0x3f8000003f800000,0x3f8000003f800000,0x3f7ffec43f800000,0x3f7ff4e63f7ffb11,0x3f7ffb113f800000,0x3f7fd3973f7fec43,0x3f7ff4e63f800000,0x3f7f9c183f7fd397,0x3f7fec433f800000,0x3f7f4e6d3f7fb10f,0x3f7fe1293f800000,0x3f7eea9d3f7f84ab,0x3f7fd3973f800000,0x3f7e70b03f7f4e6d,0x3f7fc38f3f800000,0x3f7de0b13f7f0e58
.quad 0x3f7fb10f3f800000,0x3f7d3aac3f7ec46d,0x3f7f9c183f800000,0x3f7c7eb03f7e70b0,0x3f7f84ab3f800000,0x3f7baccd3f7e1324,0x3f7f6ac73f800000,0x3f7ac5163f7dabcc,0x3f7f4e6d3f800000,0x3f79c79d3f7d3aac,0x3f7f2f9d3f800000,0x3f78b47b3f7cbfc9,0x3f7f0e583f800000,0x3f778bc53f7c3b28,0x3f7eea9d3f800000,0x3f764d973f7baccd
.quad 0x3f7ec46d3f800000,0x3f74fa0b3f7b14be,0x3f7e9bc93f800000,0x3f73913f3f7a7302,0x3f7e70b03f800000,0x3f7213523f79c79d,0x3f7e43233f800000,0x3f7080663f791298,0x3f7e13243f800000,0x3f6ed89e3f7853f8,0x3f7de0b13f800000,0x3f6d1c1d3f778bc5,0x3f7dabcc3f800000,0x3f6b4b0c3f76ba07,0x3f7d74743f800000,0x3f6965913f75dec6
.quad 0x3f7d3aac3f800000,0x3f676bd83f74fa0b,0x3f7cfe733f800000,0x3f655e0b3f740bdd,0x3f7cbfc93f800000,0x3f633c5a3f731447,0x3f7c7eb03f800000,0x3f6106f23f721352,0x3f7c3b283f800000,0x3f5ebe053f710908,0x3f7bf5313f800000,0x3f5c61c73f6ff573,0x3f7baccd3f800000,0x3f59f26a3f6ed89e,0x3f7b61fc3f800000,0x3f5770263f6db293
.quad 0x3f8000003f800000,0x3f8000003f800000,0x3f7fe1293f7fec43,0x3f7fc38f3f7fd397,0x3f7f84ab3f7fb10f,0x3f7f0e583f7f4e6d,0x3f7eea9d3f7f4e6d,0x3f7de0b13f7e70b0,0x3f7e13243f7ec46d,0x3f7c3b283f7d3aac,0x3f7cfe733f7e1324,0x3f7a1e843f7baccd,0x3f7baccd3f7d3aac,0x3f778bc53f79c79d,0x3f7a1e843f7c3b28,0x3f7484223f778bc5
.quad 0x3f7853f83f7b14be,0x3f7109083f74fa0b,0x3f764d973f79c79d,0x3f6d1c1d3f721352,0x3f740bdd3f7853f8,0x3f68bf3c3f6ed89e,0x3f718f573f76ba07,0x3f63f4733f6b4b0c,0x3f6ed89e3f74fa0b,0x3f5ebe053f676bd8,0x3f6be8583f731447,0x3f591e6a3f633c5a,0x3f68bf3c3f710908,0x3f5318493f5ebe05,0x3f655e0b3f6ed89e,0x3f4cae793f59f26a
.quad 0x3f61c5983f6c835e,0x3f45e4033f54db31,0x3f5df6be3f6a09a7,0x3f3ebc1b3f4f7a1f,0x3f59f26a3f676bd8,0x3f373a233f49d112,0x3f55b9933f64aa59,0x3f2f61a53f43e200,0x3f514d3d3f61c598,0x3f2736563f3daef9,0x3f4cae793f5ebe05,0x3f1ebc123f373a23,0x3f47de653f5b941a,0x3f15f6d93f3085bb,0x3f42de293f584853,0x3f0cead03f299415
.quad 0x3f3daef93f54db31,0x3f039c3d3f226799,0x3f3852163f514d3d,0x3ef41f073f1b02c6,0x3f32c8c93f4d9f02,0x3ee0924f3f13682a,0x3f2d14693f49d112,0x3ecc9b8b3f0b9a6b,0x3f2736563f45e403,0x3eb8442a3f039c3d,0x3f212ff93f41d870,0x3ea395c53ef6e0cb,0x3f1b02c63f3daef9,0x3e8e9a223ee63375,0x3f14b0393f396842,0x3e72b6513ed53641
.quad 0x0,0x0,0x3bc90f8800000000,0x3c96c9b63c490e90,0x3c490e9000000000,0x3d16c32c3cc90ab0,0x3c96c9b600000000,0x3d6214693d16c32c,0x3cc90ab000000000,0x3d96a9053d48fb30,0x3cfb49ba00000000,0x3dbc3ac33d7b2b74,0x3d16c32c00000000,0x3de1bc2e3d96a905,0x3d2fe00700000000,0x3e0395023dafb680
.quad 0x3d48fb3000000000,0x3e1640833dc8bd36,0x3d62146900000000,0x3e28defc3de1bc2e,0x3d7b2b7400000000,0x3e3b6ecf3dfab273,0x3d8a200a00000000,0x3e4dee603e09cf86,0x3d96a90500000000,0x3e605c133e164083,0x3da3308c00000000,0x3e72b6513e22abb6,0x3dafb68000000000,0x3e827dc03e2f10a2,0x3dbc3ac300000000,0x3e8b95073e3b6ecf
.quad 0x3dc8bd3600000000,0x3e94a0313e47c5c2,0x3dd53db900000000,0x3e9d9e783e541501,0x3de1bc2e00000000,0x3ea68f123e605c13,0x3dee387600000000,0x3eaf713a3e6c9a7f,0x3dfab27300000000,0x3eb8442a3e78cfcc,0x3e03950200000000,0x3ec1071e3e827dc0,0x3e09cf8600000000,0x3ec9b9533e888e93,0x3e1008b700000000,0x3ed25a093e8e9a22
.quad 0x3e16408300000000,0x3edae8803e94a031,0x3e1c76de00000000,0x3ee363fa3e9aa086,0x3e22abb600000000,0x3eebcbbb3ea09ae5,0x3e28defc00000000,0x3ef41f073ea68f12,0x3e2f10a200000000,0x3efc5d273eac7cd4,0x3e35409800000000,0x3f0242b13eb263ef,0x3e3b6ecf00000000,0x3f064b823eb8442a,0x3e419b3700000000,0x3f0a48ad3ebe1d4a
.quad 0x0,0x0,0x3cfb49ba3cc90ab0,0x3d2fe0073d16c32c,0x3d7b2b743d48fb30,0x3dafb6803d96a905,0x3dbc3ac33d96a905,0x3e0395023de1bc2e,0x3dfab2733dc8bd36,0x3e2f10a23e164083,0x3e1c76de3dfab273,0x3e5a39973e3b6ecf,0x3e3b6ecf3e164083,0x3e827dc03e605c13,0x3e5a39973e2f10a2,0x3e97a1173e827dc0
.quad 0x3e78cfcc3e47c5c2,0x3eac7cd43e94a031,0x3e8b95073e605c13,0x3ec1071e3ea68f12,0x3e9aa0863e78cfcc,0x3ed536413eb8442a,0x3ea986c43e888e93,0x3ee900b73ec9b953,0x3eb8442a3e94a031,0x3efc5d273edae880,0x3ec6d5293ea09ae5,0x3f07a1363eebcbbb,0x3ed536413eac7cd4,0x3f10d3cd3efc5d27,0x3ee363fa3eb8442a,0x3f19c2003f064b82
.quad 0x3ef15aea3ec3ef15,0x3f2267993f0e39da,0x3eff17b23ecf7bca,0x3f2ac0823f15f6d9,0x3f064b823edae880,0x3f32c8c93f1d7fd1,0x3f0cead03ee63375,0x3f3a7ca43f24d225,0x3f13682a3ef15aea,0x3f41d8703f2beb4a,0x3f19c2003efc5d27,0x3f48d8b33f32c8c9,0x3f1ff6cb3f039c3d,0x3f4f7a1f3f396842,0x3f26050a3f08f59b,0x3f55b9933f3fc767
.quad 0x3f2beb4a3f0e39da,0x3f5b941a3f45e403,0x3f31a81d3f13682a,0x3f6106f23f4bbbf8,0x3f373a233f187fc0,0x3f660f883f514d3d,0x3f3ca0033f1d7fd1,0x3f6aab7b3f5695e5,0x3f41d8703f226799,0x3f6ed89e3f5b941a,0x3f46e22a3f273656,0x3f7294f83f604621,0x3f4bbbf83f2beb4a,0x3f75dec63f64aa59,0x3f5064af3f3085bb,0x3f78b47b3f68bf3c
.quad 0x3f8000003f800000,0x3f8000003f800000,0x3f7f9c183f7fb10f,0x3f7f6ac73f7f84ab,0x3f7e70b03f7ec46d,0x3f7dabcc3f7e1324,0x3f7c7eb03f7d3aac,0x3f7ac5163f7baccd,0x3f79c79d3f7b14be,0x3f76ba073f7853f8,0x3f764d973f7853f8,0x3f718f573f740bdd,0x3f7213523f74fa0b,0x3f6b4b0c3f6ed89e,0x3f6d1c1d3f710908,0x3f63f4733f68bf3c
.quad 0x3f676bd83f6c835e,0x3f5b941a3f61c598,0x3f6106f23f676bd8,0x3f5233c63f59f26a,0x3f59f26a3f61c598,0x3f47de653f514d3d,0x3f5233c63f5b941a,0x3f3ca0033f47de65,0x3f49d1123f54db31,0x3f3085bb3f3daef9,0x3f40d0da3f4d9f02,0x3f239da93f32c8c9,0x3f373a233f45e403,0x3f15f6d93f273656,0x3f2d14693f3daef9,0x3f07a1363f1b02c6
.quad 0x3f2267993f3504f3,0x3ef15aea3f0e39da,0x3f173c073f2beb4a,0x3ed25a093f00e7e4,0x3f0b9a6b3f226799,0x3eb263ef3ee63375,0x3eff17b23f187fc0,0x3e919ddd3ec9b953,0x3ee633753f0e39da,0x3e605c133eac7cd4,0x3ecc9b8b3f039c3d,0x3e1c76de3e8e9a22,0x3eb263ef3ef15aea,0x3dafb6803e605c13,0x3e97a1173edae880,0x3c96c9b63e22abb6
.quad 0x3e78cfcc3ec3ef15,0xbd48fb303dc8bd36,0x3e419b373eac7cd4,0xbdee38763d16c32c,0x3e09cf863e94a031,0xbe3b6ecfbcc90ab0,0x3da3308c3e78cfcc,0xbe7ee6e1bdafb680,0x3cc90ab03e47c5c2,0xbea09ae5be164083,0xbcfb49ba3e164083,0xbec1071ebe541501,0xbdafb6803dc8bd36,0xbee0924fbe888e93,0xbe1008b73d48fb30,0xbeff17b2bea68f12
.quad 0x3f8000003f800000,0x3f8000003f800000,0x3f7f2f9d3f7f4e6d,0x3f7eea9d3f7f0e58,0x3f7cbfc93f7d3aac,0x3f7baccd3f7c3b28,0x3f78b47b3f79c79d,0x3f764d973f778bc5,0x3f7314473f74fa0b,0x3f6ed89e3f710908,0x3f6be8583f6ed89e,0x3f655e0b3f68bf3c,0x3f633c5a3f676bd8,0x3f59f26a3f5ebe05,0x3f591e6a3f5ebe05,0x3f4cae793f531849
.quad 0x3f4d9f023f54db31,0x3f3daef93f45e403,0x3f40d0da3f49d112,0x3f2d14693f373a23,0x3f32c8c93f3daef9,0x3f1b02c63f273656,0x3f239da93f3085bb,0x3f07a1363f15f6d9,0x3f13682a3f226799,0x3ee633753f039c3d,0x3f0242b13f13682a,0x3ebb31a03ee0924f,0x3ee0924f3f039c3d,0x3e8e9a223eb8442a,0x3ebb31a03ee63375,0x3e419b373e8e9a22
.quad 0x3e94a0313ec3ef15,0x3dc8bd363e47c5c2,0x3e5a39973ea09ae5,0x3bc90f883de1bc2e,0x3e09cf863e78cfcc,0xbdafb6803cc90ab0,0x3d6214693e2f10a2,0xbe354098bd7b2b74,0xbcc90ab03dc8bd36,0xbe888e93be164083,0xbdd53db93cc90ab0,0xbeb554ecbe6c9a7f,0xbe3b6ecfbd48fb30,0xbee0924fbea09ae5,0xbe8586cebdfab273,0xbf04f484bec9b953
.quad 0xbeac7cd4be47c5c2,0xbf187fc0bef15aea,0xbed25a09be888e93,0xbf2ac082bf0b9a6b,0xbef6e0cbbeac7cd4,0xbf3b8f3bbf1d7fd1,0xbf0cead0becf7bca,0xbf4ac77fbf2e3bde,0xbf1d7fd1bef15aea,0xbf584853bf3daef9,0xbf2d1469bf08f59b,0xbf63f473bf4bbbf8,0xbf3b8f3bbf187fc0,0xbf6db293bf584853,0xbf48d8b3bf273656,0xbf756d97bf633c5a
.quad 0x0,0x0,0x3d6214693d48fb30,0x3d8a200a3d7b2b74,0x3de1bc2e3dc8bd36,0x3e09cf863dfab273,0x3e28defc3e164083,0x3e4dee603e3b6ecf,0x3e605c133e47c5c2,0x3e888e933e78cfcc,0x3e8b95073e78cfcc,0x3ea986c43e9aa086,0x3ea68f123e94a031,0x3ec9b9533eb8442a,0x3ec1071e3eac7cd4,0x3ee900b73ed53641
.quad 0x3edae8803ec3ef15,0x3f039c3d3ef15aea,0x3ef41f073edae880,0x3f121eb03f064b82,0x3f064b823ef15aea,0x3f1ff6cb3f13682a,0x3f121eb03f039c3d,0x3f2d14693f1ff6cb,0x3f1d7fd13f0e39da,0x3f3968423f2beb4a,0x3f2866053f187fc0,0x3f44e3f53f373a23,0x3f32c8c93f226799,0x3f4f7a1f3f41d870,0x3f3ca0033f2beb4a,0x3f591e6a3f4bbbf8
.quad 0x3f45e4033f3504f3,0x3f61c5983f54db31,0x3f4e8d903f3daef9,0x3f6965913f5d2d53,0x3f5695e53f45e403,0x3f6ff5733f64aa59,0x3f5df6be3f4d9f02,0x3f756d973f6b4b0c,0x3f64aa593f54db31,0x3f79c79d3f710908,0x3f6aab7b3f5b941a,0x3f7cfe733f75dec6,0x3f6ff5733f61c598,0x3f7f0e583f79c79d,0x3f7484223f676bd8,0x3f7ff4e63f7cbfc9
.quad 0x3f7853f83f6c835e,0x3f7fb10f3f7ec46d,0x3f7b61fc3f710908,0x3f7e43233f7fd397,0x3f7dabcc3f74fa0b,0x3f7baccd3f7fec43,0x3f7f2f9d3f7853f8,0x3f77f1103f7f0e58,0x3f7fec433f7b14be,0x3f7314473f7d3aac,0x3f7fe1293f7d3aac,0x3f6d1c1d3f7a7302,0x3f7f0e583f7ec46d,0x3f660f883f76ba07,0x3f7d74743f7fb10f,0x3f5df6be3f721352
.quad 0x0,0x0,0x3da3308c3d96a905,0x3dbc3ac33dafb680,0x3e22abb63e164083,0x3e3b6ecf3e2f10a2,0x3e72b6513e605c13,0x3e8b95073e827dc0,0x3ea09ae53e94a031,0x3eb8442a3eac7cd4,0x3ec6d5293eb8442a,0x3ee363fa3ed53641,0x3eebcbbb3edae880,0x3f064b823efc5d27,0x3f07a1363efc5d27,0x3f19c2003f10d3cd
.quad 0x3f187fc03f0e39da,0x3f2beb4a3f226799,0x3f2866053f1d7fd1,0x3f3ca0033f32c8c9,0x3f373a233f2beb4a,0x3f4bbbf83f41d870,0x3f44e3f53f396842,0x3f591e6a3f4f7a1f,0x3f514d3d3f45e403,0x3f64aa593f5b941a,0x3f5c61c73f514d3d,0x3f6e46be3f660f88,0x3f660f883f5b941a,0x3f75dec63f6ed89e,0x3f6e46be3f64aa59,0x3f7b61fc3f75dec6
.quad 0x3f74fa0b3f6c835e,0x3f7ec46d3f7b14be,0x3f7a1e843f731447,0x3f7ffec43f7e70b0,0x3f7dabcc3f7853f8,0x3f7f0e583f7fec43,0x3f7f9c183f7c3b28,0x3f7bf5313f7f84ab,0x3f7fec433f7ec46d,0x3f76ba073f7d3aac,0x3f7e9bc93f7fec43,0x3f6f68303f791298,0x3f7baccd3f7fb10f,0x3f660f883f731447,0x3f7724173f7e1324,0x3f5ac4503f6b4b0c
.quad 0x3f7109083f7b14be,0x3f4d9f023f61c598,0x3f6965913f76ba07,0x3f3ebc1b3f5695e5,0x3f6046213f710908,0x3f2e3bde3f49d112,0x3f55b9933f6a09a7,0x3f1c420c3f3b8f3b,0x3f49d1123f61c598,0x3f08f59b3f2beb4a,0x3f3ca0033f584853,0x3ee900b73f1b02c6,0x3f2e3bde3f4d9f02,0x3ebe1d4a3f08f59b,0x3f1ebc123f41d870,0x3e919ddd3eebcbbb
.quad 0x3f8000003f800000,0x3f8000003f800000,0x3f7e9bc93f7ec46d,0x3f7e43233f7e70b0,0x3f7a73023f7b14be,0x3f7912983f79c79d,0x3f73913f3f74fa0b,0x3f7080663f721352,0x3f6a09a73f6c835e,0x3f64aa593f676bd8,0x3f5df6be3f61c598,0x3f55b9933f59f26a,0x3f4f7a1f3f54db31,0x3f43e2003f49d112,0x3f3ebc1b3f45e403,0x3f2f61a53f373a23
.quad 0x3f2beb4a3f3504f3,0x3f187fc03f226799,0x3f173c073f226799,0x3eff17b23f0b9a6b,0x3f00e7e43f0e39da,0x3ec9b9533ee63375,0x3ed25a093ef15aea,0x3e919ddd3eb263ef,0x3ea09ae53ec3ef15,0x3e2f10a23e78cfcc,0x3e5a39973e94a031,0x3d6214693e09cf86,0x3de1bc2e3e47c5c2,0xbd7b2b743cc90ab0,0x3bc90f883dc8bd36,0xbe354098bdafb680
.quad 0xbdc8bd36248d3132,0xbe94a031be47c5c2,0xbe4dee60bdc8bd36,0xbecc9b8bbe9aa086,0xbe9aa086be47c5c2,0xbf00e7e4becf7bca,0xbecc9b8bbe94a031,0xbf19c200bf00e7e4,0xbefc5d27bec3ef15,0xbf3085bbbf187fc0,0xbf14b039bef15aea,0xbf44e3f5bf2e3bde,0xbf299415bf0e39da,0xbf5695e5bf41d870,0xbf3ca003bf226799,0xbf655e0bbf531849
.quad 0xbf4d9f02bf3504f3,0xbf710908bf61c598,0xbf5c61c7bf45e403,0xbf796e4ebf6db293,0xbf68bf3cbf54db31,0xbf7e70b0bf76ba07,0xbf7294f8bf61c598,0xbf7ffec4bf7cbfc9,0xbf79c79dbf6c835e,0xbf7e1324bf7fb10f,0xbf7e4323bf74fa0b,0xbf78b47bbf7f84ab,0xbf7ffb11bf7b14be,0xbf6ff573bf7c3b28,0xbf7eea9dbf7ec46d,0xbf63f473bf75dec6
.quad 0x3f8000003f800000,0x3f8000003f800000,0x3f7de0b13f7e1324,0x3f7d74743f7dabcc,0x3f778bc53f7853f8,0x3f75dec63f76ba07,0x3f6d1c1d3f6ed89e,0x3f6965913f6b4b0c,0x3f5ebe053f61c598,0x3f5848533f5b941a,0x3f4cae793f514d3d,0x3f42de293f47de65,0x3f373a233f3daef9,0x3f2994153f3085bb,0x3f1ebc123f273656,0x3f0cead03f15f6d9
.quad 0x3f039c3d3f0e39da,0x3edae8803ef15aea,0x3ecc9b8b3ee63375,0x3e97a1173eb263ef,0x3e8e9a223eac7cd4,0x3e22abb63e605c13,0x3e1c76de3e605c13,0x3c96c9b63dafb680,0x3cc90ab03dc8bd36,0xbdfab273bd48fb30,0xbdd53db9bcc90ab0,0xbe8586cebe3b6ecf,0xbe6c9a7fbe164083,0xbec9b953bea09ae5,0xbeb554ecbe888e93,0xbf04f484bee0924f
.quad 0xbef15aeabec3ef15,0xbf226799bf0e39da,0xbf14b039befc5d27,0xbf3ca003bf299415,0xbf2e3bdebf187fc0,0xbf531849bf41d870,0xbf44e3f5bf3085bb,0xbf655e0bbf5695e5,0xbf584853bf45e403,0xbf731447bf676bd8,0xbf6816a8bf584853,0xbf7bf531bf740bdd,0xbf740bddbf676bd8,0xbf7fd397bf7c3b28,0xbf7bf531bf731447,0xbf7e9bc9bf7fd397
.quad 0xbf7fb10fbf7b14be,0xbf7853f8bf7ec46d,0xbf7f2f9dbf7f4e6d,0xbf6d1c1dbf791298,0xbf7a7302bf7fb10f,0xbf5d2d53bf6ed89e,0xbf718f57bf7c3b28,0xbf48d8b3bf604621,0xbf64aa59bf74fa0b,0xbf3085bbbf4d9f02,0xbf53fac3bf6a09a7,0xbf14b039bf373a23,0xbf3fc767bf5b941a,0xbeebcbbbbf1d7fd1,0xbf286605bf49d112,0xbea986c4bf00e7e4
.quad 0x0,0x0,0x3dd53db93dc8bd36,0x3dee38763de1bc2e,0x3e5415013e47c5c2,0x3e6c9a7f3e605c13,0x3e9d9e783e94a031,0x3eaf713a3ea68f12,0x3ecf7bca3ec3ef15,0x3ee633753edae880,0x3eff17b23ef15aea,0x3f0cead03f064b82,0x3f15f6d93f0e39da,0x3f24d2253f1d7fd1,0x3f2ac0823f226799,0x3f3a7ca43f32c8c9
.quad 0x3f3daef93f3504f3,0x3f4d9f023f45e403,0x3f4e8d903f45e403,0x3f5df6be3f5695e5,0x3f5d2d533f54db31,0x3f6b4b0c3f64aa59,0x3f6965913f61c598,0x3f756d973f6ff573,0x3f7314473f6c835e,0x3f7c3b283f7853f8,0x3f7a1e843f74fa0b,0x3f7f9c183f7dabcc,0x3f7e70b03f7b14be,0x3f7f84ab3f7fec43,0x3f7ffec43f7ec46d,0x3f7bf5313f7f0e58
.quad 0x3f7ec46d3f800000,0x3f74fa0b3f7b14be,0x3f7ac5163f7ec46d,0x3f6aab7b3f740bdd,0x3f740bdd3f7b14be,0x3f5d2d533f6a09a7,0x3f6aab7b3f74fa0b,0x3f4cae793f5d2d53,0x3f5ebe053f6c835e,0x3f3968423f4d9f02,0x3f5064af3f61c598,0x3f239da93f3b8f3b,0x3f3fc7673f54db31,0x3f0b9a6b3f273656,0x3f2d14693f45e403,0x3ee363fa3f10d3cd
.quad 0x3f187fc03f3504f3,0x3eac7cd43ef15aea,0x3f0242b13f226799,0x3e667c663ebe1d4a,0x3ed536413f0e39da,0x3de1bc2e3e888e93,0x3ea395c53ef15aea,0xbbc90f883e22abb6,0x3e605c133ec3ef15,0xbdfab2733d48fb30,0x3dee38763e94a031,0xbe72b651bd7b2b74,0x3c490e903e47c5c2,0xbeb263efbe2f10a2,0xbdbc3ac33dc8bd36,0xbee900b7be8e9a22
.quad 0x0,0x0,0x3e0395023dfab273,0x3e1008b73e09cf86,0x3e827dc03e78cfcc,0x3e8e9a223e888e93,0x3ec1071e3eb8442a,0x3ed25a093ec9b953,0x3efc5d273ef15aea,0x3f08f59b3f039c3d,0x3f19c2003f13682a,0x3f26050a3f1ff6cb,0x3f32c8c93f2beb4a,0x3f3fc7673f396842,0x3f48d8b33f41d870,0x3f55b9933f4f7a1f
.quad 0x3f5b941a3f54db31,0x3f676bd83f61c598,0x3f6aab7b3f64aa59,0x3f7484223f6ff573,0x3f75dec63f710908,0x3f7cbfc93f79c79d,0x3f7cfe733f79c79d,0x3f7ff4e63f7f0e58,0x3f7fec433f7ec46d,0x3f7e13243f7fb10f,0x3f7e9bc93f7fec43,0x3f7724173f7baccd,0x3f7912983f7d3aac,0x3f6b4b0c3f731447,0x3f6f68303f76ba07,0x3f5ac4503f660f88
.quad 0x3f61c5983f6c835e,0x3f45e4033f54db31,0x3f5064af3f5ebe05,0x3f2d14693f3fc767,0x3f3b8f3b3f4d9f02,0x3f10d3cd3f273656,0x3f239da93f396842,0x3ee363fa3f0b9a6b,0x3f08f59b3f226799,0x3ea09ae53edae880,0x3ed8106b3f08f59b,0x3e3540983e9aa086,0x3e9aa0863edae880,0x3d16c32c3e2f10a2,0x3e3540983ea09ae5,0xbdd53db93d16c32c
.quad 0x3d48fb303e47c5c2,0xbe78cfccbdc8bd36,0xbda3308c3d96a905,0xbec1071ebe6c9a7f,0xbe541501bd48fb30,0xbf00e7e4beb8442a,0xbea986c4be2f10a2,0xbf1ebc12bef6e0cb,0xbee63375be94a031,0xbf396842bf187fc0,0xbf0f8784becf7bca,0xbf5064afbf32c8c9,0xbf299415bf039c3d,0xbf633c5abf49d112,0xbf40d0dabf1d7fd1,0xbf718f57bf5d2d53
.quad 0x3f8000003f800000,0x3f8000003f800000,0x3f7cfe733f7d3aac,0x3f7c7eb03f7cbfc9,0x3f740bdd3f74fa0b,0x3f7213523f731447,0x3f655e0b3f676bd8,0x3f6106f23f633c5a,0x3f514d3d3f54db31,0x3f49d1123f4d9f02,0x3f3852163f3daef9,0x3f2d14693f32c8c9,0x3f1b02c63f226799,0x3f0b9a6b3f13682a,0x3ef41f073f039c3d,0x3ecc9b8b3ee0924f
.quad 0x3eac7cd43ec3ef15,0x3e78cfcc3e94a031,0x3e419b373e78cfcc,0x3da3308c3e09cf86,0x3d16c32c3dc8bd36,0xbdafb680bcc90ab0,0xbdee3876bd48fb30,0xbe7ee6e1be3b6ecf,0xbe888e93be47c5c2,0xbecf7bcabeac7cd4,0xbed25a09beac7cd4,0xbf0cead0bef6e0cb,0xbf0b9a6bbef15aea,0xbf2e3bdebf1d7fd1,0xbf2ac082bf187fc0,0xbf4ac77fbf3b8f3b
.quad 0xbf45e403bf3504f3,0xbf61c598bf54db31,0xbf5c61c7bf4d9f02,0xbf7294f8bf68bf3c,0xbf6db293bf61c598,0xbf7cbfc9bf76ba07,0xbf796e4ebf710908,0xbf7ffec4bf7e70b0,0xbf7f4e6dbf7b14be,0xbf7c3b28bf7fb10f,0xbf7f2f9dbf7fb10f,0xbf718f57bf7a7302,0xbf791298bf7ec46d,0xbf604621bf6ed89e,0xbf6d1c1dbf7853f8,0xbf48d8b3bf5d2d53
.quad 0xbf5b941abf6c835e,0xbf2beb4abf45e403,0xbf44e3f5bf5b941a,0xbf0a48adbf299415,0xbf299415bf45e403,0xbec9b953bf08f59b,0xbf0a48adbf2beb4a,0xbe72b651bec9b953,0xbecf7bcabf0e39da,0xbd96a905be78cfcc,0xbe8586cebedae880,0x3dbc3ac3bdafb680,0xbde1bc2ebe94a031,0x3e827dc03d96a905,0x3d2fe007be164083,0x3ed25a093e6c9a7f
.quad 0x3f8000003f800000,0x3f8000003f800000,0x3f7bf5313f7c3b28,0x3f7b61fc3f7baccd,0x3f6ff5733f710908,0x3f6db2933f6ed89e,0x3f5c61c73f5ebe05,0x3f5770263f59f26a,0x3f41d8703f45e403,0x3f3968423f3daef9,0x3f212ff93f273656,0x3f14b0393f1b02c6,0x3ef6e0cb3f039c3d,0x3ed536413ee63375,0x3ea395c53eb8442a,0x3e72b6513e8e9a22
.quad 0x3e1640833e47c5c2,0x3d48fb303dc8bd36,0xbcfb49ba3cc90ab0,0xbe1008b7bdafb680,0xbe541501be164083,0xbea68f12be888e93,0xbec1071ebea09ae5,0xbeff17b2bee0924f,0xbf08f59bbef15aea,0xbf273656bf187fc0,0xbf2d1469bf1d7fd1,0xbf48d8b3bf3b8f3b,0xbf4bbbf8bf3daef9,0xbf633c5abf584853,0xbf63f473bf584853,0xbf756d97bf6db293
.quad 0xbf74fa0bbf6c835e,0xbf7ec46dbf7b14be,0xbf7e4323bf79c79d,0xbf7eea9dbf7ffb11,0xbf7f84abbf7fb10f,0xbf75dec6bf7c3b28,0xbf78b47bbf7e1324,0xbf63f473bf6ff573,0xbf6a09a7bf74fa0b,0xbf49d112bf5b941a,0xbf53fac3bf64aa59,0xbf286605bf3fc767,0xbf373a23bf4d9f02,0xbf00e7e4bf1d7fd1,0xbf14b039bf3085bb,0xbea986c4beebcbbb
.quad 0xbedae880bf0e39da,0xbe164083be94a031,0xbe8586cebecf7bca,0x3d2fe007bde1bc2e,0xbdafb680be78cfcc,0x3e6c9a7f3d96a905,0x3dbc3ac3bd96a905,0x3ed25a093e827dc0,0x3e888e933dc8bd36,0x3f13682a3edae880,0x3eddbe793e888e93,0x3f3852163f15f6d9,0x3f15f6d93edae880,0x3f5695e53f396842,0x3f3852163f13682a,0x3f6d1c1d3f5695e5
.quad 0x0,0x0,0x3e1c76de3e164083,0x3e28defc3e22abb6,0x3e9aa0863e94a031,0x3ea68f123ea09ae5,0x3ee363fa3edae880,0x3ef41f073eebcbbb,0x3f13682a3f0e39da,0x3f1d7fd13f187fc0,0x3f31a81d3f2beb4a,0x3f3ca0033f373a23,0x3f4bbbf83f45e403,0x3f5695e53f514d3d,0x3f6106f23f5b941a,0x3f6aab7b3f660f88
.quad 0x3f7109083f6c835e,0x3f7853f83f74fa0b,0x3f7b61fc3f7853f8,0x3f7f2f9d3f7dabcc,0x3f7fd3973f7ec46d,0x3f7f0e583f7fec43,0x3f7e43233f7fb10f,0x3f77f1103f7baccd,0x3f76ba073f7b14be,0x3f6a09a73f710908,0x3f6965913f710908,0x3f55b9933f604621,0x3f5695e53f61c598,0x3f3b8f3b3f49d112,0x3f3ebc1b3f4d9f02,0x3f1c420c3f2e3bde
.quad 0x3f2267993f3504f3,0x3ef15aea3f0e39da,0x3f0242b13f187fc0,0x3ea395c53ed53641,0x3ebe1d4a3ef15aea,0x3e22abb63e888e93,0x3e667c663eac7cd4,0xbbc90f883de1bc2e,0x3d96a9053e47c5c2,0xbe2f10a2bd48fb30,0xbda3308c3d48fb30,0xbea986c4be541501,0xbe6c9a7fbdc8bd36,0xbef6e0cbbeb8442a,0xbec1071ebe78cfcc,0xbf1ebc12bf00e7e4
.quad 0xbf039c3dbec3ef15,0xbf3daef9bf226799,0xbf239da9bf039c3d,0xbf577026bf3fc767,0xbf3fc767bf226799,0xbf6b4b0cbf584853,0xbf577026bf3daef9,0xbf78b47bbf6b4b0c,0xbf6a09a7bf54db31,0xbf7f4e6dbf7853f8,0xbf772417bf676bd8,0xbf7eea9dbf7f0e58,0xbf7e70b0bf74fa0b,0xbf778bc5bf7f4e6d,0xbf7fc38fbf7d3aac,0xbf696591bf791298
.quad 0x0,0x0,0x3e3540983e2f10a2,0x3e419b373e3b6ecf,0x3eb263ef3eac7cd4,0x3ebe1d4a3eb8442a,0x3f0242b13efc5d27,0x3f0a48ad3f064b82,0x3f2736563f226799,0x3f3085bb3f2beb4a,0x3f46e22a3f41d870,0x3f5064af3f4bbbf8,0x3f6046213f5b941a,0x3f68bf3c3f64aa59,0x3f7294f83f6ed89e,0x3f78b47b3f75dec6
.quad 0x3f7d3aac3f7b14be,0x3f7fb10f3f7ec46d,0x3f7fe1293f7fec43,0x3f7d74743f7f0e58,0x3f7a73023f7d3aac,0x3f7213523f76ba07,0x3f6d1c1d3f731447,0x3f5df6be3f660f88,0x3f5848533f61c598,0x3f41d8703f4d9f02,0x3f3ca0033f49d112,0x3f1ebc123f2e3bde,0x3f1b02c63f2beb4a,0x3eebcbbb3f08f59b,0x3ee900b73f08f59b,0x3e919ddd3ebe1d4a
.quad 0x3e94a0313ec3ef15,0x3dc8bd363e47c5c2,0x3dee38763e605c13,0xbdbc3ac33c490e90,0xbd7b2b743d48fb30,0xbe8e9a22be2f10a2,0xbe72b651bdfab273,0xbee900b7beb263ef,0xbecf7bcabe94a031,0xbf1d7fd1bf039c3d,0xbf0f8784bee63375,0xbf40d0dabf299415,0xbf32c8c9bf187fc0,0xbf5d2d53bf49d112,0xbf5064afbf396842,0xbf718f57bf633c5a
.quad 0xbf676bd8bf54db31,0xbf7d3aacbf74fa0b,0xbf772417bf6a09a7,0xbf7fc38fbf7e70b0,0xbf7f0e58bf7853f8,0xbf791298bf7f4e6d,0xbf7eea9dbf7f4e6d,0xbf696591bf778bc5,0xbf76ba07bf7ec46d,0xbf514d3dbf676bd8,0xbf66beccbf76ba07,0xbf31a81dbf4f7a1f,0xbf4f7a1fbf676bd8,0xbf0b9a6bbf3085bb,0xbf31a81dbf514d3d,0xbec1071ebf0b9a6b
.quad 0x3f8000003f800000,0x3f8000003f800000,0x3f7ffd393f7fffb1,0x3f7ff0e33f7ff84a,0x3f7ff4e63f7ffec4,0x3f7fc38f3f7fe129,0x3f7fe7053f7ffd39,0x3f7f78083f7fba9e,0x3f7fd3973f7ffb11,0x3f7f0e583f7f84ab,0x3f7fba9e3f7ff84a,0x3f7e868b3f7f3f54,0x3f7f9c183f7ff4e6,0x3f7de0b13f7eea9d,0x3f7f78083f7ff0e3,0x3f7d1cdd3f7e868b
.quad 0x3f7f4e6d3f7fec43,0x3f7c3b283f7e1324,0x3f7f1f493f7fe705,0x3f7b3bab3f7d906e,0x3f7eea9d3f7fe129,0x3f7a1e843f7cfe73,0x3f7eb0693f7fdaaf,0x3f78e3d63f7c5d3a,0x3f7e70b03f7fd397,0x3f778bc53f7baccd,0x3f7e2b723f7fcbe2,0x3f76167a3f7aed37,0x3f7de0b13f7fc38f,0x3f7484223f7a1e84,0x3f7d906e3f7fba9e,0x3f72d4eb3f7940c0
.quad 0x3f7d3aac3f7fb10f,0x3f7109083f7853f8,0x3f7cdf6c3f7fa6e3,0x3f6f20b03f77583a,0x3f7c7eb03f7f9c18,0x3f6d1c1d3f764d97,0x3f7c187a3f7f90b1,0x3f6afb8c3f75341d,0x3f7baccd3f7f84ab,0x3f68bf3c3f740bdd,0x3f7b3bab3f7f7808,0x3f6667713f72d4eb,0x3f7ac5163f7f6ac7,0x3f63f4733f718f57,0x3f7a49103f7f5ce9,0x3f61668a3f703b37
.quad 0x3f79c79d3f7f4e6d,0x3f5ebe053f6ed89e,0x3f7940c03f7f3f54,0x3f5bfb343f6d67a1,0x3f78b47b3f7f2f9d,0x3f591e6a3f6be858,0x3f7822d13f7f1f49,0x3f5627fe3f6a5ad9,0x3f778bc53f7f0e58,0x3f5318493f68bf3c,0x3f76ef5b3f7efcc9,0x3f4fefa83f671599,0x3f764d973f7eea9d,0x3f4cae793f655e0b,0x3f75a67b3f7ed7d4,0x3f4955213f6398ac
.quad 0x3f8000003f800000,0x3f8000003f800000,0x3f7fdaaf3f7fe705,0x3f7fba9e3f7fcbe2,0x3f7f6ac73f7f9c18,0x3f7eea9d3f7f2f9d,0x3f7eb0693f7f1f49,0x3f7d906e3f7e2b72,0x3f7dabcc3f7e70b0,0x3f7baccd3f7cbfc9,0x3f7c5d3a3f7d906e,0x3f7940c03f7aed37,0x3f7ac5163f7c7eb0,0x3f764d973f78b47b,0x3f78e3d63f7b3bab,0x3f72d4eb3f76167a
.quad 0x3f76ba073f79c79d,0x3f6ed89e3f731447,0x3f74484b3f7822d1,0x3f6a5ad93f6faf1b,0x3f718f573f764d97,0x3f655e0b3f6be858,0x3f6e8ff83f74484b,0x3f5fe4e93f67c187,0x3f6b4b0c3f721352,0x3f59f26a3f633c5a,0x3f67c1873f6faf1b,0x3f5389c73f5e5aa6,0x3f63f4733f6d1c1d,0x3f4cae793f591e6a,0x3f5fe4e93f6a5ad9,0x3f4564393f5389c7
.quad 0x3f5b941a3f676bd8,0x3f3daef93f4d9f02,0x3f5703483f644fac,0x3f3592e73f476085,0x3f5233c63f6106f2,0x3f2d14693f40d0da,0x3f4d26fd3f5d924d,0x3f24381a3f39f2ac,0x3f47de653f59f26a,0x3f1b02c63f32c8c9,0x3f425b893f5627fe,0x3f11796b3f2b561b,0x3f3ca0033f5233c6,0x3f07a1363f239da9,0x3f36ad7f3f4e1689,0x3efafef73f1ba299
.quad 0x3f3085bb3f49d112,0x3ee633753f13682a,0x3f2a2a803f456439,0x3ed0eb2a3f0af1b7,0x3f239da93f40d0da,0x3ebb31a03f0242b1,0x3f1ce11f3f3c17d9,0x3ea5129f3ef2bd43,0x3f15f6d93f373a23,0x3e8e9a223ee0924f,0x3f0ee0db3f3238aa,0x3e6fa8b23ece0bea,0x3f07a1363f2d1469,0x3e419b373ebb31a0,0x3f003a063f27ce61,0x3e1324ca3ea80b1f
.quad 0x0,0x0,0x3c16cb583b490fc6,0x3cafea693c7b514b,0x3c96c9b63bc90f88,0x3d2fe0073cfb49ba,0x3ce22a7a3c16cb58,0x3d83db0a3d3c6dd5,0x3d16c32c3c490e90,0x3dafb6803d7b2b74,0x3d3c6dd53c7b514b,0x3ddb7d373d9cecf9,0x3d6214693c96c9b6,0x3e0395023dbc3ac3,0x3d83db0a3cafea69,0x3e195be03ddb7d37
.quad 0x3d96a9053cc90ab0,0x3e2f10a23dfab273,0x3da973ba3ce22a7a,0x3e44b0b93e0cec4a,0x3dbc3ac33cfb49ba,0x3e5a39973e1c76de,0x3dcefdb73d0a342f,0x3e6fa8b23e2bf804,0x3de1bc2e3d16c32c,0x3e827dc03e3b6ecf,0x3df475c03d2351cb,0x3e8d17c03e4ada4f,0x3e0395023d2fe007,0x3e97a1173e5a3997,0x3e0cec4a3d3c6dd5,0x3ea218873e698bba
.quad 0x3e1640833d48fb30,0x3eac7cd43e78cfcc,0x3e1f917b3d55880e,0x3eb6ccc33e840270,0x3e28defc3d621469,0x3ec1071e3e8b9507,0x3e3228d43d6ea038,0x3ecb2aae3e931f35,0x3e3b6ecf3d7b2b74,0x3ed536413e9aa086,0x3e44b0b93d83db0a,0x3edf28a93ea21887,0x3e4dee603d8a200a,0x3ee900b73ea986c4,0x3e57278f3d9064b4,0x3ef2bd433eb0eacb
.quad 0x3e605c133d96a905,0x3efc5d273eb8442a,0x3e698bba3d9cecf9,0x3f02ef9f3ebf926f,0x3e72b6513da3308c,0x3f07a1363ec6d529,0x3e7bdba43da973ba,0x3f0c42c93ece0bea,0x3e827dc03dafb680,0x3f10d3cd3ed53641,0x3e870ada3db5f8da,0x3f1553b73edc53c1,0x3e8b95073dbc3ac3,0x3f19c2003ee363fa,0x3e901c2c3dc27c39,0x3f1e1e223eea6681
.quad 0x0,0x0,0x3d0a342f3ce22a7a,0x3d3c6dd53d2351cb,0x3d8a200a3d621469,0x3dbc3ac33da3308c,0x3dcefdb73da973ba,0x3e0cec4a3df475c0,0x3e09cf863de1bc2e,0x3e3b6ecf3e22abb6,0x3e2bf8043e0cec4a,0x3e698bba3e4ada4f,0x3e4dee603e28defc,0x3e8b95073e72b651,0x3e6fa8b23e44b0b9,0x3ea218873e8d17c0
.quad 0x3e888e933e605c13,0x3eb8442a3ea09ae5,0x3e9920fe3e7bdba4,0x3ece0bea3eb3dca5,0x3ea986c43e8b9507,0x3ee363fa3ec6d529,0x3eb9bb1e3e9920fe,0x3ef840c83ed97cb9,0x3ec9b9533ea68f12,0x3f064b823eebcbbb,0x3ed97cb93eb3dca5,0x3f102dd53efdbabb,0x3ee900b73ec1071e,0x3f19c2003f07a136,0x3ef840c83ece0bea,0x3f2302d33f102dd5
.quad 0x3f039c3d3edae880,0x3f2beb4a3f187fc0,0x3f0af1b73ee79a5d,0x3f34768f3f209393,0x3f121eb03ef41f07,0x3f3ca0033f286605,0x3f19210f3f003a06,0x3f4463373f2ff3e6,0x3f1ff6cb3f064b82,0x3f4bbbf83f373a23,0x3f269de33f0c42c9,0x3f52a6493f3e35c5,0x3f2d14693f121eb0,0x3f591e6a3f44e3f5,0x3f33587a3f17de12,0x3f5f20db3f4b41fa
.quad 0x3f3968423f1d7fd1,0x3f64aa593f514d3d,0x3f3f41fc3f2302d3,0x3f69b7e43f570348,0x3f44e3f53f286605,0x3f6e46be3f5c61c7,0x3f4a4c873f2da859,0x3f7254703f61668a,0x3f4f7a1f3f32c8c9,0x3f75dec63f660f88,0x3f546b3b3f37c655,0x3f78e3d63f6a5ad9,0x3f591e6a3f3ca003,0x3f7b61fc3f6e46be,0x3f5d924d3f4154e1,0x3f7d57de3f71d19f
.quad 0x3f8000003f800000,0x3f8000003f800000,0x3f7f90b13f7fa6e3,0x3f7f5ce93f7f7808,0x3f7e43233f7e9bc9,0x3f7d74743f7de0b1,0x3f7c187a3f7cdf6c,0x3f7a49103f7b3bab,0x3f7912983f7a7302,0x3f75dec63f778bc5,0x3f75341d3f77583a,0x3f703b373f72d4eb,0x3f7080663f73913f,0x3f6965913f6d1c1d,0x3f6afb8c3f6f20b0,0x3f61668a3f666771
.quad 0x3f64aa593f6a09a7,0x3f5848533f5ebe05,0x3f5d924d3f644fac,0x3f4e16893f5627fe,0x3f55b9933f5df6be,0x3f42de293f4cae79,0x3f4d26fd3f570348,0x3f36ad7f3f425b89,0x3f43e2003f4f7a1f,0x3f2994153f373a23,0x3f39f2ac3f476085,0x3f1ba2993f2b561b,0x3f2f61a53f3ebc1b,0x3f0cead03f1ebc12,0x3f24381a3f3592e7,0x3efafef73f11796b
.quad 0x3f187fc03f2beb4a,0x3edae8803f039c3d,0x3f0c42c93f21cbfb,0x3eb9bb1e3eea6681,0x3eff17b23f173c07,0x3e97a1173ecc9b8b,0x3ee4cbfe3f0c42c9,0x3e698bba3eadf73c,0x3ec9b9533f00e7e4,0x3e22abb63e8e9a22,0x3eadf73c3eea6681,0x3db5f8da3e5d4b1a,0x3e919ddd3ed25a09,0x3c96c9b63e1c76de,0x3e698bba3eb9bb1e,0xbd55880e3db5f8da
.quad 0x3e2f10a23ea09ae5,0xbdfab2733cc90ab0,0x3de7fa9a3e870ada,0xbe44b0b9bd2351cb,0x3d6214693e5a3997,0xbe8586cebdd53db9,0xbb490fc63e25c58c,0xbea80b1fbe2bf804,0xbd7b2b743de1bc2e,0xbec9b953be6c9a7f,0xbdf475c03d6ea038,0xbeea6681be9620d2,0xbe3540983bc90f88,0xbf04f484beb554ec,0xbe6fa8b2bd3c6dd5,0xbf140c5fbed3c867
.quad 0x3f8000003f800000,0x3f8000003f800000,0x3f7f1f493f7f3f54,0x3f7ed7d43f7efcc9,0x3f7c7eb03f7cfe73,0x3f7b61fc3f7bf531,0x3f7822d13f7940c0,0x3f75a67b3f76ef5b,0x3f7213523f740bdd,0x3f6db2933f6ff573,0x3f6a5ad93f6d67a1,0x3f6398ac3f671599,0x3f6106f23f655e0b,0x3f5770263f5c61c7,0x3f5627fe3f5bfb34,0x3f4955213f4fefa8
.quad 0x3f49d1123f514d3d,0x3f3968423f41d870,0x3f3c17d93f456439,0x3f27ce613f3238aa,0x3f2d14693f385216,0x3f14b0393f212ff9,0x3f1ce11f3f2a2a80,0x3f003a063f0ee0db,0x3f0b9a6b3f1b02c6,0x3ed536413ef6e0cb,0x3ef2bd433f0af1b7,0x3ea80b1f3ece0bea,0x3ecc9b8b3ef41f07,0x3e72b6513ea395c5,0x3ea5129f3ed0eb2a,0x3e1324ca3e6fa8b2
.quad 0x3e78cfcc3eac7cd4,0x3d48fb303e164083,0x3e25c58c3e870ada,0xbd3c6dd53d6ea038,0x3da3308c3e419b37,0xbe1008b7bcfb49ba,0xbb490fc63de7fa9a,0xbe6fa8b2bdf475c0,0xbdafb6803d16c32c,0xbea68f12be541501,0xbe2bf804bd2351cb,0xbed3c867be9620d2,0xbe7ee6e1bdee3876,0xbeff17b2bec1071e,0xbea80b1fbe44b0b9,0xbf140c5fbeea6681
.quad 0xbecf7bcabe888e93,0xbf273656bf08f59b,0xbef58035beadf73c,0xbf38dd65bf1ba299,0xbf0cead0bed25a09,0xbf48d8b3bf2d1469,0xbf1e1e22bef58035,0xbf570348bf3d27b8,0xbf2e3bdebf0b9a6b,0xbf633c5abf4bbbf8,0xbf3d27b8bf1ba299,0xbf6d67a1bf58b3a1,0xbf4ac77fbf2ac082,0xbf756d97bf63f473,0xbf570348bf38dd65,0xbf7b3babbf6d67a1
.quad 0x0,0x0,0x3d6ea0383d55880e,0x3d9064b43d83db0a,0x3dee38763dd53db9,0x3e1008b73e039502,0x3e3228d43e1f917b,0x3e57278f3e44b0b9,0x3e6c9a7f3e541501,0x3e8e9a223e827dc0,0x3e931f353e840270,0x3eb0eacb3ea21887,0x3eaf713a3e9d9e78,0x3ed25a093ec1071e,0x3ecb2aae3eb6ccc3,0x3ef2bd433edf28a9
.quad 0x3ee633753ecf7bca,0x3f08f59b3efc5d27,0x3f003a063ee79a5d,0x3f17de123f0c42c9,0x3f0cead03eff17b2,0x3f26050a3f19c200,0x3f19210f3f0af1b7,0x3f33587a3f269de3,0x3f24d2253f15f6d9,0x3f3fc7673f32c8c9,0x3f2ff3e63f209393,0x3f4b41fa3f3e35c5,0x3f3a7ca43f2ac082,0x3f55b9933f48d8b3,0x3f4463373f34768f,0x3f5f20db3f52a649
.quad 0x3f4d9f023f3daef9,0x3f676bd83f5b941a,0x3f5627fe3f466354,0x3f6e8ff83f6398ac,0x3f5df6be3f4e8d90,0x3f7484223f6aab7b,0x3f6504793f5627fe,0x3f7940c03f70c501,0x3f6b4b0c3f5d2d53,0x3f7cbfc93f75dec6,0x3f70c5013f6398ac,0x3f7efcc93f79f35e,0x3f756d973f696591,0x3f7ff4e63f7cfe73,0x3f7940c03f6e8ff8,0x3f7fa6e33f7efcc9
.quad 0x3f7c3b283f731447,0x3f7e13243f7fec43,0x3f7e5a383f76ef5b,0x3f7b3bab3f7fcbe2,0x3f7f9c183f7a1e84,0x3f7724173f7e9bc9,0x3f7fffb13f7c9f8a,0x3f71d19f3f7c5d3a,0x3f7f84ab3f7e70b0,0x3f6b4b0c3f791298,0x3f7e2b723f7f90b1,0x3f6398ac3f74bf62,0x3f7bf5313f7ffec4,0x3f5ac4503f6f6830,0x3f78e3d63f7fba9e,0x3f50d9373f6912ae
.quad 0x0,0x0,0x3da973ba3d9cecf9,0x3dc27c393db5f8da,0x3e28defc3e1c76de,0x3e419b373e354098,0x3e7bdba43e698bba,0x3e901c2c3e870ada,0x3ea68f123e9aa086,0x3ebe1d4a3eb263ef,0x3ece0bea3ebf926f,0x3eea66813edc53c1,0x3ef41f073ee363fa,0x3f0a48ad3f0242b1,0x3f0c42c93f02ef9f,0x3f1e1e223f1553b7
.quad 0x3f1d7fd13f13682a,0x3f3085bb3f273656,0x3f2da8593f2302d3,0x3f4154e13f37c655,0x3f3ca0033f31a81d,0x3f5064af3f46e22a,0x3f4a4c873f3f41fc,0x3f5d924d3f546b3b,0x3f5695e53f4bbbf8,0x3f68bf3c3f604621,0x3f61668a3f570348,0x3f71d19f3f6a5ad9,0x3f6aab7b3f6106f2,0x3f78b47b3f7294f8,0x3f7254703f69b7e4,0x3f7d57de3f78e3d6
.quad 0x3f7853f83f710908,0x3f7fb10f3f7d3aac,0x3f7c9f8a3f76ef5b,0x3f7fba9e3f7f90b1,0x3f7f2f9d3f7b61fc,0x3f7d74743f7fe129,0x3f7fffb13f7e5a38,0x3f78e3d63f7e2b72,0x3f7f0e583f7fd397,0x3f7213523f7a7302,0x3f7c5d3a3f7fcbe2,0x3f6912ae3f74bf62,0x3f77f1103f7e4323,0x3f5df6be3f6d1c1d,0x3f71d19f3f7b3bab,0x3f50d9373f6398ac
.quad 0x3f6a09a73f76ba07,0x3f41d8703f584853,0x3f60a6cf3f70c501,0x3f3117223f4b41fa,0x3f55b9933f696591,0x3f1ebc123f3ca003,0x3f4955213f60a6cf,0x3f0af1b73f2c800f,0x3f3b8f3b3f5695e5,0x3eebcbbb3f1b02c6,0x3f2c800f3f4b41fa,0x3ebf926f3f084b92,0x3f1c420c3f3ebc1b,0x3e919ddd3ee900b7,0x3f0af1b73f311722,0x3e44b0b93ebf926f
.quad 0x3f8000003f800000,0x3f8000003f800000,0x3f7e868b3f7eb069,0x3f7e2b723f7e5a38,0x3f7a1e843f7ac516,0x3f78b47b3f796e4e,0x3f72d4eb3f74484b,0x3f6faf1b3f714c7a,0x3f68bf3c3f6b4b0c,0x3f633c5a3f660f88,0x3f5bfb343f5fe4e9,0x3f5389c73f57dc7f,0x3f4cae793f5233c6,0x3f40d0da3f46e22a,0x3f3b06293f425b89,0x3f2b561b3f33587a
.quad 0x3f2736563f3085bb,0x3f13682a3f1d7fd1,0x3f11796b3f1ce11f,0x3ef2bd433f05a02c,0x3ef41f073f07a136,0x3ebb31a03ed8106b,0x3ec27b553ee1fb6a,0x3e80f8c03ea21887,0x3e8e9a223eb263ef,0x3e09cf863e541501,0x3e3228d43e80f8c0,0x3c7b514b3dc27c39,0x3d8a200a3e1c76de,0xbdd53db9bc96c9b6,0xbd2351cb3d55880e,0xbe636c83be06b26e
.quad 0xbe164083bd48fb30,0xbeac7cd4be78cfcc,0xbe80f8c0be195be0,0xbee4cbfebeb3dca5,0xbeb554ecbe7ee6e1,0xbf0cead0bee900b7,0xbee79a5dbeb0eacb,0xbf256bcbbf0d9281,0xbf0b9a6bbee0924f,0xbf3b8f3bbf24d225,0xbf21cbfbbf06f686,0xbf4f0417bf39f2ac,0xbf36206cbf1c420c,0xbf5f8327bf4cae79,0xbf485bcabf2ff3e6,0xbf6cd007bf5cc7d1
.quad 0xbf584853bf41d870,0xbf76ba07bf6a09a7,0xbf65b710bf51c0c2,0xbf7d1cddbf74484b,0xbf708066bf5f8327,0xbf7fe129bf7b61fc,0xbf788486bf6afb8c,0xbf7efcc9bf7f3f54,0xbf7dabccbf740bdd,0xbf7a7302bf7fd397,0xbf7fe705bf7a9c59,0xbf725470bf7d1cdd,0xbf7f2f9dbf7e9bc9,0xbf66beccbf772417,0xbf7b87b2bf7fffb1,0xbf57dc7fbf6dfcf2
.quad 0x3f8000003f800000,0x3f8000003f800000,0x3f7dc68c3f7dfa38,0x3f7d57de3f7d906e,0x3f7724173f77f110,0x3f756d973f764d97,0x3f6c36243f6dfcf2,0x3f686b393f6a5ad9,0x3f5d2d533f604621,0x3f5695e53f59f26a,0x3f4a4c873f4f0417,0x3f404c5c3f456439,0x3f33e7bc3f3a7ca4,0x3f26050a3f2d1469,0x3f1a62933f2302d3,0x3f084b923f11796b
.quad 0x3efc5d273f08f59b,0x3ecf7bca3ee63375,0x3ebf926f3ed97cb9,0x3e8a11f73ea5129f,0x3e7ee6e13e9d9e78,0x3e0395023e419b37,0x3df475c03e3e853e,0xbc7b514b3d55880e,0xbc490e903d7b2b74,0xbe22abb6bdafb680,0xbe1324cabd83db0a,0xbe9920febe636c83,0xbe8b9507be419b37,0xbeddbe79beb554ec,0xbecb2aaebe9f1cdf,0xbf0ee0dbbef58035
.quad 0xbf039c3dbedae880,0xbf2beb4abf187fc0,0xbf1f599fbf099f4e,0xbf456439bf33587a,0xbf385216bf239da9,0xbf5ac450bf4ac77f,0xbf4e1689bf3b0629,0xbf6b99fbbf5e5aa6,0xbf604621bf4f7a1f,0xbf778bc5bf6db293,0xbf6e8ff8bf60a6cf,0xbf7e5a38bf788486,0xbf78b47bbf6e46be,0xbf7fe129bf7e9bc9,0xbf7e868bbf7822d1,0xbf7c187abf7fdaaf
.quad 0xbf7fec43bf7e1324,0xbf731447bf7c3b28,0xbf7cdf6cbf7fffb1,0xbf650479bf73ced9,0xbf756d97bf7de0b1,0xbf5233c6bf66becc,0xbf69b7e4bf77beb7,0xbf3b0629bf554aa4,0xbf59f26abf6db293,0xbf1ff6cbbf3fc767,0xbf466354bf5fe4e9,0xbf019573bf269de3,0xbf2f61a5bf4e8d90,0xbec1071ebf0a48ad,0xbf1553b7bf39f2ac,0xbe75c35abed6a399
.quad 0x0,0x0,0x3ddb7d373dcefdb7,0x3df475c03de7fa9a,0x3e5a39973e4dee60,0x3e72b6513e667c66,0x3ea218873e9920fe,0x3eb3dca53eab0201,0x3ed536413ec9b953,0x3eebcbbb3ee0924f,0x3f02ef9f3ef840c8,0x3f102dd53f099f4e,0x3f19c2003f121eb0,0x3f2866053f212ff9,0x3f2ecef73f269de3,0x3f3e35c53f36ad7f
.quad 0x3f41d8703f396842,0x3f514d3d3f49d112,0x3f52a6493f4a4c87,0x3f61668a3f5a5ba0,0x3f6106f23f591e6a,0x3f6e46be3f6816a8,0x3f6cd0073f65b710,0x3f77beb73f72d4eb,0x3f75dec63f6ff573,0x3f7dabcc3f7a7302,0x3f7c187a3f77beb7,0x3f7ff84a3f7ed7d4,0x3f7f6ac73f7cfe73,0x3f7e9bc93f7ff4e6,0x3f7fcbe23f7fa6e3,0x3f799b433f7dc68c
.quad 0x3f7d3aac3f7fb10f,0x3f7109083f7853f8,0x3f77beb73f7d1cdd,0x3f6504793f6faf1b,0x3f6f68303f77f110,0x3f55b9933f63f473,0x3f644fac3f703b37,0x3f4360513f554aa4,0x3f5695e53f660f88,0x3f2e3bde3f43e200,0x3f4663543f5988ad,0x3f16999f3f2ff3e6,0x3f33e7bc3f4ac77f,0x3ef9a02d3f19c200,0x3f1f599f3f39f2ac,0x3ec27b553f019573
.quad 0x3f08f59b3f273656,0x3e888e933ecf7bca,0x3ee1fb6a3f12c39a,0x3e195be03e9920fe,0x3eaf713a3ef9a02d,0x3cfb49ba3e419b37,0x3e75c35a3ecb2aae,0xbdb5f8da3d9cecf9,0x3e09cf863e9aa086,0xbe541501bd16c32c,0x3ce22a7a3e5101f1,0xbea5129fbe195be0,0xbda3308c3dd53db9,0xbeddbe79be8586ce,0xbe3e853e3b490fc6,0xbf099f4ebebca7af
.quad 0x0,0x0,0x3e06b26e3e007745,0x3e1324ca3e0cec4a,0x3e8586ce3e7ee6e1,0x3e919ddd3e8b9507,0x3ec5625c3ebca7af,0x3ed6a3993ece0bea,0x3f00e7e43ef6e0cb,0x3f0b9a6b3f064b82,0x3f1ce11f3f16999f,0x3f28fd413f2302d3,0x3f36206c3f2f61a5,0x3f42de293f3ca003,0x3f4c35783f456439,0x3f58b3a13f52a649
.quad 0x3f5ebe053f584853,0x3f6a09a73f64aa59,0x3f6d67a13f67c187,0x3f76841b3f725470,0x3f77f1103f73913f,0x3f7de0b13f7b61fc,0x3f7e2b723f7b87b2,0x3f7ff84a3f7fa6e3,0x3f7ffb113f7f84ab,0x3f7cbfc93f7f0e58,0x3f7d57de3f7f7808,0x3f74484b3f799b43,0x3f764d973f7b61fc,0x3f66becc3f6f6830,0x3f6afb8c3f73530e,0x3f546b3b3f60a6cf
.quad 0x3f5b941a3f676bd8,0x3f3daef93f4d9f02,0x3f485bca3f57dc7f,0x3f2302d33f36ad7f,0x3f31a81d3f44e3f5,0x3f04f4843f1c420c,0x3f17de123f2ecef7,0x3ec8477c3efdbabb,0x3ef6e0cb3f15f6d9,0x3e827dc03ebe1d4a,0x3eb9bb1e3ef58035,0x3de7fa9a3e75c35a,0x3e72b6513ebb31a0,0xbcfb49ba3dd53db9,0x3ddb7d373e7bdba4,0xbe3228d4bd0a342f
.quad 0xbcc90ab03dfab273,0xbea09ae5be2f10a2,0xbe1f917bbb490fc6,0xbee4cbfebe9c1faf,0xbe919dddbe039502,0xbf121eb0beddbe79,0xbed0eb2abe80f8c0,0xbf2ecef7bf0d9281,0xbf064b82bebe1d4a,0xbf47de65bf299415,0xbf21cbfbbef840c8,0xbf5cc7d1bf425b89,0xbf3a7ca4bf173c07,0xbf6d1c1dbf577026,0xbf4fefa8bf2ff3e6,0xbf788486bf686b39
.quad 0x3f8000003f800000,0x3f8000003f800000,0x3f7cdf6c3f7d1cdd,0x3f7c5d3a3f7c9f8a,0x3f73913f3f748422,0x3f718f573f7294f8,0x3f644fac3f666771,0x3f5fe4e93f62241a,0x3f4f7a1f3f531849,0x3f47de653f4bbbf8,0x3f3592e73f3b0629,0x3f2a2a803f2ff3e6,0x3f173c073f1ebc12,0x3f07a1363f0f8784,0x3eea66813efdbabb,0x3ec27b553ed6a399
.quad 0x3ea09ae53eb8442a,0x3e605c133e888e93,0x3e25c58c3e5d4b1a,0x3d55880e3ddb7d37,0x3bc90f883d8a200a,0xbdee3876bd621469,0xbe195be0bda973ba,0xbe901c2cbe5d4b1a,0xbe9aa086be6c9a7f,0xbee0924fbebe1d4a,0xbee4cbfebebf926f,0xbf1553b7bf044889,0xbf14b039bf0242b1,0xbf36206cbf26050a,0xbf33587abf21cbfb,0xbf51c0c2bf436051
.quad 0xbf4d9f02bf3daef9,0xbf676bd8bf5b941a,0xbf62df7bbf554aa4,0xbf76841bbf6dfcf2,0xbf7294f8bf6816a8,0xbf7e9bc9bf7a1e84,0xbf7c5d3abf75a67b,0xbf7f7808bf7fa6e3,0xbf7ffb11bf7dabcc,0xbf791298bf7e70b0,0xbf7d57debf7ff84a,0xbf6b99fbbf76841b,0xbf748422bf7c7eb0,0xbf577026bf6816a8,0xbf65b710bf73530e,0xbf3d27b8bf5389c7
.quad 0xbf514d3dbf64aa59,0xbf1d7fd1bf396842,0xbf37c655bf50d937,0xbef2bd43bf1a6293,0xbf19c200bf385216,0xbea395c5beee9479,0xbeeff7fbbf1ba299,0xbe1f917bbea21887,0xbea68f12bef6e0cb,0x3c490e90be22abb6,0xbe3228d4beb0eacb,0x3e3857ec3b490fc6,0xbc96c9b6be4dee60,0x3eaf713a3e28defc,0x3e0cec4abd55880e,0x3efdbabb3ea5129f
.quad 0x3f8000003f800000,0x3f8000003f800000,0x3f7bd14d3f7c187a,0x3f7b3bab3f7b87b2,0x3f6f68303f708066,0x3f6d1c1d3f6e46be,0x3f5b2c793f5d924d,0x3f5627fe3f58b3a1,0x3f3fc7673f43e200,0x3f373a233f3b8f3b,0x3f1e1e223f24381a,0x3f11796b3f17de12,0x3eee94793eff17b2,0x3ecc9b8b3eddbe79,0x3e9920fe3eadf73c,0x3e5d4b1a3e840270
.quad 0x3dfab2733e2f10a2,0x3cc90ab03d96a905,0xbd6ea038bb490fc6,0xbe2bf804bde7fa9a,0xbe72b651be354098,0xbeb554ecbe97a117,0xbed0eb2abeb0eacb,0xbf06f686beeff7fb,0xbf10d3cdbf00e7e4,0xbf2e3bdebf1ff6cb,0xbf34768fbf256bcb,0xbf4f0417bf425b89,0xbf5233c6bf44e3f5,0xbf6816a8bf5df6be,0xbf6912aebf5e5aa6,0xbf788486bf71d19f
.quad 0xbf7853f8bf710908,0xbf7fb10fbf7d3aac,0xbf7f7808bf7c5d3a,0xbf7d57debf7fcbe2,0xbf7e4323bf7ffec4,0xbf718f57bf796e4e,0xbf74bf62bf7bd14d,0xbf5cc7d1bf6a5ad9,0xbf633c5abf6ff573,0xbf3fc767bf531849,0xbf4a4c87bf5cc7d1,0xbf1ba299bf34768f,0xbf2ac082bf42de29,0xbee363fabf0f8784,0xbf05a02cbf2302d3,0xbe870adabecb2aae
.quad 0xbeb8442abefc5d27,0xbd96a905be605c13,0xbe3e853ebeab0201,0x3df475c0bd0a342f,0xbbc90f88be28defc,0x3e9d9e783e1c76de,0x3e3228d43c16cb58,0x3ef840c83eab0201,0x3eb263ef3e3b6ecf,0x3f24d2253f00e7e4,0x3f02ef9f3eb3dca5,0x3f4760853f27ce61,0x3f2866053f0242b1,0x3f6282103f48d8b3,0x3f485bca3f269de3,0x3f75341d3f62df7b
.quad 0x0,0x0,0x3e1f917b3e195be0,0x3e2bf8043e25c58c,0x3e9d9e783e97a117,0x3ea986c43ea395c5,0x3ee79a5d3edf28a9,0x3ef840c83eeff7fb,0x3f15f6d93f10d3cd,0x3f1ff6cb3f1b02c6,0x3f34768f3f2ecef7,0x3f3f41fc3f39f2ac,0x3f4e8d903f48d8b3,0x3f591e6a3f53fac3,0x3f6398ac3f5e5aa6,0x3f6cd0073f686b39
.quad 0x3f7314473f6ed89e,0x3f79c79d3f76ba07,0x3f7c9f8a3f79f35e,0x3f7fa6e33f7e868b,0x3f7ffec43f7f6ac7,0x3f7e43233f7f9c18,0x3f7d1cdd3f7f1f49,0x3f75a67b3f79f35e,0x3f740bdd3f791298,0x3f660f883f6db293,0x3f6504793f6d67a1,0x3f4fefa83f5b2c79,0x3f5064af3f5c61c7,0x3f33e7bc3f42de29,0x3f36ad7f3f466354,0x3f12c39a3f256bcb
.quad 0x3f187fc03f2beb4a,0x3edae8803f039c3d,0x3eed30633f0d9281,0x3e8a11f73ebca7af,0x3ea395c53ed8106b,0x3dd53db93e5a3997,0x3e2bf8043e901c2c,0xbd83db0a3d55880e,0x3c490e903e09cf86,0xbe6c9a7fbde1bc2e,0xbe1324cabc7b514b,0xbec8477cbe8a11f7,0xbe97a117be28defc,0xbf0a48adbed8106b,0xbee1fb6abe9f1cdf,0xbf2c800fbf102dd5
.quad 0xbf13682abee63375,0xbf49d112bf3085bb,0xbf3238aabf140c5f,0xbf61668abf4c3578,0xbf4cae79bf31a81d,0xbf7294f8bf628210,0xbf62241abf4b41fa,0xbf7cdf6cbf72d4eb,0xbf721352bf604621,0xbf7ffb11bf7cbfc9,0xbf7c187abf703b37,0xbf7bd14dbf7fffb1,0xbf7ff4e6bf7ac516,0xbf708066bf7c7eb0,0xbf7d906ebf7fa6e3,0xbf5e5aa6bf725470
.quad 0x0,0x0,0x3e3857ec3e3228d4,0x3e44b0b93e3e853e,0x3eb554ec3eaf713a,0x3ec1071e3ebb31a0,0x3f0448893f003a06,0x3f0c42c93f084b92,0x3f2994153f24d225,0x3f32c8c93f2e3bde,0x3f4955213f446337,0x3f52a6493f4e1689,0x3f6282103f5df6be,0x3f6aab7b3f66becc,0x3f74484b3f70c501,0x3f79f35e3f77583a
.quad 0x3f7e13243f7c3b28,0x3f7fec433f7f4e6d,0x3f7f90b13f7fffb1,0x3f7c5d3a3f7e5a38,0x3f78b47b3f7bf531,0x3f6f68303f748422,0x3f69b7e43f703b37,0x3f5988ad3f62241a,0x3f5318493f5d2d53,0x3f3b8f3b3f47de65,0x3f3592e73f436051,0x3f16999f3f269de3,0x3f121eb03f239da9,0x3ed8106b3eff17b2,0x3ed3c8673efdbabb,0x3e75c35a3ea80b1f
.quad 0x3e78cfcc3eac7cd4,0x3d48fb303e164083,0x3d83db0a3e2bf804,0xbe1324cabd2351cb,0xbdee3876bbc90f88,0xbea986c4be667c66,0xbe9620d2be3857ec,0xbf019573bece0bea,0xbeebcbbbbeb263ef,0xbf299415bf10d3cd,0xbf1ce11fbf019573,0xbf4b41fabf3592e7,0xbf3ebc1bbf26050a,0xbf655e0bbf53fac3,0xbf5a5ba0bf456439,0xbf76ef5bbf6afb8c
.quad 0xbf6ed89ebf5ebe05,0xbf7f4e6dbf79c79d,0xbf7b87b2bf714c7a,0xbf7e2b72bf7fdaaf,0xbf7ffec4bf7c7eb0,0xbf73913fbf7cfe73,0xbf7c187abf7ffd39,0xbf5fe4e9bf714c7a,0xbf6ff573bf7baccd,0xbf43e200bf5d2d53,0xbf5bfb34bf6faf1b,0xbf209393bf4154e1,0xbf40d0dabf5c61c7,0xbeee9479bf1ebc12,0xbf1f599fbf425b89,0xbe931f35beed3063
.quad 0x3f8000003f800000,0x3f8000003f800000,0x3f7ffec43f800000,0x3f7ff4e63f7ffb11,0x3f7ffb113f800000,0x3f7fd3973f7fec43,0x3f7ff4e63f800000,0x3f7f9c183f7fd397,0x3f7fec433f800000,0x3f7f4e6d3f7fb10f,0x3f7fe1293f800000,0x3f7eea9d3f7f84ab,0x3f7fd3973f800000,0x3f7e70b03f7f4e6d,0x3f7fc38f3f800000,0x3f7de0b13f7f0e58
.quad 0x3f7fb10f3f800000,0x3f7d3aac3f7ec46d,0x3f7f9c183f800000,0x3f7c7eb03f7e70b0,0x3f7f84ab3f800000,0x3f7baccd3f7e1324,0x3f7f6ac73f800000,0x3f7ac5163f7dabcc,0x3f7f4e6d3f800000,0x3f79c79d3f7d3aac,0x3f7f2f9d3f800000,0x3f78b47b3f7cbfc9,0x3f7f0e583f800000,0x3f778bc53f7c3b28,0x3f7eea9d3f800000,0x3f764d973f7baccd
.quad 0x3f7ec46d3f800000,0x3f74fa0b3f7b14be,0x3f7e9bc93f800000,0x3f73913f3f7a7302,0x3f7e70b03f800000,0x3f7213523f79c79d,0x3f7e43233f800000,0x3f7080663f791298,0x3f7e13243f800000,0x3f6ed89e3f7853f8,0x3f7de0b13f800000,0x3f6d1c1d3f778bc5,0x3f7dabcc3f800000,0x3f6b4b0c3f76ba07,0x3f7d74743f800000,0x3f6965913f75dec6
.quad 0x3f7d3aac3f800000,0x3f676bd83f74fa0b,0x3f7cfe733f800000,0x3f655e0b3f740bdd,0x3f7cbfc93f800000,0x3f633c5a3f731447,0x3f7c7eb03f800000,0x3f6106f23f721352,0x3f7c3b283f800000,0x3f5ebe053f710908,0x3f7bf5313f800000,0x3f5c61c73f6ff573,0x3f7baccd3f800000,0x3f59f26a3f6ed89e,0x3f7b61fc3f800000,0x3f5770263f6db293
.quad 0x3f8000003f800000,0x3f8000003f800000,0x3f7fe1293f7fec43,0x3f7fc38f3f7fd397,0x3f7f84ab3f7fb10f,0x3f7f0e583f7f4e6d,0x3f7eea9d3f7f4e6d,0x3f7de0b13f7e70b0,0x3f7e13243f7ec46d,0x3f7c3b283f7d3aac,0x3f7cfe733f7e1324,0x3f7a1e843f7baccd,0x3f7baccd3f7d3aac,0x3f778bc53f79c79d,0x3f7a1e843f7c3b28,0x3f7484223f778bc5
.quad 0x3f7853f83f7b14be,0x3f7109083f74fa0b,0x3f764d973f79c79d,0x3f6d1c1d3f721352,0x3f740bdd3f7853f8,0x3f68bf3c3f6ed89e,0x3f718f573f76ba07,0x3f63f4733f6b4b0c,0x3f6ed89e3f74fa0b,0x3f5ebe053f676bd8,0x3f6be8583f731447,0x3f591e6a3f633c5a,0x3f68bf3c3f710908,0x3f5318493f5ebe05,0x3f655e0b3f6ed89e,0x3f4cae793f59f26a
.quad 0x3f61c5983f6c835e,0x3f45e4033f54db31,0x3f5df6be3f6a09a7,0x3f3ebc1b3f4f7a1f,0x3f59f26a3f676bd8,0x3f373a233f49d112,0x3f55b9933f64aa59,0x3f2f61a53f43e200,0x3f514d3d3f61c598,0x3f2736563f3daef9,0x3f4cae793f5ebe05,0x3f1ebc123f373a23,0x3f47de653f5b941a,0x3f15f6d93f3085bb,0x3f42de293f584853,0x3f0cead03f299415
.quad 0x3f3daef93f54db31,0x3f039c3d3f226799,0x3f3852163f514d3d,0x3ef41f073f1b02c6,0x3f32c8c93f4d9f02,0x3ee0924f3f13682a,0x3f2d14693f49d112,0x3ecc9b8b3f0b9a6b,0x3f2736563f45e403,0x3eb8442a3f039c3d,0x3f212ff93f41d870,0x3ea395c53ef6e0cb,0x3f1b02c63f3daef9,0x3e8e9a223ee63375,0x3f14b0393f396842,0x3e72b6513ed53641
.quad 0x0,0x0,0x3bc90f8800000000,0x3c96c9b63c490e90,0x3c490e9000000000,0x3d16c32c3cc90ab0,0x3c96c9b600000000,0x3d6214693d16c32c,0x3cc90ab000000000,0x3d96a9053d48fb30,0x3cfb49ba00000000,0x3dbc3ac33d7b2b74,0x3d16c32c00000000,0x3de1bc2e3d96a905,0x3d2fe00700000000,0x3e0395023dafb680
.quad 0x3d48fb3000000000,0x3e1640833dc8bd36,0x3d62146900000000,0x3e28defc3de1bc2e,0x3d7b2b7400000000,0x3e3b6ecf3dfab273,0x3d8a200a00000000,0x3e4dee603e09cf86,0x3d96a90500000000,0x3e605c133e164083,0x3da3308c00000000,0x3e72b6513e22abb6,0x3dafb68000000000,0x3e827dc03e2f10a2,0x3dbc3ac300000000,0x3e8b95073e3b6ecf
.quad 0x3dc8bd3600000000,0x3e94a0313e47c5c2,0x3dd53db900000000,0x3e9d9e783e541501,0x3de1bc2e00000000,0x3ea68f123e605c13,0x3dee387600000000,0x3eaf713a3e6c9a7f,0x3dfab27300000000,0x3eb8442a3e78cfcc,0x3e03950200000000,0x3ec1071e3e827dc0,0x3e09cf8600000000,0x3ec9b9533e888e93,0x3e1008b700000000,0x3ed25a093e8e9a22
.quad 0x3e16408300000000,0x3edae8803e94a031,0x3e1c76de00000000,0x3ee363fa3e9aa086,0x3e22abb600000000,0x3eebcbbb3ea09ae5,0x3e28defc00000000,0x3ef41f073ea68f12,0x3e2f10a200000000,0x3efc5d273eac7cd4,0x3e35409800000000,0x3f0242b13eb263ef,0x3e3b6ecf00000000,0x3f064b823eb8442a,0x3e419b3700000000,0x3f0a48ad3ebe1d4a
.quad 0x0,0x0,0x3cfb49ba3cc90ab0,0x3d2fe0073d16c32c,0x3d7b2b743d48fb30,0x3dafb6803d96a905,0x3dbc3ac33d96a905,0x3e0395023de1bc2e,0x3dfab2733dc8bd36,0x3e2f10a23e164083,0x3e1c76de3dfab273,0x3e5a39973e3b6ecf,0x3e3b6ecf3e164083,0x3e827dc03e605c13,0x3e5a39973e2f10a2,0x3e97a1173e827dc0
.quad 0x3e78cfcc3e47c5c2,0x3eac7cd43e94a031,0x3e8b95073e605c13,0x3ec1071e3ea68f12,0x3e9aa0863e78cfcc,0x3ed536413eb8442a,0x3ea986c43e888e93,0x3ee900b73ec9b953,0x3eb8442a3e94a031,0x3efc5d273edae880,0x3ec6d5293ea09ae5,0x3f07a1363eebcbbb,0x3ed536413eac7cd4,0x3f10d3cd3efc5d27,0x3ee363fa3eb8442a,0x3f19c2003f064b82
.quad 0x3ef15aea3ec3ef15,0x3f2267993f0e39da,0x3eff17b23ecf7bca,0x3f2ac0823f15f6d9,0x3f064b823edae880,0x3f32c8c93f1d7fd1,0x3f0cead03ee63375,0x3f3a7ca43f24d225,0x3f13682a3ef15aea,0x3f41d8703f2beb4a,0x3f19c2003efc5d27,0x3f48d8b33f32c8c9,0x3f1ff6cb3f039c3d,0x3f4f7a1f3f396842,0x3f26050a3f08f59b,0x3f55b9933f3fc767
.quad 0x3f2beb4a3f0e39da,0x3f5b941a3f45e403,0x3f31a81d3f13682a,0x3f6106f23f4bbbf8,0x3f373a233f187fc0,0x3f660f883f514d3d,0x3f3ca0033f1d7fd1,0x3f6aab7b3f5695e5,0x3f41d8703f226799,0x3f6ed89e3f5b941a,0x3f46e22a3f273656,0x3f7294f83f604621,0x3f4bbbf83f2beb4a,0x3f75dec63f64aa59,0x3f5064af3f3085bb,0x3f78b47b3f68bf3c
.quad 0x3f8000003f800000,0x3f8000003f800000,0x3f7f9c183f7fb10f,0x3f7f6ac73f7f84ab,0x3f7e70b03f7ec46d,0x3f7dabcc3f7e1324,0x3f7c7eb03f7d3aac,0x3f7ac5163f7baccd,0x3f79c79d3f7b14be,0x3f76ba073f7853f8,0x3f764d973f7853f8,0x3f718f573f740bdd,0x3f7213523f74fa0b,0x3f6b4b0c3f6ed89e,0x3f6d1c1d3f710908,0x3f63f4733f68bf3c
.quad 0x3f676bd83f6c835e,0x3f5b941a3f61c598,0x3f6106f23f676bd8,0x3f5233c63f59f26a,0x3f59f26a3f61c598,0x3f47de653f514d3d,0x3f5233c63f5b941a,0x3f3ca0033f47de65,0x3f49d1123f54db31,0x3f3085bb3f3daef9,0x3f40d0da3f4d9f02,0x3f239da93f32c8c9,0x3f373a233f45e403,0x3f15f6d93f273656,0x3f2d14693f3daef9,0x3f07a1363f1b02c6
.quad 0x3f2267993f3504f3,0x3ef15aea3f0e39da,0x3f173c073f2beb4a,0x3ed25a093f00e7e4,0x3f0b9a6b3f226799,0x3eb263ef3ee63375,0x3eff17b23f187fc0,0x3e919ddd3ec9b953,0x3ee633753f0e39da,0x3e605c133eac7cd4,0x3ecc9b8b3f039c3d,0x3e1c76de3e8e9a22,0x3eb263ef3ef15aea,0x3dafb6803e605c13,0x3e97a1173edae880,0x3c96c9b63e22abb6
.quad 0x3e78cfcc3ec3ef15,0xbd48fb303dc8bd36,0x3e419b373eac7cd4,0xbdee38763d16c32c,0x3e09cf863e94a031,0xbe3b6ecfbcc90ab0,0x3da3308c3e78cfcc,0xbe7ee6e1bdafb680,0x3cc90ab03e47c5c2,0xbea09ae5be164083,0xbcfb49ba3e164083,0xbec1071ebe541501,0xbdafb6803dc8bd36,0xbee0924fbe888e93,0xbe1008b73d48fb30,0xbeff17b2bea68f12
.quad 0x3f8000003f800000,0x3f8000003f800000,0x3f7f2f9d3f7f4e6d,0x3f7eea9d3f7f0e58,0x3f7cbfc93f7d3aac,0x3f7baccd3f7c3b28,0x3f78b47b3f79c79d,0x3f764d973f778bc5,0x3f7314473f74fa0b,0x3f6ed89e3f710908,0x3f6be8583f6ed89e,0x3f655e0b3f68bf3c,0x3f633c5a3f676bd8,0x3f59f26a3f5ebe05,0x3f591e6a3f5ebe05,0x3f4cae793f531849
.quad 0x3f4d9f023f54db31,0x3f3daef93f45e403,0x3f40d0da3f49d112,0x3f2d14693f373a23,0x3f32c8c93f3daef9,0x3f1b02c63f273656,0x3f239da93f3085bb,0x3f07a1363f15f6d9,0x3f13682a3f226799,0x3ee633753f039c3d,0x3f0242b13f13682a,0x3ebb31a03ee0924f,0x3ee0924f3f039c3d,0x3e8e9a223eb8442a,0x3ebb31a03ee63375,0x3e419b373e8e9a22
.quad 0x3e94a0313ec3ef15,0x3dc8bd363e47c5c2,0x3e5a39973ea09ae5,0x3bc90f883de1bc2e,0x3e09cf863e78cfcc,0xbdafb6803cc90ab0,0x3d6214693e2f10a2,0xbe354098bd7b2b74,0xbcc90ab03dc8bd36,0xbe888e93be164083,0xbdd53db93cc90ab0,0xbeb554ecbe6c9a7f,0xbe3b6ecfbd48fb30,0xbee0924fbea09ae5,0xbe8586cebdfab273,0xbf04f484bec9b953
.quad 0xbeac7cd4be47c5c2,0xbf187fc0bef15aea,0xbed25a09be888e93,0xbf2ac082bf0b9a6b,0xbef6e0cbbeac7cd4,0xbf3b8f3bbf1d7fd1,0xbf0cead0becf7bca,0xbf4ac77fbf2e3bde,0xbf1d7fd1bef15aea,0xbf584853bf3daef9,0xbf2d1469bf08f59b,0xbf63f473bf4bbbf8,0xbf3b8f3bbf187fc0,0xbf6db293bf584853,0xbf48d8b3bf273656,0xbf756d97bf633c5a
.quad 0x0,0x0,0x3d6214693d48fb30,0x3d8a200a3d7b2b74,0x3de1bc2e3dc8bd36,0x3e09cf863dfab273,0x3e28defc3e164083,0x3e4dee603e3b6ecf,0x3e605c133e47c5c2,0x3e888e933e78cfcc,0x3e8b95073e78cfcc,0x3ea986c43e9aa086,0x3ea68f123e94a031,0x3ec9b9533eb8442a,0x3ec1071e3eac7cd4,0x3ee900b73ed53641
.quad 0x3edae8803ec3ef15,0x3f039c3d3ef15aea,0x3ef41f073edae880,0x3f121eb03f064b82,0x3f064b823ef15aea,0x3f1ff6cb3f13682a,0x3f121eb03f039c3d,0x3f2d14693f1ff6cb,0x3f1d7fd13f0e39da,0x3f3968423f2beb4a,0x3f2866053f187fc0,0x3f44e3f53f373a23,0x3f32c8c93f226799,0x3f4f7a1f3f41d870,0x3f3ca0033f2beb4a,0x3f591e6a3f4bbbf8
.quad 0x3f45e4033f3504f3,0x3f61c5983f54db31,0x3f4e8d903f3daef9,0x3f6965913f5d2d53,0x3f5695e53f45e403,0x3f6ff5733f64aa59,0x3f5df6be3f4d9f02,0x3f756d973f6b4b0c,0x3f64aa593f54db31,0x3f79c79d3f710908,0x3f6aab7b3f5b941a,0x3f7cfe733f75dec6,0x3f6ff5733f61c598,0x3f7f0e583f79c79d,0x3f7484223f676bd8,0x3f7ff4e63f7cbfc9
.quad 0x3f7853f83f6c835e,0x3f7fb10f3f7ec46d,0x3f7b61fc3f710908,0x3f7e43233f7fd397,0x3f7dabcc3f74fa0b,0x3f7baccd3f7fec43,0x3f7f2f9d3f7853f8,0x3f77f1103f7f0e58,0x3f7fec433f7b14be,0x3f7314473f7d3aac,0x3f7fe1293f7d3aac,0x3f6d1c1d3f7a7302,0x3f7f0e583f7ec46d,0x3f660f883f76ba07,0x3f7d74743f7fb10f,0x3f5df6be3f721352
.quad 0x0,0x0,0x3da3308c3d96a905,0x3dbc3ac33dafb680,0x3e22abb63e164083,0x3e3b6ecf3e2f10a2,0x3e72b6513e605c13,0x3e8b95073e827dc0,0x3ea09ae53e94a031,0x3eb8442a3eac7cd4,0x3ec6d5293eb8442a,0x3ee363fa3ed53641,0x3eebcbbb3edae880,0x3f064b823efc5d27,0x3f07a1363efc5d27,0x3f19c2003f10d3cd
.quad 0x3f187fc03f0e39da,0x3f2beb4a3f226799,0x3f2866053f1d7fd1,0x3f3ca0033f32c8c9,0x3f373a233f2beb4a,0x3f4bbbf83f41d870,0x3f44e3f53f396842,0x3f591e6a3f4f7a1f,0x3f514d3d3f45e403,0x3f64aa593f5b941a,0x3f5c61c73f514d3d,0x3f6e46be3f660f88,0x3f660f883f5b941a,0x3f75dec63f6ed89e,0x3f6e46be3f64aa59,0x3f7b61fc3f75dec6
.quad 0x3f74fa0b3f6c835e,0x3f7ec46d3f7b14be,0x3f7a1e843f731447,0x3f7ffec43f7e70b0,0x3f7dabcc3f7853f8,0x3f7f0e583f7fec43,0x3f7f9c183f7c3b28,0x3f7bf5313f7f84ab,0x3f7fec433f7ec46d,0x3f76ba073f7d3aac,0x3f7e9bc93f7fec43,0x3f6f68303f791298,0x3f7baccd3f7fb10f,0x3f660f883f731447,0x3f7724173f7e1324,0x3f5ac4503f6b4b0c
.quad 0x3f7109083f7b14be,0x3f4d9f023f61c598,0x3f6965913f76ba07,0x3f3ebc1b3f5695e5,0x3f6046213f710908,0x3f2e3bde3f49d112,0x3f55b9933f6a09a7,0x3f1c420c3f3b8f3b,0x3f49d1123f61c598,0x3f08f59b3f2beb4a,0x3f3ca0033f584853,0x3ee900b73f1b02c6,0x3f2e3bde3f4d9f02,0x3ebe1d4a3f08f59b,0x3f1ebc123f41d870,0x3e919ddd3eebcbbb
.quad 0x3f8000003f800000,0x3f8000003f800000,0x3f7e9bc93f7ec46d,0x3f7e43233f7e70b0,0x3f7a73023f7b14be,0x3f7912983f79c79d,0x3f73913f3f74fa0b,0x3f7080663f721352,0x3f6a09a73f6c835e,0x3f64aa593f676bd8,0x3f5df6be3f61c598,0x3f55b9933f59f26a,0x3f4f7a1f3f54db31,0x3f43e2003f49d112,0x3f3ebc1b3f45e403,0x3f2f61a53f373a23
.quad 0x3f2beb4a3f3504f3,0x3f187fc03f226799,0x3f173c073f226799,0x3eff17b23f0b9a6b,0x3f00e7e43f0e39da,0x3ec9b9533ee63375,0x3ed25a093ef15aea,0x3e919ddd3eb263ef,0x3ea09ae53ec3ef15,0x3e2f10a23e78cfcc,0x3e5a39973e94a031,0x3d6214693e09cf86,0x3de1bc2e3e47c5c2,0xbd7b2b743cc90ab0,0x3bc90f883dc8bd36,0xbe354098bdafb680
.quad 0xbdc8bd36248d3132,0xbe94a031be47c5c2,0xbe4dee60bdc8bd36,0xbecc9b8bbe9aa086,0xbe9aa086be47c5c2,0xbf00e7e4becf7bca,0xbecc9b8bbe94a031,0xbf19c200bf00e7e4,0xbefc5d27bec3ef15,0xbf3085bbbf187fc0,0xbf14b039bef15aea,0xbf44e3f5bf2e3bde,0xbf299415bf0e39da,0xbf5695e5bf41d870,0xbf3ca003bf226799,0xbf655e0bbf531849
.quad 0xbf4d9f02bf3504f3,0xbf710908bf61c598,0xbf5c61c7bf45e403,0xbf796e4ebf6db293,0xbf68bf3cbf54db31,0xbf7e70b0bf76ba07,0xbf7294f8bf61c598,0xbf7ffec4bf7cbfc9,0xbf79c79dbf6c835e,0xbf7e1324bf7fb10f,0xbf7e4323bf74fa0b,0xbf78b47bbf7f84ab,0xbf7ffb11bf7b14be,0xbf6ff573bf7c3b28,0xbf7eea9dbf7ec46d,0xbf63f473bf75dec6
.quad 0x3f8000003f800000,0x3f8000003f800000,0x3f7de0b13f7e1324,0x3f7d74743f7dabcc,0x3f778bc53f7853f8,0x3f75dec63f76ba07,0x3f6d1c1d3f6ed89e,0x3f6965913f6b4b0c,0x3f5ebe053f61c598,0x3f5848533f5b941a,0x3f4cae793f514d3d,0x3f42de293f47de65,0x3f373a233f3daef9,0x3f2994153f3085bb,0x3f1ebc123f273656,0x3f0cead03f15f6d9
.quad 0x3f039c3d3f0e39da,0x3edae8803ef15aea,0x3ecc9b8b3ee63375,0x3e97a1173eb263ef,0x3e8e9a223eac7cd4,0x3e22abb63e605c13,0x3e1c76de3e605c13,0x3c96c9b63dafb680,0x3cc90ab03dc8bd36,0xbdfab273bd48fb30,0xbdd53db9bcc90ab0,0xbe8586cebe3b6ecf,0xbe6c9a7fbe164083,0xbec9b953bea09ae5,0xbeb554ecbe888e93,0xbf04f484bee0924f
.quad 0xbef15aeabec3ef15,0xbf226799bf0e39da,0xbf14b039befc5d27,0xbf3ca003bf299415,0xbf2e3bdebf187fc0,0xbf531849bf41d870,0xbf44e3f5bf3085bb,0xbf655e0bbf5695e5,0xbf584853bf45e403,0xbf731447bf676bd8,0xbf6816a8bf584853,0xbf7bf531bf740bdd,0xbf740bddbf676bd8,0xbf7fd397bf7c3b28,0xbf7bf531bf731447,0xbf7e9bc9bf7fd397
.quad 0xbf7fb10fbf7b14be,0xbf7853f8bf7ec46d,0xbf7f2f9dbf7f4e6d,0xbf6d1c1dbf791298,0xbf7a7302bf7fb10f,0xbf5d2d53bf6ed89e,0xbf718f57bf7c3b28,0xbf48d8b3bf604621,0xbf64aa59bf74fa0b,0xbf3085bbbf4d9f02,0xbf53fac3bf6a09a7,0xbf14b039bf373a23,0xbf3fc767bf5b941a,0xbeebcbbbbf1d7fd1,0xbf286605bf49d112,0xbea986c4bf00e7e4
.quad 0x0,0x0,0x3dd53db93dc8bd36,0x3dee38763de1bc2e,0x3e5415013e47c5c2,0x3e6c9a7f3e605c13,0x3e9d9e783e94a031,0x3eaf713a3ea68f12,0x3ecf7bca3ec3ef15,0x3ee633753edae880,0x3eff17b23ef15aea,0x3f0cead03f064b82,0x3f15f6d93f0e39da,0x3f24d2253f1d7fd1,0x3f2ac0823f226799,0x3f3a7ca43f32c8c9
.quad 0x3f3daef93f3504f3,0x3f4d9f023f45e403,0x3f4e8d903f45e403,0x3f5df6be3f5695e5,0x3f5d2d533f54db31,0x3f6b4b0c3f64aa59,0x3f6965913f61c598,0x3f756d973f6ff573,0x3f7314473f6c835e,0x3f7c3b283f7853f8,0x3f7a1e843f74fa0b,0x3f7f9c183f7dabcc,0x3f7e70b03f7b14be,0x3f7f84ab3f7fec43,0x3f7ffec43f7ec46d,0x3f7bf5313f7f0e58
.quad 0x3f7ec46d3f800000,0x3f74fa0b3f7b14be,0x3f7ac5163f7ec46d,0x3f6aab7b3f740bdd,0x3f740bdd3f7b14be,0x3f5d2d533f6a09a7,0x3f6aab7b3f74fa0b,0x3f4cae793f5d2d53,0x3f5ebe053f6c835e,0x3f3968423f4d9f02,0x3f5064af3f61c598,0x3f239da93f3b8f3b,0x3f3fc7673f54db31,0x3f0b9a6b3f273656,0x3f2d14693f45e403,0x3ee363fa3f10d3cd
.quad 0x3f187fc03f3504f3,0x3eac7cd43ef15aea,0x3f0242b13f226799,0x3e667c663ebe1d4a,0x3ed536413f0e39da,0x3de1bc2e3e888e93,0x3ea395c53ef15aea,0xbbc90f883e22abb6,0x3e605c133ec3ef15,0xbdfab2733d48fb30,0x3dee38763e94a031,0xbe72b651bd7b2b74,0x3c490e903e47c5c2,0xbeb263efbe2f10a2,0xbdbc3ac33dc8bd36,0xbee900b7be8e9a22
.quad 0x0,0x0,0x3e0395023dfab273,0x3e1008b73e09cf86,0x3e827dc03e78cfcc,0x3e8e9a223e888e93,0x3ec1071e3eb8442a,0x3ed25a093ec9b953,0x3efc5d273ef15aea,0x3f08f59b3f039c3d,0x3f19c2003f13682a,0x3f26050a3f1ff6cb,0x3f32c8c93f2beb4a,0x3f3fc7673f396842,0x3f48d8b33f41d870,0x3f55b9933f4f7a1f
.quad 0x3f5b941a3f54db31,0x3f676bd83f61c598,0x3f6aab7b3f64aa59,0x3f7484223f6ff573,0x3f75dec63f710908,0x3f7cbfc93f79c79d,0x3f7cfe733f79c79d,0x3f7ff4e63f7f0e58,0x3f7fec433f7ec46d,0x3f7e13243f7fb10f,0x3f7e9bc93f7fec43,0x3f7724173f7baccd,0x3f7912983f7d3aac,0x3f6b4b0c3f731447,0x3f6f68303f76ba07,0x3f5ac4503f660f88
.quad 0x3f61c5983f6c835e,0x3f45e4033f54db31,0x3f5064af3f5ebe05,0x3f2d14693f3fc767,0x3f3b8f3b3f4d9f02,0x3f10d3cd3f273656,0x3f239da93f396842,0x3ee363fa3f0b9a6b,0x3f08f59b3f226799,0x3ea09ae53edae880,0x3ed8106b3f08f59b,0x3e3540983e9aa086,0x3e9aa0863edae880,0x3d16c32c3e2f10a2,0x3e3540983ea09ae5,0xbdd53db93d16c32c
.quad 0x3d48fb303e47c5c2,0xbe78cfccbdc8bd36,0xbda3308c3d96a905,0xbec1071ebe6c9a7f,0xbe541501bd48fb30,0xbf00e7e4beb8442a,0xbea986c4be2f10a2,0xbf1ebc12bef6e0cb,0xbee63375be94a031,0xbf396842bf187fc0,0xbf0f8784becf7bca,0xbf5064afbf32c8c9,0xbf299415bf039c3d,0xbf633c5abf49d112,0xbf40d0dabf1d7fd1,0xbf718f57bf5d2d53
.quad 0x3f8000003f800000,0x3f8000003f800000,0x3f7cfe733f7d3aac,0x3f7c7eb03f7cbfc9,0x3f740bdd3f74fa0b,0x3f7213523f731447,0x3f655e0b3f676bd8,0x3f6106f23f633c5a,0x3f514d3d3f54db31,0x3f49d1123f4d9f02,0x3f3852163f3daef9,0x3f2d14693f32c8c9,0x3f1b02c63f226799,0x3f0b9a6b3f13682a,0x3ef41f073f039c3d,0x3ecc9b8b3ee0924f
.quad 0x3eac7cd43ec3ef15,0x3e78cfcc3e94a031,0x3e419b373e78cfcc,0x3da3308c3e09cf86,0x3d16c32c3dc8bd36,0xbdafb680bcc90ab0,0xbdee3876bd48fb30,0xbe7ee6e1be3b6ecf,0xbe888e93be47c5c2,0xbecf7bcabeac7cd4,0xbed25a09beac7cd4,0xbf0cead0bef6e0cb,0xbf0b9a6bbef15aea,0xbf2e3bdebf1d7fd1,0xbf2ac082bf187fc0,0xbf4ac77fbf3b8f3b
.quad 0xbf45e403bf3504f3,0xbf61c598bf54db31,0xbf5c61c7bf4d9f02,0xbf7294f8bf68bf3c,0xbf6db293bf61c598,0xbf7cbfc9bf76ba07,0xbf796e4ebf710908,0xbf7ffec4bf7e70b0,0xbf7f4e6dbf7b14be,0xbf7c3b28bf7fb10f,0xbf7f2f9dbf7fb10f,0xbf718f57bf7a7302,0xbf791298bf7ec46d,0xbf604621bf6ed89e,0xbf6d1c1dbf7853f8,0xbf48d8b3bf5d2d53
.quad 0xbf5b941abf6c835e,0xbf2beb4abf45e403,0xbf44e3f5bf5b941a,0xbf0a48adbf299415,0xbf299415bf45e403,0xbec9b953bf08f59b,0xbf0a48adbf2beb4a,0xbe72b651bec9b953,0xbecf7bcabf0e39da,0xbd96a905be78cfcc,0xbe8586cebedae880,0x3dbc3ac3bdafb680,0xbde1bc2ebe94a031,0x3e827dc03d96a905,0x3d2fe007be164083,0x3ed25a093e6c9a7f
.quad 0x3f8000003f800000,0x3f8000003f800000,0x3f7bf5313f7c3b28,0x3f7b61fc3f7baccd,0x3f6ff5733f710908,0x3f6db2933f6ed89e,0x3f5c61c73f5ebe05,0x3f5770263f59f26a,0x3f41d8703f45e403,0x3f3968423f3daef9,0x3f212ff93f273656,0x3f14b0393f1b02c6,0x3ef6e0cb3f039c3d,0x3ed536413ee63375,0x3ea395c53eb8442a,0x3e72b6513e8e9a22
.quad 0x3e1640833e47c5c2,0x3d48fb303dc8bd36,0xbcfb49ba3cc90ab0,0xbe1008b7bdafb680,0xbe541501be164083,0xbea68f12be888e93,0xbec1071ebea09ae5,0xbeff17b2bee0924f,0xbf08f59bbef15aea,0xbf273656bf187fc0,0xbf2d1469bf1d7fd1,0xbf48d8b3bf3b8f3b,0xbf4bbbf8bf3daef9,0xbf633c5abf584853,0xbf63f473bf584853,0xbf756d97bf6db293
.quad 0xbf74fa0bbf6c835e,0xbf7ec46dbf7b14be,0xbf7e4323bf79c79d,0xbf7eea9dbf7ffb11,0xbf7f84abbf7fb10f,0xbf75dec6bf7c3b28,0xbf78b47bbf7e1324,0xbf63f473bf6ff573,0xbf6a09a7bf74fa0b,0xbf49d112bf5b941a,0xbf53fac3bf64aa59,0xbf286605bf3fc767,0xbf373a23bf4d9f02,0xbf00e7e4bf1d7fd1,0xbf14b039bf3085bb,0xbea986c4beebcbbb
.quad 0xbedae880bf0e39da,0xbe164083be94a031,0xbe8586cebecf7bca,0x3d2fe007bde1bc2e,0xbdafb680be78cfcc,0x3e6c9a7f3d96a905,0x3dbc3ac3bd96a905,0x3ed25a093e827dc0,0x3e888e933dc8bd36,0x3f13682a3edae880,0x3eddbe793e888e93,0x3f3852163f15f6d9,0x3f15f6d93edae880,0x3f5695e53f396842,0x3f3852163f13682a,0x3f6d1c1d3f5695e5
.quad 0x0,0x0,0x3e1c76de3e164083,0x3e28defc3e22abb6,0x3e9aa0863e94a031,0x3ea68f123ea09ae5,0x3ee363fa3edae880,0x3ef41f073eebcbbb,0x3f13682a3f0e39da,0x3f1d7fd13f187fc0,0x3f31a81d3f2beb4a,0x3f3ca0033f373a23,0x3f4bbbf83f45e403,0x3f5695e53f514d3d,0x3f6106f23f5b941a,0x3f6aab7b3f660f88
.quad 0x3f7109083f6c835e,0x3f7853f83f74fa0b,0x3f7b61fc3f7853f8,0x3f7f2f9d3f7dabcc,0x3f7fd3973f7ec46d,0x3f7f0e583f7fec43,0x3f7e43233f7fb10f,0x3f77f1103f7baccd,0x3f76ba073f7b14be,0x3f6a09a73f710908,0x3f6965913f710908,0x3f55b9933f604621,0x3f5695e53f61c598,0x3f3b8f3b3f49d112,0x3f3ebc1b3f4d9f02,0x3f1c420c3f2e3bde
.quad 0x3f2267993f3504f3,0x3ef15aea3f0e39da,0x3f0242b13f187fc0,0x3ea395c53ed53641,0x3ebe1d4a3ef15aea,0x3e22abb63e888e93,0x3e667c663eac7cd4,0xbbc90f883de1bc2e,0x3d96a9053e47c5c2,0xbe2f10a2bd48fb30,0xbda3308c3d48fb30,0xbea986c4be541501,0xbe6c9a7fbdc8bd36,0xbef6e0cbbeb8442a,0xbec1071ebe78cfcc,0xbf1ebc12bf00e7e4
.quad 0xbf039c3dbec3ef15,0xbf3daef9bf226799,0xbf239da9bf039c3d,0xbf577026bf3fc767,0xbf3fc767bf226799,0xbf6b4b0cbf584853,0xbf577026bf3daef9,0xbf78b47bbf6b4b0c,0xbf6a09a7bf54db31,0xbf7f4e6dbf7853f8,0xbf772417bf676bd8,0xbf7eea9dbf7f0e58,0xbf7e70b0bf74fa0b,0xbf778bc5bf7f4e6d,0xbf7fc38fbf7d3aac,0xbf696591bf791298
.quad 0x0,0x0,0x3e3540983e2f10a2,0x3e419b373e3b6ecf,0x3eb263ef3eac7cd4,0x3ebe1d4a3eb8442a,0x3f0242b13efc5d27,0x3f0a48ad3f064b82,0x3f2736563f226799,0x3f3085bb3f2beb4a,0x3f46e22a3f41d870,0x3f5064af3f4bbbf8,0x3f6046213f5b941a,0x3f68bf3c3f64aa59,0x3f7294f83f6ed89e,0x3f78b47b3f75dec6
.quad 0x3f7d3aac3f7b14be,0x3f7fb10f3f7ec46d,0x3f7fe1293f7fec43,0x3f7d74743f7f0e58,0x3f7a73023f7d3aac,0x3f7213523f76ba07,0x3f6d1c1d3f731447,0x3f5df6be3f660f88,0x3f5848533f61c598,0x3f41d8703f4d9f02,0x3f3ca0033f49d112,0x3f1ebc123f2e3bde,0x3f1b02c63f2beb4a,0x3eebcbbb3f08f59b,0x3ee900b73f08f59b,0x3e919ddd3ebe1d4a
.quad 0x3e94a0313ec3ef15,0x3dc8bd363e47c5c2,0x3dee38763e605c13,0xbdbc3ac33c490e90,0xbd7b2b743d48fb30,0xbe8e9a22be2f10a2,0xbe72b651bdfab273,0xbee900b7beb263ef,0xbecf7bcabe94a031,0xbf1d7fd1bf039c3d,0xbf0f8784bee63375,0xbf40d0dabf299415,0xbf32c8c9bf187fc0,0xbf5d2d53bf49d112,0xbf5064afbf396842,0xbf718f57bf633c5a
.quad 0xbf676bd8bf54db31,0xbf7d3aacbf74fa0b,0xbf772417bf6a09a7,0xbf7fc38fbf7e70b0,0xbf7f0e58bf7853f8,0xbf791298bf7f4e6d,0xbf7eea9dbf7f4e6d,0xbf696591bf778bc5,0xbf76ba07bf7ec46d,0xbf514d3dbf676bd8,0xbf66beccbf76ba07,0xbf31a81dbf4f7a1f,0xbf4f7a1fbf676bd8,0xbf0b9a6bbf3085bb,0xbf31a81dbf514d3d,0xbec1071ebf0b9a6b
.quad 0x3f7fffb13f800000,0x3f7ffd393f7ffec4,0x3f7ffd393f800000,0x3f7fe7053f7ff4e6,0x3f7ff84a3f800000,0x3f7fba9e3f7fe129,0x3f7ff0e33f800000,0x3f7f78083f7fc38f,0x3f7fe7053f800000,0x3f7f1f493f7f9c18,0x3f7fdaaf3f800000,0x3f7eb0693f7f6ac7,0x3f7fcbe23f800000,0x3f7e2b723f7f2f9d,0x3f7fba9e3f800000,0x3f7d906e3f7eea9d
.quad 0x3f7fa6e33f800000,0x3f7cdf6c3f7e9bc9,0x3f7f90b13f800000,0x3f7c187a3f7e4323,0x3f7f78083f800000,0x3f7b3bab3f7de0b1,0x3f7f5ce93f800000,0x3f7a49103f7d7474,0x3f7f3f543f800000,0x3f7940c03f7cfe73,0x3f7f1f493f800000,0x3f7822d13f7c7eb0,0x3f7efcc93f800000,0x3f76ef5b3f7bf531,0x3f7ed7d43f800000,0x3f75a67b3f7b61fc
.quad 0x3f7eb0693f800000,0x3f74484b3f7ac516,0x3f7e868b3f800000,0x3f72d4eb3f7a1e84,0x3f7e5a383f800000,0x3f714c7a3f796e4e,0x3f7e2b723f800000,0x3f6faf1b3f78b47b,0x3f7dfa383f800000,0x3f6dfcf23f77f110,0x3f7dc68c3f800000,0x3f6c36243f772417,0x3f7d906e3f800000,0x3f6a5ad93f764d97,0x3f7d57de3f800000,0x3f686b393f756d97
.quad 0x3f7d1cdd3f800000,0x3f6667713f748422,0x3f7cdf6c3f800000,0x3f644fac3f73913f,0x3f7c9f8a3f800000,0x3f62241a3f7294f8,0x3f7c5d3a3f800000,0x3f5fe4e93f718f57,0x3f7c187a3f800000,0x3f5d924d3f708066,0x3f7bd14d3f800000,0x3f5b2c793f6f6830,0x3f7b87b23f800000,0x3f58b3a13f6e46be,0x3f7b3bab3f800000,0x3f5627fe3f6d1c1d
.quad 0x3f7ff84a3f7ffb11,0x3f7ff0e33f7ff4e6,0x3f7fba9e3f7fd397,0x3f7f78083f7f9c18,0x3f7f3f543f7f84ab,0x3f7e868b3f7eea9d,0x3f7e868b3f7f0e58,0x3f7d1cdd3f7de0b1,0x3f7d906e3f7e70b0,0x3f7b3bab3f7c7eb0,0x3f7c5d3a3f7dabcc,0x3f78e3d63f7ac516,0x3f7aed373f7cbfc9,0x3f76167a3f78b47b,0x3f7940c03f7baccd,0x3f72d4eb3f764d97
.quad 0x3f77583a3f7a7302,0x3f6f20b03f73913f,0x3f75341d3f791298,0x3f6afb8c3f708066,0x3f72d4eb3f778bc5,0x3f6667713f6d1c1d,0x3f703b373f75dec6,0x3f61668a3f696591,0x3f6d67a13f740bdd,0x3f5bfb343f655e0b,0x3f6a5ad93f721352,0x3f5627fe3f6106f2,0x3f6715993f6ff573,0x3f4fefa83f5c61c7,0x3f6398ac3f6db293,0x3f4955213f577026
.quad 0x3f5fe4e93f6b4b0c,0x3f425b893f5233c6,0x3f5bfb343f68bf3c,0x3f3b06293f4cae79,0x3f57dc7f3f660f88,0x3f33587a3f46e22a,0x3f5389c73f633c5a,0x3f2b561b3f40d0da,0x3f4f04173f604621,0x3f2302d33f3a7ca4,0x3f4a4c873f5d2d53,0x3f1a62933f33e7bc,0x3f4564393f59f26a,0x3f11796b3f2d1469,0x3f404c5c3f5695e5,0x3f084b923f26050a
.quad 0x3f3b06293f531849,0x3efdbabb3f1ebc12,0x3f3592e73f4f7a1f,0x3eea66813f173c07,0x3f2ff3e63f4bbbf8,0x3ed6a3993f0f8784,0x3f2a2a803f47de65,0x3ec27b553f07a136,0x3f24381a3f43e200,0x3eadf73c3eff17b2,0x3f1e1e223f3fc767,0x3e9920fe3eee9479,0x3f17de123f3b8f3b,0x3e8402703eddbe79,0x3f11796b3f373a23,0x3e5d4b1a3ecc9b8b
.quad 0x3b490fc600000000,0x3c16cb583bc90f88,0x3c16cb5800000000,0x3ce22a7a3c96c9b6,0x3c7b514b00000000,0x3d3c6dd53cfb49ba,0x3cafea6900000000,0x3d83db0a3d2fe007,0x3ce22a7a00000000,0x3da973ba3d621469,0x3d0a342f00000000,0x3dcefdb73d8a200a,0x3d2351cb00000000,0x3df475c03da3308c,0x3d3c6dd500000000,0x3e0cec4a3dbc3ac3
.quad 0x3d55880e00000000,0x3e1f917b3dd53db9,0x3d6ea03800000000,0x3e3228d43dee3876,0x3d83db0a00000000,0x3e44b0b93e039502,0x3d9064b400000000,0x3e57278f3e1008b7,0x3d9cecf900000000,0x3e698bba3e1c76de,0x3da973ba00000000,0x3e7bdba43e28defc,0x3db5f8da00000000,0x3e870ada3e354098,0x3dc27c3900000000,0x3e901c2c3e419b37
.quad 0x3dcefdb700000000,0x3e9920fe3e4dee60,0x3ddb7d3700000000,0x3ea218873e5a3997,0x3de7fa9a00000000,0x3eab02013e667c66,0x3df475c000000000,0x3eb3dca53e72b651,0x3e00774500000000,0x3ebca7af3e7ee6e1,0x3e06b26e00000000,0x3ec5625c3e8586ce,0x3e0cec4a00000000,0x3ece0bea3e8b9507,0x3e1324ca00000000,0x3ed6a3993e919ddd
.quad 0x3e195be000000000,0x3edf28a93e97a117,0x3e1f917b00000000,0x3ee79a5d3e9d9e78,0x3e25c58c00000000,0x3eeff7fb3ea395c5,0x3e2bf80400000000,0x3ef840c83ea986c4,0x3e3228d400000000,0x3f003a063eaf713a,0x3e3857ec00000000,0x3f0448893eb554ec,0x3e3e853e00000000,0x3f084b923ebb31a0,0x3e44b0b900000000,0x3f0c42c93ec1071e
.quad 0x3c7b514b3c490e90,0x3cafea693c96c9b6,0x3d3c6dd53d16c32c,0x3d83db0a3d621469,0x3d9cecf93d7b2b74,0x3ddb7d373dbc3ac3,0x3ddb7d373dafb680,0x3e195be03e039502,0x3e0cec4a3de1bc2e,0x3e44b0b93e28defc,0x3e2bf8043e09cf86,0x3e6fa8b23e4dee60,0x3e4ada4f3e22abb6,0x3e8d17c03e72b651,0x3e698bba3e3b6ecf,0x3ea218873e8b9507
.quad 0x3e8402703e541501,0x3eb6ccc33e9d9e78,0x3e931f353e6c9a7f,0x3ecb2aae3eaf713a,0x3ea218873e827dc0,0x3edf28a93ec1071e,0x3eb0eacb3e8e9a22,0x3ef2bd433ed25a09,0x3ebf926f3e9aa086,0x3f02ef9f3ee363fa,0x3ece0bea3ea68f12,0x3f0c42c93ef41f07,0x3edc53c13eb263ef,0x3f1553b73f0242b1,0x3eea66813ebe1d4a,0x3f1e1e223f0a48ad
.quad 0x3ef840c83ec9b953,0x3f269de33f121eb0,0x3f02ef9f3ed53641,0x3f2ecef73f19c200,0x3f099f4e3ee0924f,0x3f36ad7f3f212ff9,0x3f102dd53eebcbbb,0x3f3e35c53f286605,0x3f16999f3ef6e0cb,0x3f4564393f2f61a5,0x3f1ce11f3f00e7e4,0x3f4c35783f36206c,0x3f2302d33f064b82,0x3f52a6493f3ca003,0x3f28fd413f0b9a6b,0x3f58b3a13f42de29
.quad 0x3f2ecef73f10d3cd,0x3f5e5aa63f48d8b3,0x3f34768f3f15f6d9,0x3f6398ac3f4e8d90,0x3f39f2ac3f1b02c6,0x3f686b393f53fac3,0x3f3f41fc3f1ff6cb,0x3f6cd0073f591e6a,0x3f4463373f24d225,0x3f70c5013f5df6be,0x3f4955213f299415,0x3f74484b3f628210,0x3f4e16893f2e3bde,0x3f77583a3f66becc,0x3f52a6493f32c8c9,0x3f79f35e3f6aab7b
.quad 0x3f7fe7053f7fec43,0x3f7fdaaf3f7fe129,0x3f7f1f493f7f4e6d,0x3f7eb0693f7eea9d,0x3f7d906e3f7e1324,0x3f7c5d3a3f7cfe73,0x3f7b3bab3f7c3b28,0x3f78e3d63f7a1e84,0x3f7822d13f79c79d,0x3f74484b3f764d97,0x3f74484b3f76ba07,0x3f6e8ff83f718f57,0x3f6faf1b3f731447,0x3f67c1873f6be858,0x3f6a5ad93f6ed89e,0x3f5fe4e93f655e0b
.quad 0x3f644fac3f6a09a7,0x3f5703483f5df6be,0x3f5d924d3f64aa59,0x3f4d26fd3f55b993,0x3f5627fe3f5ebe05,0x3f425b893f4cae79,0x3f4e16893f584853,0x3f36ad7f3f42de29,0x3f4564393f514d3d,0x3f2a2a803f385216,0x3f3c17d93f49d112,0x3f1ce11f3f2d1469,0x3f3238aa3f41d870,0x3f0ee0db3f212ff9,0x3f27ce613f396842,0x3f003a063f14b039
.quad 0x3f1ce11f3f3085bb,0x3ee1fb6a3f07a136,0x3f11796b3f273656,0x3ec27b553ef41f07,0x3f05a02c3f1d7fd1,0x3ea218873ed8106b,0x3ef2bd433f13682a,0x3e80f8c03ebb31a0,0x3ed97cb93f08f59b,0x3e3e853e3e9d9e78,0x3ebf926f3efc5d27,0x3df475c03e7ee6e1,0x3ea5129f3ee63375,0x3d55880e3e419b37,0x3e8a11f73ecf7bca,0xbc7b514b3e039502
.quad 0x3e5d4b1a3eb8442a,0xbda973ba3d8a200a,0x3e25c58c3ea09ae5,0xbe195be03bc90f88,0x3ddb7d373e888e93,0xbe5d4b1abd621469,0x3d55880e3e605c13,0xbe901c2cbdee3876,0xbb490fc63e2f10a2,0xbeb0eacbbe354098,0xbd6ea0383dfab273,0xbed0eb2abe72b651,0xbde7fa9a3d96a905,0xbeeff7fbbe97a117,0xbe2bf8043cc90ab0,0xbf06f686beb554ec
.quad 0x3f7fcbe23f7fd397,0x3f7fba9e3f7fc38f,0x3f7e2b723f7e70b0,0x3f7d906e3f7de0b1,0x3f7aed373f7baccd,0x3f7940c03f7a1e84,0x3f76167a3f778bc5,0x3f72d4eb3f748422,0x3f6faf1b3f721352,0x3f6a5ad93f6d1c1d,0x3f67c1873f6b4b0c,0x3f5fe4e93f63f473,0x3f5e5aa63f633c5a,0x3f5389c73f591e6a,0x3f5389c73f59f26a,0x3f4564393f4cae79
.quad 0x3f4760853f4f7a1f,0x3f3592e73f3ebc1b,0x3f39f2ac3f43e200,0x3f24381a3f2f61a5,0x3f2b561b3f373a23,0x3f11796b3f1ebc12,0x3f1ba2993f299415,0x3efafef73f0cead0,0x3f0af1b73f1b02c6,0x3ed0eb2a3ef41f07,0x3ef2bd433f0b9a6b,0x3ea5129f3ecc9b8b,0x3ece0bea3ef6e0cb,0x3e6fa8b23ea395c5,0x3ea80b1f3ed53641,0x3e1324ca3e72b651
.quad 0x3e80f8c03eb263ef,0x3d55880e3e1c76de,0x3e3228d43e8e9a22,0xbd2351cb3d8a200a,0x3dc27c393e541501,0xbe06b26ebc96c9b6,0x3c7b514b3e09cf86,0xbe636c83bdd53db9,0xbd83db0a3d7b2b74,0xbe9f1cdfbe419b37,0xbe1324cabc490e90,0xbecb2aaebe8b9507,0xbe636c83bdafb680,0xbef58035beb554ec,0xbe9920febe22abb6,0xbf0ee0dbbeddbe79
.quad 0xbebf926fbe6c9a7f,0xbf21cbfbbf0242b1,0xbee4cbfebe9aa086,0xbf33587abf14b039,0xbf044889bebe1d4a,0xbf436051bf26050a,0xbf1553b7bee0924f,0xbf51c0c2bf36206c,0xbf256bcbbf00e7e4,0xbf5e5aa6bf44e3f5,0xbf34768fbf10d3cd,0xbf6912aebf5233c6,0xbf425b89bf1ff6cb,0xbf71d19fbf5df6be,0xbf4f0417bf2e3bde,0xbf788486bf6816a8
.quad 0x3ce22a7a3cc90ab0,0x3d0a342f3cfb49ba,0x3da973ba3d96a905,0x3dcefdb73dbc3ac3,0x3e0cec4a3dfab273,0x3e2bf8043e1c76de,0x3e44b0b93e2f10a2,0x3e6fa8b23e5a3997,0x3e7bdba43e605c13,0x3e9920fe3e8b9507,0x3e9920fe3e888e93,0x3eb9bb1e3ea986c4,0x3eb3dca53ea09ae5,0x3ed97cb93ec6d529,0x3ece0bea3eb8442a,0x3ef840c83ee363fa
.quad 0x3ee79a5d3ecf7bca,0x3f0af1b73eff17b2,0x3f003a063ee63375,0x3f19210f3f0cead0,0x3f0c42c93efc5d27,0x3f269de33f19c200,0x3f17de123f08f59b,0x3f33587a3f26050a,0x3f2302d33f13682a,0x3f3f41fc3f31a81d,0x3f2da8593f1d7fd1,0x3f4a4c873f3ca003,0x3f37c6553f273656,0x3f546b3b3f46e22a,0x3f4154e13f3085bb,0x3f5d924d3f5064af
.quad 0x3f4a4c873f396842,0x3f65b7103f591e6a,0x3f52a6493f41d870,0x3f6cd0073f6106f2,0x3f5a5ba03f49d112,0x3f72d4eb3f6816a8,0x3f61668a3f514d3d,0x3f77beb73f6e46be,0x3f67c1873f584853,0x3f7b87b23f73913f,0x3f6d67a13f5ebe05,0x3f7e2b723f77f110,0x3f7254703f64aa59,0x3f7fa6e33f7b61fc,0x3f76841b3f6a09a7,0x3f7ff84a3f7de0b1
.quad 0x3f79f35e3f6ed89e,0x3f7f1f493f7f6ac7,0x3f7c9f8a3f731447,0x3f7d1cdd3f7ffec4,0x3f7e868b3f76ba07,0x3f79f35e3f7f9c18,0x3f7fa6e33f79c79d,0x3f75a67b3f7e4323,0x3f7fffb13f7c3b28,0x3f703b373f7bf531,0x3f7f90b13f7e1324,0x3f69b7e43f78b47b,0x3f7e5a383f7f4e6d,0x3f62241a3f748422,0x3f7c5d3a3f7fec43,0x3f5988ad3f6f6830
.quad 0x3d2351cb3d16c32c,0x3d3c6dd53d2fe007,0x3df475c03de1bc2e,0x3e0cec4a3e039502,0x3e4ada4f3e3b6ecf,0x3e698bba3e5a3997,0x3e8d17c03e827dc0,0x3ea218873e97a117,0x3eb3dca53ea68f12,0x3ece0bea3ec1071e,0x3ed97cb93ec9b953,0x3ef840c83ee900b7,0x3efdbabb3eebcbbb,0x3f102dd53f07a136,0x3f102dd53f064b82,0x3f2302d33f19c200
.quad 0x3f2093933f15f6d9,0x3f34768f3f2ac082,0x3f2ff3e63f24d225,0x3f4463373f3a7ca4,0x3f3e35c53f32c8c9,0x3f52a6493f48d8b3,0x3f4b41fa3f3fc767,0x3f5f20db3f55b993,0x3f5703483f4bbbf8,0x3f69b7e43f6106f2,0x3f61668a3f5695e5,0x3f7254703f6aab7b,0x3f6a5ad93f604621,0x3f78e3d63f7294f8,0x3f71d19f3f68bf3c,0x3f7d57de3f78b47b
.quad 0x3f77beb73f6ff573,0x3f7fa6e33f7cfe73,0x3f7c187a3f75dec6,0x3f7fcbe23f7f6ac7,0x3f7ed7d43f7a7302,0x3f7dc68c3f7ff4e6,0x3f7ff84a3f7dabcc,0x3f799b433f7e9bc9,0x3f7f78083f7f84ab,0x3f73530e3f7b61fc,0x3f7d57de3f7ffb11,0x3f6afb8c3f764d97,0x3f799b433f7f0e58,0x3f60a6cf3f6f6830,0x3f74484b3f7cbfc9,0x3f546b3b3f66becc
.quad 0x3f6d67a13f791298,0x3f4663543f5c61c7,0x3f6504793f740bdd,0x3f36ad7f3f5064af,0x3f5b2c793f6db293,0x3f256bcb3f42de29,0x3f4fefa83f660f88,0x3f12c39a3f33e7bc,0x3f4360513f5d2d53,0x3efdbabb3f239da9,0x3f3592e73f531849,0x3ed3c8673f121eb0,0x3f269de33f47de65,0x3ea80b1f3eff17b2,0x3f16999f3f3b8f3b,0x3e75c35a3ed8106b
.quad 0x3f7fa6e33f7fb10f,0x3f7f90b13f7f9c18,0x3f7cdf6c3f7d3aac,0x3f7c187a3f7c7eb0,0x3f77583a3f7853f8,0x3f75341d3f764d97,0x3f6f20b03f710908,0x3f6afb8c3f6d1c1d,0x3f644fac3f676bd8,0x3f5d924d3f6106f2,0x3f5703483f5b941a,0x3f4d26fd3f5233c6,0x3f4760853f4d9f02,0x3f39f2ac3f40d0da,0x3f3592e73f3daef9,0x3f24381a3f2d1469
.quad 0x3f21cbfb3f2beb4a,0x3f0c42c93f173c07,0x3f0c42c93f187fc0,0x3ee4cbfe3eff17b2,0x3eea66813f039c3d,0x3eadf73c3ecc9b8b,0x3eb9bb1e3edae880,0x3e698bba3e97a117,0x3e870ada3eac7cd4,0x3de7fa9a3e419b37,0x3e25c58c3e78cfcc,0xbb490fc63da3308c,0x3d6ea0383e164083,0xbdf475c0bcfb49ba,0xbd3c6dd53d48fb30,0xbe6fa8b2be1008b7
.quad 0xbe195be0bd48fb30,0xbeb0eacbbe7ee6e1,0xbe80f8c0be164083,0xbee79a5dbeb554ec,0xbeb3dca5be78cfcc,0xbf0d9281bee900b7,0xbee4cbfebeac7cd4,0xbf256bcbbf0cead0,0xbf099f4ebedae880,0xbf3b0629bf239da9,0xbf1f599fbf039c3d,0xbf4e1689bf385216,0xbf33587abf187fc0,0xbf5e5aa6bf4ac77f,0xbf456439bf2beb4a,0xbf6b99fbbf5ac450
.quad 0xbf554aa4bf3daef9,0xbf75a67bbf6816a8,0xbf62df7bbf4d9f02,0xbf7c5d3abf7294f8,0xbf6dfcf2bf5b941a,0xbf7fa6e3bf7a1e84,0xbf76841bbf676bd8,0xbf7f7808bf7e9bc9,0xbf7c5d3abf710908,0xbf7bd14dbf7ffec4,0xbf7f7808bf7853f8,0xbf74bf62bf7e4323,0xbf7fcbe2bf7d3aac,0xbf6a5ad9bf796e4e,0xbf7d57debf7fb10f,0xbf5cc7d1bf718f57
.quad 0x3f7f78083f7f84ab,0x3f7f5ce93f7f6ac7,0x3f7b3bab3f7baccd,0x3f7a49103f7ac516,0x3f72d4eb3f740bdd,0x3f703b373f718f57,0x3f6667713f68bf3c,0x3f61668a3f63f473,0x3f5627fe3f59f26a,0x3f4e16893f5233c6,0x3f425b893f47de65,0x3f36ad7f3f3ca003,0x3f2b561b3f32c8c9,0x3f1ba2993f239da9,0x3f11796b3f1b02c6,0x3efafef73f07a136
.quad 0x3eea66813f00e7e4,0x3eb9bb1e3ed25a09,0x3eadf73c3ec9b953,0x3e698bba3e919ddd,0x3e5d4b1a3e8e9a22,0x3db5f8da3e1c76de,0x3db5f8da3e22abb6,0xbd55880e3c96c9b6,0xbd2351cb3d16c32c,0xbe44b0b9bdee3876,0xbe2bf804bdafb680,0xbea80b1fbe7ee6e1,0xbe9620d2be541501,0xbeea6681bec1071e,0xbed3c867bea68f12,0xbf140c5fbeff17b2
.quad 0xbf06f686bee0924f,0xbf2ff3e6bf1c420c,0xbf21cbfbbf0b9a6b,0xbf485bcabf36206c,0xbf39f2acbf24d225,0xbf5cc7d1bf4cae79,0xbf4f0417bf3b8f3b,0xbf6cd007bf5f8327,0xbf60a6cfbf4f7a1f,0xbf7822d1bf6e46be,0xbf6e8ff8bf604621,0xbf7e868bbf78b47b,0xbf788486bf6db293,0xbf7fdaafbf7e9bc9,0xbf7e5a38bf778bc5,0xbf7c187abf7fe129
.quad 0xbf7ff84abf7dabcc,0xbf73530ebf7c7eb0,0xbf7d57debf7ffb11,0xbf65b710bf748422,0xbf76841bbf7e70b0,0xbf5389c7bf6816a8,0xbf6b99fbbf791298,0xbf3d27b8bf577026,0xbf5cc7d1bf6ff573,0xbf2302d3bf42de29,0xbf4a4c87bf633c5a,0xbf05a02cbf2ac082,0xbf34768fbf531849,0xbecb2aaebf0f8784,0xbf1ba299bf3fc767,0xbe870adabee363fa
.quad 0x3d55880e3d48fb30,0x3d6ea0383d621469,0x3e1f917b3e164083,0x3e3228d43e28defc,0x3e8402703e78cfcc,0x3e931f353e8b9507,0x3eb6ccc33eac7cd4,0x3ecb2aae3ec1071e,0x3ee79a5d3edae880,0x3f003a063ef41f07,0x3f0af1b73f039c3d,0x3f19210f3f121eb0,0x3f2093933f187fc0,0x3f2ff3e63f286605,0x3f34768f3f2beb4a,0x3f4463373f3ca003
.quad 0x3f4663543f3daef9,0x3f5627fe3f4e8d90,0x3f5627fe3f4d9f02,0x3f6504793f5df6be,0x3f6398ac3f5b941a,0x3f70c5013f6aab7b,0x3f6e8ff83f676bd8,0x3f7940c03f748422,0x3f76ef5b3f710908,0x3f7e5a383f7b61fc,0x3f7c9f8a3f7853f8,0x3f7fffb13f7f2f9d,0x3f7f90b13f7d3aac,0x3f7e2b723f7fe129,0x3f7fba9e3f7fb10f,0x3f78e3d63f7d7474
.quad 0x3f7d1cdd3f7fb10f,0x3f703b373f77f110,0x3f77beb73f7d3aac,0x3f644fac3f6f6830,0x3f6faf1b3f7853f8,0x3f554aa43f63f473,0x3f6504793f710908,0x3f4360513f55b993,0x3f57dc7f3f676bd8,0x3f2ecef73f44e3f5,0x3f485bca3f5b941a,0x3f17de123f31a81d,0x3f36ad7f3f4d9f02,0x3efdbabb3f1c420c,0x3f2302d33f3daef9,0x3ec8477c3f04f484
.quad 0x3f0d92813f2beb4a,0x3e901c2c3ed8106b,0x3eed30633f187fc0,0x3e2bf8043ea395c5,0x3ebca7af3f039c3d,0x3d55880e3e5a3997,0x3e8a11f73edae880,0xbd83db0a3dd53db9,0x3e2bf8043eac7cd4,0xbe3857ecbbc90f88,0x3d83db0a3e78cfcc,0xbe9620d2bdee3876,0xbd2351cb3e164083,0xbece0beabe667c66,0xbe1324ca3d48fb30,0xbf019573bea986c4
.quad 0x3d83db0a3d7b2b74,0x3d9064b43d8a200a,0x3e44b0b93e3b6ecf,0x3e57278f3e4dee60,0x3ea218873e9aa086,0x3eb0eacb3ea986c4,0x3edf28a93ed53641,0x3ef2bd433ee900b7,0x3f0c42c93f064b82,0x3f17de123f121eb0,0x3f269de33f1ff6cb,0x3f33587a3f2d1469,0x3f3e35c53f373a23,0x3f4b41fa3f44e3f5,0x3f52a6493f4bbbf8,0x3f5f20db3f591e6a
.quad 0x3f6398ac3f5d2d53,0x3f6e8ff83f696591,0x3f70c5013f6b4b0c,0x3f7940c03f756d97,0x3f79f35e3f75dec6,0x3f7efcc93f7cfe73,0x3f7efcc93f7cbfc9,0x3f7fa6e33f7ff4e6,0x3f7fcbe23f7fd397,0x3f7b3bab3f7e4323,0x3f7c5d3a3f7f0e58,0x3f71d19f3f77f110,0x3f74bf623f7a7302,0x3f6398ac3f6d1c1d,0x3f6912ae3f721352,0x3f50d9373f5df6be
.quad 0x3f5988ad3f660f88,0x3f39f2ac3f4ac77f,0x3f4663543f5695e5,0x3f1f599f3f33e7bc,0x3f2ff3e63f43e200,0x3f0195733f19c200,0x3f16999f3f2e3bde,0x3ec27b553ef9a02d,0x3ef580353f15f6d9,0x3e7bdba43ebb31a0,0x3eb9bb1e3ef6e0cb,0x3ddb7d373e72b651,0x3e75c35a3ebe1d4a,0xbd0a342f3dd53db9,0x3de7fa9a3e827dc0,0xbe3228d4bcfb49ba
.quad 0xbc7b514b3e09cf86,0xbe9f1cdfbe28defc,0xbe1324ca3c490e90,0xbee1fb6abe97a117,0xbe8a11f7bde1bc2e,0xbf102dd5bed8106b,0xbec8477cbe6c9a7f,0xbf2c800fbf0a48ad,0xbf019573beb263ef,0xbf456439bf26050a,0xbf1ce11fbeebcbbb,0xbf5a5ba0bf3ebc1b,0xbf3592e7bf10d3cd,0xbf6afb8cbf53fac3,0xbf4b41fabf299415,0xbf76ef5bbf655e0b
.quad 0x3f7f3f543f7f4e6d,0x3f7f1f493f7f2f9d,0x3f7940c03f79c79d,0x3f7822d13f78b47b,0x3f6d67a13f6ed89e,0x3f6a5ad93f6be858,0x3f5bfb343f5ebe05,0x3f5627fe3f591e6a,0x3f4564393f49d112,0x3f3c17d93f40d0da,0x3f2a2a803f3085bb,0x3f1ce11f3f239da9,0x3f0af1b73f13682a,0x3ef2bd433f0242b1,0x3ed0eb2a3ee63375,0x3ea5129f3ebb31a0
.quad 0x3e870ada3ea09ae5,0x3e25c58c3e5a3997,0x3de7fa9a3e2f10a2,0xbb490fc63d621469,0xbd2351cb3cc90ab0,0xbe2bf804bdd53db9,0xbe44b0b9bdfab273,0xbea80b1fbe8586ce,0xbeadf73cbe888e93,0xbef58035bed25a09,0xbef58035becf7bca,0xbf1e1e22bf0cead0,0xbf1ba299bf08f59b,0xbf3d27b8bf2d1469,0xbf38dd65bf273656,0xbf570348bf48d8b3
.quad 0xbf51c0c2bf41d870,0xbf6afb8cbf5f8327,0xbf65b710bf584853,0xbf788486bf708066,0xbf74484bbf6a09a7,0xbf7f3f54bf7b61fc,0xbf7d1cddbf76ba07,0xbf7efcc9bf7fe129,0xbf7fffb1bf7e1324,0xbf77beb7bf7de0b1,0xbf7cdf6cbf7fec43,0xbf69b7e4bf756d97,0xbf73ced9bf7c3b28,0xbf554aa4bf66becc,0xbf650479bf731447,0xbf3b0629bf5233c6
.quad 0xbf50d937bf64aa59,0xbf1ba299bf385216,0xbf37c655bf514d3d,0xbeeff7fbbf19c200,0xbf1a6293bf396842,0xbea21887beee9479,0xbef2bd43bf1d7fd1,0xbe1f917bbea395c5,0xbeab0201befc5d27,0x3c16cb58be28defc,0xbe3e853ebeb8442a,0x3e3228d4bbc90f88,0xbd0a342fbe605c13,0x3eab02013e1c76de,0x3df475c0bd96a905,0x3ef840c83e9d9e78
.quad 0x3f7efcc93f7f0e58,0x3f7ed7d43f7eea9d,0x3f76ef5b3f778bc5,0x3f75a67b3f764d97,0x3f6715993f68bf3c,0x3f6398ac3f655e0b,0x3f4fefa83f531849,0x3f4955213f4cae79,0x3f3238aa3f373a23,0x3f27ce613f2d1469,0x3f0ee0db3f15f6d9,0x3f003a063f07a136,0x3ece0bea3ee0924f,0x3ea80b1f3ebb31a0,0x3e6fa8b23e8e9a22,0x3e1324ca3e419b37
.quad 0x3d6ea0383de1bc2e,0xbd3c6dd53bc90f88,0xbdf475c0bd7b2b74,0xbe6fa8b2be354098,0xbe9620d2be6c9a7f,0xbed3c867beb554ec,0xbeea6681bec9b953,0xbf140c5fbf04f484,0xbf1ba299bf0b9a6b,0xbf38dd65bf2ac082,0xbf3d27b8bf2e3bde,0xbf570348bf4ac77f,0xbf58b3a1bf4bbbf8,0xbf6d67a1bf63f473,0xbf6d67a1bf633c5a,0xbf7b3babbf756d97
.quad 0xbf7a9c59bf740bdd,0xbf7fffb1bf7e9bc9,0xbf7fe705bf7dabcc,0xbf7b87b2bf7f2f9d,0xbf7d1cddbf7fd397,0xbf6dfcf2bf772417,0xbf725470bf7a7302,0xbf57dc7fbf66becc,0xbf5fe4e9bf6db293,0xbf39f2acbf4e8d90,0xbf466354bf59f26a,0xbf1553b7bf2f61a5,0xbf269de3bf3fc767,0xbed6a399bf0a48ad,0xbf019573bf1ff6cb,0xbe75c35abec1071e
.quad 0xbeb0eacbbef6e0cb,0xbd55880ebe4dee60,0xbe3228d4bea68f12,0x3e0cec4abc96c9b6,0x3b490fc6be22abb6,0x3ea5129f3e28defc,0x3e3857ec3c490e90,0x3efdbabb3eaf713a,0x3eb3dca53e3b6ecf,0x3f269de33f0242b1,0x3f02ef9f3eb263ef,0x3f485bca3f286605,0x3f27ce613f00e7e4,0x3f62df7b3f48d8b3,0x3f4760853f24d225,0x3f75341d3f628210
.quad 0x3d9cecf93d96a905,0x3da973ba3da3308c,0x3e698bba3e605c13,0x3e7bdba43e72b651,0x3ebf926f3eb8442a,0x3ece0bea3ec6d529,0x3f02ef9f3efc5d27,0x3f0c42c93f07a136,0x3f2302d33f1d7fd1,0x3f2da8593f286605,0x3f3f41fc3f396842,0x3f4a4c873f44e3f5,0x3f5703483f514d3d,0x3f61668a3f5c61c7,0x3f69b7e43f64aa59,0x3f7254703f6e46be
.quad 0x3f76ef5b3f731447,0x3f7c9f8a3f7a1e84,0x3f7e5a383f7c3b28,0x3f7fffb13f7f9c18,0x3f7fcbe23f7fec43,0x3f7c5d3a3f7e9bc9,0x3f7b3bab3f7e1324,0x3f71d19f3f772417,0x3f70c5013f76ba07,0x3f60a6cf3f696591,0x3f60a6cf3f6a09a7,0x3f4955213f55b993,0x3f4b41fa3f584853,0x3f2c800f3f3ca003,0x3f3117223f41d870,0x3f0af1b73f1ebc12
.quad 0x3f12c39a3f273656,0x3ecb2aae3ef9a02d,0x3ee1fb6a3f08f59b,0x3e75c35a3eaf713a,0x3e9920fe3ecf7bca,0x3d9cecf93e419b37,0x3e195be03e888e93,0xbdb5f8da3cfb49ba,0xbb490fc63dfab273,0xbe80f8c0be039502,0xbe1f917bbcc90ab0,0xbed0eb2abe919ddd,0xbe9c1fafbe2f10a2,0xbf0d9281beddbe79,0xbee4cbfebea09ae5,0xbf2ecef7bf121eb0
.quad 0xbf140c5fbee63375,0xbf4b41fabf31a81d,0xbf3238aabf13682a,0xbf62241abf4cae79,0xbf4c3578bf3085bb,0xbf72d4ebbf628210,0xbf61668abf49d112,0xbf7cdf6cbf7294f8,0xbf714c7abf5ebe05,0xbf7ffd39bf7c7eb0,0xbf7b87b2bf6ed89e,0xbf7c187abf7ffec4,0xbf7fdaafbf79c79d,0xbf714c7abf7cfe73,0xbf7e2b72bf7f4e6d,0xbf5fe4e9bf73913f
.quad 0x3db5f8da3dafb680,0x3dc27c393dbc3ac3,0x3e870ada3e827dc0,0x3e901c2c3e8b9507,0x3edc53c13ed53641,0x3eea66813ee363fa,0x3f1553b73f10d3cd,0x3f1e1e223f19c200,0x3f37c6553f32c8c9,0x3f4154e13f3ca003,0x3f546b3b3f4f7a1f,0x3f5d924d3f591e6a,0x3f6a5ad93f660f88,0x3f71d19f3f6e46be,0x3f78e3d63f75dec6,0x3f7d57de3f7b61fc
.quad 0x3f7f90b13f7e70b0,0x3f7fba9e3f7ffec4,0x3f7e2b723f7f84ab,0x3f78e3d63f7bf531,0x3f74bf623f791298,0x3f6912ae3f6f6830,0x3f6398ac3f6b4b0c,0x3f50d9373f5ac450,0x3f4b41fa3f5695e5,0x3f3117223f3ebc1b,0x3f2c800f3f3b8f3b,0x3f0af1b73f1c420c,0x3f084b923f1b02c6,0x3ebf926f3ee900b7,0x3ebf926f3eebcbbb,0x3e44b0b93e919ddd
.quad 0x3e5101f13e9aa086,0x3b490fc63dd53db9,0x3ce22a7a3e09cf86,0xbe3e853ebda3308c,0xbe195be0bd16c32c,0xbebca7afbe8586ce,0xbea5129fbe541501,0xbf099f4ebeddbe79,0xbef840c8bebe1d4a,0xbf2ff3e6bf173c07,0xbf21cbfbbf064b82,0xbf4fefa8bf3a7ca4,0xbf425b89bf299415,0xbf686b39bf577026,0xbf5cc7d1bf47de65,0xbf788486bf6d1c1d
.quad 0xbf703b37bf604621,0xbf7fa6e3bf7ac516,0xbf7c187abf721352,0xbf7d906ebf7ff4e6,0xbf7fffb1bf7cbfc9,0xbf725470bf7c7eb0,0xbf7bd14dbf7ffb11,0xbf5e5aa6bf708066,0xbf6faf1bbf7baccd,0xbf425b89bf5c61c7,0xbf5bfb34bf6ff573,0xbf1f599fbf40d0da,0xbf4154e1bf5d2d53,0xbeed3063bf1ebc12,0xbf209393bf43e200,0xbe931f35beee9479
.size tab_a2, 51200
.p2align 8
.type tab_a3,@object
tab_a3:
.quad 0x35e435e435e43564,0x35e435e435e435e4,0x35e235e335e33564,0x35d935dc35de35e0,0x35dc35e035e33564,0x35ba35c535ce35d6,0x35d235dc35e23564,0x358b35a135b535c5,0x35c535d635e03564,0x351c3564359235ae,0x35b535ce35de3564,0x339f34ec35523592,0x35a135c535dc3564,0xb4ec1afb34ec3564,0x358b35ba35d93564,0xb575b4ec339f351c
.quad 0x356435ae35d63564,0xb5aeb564b49e349e,0x352e35a135d23564,0xb5d2b5a1b52e1afb,0x34ec359235ce3564,0xb5e3b5c5b583b49e,0x346e358335ca3564,0xb5deb5dcb5a8b51c,0x1afb356435c53564,0xb5c5b5e4b5c5b564,0xb46e354035c03564,0xb59ab5dcb5d9b592,0xb4ec351c35ba3564,0xb540b5c5b5e3b5ae,0xb52e34ec35b53564,0xb46eb5a1b5e2b5c5
.quad 0xb564349e35ae3564,0x349eb564b5d6b5d6,0xb58b341f35a83564,0x3552b4ecb5c0b5e0,0xb5a11afb35a13564,0x35a19bbcb5a1b5e4,0xb5b5b41f359a3564,0x35ca34ecb575b5e0,0xb5c5b49e35923564,0x35e03564b51cb5d6,0xb5d2b4ec358b3564,0x35e235a1b46eb5c5,0xb5dcb51c35833564,0x35ce35c5341fb5ae,0xb5e2b54035753564,0x35a835dc3509b592
.quad 0xb5e4b56435643564,0x356435e43564b564,0xb5e2b58335523564,0x34c535dc359ab51c,0xb5dcb59235403564,0xb41f35c535bab49e,0xb5d2b5a1352e3564,0xb52e35a135d29bbc,0xb5c5b5ae351c3564,0xb592356435e0349e,0xb5b5b5ba35093564,0xb5c034ec35e3351c,0xb5a1b5c534ec3564,0xb5dc1afb35dc3564,0xb58bb5ce34c53564,0xb5e3b4ec35ca3592
.quad 0x35e435e435e435e4,0x35e435e435e435e4,0x35ca35ce35d235d6,0x35b535ba35c035c5,0x3583359235a135ae,0x34ec351c35403564,0x346e34ec352e3564,0xb52eb4ecb46e1afb,0xb51cb49e1afb349e,0xb5c5b5aeb592b564,0xb5a8b583b52eb49e,0xb5e2b5e3b5d9b5c5,0xb5dcb5c5b5a1b564,0xb5a1b5c5b5dcb5e4,0xb5deb5e3b5d2b5ae,0xb46eb540b59ab5c5
.quad 0xb5aeb5d6b5e4b5d6,0x3564349eb49eb564,0xb52eb5a1b5d2b5e4,0x35d235a1352e9bbc,0x341fb51cb5a1b5d6,0x35dc35e035ba3564,0x3575341fb52eb5ae,0x358b35ce35e335c5,0x35c535649bbcb564,0x1afb356435c535e4,0x35e335ba352eb49e,0xb58bb41f355235c5,0x35ce35e035a1349e,0xb5dcb592b41f3564,0x358b35dc35d23564,0xb5d2b5dcb58b1afb
.quad 0x349e35ae35e435ae,0xb564b5d6b5d6b564,0xb509354035d235d6,0x346eb583b5deb5c5,0xb5a11afb35a135e4,0x35a19bbcb5a1b5e4,0xb5d9b540352e35d6,0x35e23583b4c5b5c5,0xb5e0b5ae1afb35ae,0x35c535d6351cb564,0xb5b5b5dcb52e3564,0x352e35dc35b59bbc,0xb540b5e0b5a1349e,0xb4ec359235e33564,0x339fb5bab5d2b49e,0xb5b5341f35ca35c5
.quad 0x3564b564b5e4b564,0xb5e4b564356435e4,0x35c0b41fb5d2b5ae,0xb5b5b5ceb39f35c5,0x35e3351cb5a1b5d6,0xb4ecb5e0b5833564,0x35d235a1b52eb5e4,0x352eb5a1b5d21afb,0x359235d69bbcb5d6,0x35c5b49eb5e0b564,0x34c535e3352eb5ae,0x35e23540b5a8b5c5,0xb4ec35c535a1b564,0x35a135c5b4ecb5e4,0xb59a358335d2b49e,0x346e35e33509b5c5
.quad 0x35e435e435e435e4,0x35e435e435e435e4,0x359a35a135a835ae,0x35753583358b3592,0xb41f1afb341f349e,0xb540b51cb4ecb49e,0xb5b5b5a1b58bb564,0xb5e2b5dcb5d2b5c5,0xb5e0b5e4b5e0b5d6,0xb592b5aeb5c5b5d6,0xb575b5a1b5c0b5d6,0x3509341fb46eb51c,0x34ec9bbcb4ecb564,0x35dc35c535a13564,0x35ca35a13552349e,0x35a835ce35e235e0
.quad 0x35d635e435d635ae,0xb49e349e356435ae,0x352e35a135d235e4,0xb5d2b5a1b52e1afb,0xb5401afb354035ae,0xb5bab5e0b5dcb5ae,0xb5d9b5a1b509349e,0x339fb540b5b5b5e0,0xb5c5b5e4b5c5b564,0x35c535649bbcb564,0xb4c5b5a1b5deb5d6,0x35ca35e335b5351c,0x35839bbcb583b5d6,0x341f359235dc35d6,0x35e235a1346eb564,0xb5b5b4ec352e35c5
.quad 0x35ae35e435ae349e,0xb5d6b5d6b564349e,0x339f35a135e335ae,0xb4c5b5bab5e2b592,0xb5a11afb35a135e4,0x35a19bbcb5a1b5e4,0xb5e3b5a1339f35ae,0x35de35ba346eb592,0xb592b5e4b592349e,0x351c35d635c5349e,0x346eb5a1b5e2b564,0xb58b34ec35d235c5,0x35ba9bbcb5bab5d6,0xb5e3b59234ec35d6,0x35de35a1b4c5b5d6,0xb552b5e3b58b351c
.quad 0x356435e43564b564,0x3564b564b5e4b564,0xb50935a135d9349e,0x35e33540b58bb5e0,0xb5ce1afb35ce35ae,0x358335e034ecb5ae,0xb5d2b5a1352e35e4,0xb52e35a135d29bbc,0xb51cb5e4b51c35ae,0xb5e0b49e35c535ae,0x3552b5a1b5ca349e,0xb59ab5ce346e35e0,0x35dc9bbcb5dcb564,0x34ecb5c5b5a13564,0x35c035a1b575b5d6,0x35d9b41fb5e2b51c
.quad 0x35e435e435e435e4,0x35e435e435e435e4,0x352e354035523564,0x34c534ec3509351c,0xb5a1b592b583b564,0xb5ceb5c5b5bab5ae,0xb5d2b5dcb5e2b5e4,0xb58bb5a1b5b5b5c5,0x9bbcb49eb51cb564,0x35923564351c349e,0x35d235ba359a3564,0x35ca35dc35e335e0,0x35a135c535dc35e4,0xb4ec1afb34ec3564,0xb52eb41f34c53564,0xb5e3b5dcb5c0b592
.quad 0xb5e4b5d6b5aeb564,0xb49eb564b5aeb5d6,0xb52eb5a1b5d2b5e4,0x35d235a1352e9bbc,0x35a1351cb41fb564,0x358335c535e335d6,0x35d235e335c03564,0xb59ab4ec34c53592,0x1afb356435c535e4,0xb5c5b5e4b5c5b564,0xb5d2b583b39f3564,0x3509b4ecb5a8b5e0,0xb5a1b5e0b5ceb564,0x35e335c53540b49e,0x352eb4ecb5b5b5e4,0x346e35a135e235c5
.quad 0x35e435ae349eb564,0xb5d6b564349e35ae,0x352e35ce35d93564,0xb575b5dcb5cab51c,0xb5a11afb35a135e4,0x35a19bbcb5a1b5e4,0xb5d2b5ceb5093564,0x35c035dc3552b51c,0x9bbcb5aeb5e0b564,0xb51c356435e035ae,0x35d234ecb58bb5e4,0xb5e2b5a1346e35c5,0x35a135e03540b564,0xb41fb5c5b5ceb49e,0xb52e358335e33564,0x35d934ecb59ab5e0
.quad 0xb5e4b564356435e4,0x356435e43564b564,0xb52eb5e3b5753564,0xb5a834ec35de3592,0x35a1b51cb5e3b564,0xb5bab5c5341f35d6,0x35d235a1b52eb5e4,0x352eb5a1b5d21afb,0x1afb35d63592b564,0x35e03564b592b5d6,0xb5d2341f35de3564,0x339f35dc3575b592,0xb5a1b5c534ec35e4,0xb5dc1afb35dc3564,0x352eb5bab5a83564,0xb552b5dc339f35e0
.quad 0x35e435e435e435e4,0x35e435e435e435e4,0x339f341f346e349e,0xb46eb41fb39f1afb,0xb5e3b5e0b5dcb5d6,0xb5dcb5e0b5e3b5e4,0xb46eb4ecb52eb564,0x352e34ec346e9bbc,0x35e035d635c535ae,0x35c535d635e035e4,0x34c53540358b35ae,0xb58bb540b4c51afb,0xb5dcb5c5b5a1b564,0xb5a1b5c5b5dcb5e4,0xb509b583b5b5b5d6,0x35b5358335099bbc
.quad 0x35d635ae3564349e,0x356435ae35d635e4,0x352e35a135d235e4,0xb5d2b5a1b52e1afb,0xb5ceb592b4ec349e,0xb4ecb592b5ceb5e4,0xb552b5bab5e2b5d6,0x35e235ba35529bbc,0x35c535649bbcb564,0x1afb356435c535e4,0x357535ce35e235ae,0xb5e2b5ceb5751afb,0xb5bab51c34ec35ae,0x34ecb51cb5bab5e4,0xb58bb5dcb5d2b564,0x35d235dc358b9bbc
.quad 0x35ae349eb564b5d6,0xb564349e35ae35e4,0x359a35e335b5349e,0xb5b5b5e3b59a1afb,0xb5a11afb35a135e4,0x35a19bbcb5a1b5e4,0xb5a8b5e3b58b349e,0x358b35e335a89bbc,0x3592b49eb5c5b5d6,0xb5c5b49e359235e4,0x35b535dc352eb564,0xb52eb5dcb5b51afb,0xb583351c35dc35ae,0x35dc351cb583b5e4,0xb5c0b5ceb46e35ae,0x346e35ce35c09bbc
.quad 0x3564b564b5e4b564,0xb5e4b564356435e4,0x35ca35bab46eb5d6,0x346eb5bab5ca1afb,0xb540359235dc349e,0x35dc3592b540b5e4,0xb5d2b5a1352e35e4,0xb52e35a135d29bbc,0x351cb5aeb5c5349e,0xb5c5b5ae351c35e4,0x35d93583b58bb5d6,0x358bb583b5d91afb,0xb4ec35c535a1b564,0x35a135c5b4ecb5e4,0xb5deb54035b535ae,0xb5b5354035de9bbc
.quad 0x35e435e435e435e4,0x35e435e435e435e4,0xb509b4ecb4c5b49e,0xb552b540b52eb51c,0xb5bab5c5b5ceb5d6,0xb583b592b5a1b5ae,0x35b535a1358b3564,0x35e235dc35d235c5,0x351c3564359235ae,0xb51cb49e1afb349e,0xb5e3b5dcb5cab5ae,0xb59ab5bab5d2b5e0,0x34ec9bbcb4ecb564,0x35dc35c535a13564,0x35c035dc35e335d6,0xb4c5341f352e3592
.quad 0xb5aeb564b49e349e,0xb5aeb5d6b5e4b5d6,0xb52eb5a1b5d2b5e4,0x35d235a1352e9bbc,0x35e335c53583349e,0xb41f351c35a135d6,0xb4c534ec359a35d6,0xb5c0b5e3b5d2b592,0xb5c5b5e4b5c5b564,0x35c535649bbcb564,0x35a834ecb509b5ae,0x339f358335d235e0,0x354035c535e335ae,0xb5ceb5e0b5a1b49e,0xb5e2b5a1b46e3564,0x35b534ecb52eb5c5
.quad 0x349eb564b5d6b5d6,0x349e35ae35e435ae,0x35ca35dc3575b49e,0xb5d9b5ceb52e351c,0xb5a11afb35a135e4,0x35a19bbcb5a1b5e4,0xb552b5dcb5c0b49e,0x350935ce35d2351c,0x35e03564b51cb5d6,0xb5e0b5ae1afb35ae,0xb46e35a135e23564,0x358bb4ecb5d2b5c5,0xb5ceb5c5b41f35ae,0x354035e035a1b49e,0x359ab4ecb5d9b5ae,0xb5e3b583352e35e0
.quad 0x356435e43564b564,0x3564b564b5e4b564,0xb5deb4ec35a835d6,0x357535e3352eb592,0x341fb5c5b5ba349e,0xb5e3b51c35a135d6,0x35d235a1b52eb5e4,0x352eb5a1b5d21afb,0xb592356435e0349e,0x359235d69bbcb5d6,0xb575b5dcb39f35d6,0xb5deb41f35d23592,0x35dc9bbcb5dcb564,0x34ecb5c5b5a13564,0xb39f35dc3552b5ae,0x35a835bab52eb5e0
.quad 0x35e435e435e435e4,0x35e435e435e435e4,0xb58bb583b575b564,0xb5a8b5a1b59ab592,0xb4ecb51cb540b564,0x341f9bbcb41fb49e,0x35d235dc35e235e4,0x358b35a135b535c5,0xb5c5b5aeb592b564,0xb5e0b5e4b5e0b5d6,0x346eb41fb509b564,0x35c035a13575351c,0x35a135c535dc35e4,0xb4ec1afb34ec3564,0xb5e2b5ceb5a8b564,0xb552b5a1b5cab5e0
.quad 0x3564349eb49eb564,0x35d635e435d635ae,0x352e35a135d235e4,0xb5d2b5a1b52e1afb,0xb5dcb5e0b5bab564,0x35409bbcb540b5ae,0x35b53540b39fb564,0x350935a135d935e0,0x1afb356435c535e4,0xb5c5b5e4b5c5b564,0xb5b5b5e3b5cab564,0x35de35a134c5b51c,0x35dc3592341fb564,0xb5831afb358335d6,0xb52e34ec35b535e4,0xb46eb5a1b5e2b5c5
.quad 0xb564b5d6b5d6b564,0x35ae35e435ae349e,0x35e235ba34c5b564,0xb5e3b5a1b39f3592,0xb5a11afb35a135e4,0x35a19bbcb5a1b5e4,0xb46eb5bab5deb564,0xb39f35a135e33592,0x35c535d6351cb564,0xb592b5e4b592349e,0xb5d2b4ec358b35e4,0x35e235a1b46eb5c5,0x34ecb592b5e3b564,0xb5ba1afb35ba35d6,0x358b35e33552b564,0x34c5b5a1b5deb51c
.quad 0xb5e4b564356435e4,0x356435e43564b564,0x358bb540b5e3b564,0xb5d9b5a1350935e0,0x34ec35e03583b564,0x35ce9bbcb5ceb5ae,0xb5d2b5a1352e35e4,0xb52e35a135d29bbc,0x35c5b49eb5e0b564,0xb51cb5e4b51c35ae,0xb46e35ce359ab564,0x35ca35a1b552b5e0,0xb5a1b5c534ec35e4,0xb5dc1afb35dc3564,0x35e2341fb5d9b564,0x3575b5a1b5c0351c
.quad 0x35e435e435e435e4,0x35e435e435e435e4,0xb5c0b5bab5b5b5ae,0xb5d2b5ceb5cab5c5,0x3540351c34ec349e,0x35a1359235833564,0x346e34ec352e3564,0xb52eb4ecb46e1afb,0xb592b5aeb5c5b5d6,0x9bbcb49eb51cb564,0x35d935e335e235d6,0x352e358335a835c5,0xb5dcb5c5b5a1b564,0xb5a1b5c5b5dcb5e4,0x359a3540346eb49e,0x35d235e335de35c5
.quad 0xb49e349e356435ae,0xb5e4b5d6b5aeb564,0xb52eb5a1b5d2b5e4,0x35d235a1352e9bbc,0x35ba35e035dc35ae,0xb5a1b51c341f3564,0xb5e3b5ceb58bb49e,0x352eb41fb575b5c5,0x35c535649bbcb564,0x1afb356435c535e4,0xb552341f358b35d6,0xb52eb5bab5e3b5c5,0xb41fb592b5dcb5d6,0x35a135e035ce3564,0x358b35dc35d23564,0xb5d2b5dcb58b1afb
.quad 0xb5d6b5d6b564349e,0x35e435ae349eb564,0x35de3583b46eb5ae,0xb5d2b540350935c5,0xb5a11afb35a135e4,0x35a19bbcb5a1b5e4,0x34c5b583b5e2b5ae,0xb52e354035d935c5,0x351c35d635c5349e,0x9bbcb5aeb5e0b564,0xb5b5b5dcb52e3564,0x352e35dc35b59bbc,0x35e33592b4ecb5d6,0xb5a1b5e0b5403564,0xb5cab41f35b535d6,0x35d235bab39fb5c5
.quad 0x3564b564b5e4b564,0xb5e4b564356435e4,0x339f35ce35b5b49e,0x35d2341fb5c0b5c5,0xb583b5e0b4ec35ae,0xb5a1351c35e33564,0x35d235a1b52eb5e4,0x352eb5a1b5d21afb,0xb5e0b49e35c535ae,0x1afb35d63592b564,0x35a8b540b5e2b49e,0xb52eb5e3b4c535c5,0xb4ec35c535a1b564,0x35a135c5b4ecb5e4,0xb509b5e3b46e35d6,0xb5d2b583359a35c5
.quad 0x35e435e435e435e4,0x35e435e435e435e4,0xb5deb5dcb5d9b5d6,0xb5e3b5e3b5e2b5e0,0x35ce35c535ba35ae,0x35e335e035dc35d6,0xb5b5b5a1b58bb564,0xb5e2b5dcb5d2b5c5,0x35923564351c349e,0x35e035d635c535ae,0xb552b4ecb39f349e,0xb5deb5ceb5b5b592,0x34ec9bbcb4ecb564,0x35dc35c535a13564,0xb39f34ec357535ae,0xb5d9b5bab58bb51c
.quad 0xb49eb564b5aeb5d6,0x35d635ae3564349e,0x352e35a135d235e4,0xb5d2b5a1b52e1afb,0xb583b5c5b5e3b5d6,0x35ce359234ecb49e,0x35a835dc35de35ae,0xb5cab583b46e351c,0xb5c5b5e4b5c5b564,0x35c535649bbcb564,0x35d935dc359a349e,0xb5c0b540346e3592,0xb5e3b5c5b540349e,0x35ba351cb4ecb5ae,0x35e235a1346eb564,0xb5b5b4ec352e35c5
.quad 0xb5d6b564349e35ae,0x35ae349eb564b5d6,0x35c034ecb552b5d6,0xb5a8b41f358b35e0,0xb5a11afb35a135e4,0x35a19bbcb5a1b5e4,0x3575b4ecb5cab5d6,0xb59a341f35b535e0,0xb51c356435e035ae,0x3592b49eb5c5b5d6,0x346eb5a1b5e2b564,0xb58b34ec35d235c5,0x341f35c535ce349e,0x3583b51cb5dcb5ae,0xb509b5dcb5a8349e,0xb575354035e23592
.quad 0x356435e43564b564,0x3564b564b5e4b564,0xb59ab5dcb4c535ae,0xb552358335e2351c,0x35ba35c5b41fb5d6,0x3540b592b5dcb49e,0xb5d2b5a1352e35e4,0xb52e35a135d29bbc,0x35e03564b592b5d6,0x351cb5aeb5c5349e,0xb5e3b4ec35c035ae,0xb50935ba35b5b51c,0x35dc9bbcb5dcb564,0x34ecb5c5b5a13564,0xb5ca34ec35e3349e,0xb4c535ce358bb592
.quad 0x8000800080003564,0x8000800080008000,0xb41fb39f8000b564,0xb4ecb4c5b49eb46e,0xb49eb41f80003564,0xb564b540b51cb4ec,0xb4ecb46e8000b564,0xb5a1b58bb564b52e,0xb51cb49e80003564,0xb5c5b5aeb592b564,0xb540b4c58000b564,0xb5dcb5cab5aeb58b,0xb564b4ec80003564,0xb5e4b5dcb5c5b5a1,0xb583b5098000b564,0xb5dcb5e3b5d6b5b5
.quad 0xb592b51c80003564,0xb5c5b5e0b5e0b5c5,0xb5a1b52e8000b564,0xb5a1b5d2b5e4b5d2,0xb5aeb54080003564,0xb564b5bab5e0b5dc,0xb5bab5528000b564,0xb4ecb59ab5d6b5e2,0xb5c5b56480003564,0x9b7bb564b5c5b5e4,0xb5ceb5758000b564,0x34ecb509b5aeb5e2,0xb5d6b58380003564,0x3564b41fb592b5dc,0xb5dcb58b8000b564,0x35a1346eb564b5d2
.quad 0xb5e0b59280003564,0x35c5351cb51cb5c5,0xb5e3b59a8000b564,0x35dc3575b49eb5b5,0xb5e4b5a180003564,0x35e435a19b7bb5a1,0xb5e3b5a88000b564,0x35dc35c0349eb58b,0xb5e0b5ae80003564,0x35c535d6351cb564,0xb5dcb5b58000b564,0x35a135e23564b52e,0xb5d6b5ba80003564,0x356435e33592b4ec,0xb5ceb5c08000b564,0x34ec35d935aeb46e
.quad 0xb5c5b5c580003564,0x800035c535c59b7b,0xb5bab5ca8000b564,0xb4ec35a835d6346e,0xb5aeb5ce80003564,0xb564358335e034ec,0xb5a1b5d28000b564,0xb5a1352e35e4352e,0xb592b5d680003564,0xb5c5349e35e03564,0xb583b5d98000b564,0xb5dcb39f35d6358b,0xb564b5dc80003564,0xb5e4b4ec35c535a1,0xb540b5de8000b564,0xb5dcb55235ae35b5
.quad 0x8000800080008000,0x8000800080008000,0xb540b52eb51cb509,0xb583b575b564b552,0xb5aeb5a1b592b583,0xb5d6b5ceb5c5b5ba,0xb5dcb5d2b5c5b5b5,0xb5dcb5e2b5e4b5e2,0xb5e0b5e4b5e0b5d6,0xb592b5aeb5c5b5d6,0xb5bab5d2b5e0b5e3,0xb41fb509b564b59a,0xb564b5a1b5c5b5dc,0x356434ec9b7bb4ec,0xb41fb52eb592b5c0,0x35ce35a8356434c5
.quad 0x351c9b7bb51cb592,0x35e035e035c53592,0x35a1352e9b7bb52e,0x35a135d235e435d2,0x35d635a1351cb41f,0x349e358335c535e3,0x35e335d2359234c5,0xb540339f356435c0,0x35c535e435c53564,0xb5c5b56480003564,0x358335d235e035a8,0xb5e3b5cab564339f,0x349e35a135e035ce,0xb5aeb5e3b5c5b540,0xb4ec352e35c535e2,0xb4ecb5b5b5e4b5b5
.quad 0xb5928000359235e0,0x351cb51cb5c5b5e0,0xb5ceb52e351c35ca,0x35ba34c5b564b5d9,0xb5e4b5a1800035a1,0x35e435a19b7bb5a1,0xb5ceb5d2b51c3552,0x35ba35de3564b509,0xb592b5e4b592349e,0x351c35d635c5349e,0xb4ecb5d2b5c5b46e,0xb4ec358b35e4358b,0x349eb5a1b5e0b540,0xb5ae341f35c535ce,0x3583b52eb5e0b59a,0xb5e3b552356435e3
.quad 0x35c59b7bb5c5b5c5,0xb5c5b5c5800035c5,0x35e3352eb592b5de,0xb540b5e3b5643575,0x35d635a1b51cb5e3,0x349eb5bab5c5341f,0x35a135d29b7bb5d2,0x35a1b52eb5e4b52e,0x351c35e4351cb5ae,0x35e0349eb5c5b5ae,0xb41f35d23592b575,0x35ce359ab564b5de,0xb56435a135c5b4ec,0x356435dc9b7bb5dc,0xb5ba352e35e0339f,0xb41f35d93564b5a8
.quad 0x8000800080008000,0x8000800080008000,0xb5a1b59ab592b58b,0xb5bab5b5b5aeb5a8,0xb5e4b5e3b5e0b5dc,0xb5d6b5dcb5e0b5e3,0xb5a1b5b5b5c5b5d2,0xb4ecb52eb564b58b,0x9b7bb49eb51cb564,0x35923564351c349e,0x35a13575351c346e,0x35e335e235d635c0,0x35e435dc35c535a1,0x356435a135c535dc,0x35a135ca35e035e2,0xb540b46e349e3552
.quad 0x8000351c359235c5,0xb5e0b5c5b592b51c,0xb5a1b52e8000352e,0xb5a1b5d2b5e4b5d2,0xb5e4b5ceb592b4ec,0x349eb4ecb592b5ce,0xb5a1b5d9b5e0b5b5,0x35ce358b349eb509,0x9b7bb564b5c5b5e4,0x35c535e435c53564,0x35a134c5b51cb5b5,0x341f358b35d635de,0x35e435ba351cb4ec,0xb5aeb4ec351c35ba,0x35a135e235c5352e,0xb5dcb5d2b564346e
.quad 0x8000359235e035c5,0xb51cb5c5b5e0b592,0xb5a1b39f359235e2,0x3583b46eb5aeb5e3,0xb5e4b5a1800035a1,0x35e435a19b7bb5a1,0xb5a1b5e3b592346e,0x358335e235ae339f,0x9b7bb5aeb5e0b564,0xb51c356435e035ae,0x35a1b46eb5c5b5d2,0xb5dcb52e356435e2,0x35e43583b51cb5dc,0xb5aeb5dcb51c3583,0x35a135de351cb58b,0x341fb5b5b5d6b4c5
.quad 0x800035c535c59b7b,0x35c59b7bb5c5b5c5,0xb5a1350935e0358b,0x35ce35b5b49eb5d9,0xb5e4b540359235dc,0x349e35dc3592b540,0xb5a1b5d2800035d2,0xb5a1352e35e4352e,0x9b7bb5d6b5923564,0xb5e0b564359235d6,0x35a1b552b5e0b46e,0xb540b5e2b49e35ca,0x35e434ecb5c5b5a1,0x3564b5a1b5c534ec,0x35a135c0b51cb5e2,0x35e3346eb5d6b575
.quad 0x8000800080008000,0x8000800080008000,0xb5ceb5cab5c5b5c0,0xb5dcb5d9b5d6b5d2,0xb5aeb5bab5c5b5ce,0xb564b583b592b5a1,0x34ec346e9b7bb46e,0x35a1358b3564352e,0x35e035d635c535ae,0x35c535d635e035e4,0x358335a835c535d9,0xb4ecb39f349e352e,0xb564b4ec800034ec,0xb5e4b5dcb5c5b5a1,0xb5e3b5deb5c5b59a,0xb4ecb575b5aeb5d2
.quad 0xb51cb592b5c5b5e0,0x35c53592351c9b7b,0x35a1352e9b7bb52e,0x35a135d235e435d2,0x35d635e335c53583,0xb564b41f351c35a1,0x341f357535c535e3,0xb5dcb5deb5aeb52e,0xb5c5b56480003564,0x9b7bb564b5c5b5e4,0xb5bab5e3b5c5b552,0x35dc359a349eb52e,0x349eb540b5c5b5e3,0x356435ce35e035a1,0x35dc358b9b7bb58b,0xb5a1b46e356435d2
.quad 0x359235e035c5351c,0xb5c5b5e0b5928000,0xb540350935c535de,0x34ecb552b5d6b5d2,0xb5e4b5a1800035a1,0x35e435a19b7bb5a1,0xb540b5d9b5c5b4c5,0x34ec35ca35d6352e,0x3592b49eb5c5b5d6,0xb5c5b49e359235e4,0x35dc35b59b7bb5b5,0xb5a1b5e2b564352e,0x349e35ce35c5341f,0x3564b540b5e0b5a1,0xb5ba339f35c535ca,0x35dc35a8b49eb5d2
.quad 0xb5c5b5c5800035c5,0x800035c535c59b7b,0x341fb5c0b5c5339f,0xb5dcb4c535ae35d2,0x35d6341fb5c5b5ba,0xb564b5e3b51c35a1,0x35a135d29b7bb5d2,0x35a1b52eb5e4b52e,0xb51c35ae35c5b49e,0x35c535aeb51cb5e4,0xb5e3b4c535c535a8,0xb4ec35c035aeb52e,0xb564b5dc800035dc,0xb5e4b4ec35c535a1,0x3583b59ab5c53509,0xb4ecb5e3b49e35d2
.quad 0x8000800080008000,0x8000800080008000,0xb5e3b5e2b5e0b5de,0xb5e3b5e3b5e4b5e3,0xb49eb4ecb51cb540,0x349e341f9b7bb41f,0x35dc35d235c535b5,0x35dc35e235e435e2,0x351c3564359235ae,0xb51cb49e8000349e,0xb5ceb5b5b592b552,0xb5ceb5deb5e4b5de,0xb564b5a1b5c5b5dc,0x356434ec9b7bb4ec,0x35ba358b351c339f,0x35ba35d935e435d9
.quad 0x359235c535e035e0,0xb592b51c8000351c,0xb5a1b52e8000352e,0xb5a1b5d2b5e4b5d2,0xb5aeb5dcb5e0b5ba,0x35ae35409b7bb540,0x3583346eb51cb5a8,0x358335ca35e435ca,0x35c535e435c53564,0xb5c5b56480003564,0xb540346e359235d9,0xb540b5c0b5e4b5c0,0xb5d6b5dcb592b41f,0x35d635839b7bb583,0x34ecb52eb5c5b5e2,0x34ec35b535e435b5
.quad 0x35e035c5351cb51c,0xb5e0b59280003592,0xb41f358b35e035c0,0xb41fb5a8b5e4b5a8,0xb5e4b5a1800035a1,0x35e435a19b7bb5a1,0xb41fb5b5b5e0b575,0xb41f359a35e4359a,0x35e03564b51cb5d6,0xb5e0b5ae800035ae,0x34ec35d235c5346e,0x34ecb58bb5e4b58b,0xb5d6b4ec359235e3,0x35d635ba9b7bb5ba,0xb540b5e2b5923509,0xb540357535e43575
.quad 0x35c59b7bb5c5b5c5,0xb5c5b5c5800035c5,0x358335e2351cb59a,0x3583b552b5e4b552,0xb5ae34ec35e03583,0x35ae35ce9b7bb5ce,0xb5a1b5d2800035d2,0xb5a1352e35e4352e,0x3592b564b5e0b49e,0xb592b5d6800035d6,0x35ba35b5b51cb5e3,0x35bab509b5e4b509,0xb56435a135c5b4ec,0x356435dc9b7bb5dc,0xb5ceb58b359235ca,0xb5ce34c535e434c5
.quad 0x8000800080008000,0x8000800080008000,0xb5dcb5deb5e0b5e2,0xb5ceb5d2b5d6b5d9,0x35643540351c34ec,0x35ae35a135923583,0x35a135b535c535d2,0x34ec352e3564358b,0xb5c5b5aeb592b564,0xb5e0b5e4b5e0b5d6,0xb4ecb552b592b5b5,0x3583352e349eb39f,0x35e435dc35c535a1,0x356435a135c535dc,0xb4ec339f351c358b,0xb5e3b5d2b5aeb575
.quad 0xb5c5b5e0b5e0b5c5,0x351c9b7bb51cb592,0x35a1352e9b7bb52e,0x35a135d235e435d2,0x356435ba35e035dc,0xb5d6b5a1b51c341f,0xb5dcb5a8b51c346e,0x341fb52eb5aeb5de,0x9b7bb564b5c5b5e4,0x35c535e435c53564,0x35dc35d93592346e,0xb5bab52e349e359a,0xb564341f359235dc,0xb49eb5a1b5e0b5ce,0xb5a1b5e2b5c5b52e,0x35dc35d23564b46e
.quad 0x35c5351cb51cb5c5,0xb5928000359235e0,0x34ec35c035e0358b,0xb540b5d2b5d6b552,0xb5e4b5a1800035a1,0x35e435a19b7bb5a1,0x34ecb575b5e0b5b5,0xb540352e35d635ca,0x35c535d6351cb564,0xb592b5e4b592349e,0xb5a1346e35c535d2,0x35dc352eb564b5e2,0xb564b5e3b59234ec,0xb49e35a135e03540,0x35dc3509b592b5e2,0xb5bab5d2b49e35a8
.quad 0x800035c535c59b7b,0x35c59b7bb5c5b5c5,0xb5dcb59a351c35e2,0x341f35d235aeb4c5,0x3564b583b5e0b4ec,0xb5d6b5a1351c35e3,0x35a135d29b7bb5d2,0x35a1b52eb5e4b52e,0xb5c5349e35e03564,0x351c35e4351cb5ae,0xb4ecb5e3b51c35b5,0xb5e3b52e35ae35c0,0x35e434ecb5c5b5a1,0x3564b5a1b5c534ec,0xb4ec35ca3592b58b,0x358335d2b49eb5e3
.quad 0x8000800080008000,0x8000800080008000,0xb5bab5c0b5c5b5ca,0xb5a1b5a8b5aeb5b5,0x35d635ce35c535ba,0x35e435e335e035dc,0xb4ecb46e8000346e,0xb5a1b58bb564b52e,0xb592b5aeb5c5b5d6,0x9b7bb49eb51cb564,0x35e335d935c535a8,0x35a135c035d635e2,0xb564b4ec800034ec,0xb5e4b5dcb5c5b5a1,0xb540b59ab5c5b5de,0x35a13552349eb46e
.quad 0x35e035e035c53592,0x8000351c359235c5,0xb5a1b52e8000352e,0xb5a1b5d2b5e4b5d2,0xb49eb583b5c5b5e3,0x35e435ce359234ec,0x35ce35e335c53575,0xb5a1b509349e358b,0xb5c5b56480003564,0x9b7bb564b5c5b5e4,0x341fb552b5c5b5e3,0x35a135de35d6358b,0x35ae35e335c53540,0xb5e4b5bab51c34ec,0xb5dcb58b8000358b,0x35a1346eb564b5d2
.quad 0x351cb51cb5c5b5e0,0x8000359235e035c5,0x358335de35c53509,0xb5a1b5e3b5aeb46e,0xb5e4b5a1800035a1,0x35e435a19b7bb5a1,0x3583b4c5b5c5b5d9,0xb5a1339f35ae35e2,0x351c35d635c5349e,0x9b7bb5aeb5e0b564,0xb5dcb5b5800035b5,0x35a135e23564b52e,0x35aeb41fb5c5b5ce,0xb5e4b583351c35dc,0x341f35ca35c5339f,0x35a1b4c5b5d6b5b5
.quad 0xb5c5b5c5800035c5,0x800035c535c59b7b,0x35ce339fb5c5b5c0,0xb5a1b5d9b49e35b5,0xb49e35ba35c5b41f,0x35e43540b592b5dc,0xb5a1b5d2800035d2,0xb5a1352e35e4352e,0x35e0349eb5c5b5ae,0x9b7bb5d6b5923564,0xb54035a835c5b4c5,0x35a135cab49eb5e2,0xb564b5dc800035dc,0xb5e4b4ec35c535a1,0x35e33509b5c5b59a,0x35a1b575b5d6346e
.quad 0x8000800080008000,0x8000800080008000,0xb583b58bb592b59a,0xb540b552b564b575,0x35d635dc35e035e3,0x35ae35ba35c535ce,0xb5dcb5d2b5c5b5b5,0xb5dcb5e2b5e4b5e2,0x35923564351c349e,0x35e035d635c535ae,0xb41f346e351c3575,0xb5bab59ab564b509,0xb564b5a1b5c5b5dc,0x356434ec9b7bb4ec,0x35ce35e235e035ca,0xb41f34c5356435a8
.quad 0xb5e0b5c5b592b51c,0xb51cb592b5c5b5e0,0x35a1352e9b7bb52e,0x35a135d235e435d2,0xb49e34ec359235ce,0xb5d6b5e3b5c5b583,0xb540b5b5b5e0b5d9,0x35e335c03564339f,0x35c535e435c53564,0xb5c5b56480003564,0xb5e3b5b5b51c34c5,0x3583339fb564b5ca,0x35ae34ecb51cb5ba,0xb49e354035c535e3,0xb4ec352e35c535e2,0xb4ecb5b5b5e4b5b5
.quad 0xb51cb5c5b5e0b592,0x359235e035c5351c,0x35ba35e23592b39f,0xb5ceb5d9b56434c5,0xb5e4b5a1800035a1,0x35e435a19b7bb5a1,0x35ba346eb592b5e3,0xb5ceb509356435de,0xb51c356435e035ae,0x3592b49eb5c5b5d6,0xb4ecb5d2b5c5b46e,0xb4ec358b35e4358b,0x35ae35dc351cb583,0xb49eb5ceb5c5b41f,0xb5e3b58b351c35de,0x358335e33564b552
.quad 0x35c59b7bb5c5b5c5,0xb5c5b5c5800035c5,0xb540358b35e03509,0x35e33575b564b5e3,0xb49eb5dcb5923540,0xb5d6b41f35c535ba,0x35a135d29b7bb5d2,0x35a1b52eb5e4b52e,0xb5e0b564359235d6,0xb51c35ae35c5b49e,0x35ceb46eb5e0b552,0xb41fb5deb564359a,0xb56435a135c5b4ec,0x356435dc9b7bb5dc,0xb41fb5e2b51c35c0,0xb5bab5a8356435d9
.quad 0x8000800080008000,0x8000800080008000,0xb4ecb509b51cb52e,0xb41fb46eb49eb4c5,0x35643583359235a1,0x349e34ec351c3540,0xb5a1b5b5b5c5b5d2,0xb4ecb52eb564b58b,0x35c535d635e035e4,0x351c3564359235ae,0xb5dcb5e3b5e0b5d2,0xb540b58bb5aeb5ca,0x35e435dc35c535a1,0x356435a135c535dc,0xb5dcb5c0b592b52e,0xb583b5b5b5d6b5e3
.quad 0x35c53592351c9b7b,0x359235c535e035e0,0xb5a1b52e8000352e,0xb5a1b5d2b5e4b5d2,0x3564341fb51cb5a1,0x35ae35dc35e035ba,0xb4ec34c5359235d2,0xb5bab5e2b5d6b59a,0x9b7bb564b5c5b5e4,0x35c535e435c53564,0x34ec35a835e035d2,0xb5ceb5e2b5aeb509,0xb564b5ceb5e0b5a1,0x35d635dc3592341f,0x35a135e235c5352e,0xb5dcb5d2b564346e
.quad 0xb5c5b5e0b5928000,0x35e035c5351cb51c,0x35dc35ca351cb52e,0xb5e3b5b5b49e3575,0xb5e4b5a1800035a1,0x35e435a19b7bb5a1,0x35dc3552b51cb5d2,0xb5e3b58b349e35c0,0xb5c5b49e359235e4,0x35e03564b51cb5d6,0x35a1b46eb5c5b5d2,0xb5dcb52e356435e2,0xb564354035e035a1,0x35d634ecb592b5e3,0x34ecb59ab5e0b52e,0xb5ceb46e35ae35d9
.quad 0x800035c535c59b7b,0x35c59b7bb5c5b5c5,0xb4ecb5deb592352e,0xb5ba346e35d635a8,0x356435e3351cb5a1,0x35aeb4ecb5e0b583,0xb5a1b5d2800035d2,0xb5a1352e35e4352e,0x35c535aeb51cb5e4,0x3592b564b5e0b49e,0xb5dcb575359235d2,0xb583358b35d6b39f,0x35e434ecb5c5b5a1,0x3564b5a1b5c534ec,0xb5dc339f35e0352e,0xb54035b535aeb552
.quad 0x80008000,0x0,0x9afbb39f,0x0,0x8000341f,0x0,0x9afbb46e,0x0,0x8000349e,0x0,0x9afbb4c5,0x0,0x800034ec,0x0,0x9afbb509,0x0
.quad 0x8000351c,0x0,0x9afbb52e,0x0,0x80003540,0x0,0x9afbb552,0x0,0x80003564,0x0,0x9afbb575,0x0,0x80003583,0x0,0x9afbb58b,0x0
.quad 0x80003592,0x0,0x9afbb59a,0x0,0x800035a1,0x0,0x9afbb5a8,0x0,0x800035ae,0x0,0x9afbb5b5,0x0,0x800035ba,0x0,0x9afbb5c0,0x0
.quad 0x800035c5,0x0,0x9afbb5ca,0x0,0x800035ce,0x0,0x9afbb5d2,0x0,0x800035d6,0x0,0x9afbb5d9,0x0,0x800035dc,0x0,0x9afbb5de,0x0
.quad 0x0,0x0,0x0,0x0,0x0,0x0,0x0,0x0,0x0,0x0,0x0,0x0,0x0,0x0,0x0,0x0
.quad 0x0,0x0,0x0,0x0,0x0,0x0,0x0,0x0,0x0,0x0,0x0,0x0,0x0,0x0,0x0,0x0
.quad 0x0,0x0,0x0,0x0,0x0,0x0,0x0,0x0,0x0,0x0,0x0,0x0,0x0,0x0,0x0,0x0
.quad 0x0,0x0,0x0,0x0,0x0,0x0,0x0,0x0,0x0,0x0,0x0,0x0,0x0,0x0,0x0,0x0
.quad 0xb564b5d6349e3564,0xb5d6b56435ae35ae,0xb52eb5dc346e3564,0xb5b5b5a1358b35c5,0xb4ecb5e0341f3564,0xb583b5c5354035d6,0xb46eb5e3339f3564,0xb509b5dc34c535e0,0x9bbcb5e41afb3564,0x9bbcb5e41afb35e4,0x346eb5e3b39f3564,0x3509b5dcb4c535e0,0x34ecb5e0b41f3564,0x3583b5c5b54035d6,0x352eb5dcb46e3564,0x35b5b5a1b58b35c5
.quad 0x3564b5d6b49e3564,0x35d6b564b5ae35ae,0x358bb5ceb4c53564,0x35e3b4ecb5ca3592,0x35a1b5c5b4ec3564,0x35dc9bbcb5dc3564,0x35b5b5bab5093564,0x35c034ecb5e3351c,0x35c5b5aeb51c3564,0x35923564b5e0349e,0x35d2b5a1b52e3564,0x352e35a1b5d21afb,0x35dcb592b5403564,0x341f35c5b5bab49e,0x35e2b583b5523564,0xb4c535dcb59ab51c
.quad 0x35e4b564b5643564,0xb56435e4b564b564,0x35e2b540b5753564,0xb5a835dcb509b592,0x35dcb51cb5833564,0xb5ce35c5b41fb5ae,0x35d2b4ecb58b3564,0xb5e235a1346eb5c5,0x35c5b49eb5923564,0xb5e03564351cb5d6,0x35b5b41fb59a3564,0xb5ca34ec3575b5e0,0x35a19bbcb5a13564,0xb5a11afb35a1b5e4,0x358b341fb5a83564,0xb552b4ec35c0b5e0
.quad 0x3564349eb5ae3564,0xb49eb56435d6b5d6,0x352e34ecb5b53564,0x346eb5a135e2b5c5,0x34ec351cb5ba3564,0x3540b5c535e3b5ae,0x346e3540b5c03564,0x359ab5dc35d9b592,0x1afb3564b5c53564,0x35c5b5e435c5b564,0xb46e3583b5ca3564,0x35deb5dc35a8b51c,0xb4ec3592b5ce3564,0x35e3b5c53583b49e,0xb52e35a1b5d23564,0x35d2b5a1352e9bbc
.quad 0xb5d6349e35e4349e,0xb56435ae35aeb564,0xb5e2b4ec35d23564,0xb5d234ec35e29bbc,0xb5bab59235a135ae,0xb5dcb51c35ce3564,0xb552b5ce352e35d6,0xb58bb5ba357535c5,0x9bbcb5e41afb35e4,0x9bbcb5e41afb35e4,0x3552b5ceb52e35d6,0x358bb5bab57535c5,0x35bab592b5a135ae,0x35dcb51cb5ce3564,0x35e2b4ecb5d23564,0x35d234ecb5e21afb
.quad 0x35d6349eb5e4349e,0x356435aeb5aeb564,0x359a3583b5d2b49e,0xb46e35e3b509b5c5,0x34ec35c5b5a1b564,0xb5a135c534ecb5e4,0xb4c535e3b52eb5ae,0xb5e2354035a8b5c5,0xb59235d69bbcb5d6,0xb5c5b49e35e0b564,0xb5d235a1352eb5e4,0xb52eb5a135d29bbc,0xb5e3351c35a1b5d6,0x34ecb5e035833564,0xb5c0b41f35d2b5ae,0x35b5b5ce339f35c5
.quad 0xb564b56435e4b564,0x35e4b564b56435e4,0xb39fb5ba35d2b49e,0x35b5341fb5ca35c5,0x3540b5e035a1349e,0x34ec3592b5e33564,0x35b5b5dc352e3564,0xb52e35dcb5b51afb,0x35e0b5ae1afb35ae,0xb5c535d6b51cb564,0x35d9b540b52e35d6,0xb5e2358334c5b5c5,0x35a19bbcb5a135e4,0xb5a11afb35a1b5e4,0x35093540b5d235d6,0xb46eb58335deb5c5
.quad 0xb49e35aeb5e435ae,0x3564b5d635d6b564,0xb58b35dcb5d23564,0x35d2b5dc358b9bbc,0xb5ce35e0b5a1349e,0x35dcb592341f3564,0xb5e335bab52eb49e,0x358bb41fb55235c5,0xb5c535649bbcb564,0x1afb3564b5c535e4,0xb575341f352eb5ae,0xb58b35ceb5e335c5,0xb41fb51c35a1b5d6,0xb5dc35e0b5ba3564,0x352eb5a135d2b5e4,0xb5d235a1b52e1afb
.quad 0x349e35e4349eb5d6,0x35ae35aeb564b5d6,0xb58b35a135b5b564,0xb46e35dc352eb5c5,0xb5e31afb35e3349e,0xb5ce351c35dcb49e,0xb5a8b5a1359a35ae,0xb5c0b58335b53592,0x9bbcb5e41afb35e4,0x9bbcb5e41afb35e4,0x35a8b5a1b59a35ae,0x35c0b583b5b53592,0x35e39bbcb5e3349e,0x35ce351cb5dcb49e,0x358b35a1b5b5b564,0x346e35dcb52eb5c5
.quad 0xb49e35e4b49eb5d6,0xb5ae35ae3564b5d6,0xb5c035a13575b5d6,0xb5d9b41f35e2b51c,0xb5dc1afb35dcb564,0xb4ecb5c535a13564,0xb552b5a135ca349e,0x359ab5ceb46e35e0,0x351cb5e4351c35ae,0x35e0b49eb5c535ae,0x35d2b5a1b52e35e4,0x352e35a1b5d21afb,0x35ce9bbcb5ce35ae,0xb58335e0b4ecb5ae,0x350935a1b5d9349e,0xb5e33540358bb5e0
.quad 0xb56435e4b564b564,0xb564b56435e4b564,0xb5de35a134c5b5d6,0x3552b5e3358b351c,0xb5ba1afb35bab5d6,0x35e3b592b4ec35d6,0xb46eb5a135e2b564,0x358b34ecb5d235c5,0x3592b5e43592349e,0xb51c35d6b5c5349e,0x35e3b5a1b39f35ae,0xb5de35bab46eb592,0x35a19bbcb5a135e4,0xb5a11afb35a1b5e4,0xb39f35a1b5e335ae,0x34c5b5ba35e2b592
.quad 0xb5ae35e4b5ae349e,0x35d6b5d63564349e,0xb5e235a1b46eb564,0x35b5b4ecb52e35c5,0xb5831afb3583b5d6,0xb41f3592b5dc35d6,0x34c5b5a135deb5d6,0xb5ca35e3b5b5351c,0x35c5b5e435c5b564,0xb5c535649bbcb564,0x35d9b5a13509349e,0xb39fb54035b5b5e0,0x35409bbcb54035ae,0x35bab5e035dcb5ae,0xb52e35a1b5d235e4,0x35d2b5a1352e9bbc
.quad 0x35e4349eb5d6b564,0x35aeb564b5d6349e,0x352e35dcb46eb5e4,0x35b535a1b58bb5c5,0xb5a1359235bab564,0xb54035c53583b5ae,0xb5d2b54035ca3564,0xb5deb4ec35d9351c,0x9bbcb5e41afb35e4,0x9bbcb5e41afb35e4,0x35d2b540b5ca3564,0x35deb4ecb5d9351c,0x35a13592b5bab564,0x354035c5b583b5ae,0xb52e35dc346eb5e4,0xb5b535a1358bb5c5
.quad 0xb5e4349e35d6b564,0xb5aeb56435d6349e,0xb52eb5ba35a83564,0x3552b5dcb39f35e0,0x35a1b5c5b4ec35e4,0x35dc9bbcb5dc3564,0x35d2341fb5de3564,0xb39f35dcb575b592,0x1afb35d6b592b564,0xb5e035643592b5d6,0xb5d235a1352eb5e4,0xb52eb5a135d29bbc,0xb5a1b51c35e3b564,0x35bab5c5b41f35d6,0x352eb5e335753564,0x35a834ecb5de3592
.quad 0x35e4b564b56435e4,0xb56435e4b564b564,0x352e3583b5e33564,0xb5d934ec359ab5e0,0xb5a135e0b540b564,0x341fb5c535ceb49e,0xb5d234ec358bb5e4,0x35e2b5a1b46e35c5,0x9bbcb5ae35e0b564,0x351c3564b5e035ae,0x35d2b5ce35093564,0xb5c035dcb552b51c,0x35a19bbcb5a135e4,0xb5a11afb35a1b5e4,0xb52e35ceb5d93564,0x3575b5dc35cab51c
.quad 0xb5e435aeb49eb564,0x35d6b564b49e35ae,0xb52eb4ec35b5b5e4,0xb46e35a1b5e235c5,0x35a1b5e035ceb564,0xb5e335c5b540b49e,0x35d2b583339f3564,0xb509b4ec35a8b5e0,0x1afb3564b5c535e4,0x35c5b5e435c5b564,0xb5d235e3b5c03564,0x359ab4ecb4c53592,0xb5a1351c341fb564,0xb58335c5b5e335d6,0x352eb5a135d2b5e4,0xb5d235a1b52e1afb
.quad 0x349eb5d6b56435ae,0xb564b5d6349e35e4,0x35e234ecb5d2b564,0x35d2b4ecb5e21afb,0xb41f35e034ecb5d6,0x34ec35e0b41fb5e4,0xb5e3b41f35e2349e,0xb5e2341f35e39bbc,0x9bbcb5e41afb35e4,0x9bbcb5e41afb35e4,0x35e3b41fb5e2349e,0x35e2341fb5e31afb,0x341f35e0b4ecb5d6,0xb4ec35e0341fb5e4,0xb5e234ec35d2b564,0xb5d2b4ec35e29bbc
.quad 0xb49eb5d6356435ae,0x3564b5d6b49e35e4,0x35deb540b5b535ae,0x35b53540b5de1afb,0x34ec35c5b5a1b564,0xb5a135c534ecb5e4,0xb5d93583358bb5d6,0xb58bb58335d99bbc,0xb51cb5ae35c5349e,0x35c5b5aeb51c35e4,0x35d2b5a1b52e35e4,0x352e35a1b5d21afb,0x35403592b5dc349e,0xb5dc35923540b5e4,0xb5ca35ba346eb5d6,0xb46eb5ba35ca9bbc
.quad 0xb564b56435e4b564,0x35e4b564b56435e4,0x35c0b5ce346e35ae,0xb46e35ceb5c01afb,0x3583351cb5dc35ae,0xb5dc351c3583b5e4,0xb5b535dcb52eb564,0x352eb5dc35b59bbc,0xb592b49e35c5b5d6,0x35c5b49eb59235e4,0x35a8b5e3358b349e,0xb58b35e3b5a81afb,0x35a19bbcb5a135e4,0xb5a11afb35a1b5e4,0xb59a35e3b5b5349e,0x35b5b5e3359a9bbc
.quad 0xb5ae349e3564b5d6,0x3564349eb5ae35e4,0x358bb5dc35d2b564,0xb5d235dcb58b1afb,0x35bab51cb4ec35ae,0xb4ecb51c35bab5e4,0xb57535ceb5e235ae,0x35e2b5ce35759bbc,0xb5c535649bbcb564,0x1afb3564b5c535e4,0x3552b5ba35e2b5d6,0xb5e235bab5521afb,0x35ceb59234ec349e,0x34ecb59235ceb5e4,0xb52e35a1b5d235e4,0x35d2b5a1352e9bbc
.quad 0xb5d6b56435ae35ae,0xb5d6349e35e4349e,0x358bb5a1b5b53564,0x346eb5dcb52e35c5,0x358335c5b540b5d6,0x35ba3592b5a1b5ae,0xb5d934ec35deb49e,0xb5ca354035d2b51c,0x9bbcb5e41afb35e4,0x9bbcb5e41afb35e4,0x35d934ecb5deb49e,0x35ca3540b5d2b51c,0xb58335c53540b5d6,0xb5ba359235a1b5ae,0xb58bb5a135b53564,0xb46eb5dc352e35c5
.quad 0x35d6b564b5ae35ae,0x35d6349eb5e4349e,0x339f35dcb552b5ae,0xb5a835ba352eb5e0,0xb5dc1afb35dcb564,0xb4ecb5c535a13564,0x3575b5dc339f35d6,0x35deb41fb5d23592,0x35923564b5e0349e,0xb59235d69bbcb5d6,0xb5d235a1352eb5e4,0xb52eb5a135d29bbc,0xb41fb5c535ba349e,0x35e3b51cb5a135d6,0x35deb4ecb5a835d6,0xb57535e3b52eb592
.quad 0xb56435e4b564b564,0xb564b56435e4b564,0xb59ab4ec35d9b5ae,0x35e3b583b52e35e0,0x35ceb5c5341f35ae,0xb54035e0b5a1b49e,0x346e35a1b5e23564,0xb58bb4ec35d2b5c5,0xb5e03564351cb5d6,0x35e0b5ae1afb35ae,0x3552b5dc35c0b49e,0xb50935ceb5d2351c,0x35a19bbcb5a135e4,0xb5a11afb35a1b5e4,0xb5ca35dcb575b49e,0x35d9b5ce352e351c
.quad 0xb49eb56435d6b5d6,0xb49e35aeb5e435ae,0x35e2b5a1346e3564,0xb5b534ec352eb5c5,0xb54035c5b5e335ae,0x35ceb5e035a1b49e,0xb5a834ec3509b5ae,0xb39f3583b5d235e0,0x35c5b5e435c5b564,0xb5c535649bbcb564,0x34c534ecb59a35d6,0x35c0b5e335d2b592,0xb5e335c5b583349e,0x341f351cb5a135d6,0x352eb5a135d2b5e4,0xb5d235a1b52e1afb
.quad 0xb56435ae35aeb564,0x349e35e4349eb5d6,0xb52eb5dc346e35e4,0xb5b5b5a1358b35c5,0x35dc351cb5ceb564,0x35e39bbcb5e3b49e,0xb5b5358335c0b564,0xb59a35a135a8b592,0x9bbcb5e41afb35e4,0x9bbcb5e41afb35e4,0x35b53583b5c0b564,0x359a35a1b5a8b592,0xb5dc351c35ceb564,0xb5e31afb35e3b49e,0x352eb5dcb46e35e4,0x35b5b5a1b58b35c5
.quad 0x356435aeb5aeb564,0xb49e35e4b49eb5d6,0xb5e2341f35d9b564,0xb575b5a135c0351c,0x35a1b5c5b4ec35e4,0x35dc9bbcb5dc3564,0x346e35ceb59ab564,0xb5ca35a13552b5e0,0xb5c5b49e35e0b564,0x351cb5e4351c35ae,0x35d2b5a1b52e35e4,0x352e35a1b5d21afb,0xb4ec35e0b583b564,0xb5ce1afb35ceb5ae,0xb58bb54035e3b564,0x35d9b5a1b50935e0
.quad 0x35e4b564b56435e4,0xb56435e4b564b564,0xb58b35e3b552b564,0xb4c5b5a135deb51c,0xb4ecb59235e3b564,0x35ba9bbcb5ba35d6,0x35d2b4ecb58b35e4,0xb5e235a1346eb5c5,0xb5c535d6b51cb564,0x3592b5e43592349e,0x346eb5ba35deb564,0x339f35a1b5e33592,0x35a19bbcb5a135e4,0xb5a11afb35a1b5e4,0xb5e235bab4c5b564,0x35e3b5a1339f3592
.quad 0x3564b5d635d6b564,0xb5ae35e4b5ae349e,0x352e34ecb5b535e4,0x346eb5a135e2b5c5,0xb5dc3592b41fb564,0x35839bbcb58335d6,0x35b5b5e335cab564,0xb5de35a1b4c5b51c,0x1afb3564b5c535e4,0x35c5b5e435c5b564,0xb5b53540339fb564,0xb50935a1b5d935e0,0x35dcb5e035bab564,0xb5401afb3540b5ae,0xb52e35a1b5d235e4,0x35d2b5a1352e9bbc
.quad 0x35ae35aeb564b5d6,0x35e4349eb5d6b564,0xb5e2b4ec35d23564,0xb5d234ec35e29bbc,0x35ceb51cb5dc349e,0x35a1b592b5ba3564,0xb57535ba358bb5ae,0xb52e35ce3552b5c5,0x9bbcb5e41afb35e4,0x9bbcb5e41afb35e4,0x357535bab58bb5ae,0x352e35ceb552b5c5,0xb5ceb51c35dc349e,0xb5a1b59235ba3564,0x35e2b4ecb5d23564,0x35d234ecb5e21afb
.quad 0xb5ae35ae3564b5d6,0xb5e4349e35d6b564,0x3509b5e3346e35d6,0x35d2b583b59a35c5,0x34ec35c5b5a1b564,0xb5a135c534ecb5e4,0xb5a8b54035e2b49e,0x352eb5e334c535c5,0x35e0b49eb5c535ae,0x1afb35d6b592b564,0xb5d235a1352eb5e4,0xb52eb5a135d29bbc,0x3583b5e034ec35ae,0x35a1351cb5e33564,0xb39f35ceb5b5b49e,0xb5d2341f35c0b5c5
.quad 0xb564b56435e4b564,0x35e4b564b56435e4,0x35cab41fb5b535d6,0xb5d235ba339fb5c5,0xb5e3359234ecb5d6,0x35a1b5e035403564,0x35b5b5dc352e3564,0xb52e35dcb5b51afb,0xb51c35d6b5c5349e,0x9bbcb5ae35e0b564,0xb4c5b58335e2b5ae,0x352e3540b5d935c5,0x35a19bbcb5a135e4,0xb5a11afb35a1b5e4,0xb5de3583346eb5ae,0x35d2b540b50935c5
.quad 0x35d6b5d63564349e,0xb5e435aeb49eb564,0xb58b35dcb5d23564,0x35d2b5dc358b9bbc,0x341fb59235dcb5d6,0xb5a135e0b5ce3564,0x3552341fb58b35d6,0x352eb5ba35e3b5c5,0xb5c535649bbcb564,0x1afb3564b5c535e4,0x35e3b5ce358bb49e,0xb52eb41f3575b5c5,0xb5ba35e0b5dc35ae,0x35a1b51cb41f3564,0x352eb5a135d2b5e4,0xb5d235a1b52e1afb
.quad 0x35aeb564b5d6349e,0x349eb5d6b56435ae,0xb58b35a135b5b564,0xb46e35dc352eb5c5,0x3540b5c5b58335ae,0x341fb5e0b4ec35d6,0xb4c535dc3509b5d6,0xb39f35e3346eb5e0,0x9bbcb5e41afb35e4,0x9bbcb5e41afb35e4,0x34c535dcb509b5d6,0x339f35e3b46eb5e0,0xb540b5c5358335ae,0xb41fb5e034ec35d6,0x358b35a1b5b5b564,0x346e35dcb52eb5c5
.quad 0xb5aeb56435d6349e,0xb49eb5d6356435ae,0x35ca34ecb5e3349e,0x34c535ceb58bb592,0xb5dc1afb35dcb564,0xb4ecb5c535a13564,0x35e3b4ecb5c035ae,0x350935bab5b5b51c,0xb5e035643592b5d6,0xb51cb5ae35c5349e,0x35d2b5a1b52e35e4,0x352e35a1b5d21afb,0xb5ba35c5341fb5d6,0xb540b59235dcb49e,0x359ab5dc34c535ae,0x35523583b5e2351c
.quad 0xb56435e4b564b564,0xb564b56435e4b564,0x3509b5dc35a8349e,0x35753540b5e23592,0xb41f35c5b5ce349e,0xb583b51c35dcb5ae,0xb46eb5a135e2b564,0x358b34ecb5d235c5,0x351c3564b5e035ae,0xb592b49e35c5b5d6,0xb575b4ec35cab5d6,0x359a341fb5b535e0,0x35a19bbcb5a135e4,0xb5a11afb35a1b5e4,0xb5c034ec3552b5d6,0x35a8b41fb58b35e0
.quad 0x35d6b564b49e35ae,0xb5ae349e3564b5d6,0xb5e235a1b46eb564,0x35b5b4ecb52e35c5,0x35e3b5c53540349e,0xb5ba351c34ecb5ae,0xb5d935dcb59a349e,0x35c0b540b46e3592,0x35c5b5e435c5b564,0xb5c535649bbcb564,0xb5a835dcb5de35ae,0x35cab583346e351c,0x3583b5c535e3b5d6,0xb5ce3592b4ecb49e,0xb52e35a1b5d235e4,0x35d2b5a1352e9bbc
.quad 0xb51cb5e080003564,0xb5c5b592359235c5,0xb4ecb5e28000b564,0xb5a1b5b5356435d2,0xb49eb5e380003564,0xb564b5ce351c35dc,0xb41fb5e38000b564,0xb4ecb5de349e35e2,0x9b7bb5e480003564,0x9b7bb5e4800035e4,0x341fb5e38000b564,0x34ecb5deb49e35e2,0x349eb5e380003564,0x3564b5ceb51c35dc,0x34ecb5e28000b564,0x35a1b5b5b56435d2
.quad 0x351cb5e080003564,0x35c5b592b59235c5,0x3540b5de8000b564,0x35dcb552b5ae35b5,0x3564b5dc80003564,0x35e4b4ecb5c535a1,0x3583b5d98000b564,0x35dcb39fb5d6358b,0x3592b5d680003564,0x35c5349eb5e03564,0x35a1b5d28000b564,0x35a1352eb5e4352e,0x35aeb5ce80003564,0x35643583b5e034ec,0x35bab5ca8000b564,0x34ec35a8b5d6346e
.quad 0x35c5b5c580003564,0x800035c5b5c58000,0x35ceb5c08000b564,0xb4ec35d9b5aeb46e,0x35d6b5ba80003564,0xb56435e3b592b4ec,0x35dcb5b58000b564,0xb5a135e2b564b52e,0x35e0b5ae80003564,0xb5c535d6b51cb564,0x35e3b5a88000b564,0xb5dc35c0b49eb58b,0x35e4b5a180003564,0xb5e435a19b7bb5a1,0x35e3b59a8000b564,0xb5dc3575349eb5b5
.quad 0x35e0b59280003564,0xb5c5351c351cb5c5,0x35dcb58b8000b564,0xb5a1346e3564b5d2,0x35d6b58380003564,0xb564b41f3592b5dc,0x35ceb5758000b564,0xb4ecb50935aeb5e2,0x35c5b56480003564,0x9b7bb56435c5b5e4,0x35bab5528000b564,0x34ecb59a35d6b5e2,0x35aeb54080003564,0x3564b5ba35e0b5dc,0x35a1b52e8000b564,0x35a1b5d235e4b5d2
.quad 0xb5e0800035e0351c,0xb592359235c5b51c,0xb5dcb52e35c5358b,0xb5dc346e35e4346e,0xb5aeb5a1359235ba,0xb5d6b54035c53583,0xb540b5d2351c35d9,0xb583b5c0356435ca,0x9b7bb5e4800035e4,0x9b7bb5e4800035e4,0x3540b5d2b51c35d9,0x3583b5c0b56435ca,0x35aeb5a1b59235ba,0x35d6b540b5c53583,0x35dcb52eb5c5358b,0x35dc346eb5e4346e
.quad 0x35e09b7bb5e0351c,0x35923592b5c5b51c,0x35ba352eb5e0339f,0x341f35d9b564b5a8,0x356435a1b5c5b4ec,0xb56435dc9b7bb5dc,0x341f35d2b592b575,0xb5ce359a3564b5de,0xb51c35e4b51cb5ae,0xb5e0349e35c5b5ae,0xb5a135d29b7bb5d2,0xb5a1b52e35e4b52e,0xb5d635a1351cb5e3,0xb49eb5ba35c5341f,0xb5e3352e3592b5de,0x3540b5e335643575
.quad 0xb5c5800035c5b5c5,0x35c5b5c5800035c5,0xb583b52e35e0b59a,0x35e3b552b56435e3,0xb49eb5a135e0b540,0x35ae341fb5c535ce,0x34ecb5d235c5b46e,0x34ec358bb5e4358b,0x3592b5e43592349e,0xb51c35d6b5c5349e,0x35ceb5d2351c3552,0xb5ba35deb564b509,0x35e4b5a1800035a1,0xb5e435a19b7bb5a1,0x35ceb52eb51c35ca,0xb5ba34c53564b5d9
.quad 0x35929b7bb59235e0,0xb51cb51c35c5b5e0,0x34ec352eb5c535e2,0x34ecb5b535e4b5b5,0xb49e35a1b5e035ce,0x35aeb5e335c5b540,0xb58335d2b5e035a8,0x35e3b5ca3564339f,0xb5c535e4b5c53564,0x35c5b56480003564,0xb5e335d2b59234c5,0x3540339fb56435c0,0xb5d635a1b51cb41f,0xb49e3583b5c535e3,0xb5a1352e9b7bb52e,0xb5a135d2b5e435d2
.quad 0x800035e0351cb5c5,0x359235c5b51cb5e0,0xb5a1358b35c5b52e,0xb4ec35d23564b5b5,0xb5e4b41f35e034ec,0xb5d634ec35e0b41f,0xb5a1b5a8359235b5,0xb5bab58b35ae359a,0x9b7bb5e4800035e4,0x9b7bb5e4800035e4,0x35a1b5a8b59235b5,0x35bab58bb5ae359a,0x35e4b41fb5e034ec,0x35d634ecb5e0b41f,0x35a1358bb5c5b52e,0x34ec35d2b564b5b5
.quad 0x800035e0b51cb5c5,0xb59235c5351cb5e0,0xb5a135c0351cb5e2,0xb5e3346e35d6b575,0xb5e434ec35c5b5a1,0xb564b5a135c534ec,0xb5a1b55235e0b46e,0x3540b5e2349e35ca,0x9b7bb5d635923564,0x35e0b564b59235d6,0x35a1b5d2800035d2,0x35a1352eb5e4352e,0x35e4b540b59235dc,0xb49e35dcb592b540,0x35a13509b5e0358b,0xb5ce35b5349eb5d9
.quad 0x800035c5b5c58000,0xb5c5800035c5b5c5,0xb5a135deb51cb58b,0xb41fb5b535d6b4c5,0xb5e43583351cb5dc,0x35aeb5dc351c3583,0xb5a1b46e35c5b5d2,0x35dcb52eb56435e2,0x9b7bb5ae35e0b564,0x351c3564b5e035ae,0x35a1b5e33592346e,0xb58335e2b5ae339f,0x35e4b5a1800035a1,0xb5e435a19b7bb5a1,0x35a1b39fb59235e2,0xb583b46e35aeb5e3
.quad 0x80003592b5e035c5,0x351cb5c535e0b592,0xb5a135e2b5c5352e,0x35dcb5d23564346e,0xb5e435bab51cb4ec,0x35aeb4ecb51c35ba,0xb5a134c5351cb5b5,0xb41f358bb5d635de,0x9b7bb56435c5b5e4,0xb5c535e4b5c53564,0x35a1b5d935e0b5b5,0xb5ce358bb49eb509,0x35e4b5ce3592b4ec,0xb49eb4ec3592b5ce,0x35a1b52e8000352e,0x35a1b5d235e4b5d2
.quad 0x35e0351cb5c5b592,0x35c5b51cb5e08000,0x34ec35e29b7bb5e2,0x35a135b5b564b5d2,0xb5ae358335c5b540,0xb56435ba3592b5a1,0xb5ceb55235c53575,0xb5dcb50935d6352e,0x9b7bb5e4800035e4,0x9b7bb5e4800035e4,0x35ceb552b5c53575,0x35dcb509b5d6352e,0x35ae3583b5c5b540,0x356435bab592b5a1,0xb4ec35e29b7bb5e2,0xb5a135b53564b5d2
.quad 0xb5e0351c35c5b592,0xb5c5b51c35e09b7b,0xb583b59a35c53509,0x34ecb5e3349e35d2,0x3564b5dc800035dc,0x35e4b4ecb5c535a1,0x35e3b4c5b5c535a8,0x34ec35c0b5aeb52e,0x351c35aeb5c5b49e,0xb5c535ae351cb5e4,0xb5a135d29b7bb5d2,0xb5a1b52e35e4b52e,0xb5d6341f35c5b5ba,0x3564b5e3351c35a1,0xb41fb5c035c5339f,0x35dcb4c5b5ae35d2
.quad 0x35c5b5c5800035c5,0x800035c5b5c58000,0x35ba339fb5c535ca,0xb5dc35a8349eb5d2,0xb49e35ceb5c5341f,0xb564b54035e0b5a1,0xb5dc35b59b7bb5b5,0x35a1b5e23564352e,0xb592b49e35c5b5d6,0x35c5b49eb59235e4,0x3540b5d935c5b4c5,0xb4ec35cab5d6352e,0x35e4b5a1800035a1,0xb5e435a19b7bb5a1,0x35403509b5c535de,0xb4ecb55235d6b5d2
.quad 0xb59235e0b5c5351c,0x35c5b5e035929b7b,0xb5dc358b9b7bb58b,0x35a1b46eb56435d2,0xb49eb54035c5b5e3,0xb56435ceb5e035a1,0x35bab5e335c5b552,0xb5dc359ab49eb52e,0x35c5b56480003564,0x9b7bb56435c5b5e4,0xb41f3575b5c535e3,0x35dcb5de35aeb52e,0xb5d635e3b5c53583,0x3564b41fb51c35a1,0xb5a1352e9b7bb52e,0xb5a135d2b5e435d2
.quad 0x351cb5c5b5923592,0xb51cb5e0800035e0,0x35dc352eb5c5b58b,0x35dcb46eb5e4b46e,0xb49e35dc351cb5ce,0x349e35e39b7bb5e3,0xb5e3b46e35e034c5,0xb5e3339f35e4339f,0x9b7bb5e4800035e4,0x9b7bb5e4800035e4,0x35e3b46eb5e034c5,0x35e3339fb5e4339f,0x349e35dcb51cb5ce,0xb49e35e39b7bb5e3,0xb5dc352e35c5b58b,0xb5dcb46e35e4b46e
.quad 0xb51cb5c535923592,0x351cb5e0800035e0,0x35ceb58bb59235ca,0x35ce34c5b5e434c5,0x356435a1b5c5b4ec,0xb56435dc9b7bb5dc,0xb5ba35b5351cb5e3,0xb5bab50935e4b509,0xb592b56435e0b49e,0x3592b5d6800035d6,0x35a1b5d2800035d2,0x35a1352eb5e4352e,0x35ae34ecb5e03583,0xb5ae35ce9b7bb5ce,0xb58335e2b51cb59a,0xb583b55235e4b552
.quad 0xb5c5800035c5b5c5,0x35c5b5c5800035c5,0x3540b5e235923509,0x35403575b5e43575,0x35d6b4ecb59235e3,0xb5d635ba9b7bb5ba,0xb4ec35d2b5c5346e,0xb4ecb58b35e4b58b,0xb5e03564351cb5d6,0x35e0b5ae800035ae,0x341fb5b535e0b575,0x341f359ab5e4359a,0x35e4b5a1800035a1,0xb5e435a19b7bb5a1,0x341f358bb5e035c0,0x341fb5a835e4b5a8
.quad 0xb5e035c5b51cb51c,0x35e0b59280003592,0xb4ecb52e35c5b5e2,0xb4ec35b5b5e435b5,0x35d6b5dc3592b41f,0xb5d635839b7bb583,0x3540346eb59235d9,0x3540b5c035e4b5c0,0xb5c535e4b5c53564,0x35c5b56480003564,0xb583346e351cb5a8,0xb58335cab5e435ca,0x35aeb5dc35e0b5ba,0xb5ae35409b7bb540,0x35a1b52e8000352e,0x35a1b5d235e4b5d2
.quad 0xb5c5b592359235c5,0xb5e0800035e0351c,0x35a1b58bb5c5352e,0x34ecb5d2b56435b5,0x356435ceb51cb5dc,0x35ae35a1b592b5ba,0xb5dc34c535e0b46e,0xb5ce352e35d6b509,0x9b7bb5e4800035e4,0x9b7bb5e4800035e4,0x35dc34c5b5e0b46e,0x35ce352eb5d6b509,0xb56435ce351cb5dc,0xb5ae35a13592b5ba,0xb5a1b58b35c5352e,0xb4ecb5d2356435b5
.quad 0x35c5b592b59235c5,0x35e09b7bb5e0351c,0x34ec35cab592b58b,0xb58335d2349eb5e3,0xb5e434ec35c5b5a1,0xb564b5a135c534ec,0x34ecb5e3351c35b5,0x35e3b52eb5ae35c0,0x35c5349eb5e03564,0xb51c35e4b51cb5ae,0xb5a135d29b7bb5d2,0xb5a1b52e35e4b52e,0xb564b58335e0b4ec,0x35d6b5a1b51c35e3,0x35dcb59ab51c35e2,0xb41f35d2b5aeb4c5
.quad 0x800035c5b5c58000,0xb5c5800035c5b5c5,0xb5dc35093592b5e2,0x35bab5d2349e35a8,0x3564b5e3359234ec,0x349e35a1b5e03540,0x35a1346eb5c535d2,0xb5dc352e3564b5e2,0xb5c535d6b51cb564,0x3592b5e43592349e,0xb4ecb57535e0b5b5,0x3540352eb5d635ca,0x35e4b5a1800035a1,0xb5e435a19b7bb5a1,0xb4ec35c0b5e0358b,0x3540b5d235d6b552
.quad 0xb5c5351c351cb5c5,0x35929b7bb59235e0,0x35a1b5e235c5b52e,0xb5dc35d2b564b46e,0x3564341fb59235dc,0x349eb5a135e0b5ce,0xb5dc35d9b592346e,0x35bab52eb49e359a,0x9b7bb56435c5b5e4,0xb5c535e4b5c53564,0x35dcb5a8351c346e,0xb41fb52e35aeb5de,0xb56435bab5e035dc,0x35d6b5a1351c341f,0xb5a1352e9b7bb52e,0xb5a135d2b5e435d2
.quad 0xb592359235c5b51c,0x800035e0351cb5c5,0xb4ecb5e2800035e2,0xb5a1b5b5356435d2,0x35d63540b5c5b583,0x35e4341fb5e0b4ec,0xb5ba357535c5b552,0xb5a1359a35aeb58b,0x9b7bb5e4800035e4,0x9b7bb5e4800035e4,0x35ba3575b5c5b552,0x35a1359ab5aeb58b,0xb5d6354035c5b583,0xb5e4341f35e0b4ec,0x34ecb5e2800035e2,0x35a1b5b5b56435d2
.quad 0x35923592b5c5b51c,0x800035e0b51cb5c5,0xb5e3350935c5b59a,0xb5a1b57535d6346e,0x3564b5dc800035dc,0x35e4b4ecb5c535a1,0x354035a8b5c5b4c5,0xb5a135ca349eb5e2,0xb5e0349e35c5b5ae,0x9b7bb5d635923564,0x35a1b5d2800035d2,0x35a1352eb5e4352e,0x349e35bab5c5b41f,0xb5e435403592b5dc,0xb5ce339f35c5b5c0,0x35a1b5d9349e35b5
.quad 0x35c5b5c5800035c5,0x800035c5b5c58000,0xb41f35cab5c5339f,0xb5a1b4c535d6b5b5,0xb5aeb41f35c5b5ce,0x35e4b583b51c35dc,0x35dcb5b5800035b5,0xb5a135e2b564b52e,0xb51c35d6b5c5349e,0x9b7bb5ae35e0b564,0xb583b4c535c5b5d9,0x35a1339fb5ae35e2,0x35e4b5a1800035a1,0xb5e435a19b7bb5a1,0xb58335deb5c53509,0x35a1b5e335aeb46e
.quad 0xb51cb51c35c5b5e0,0x80003592b5e035c5,0x35dcb58b8000358b,0xb5a1346e3564b5d2,0xb5ae35e3b5c53540,0x35e4b5ba351c34ec,0xb41fb55235c5b5e3,0xb5a135deb5d6358b,0x35c5b56480003564,0x9b7bb56435c5b5e4,0xb5ce35e3b5c53575,0x35a1b509b49e358b,0x349eb58335c5b5e3,0xb5e435ceb59234ec,0x35a1b52e8000352e,0x35a1b5d235e4b5d2
.quad 0x359235c5b51cb5e0,0x35e0351cb5c5b592,0xb5dcb52e35c5358b,0xb5dc346e35e4346e,0x35d6b4ecb5e0341f,0x35aeb583b5c53540,0xb58335b53592b5a8,0xb54035ca3564b5c0,0x9b7bb5e4800035e4,0x9b7bb5e4800035e4,0x358335b5b592b5a8,0x354035cab564b5c0,0xb5d6b4ec35e0341f,0xb5aeb58335c53540,0x35dcb52eb5c5358b,0x35dc346eb5e4346e
.quad 0xb59235c5351cb5e0,0xb5e0351c35c5b592,0x341fb5e2351c35c0,0x35bab5a8b56435d9,0x356435a1b5c5b4ec,0xb56435dc9b7bb5dc,0xb5ceb46e35e0b552,0x341fb5de3564359a,0x35e0b564b59235d6,0x351c35aeb5c5b49e,0xb5a135d29b7bb5d2,0xb5a1b52e35e4b52e,0x349eb5dc35923540,0x35d6b41fb5c535ba,0x3540358bb5e03509,0xb5e335753564b5e3
.quad 0xb5c5800035c5b5c5,0x35c5b5c5800035c5,0x35e3b58bb51c35de,0xb58335e3b564b552,0xb5ae35dcb51cb583,0x349eb5ce35c5b41f,0x34ecb5d235c5b46e,0x34ec358bb5e4358b,0x351c3564b5e035ae,0xb592b49e35c5b5d6,0xb5ba346e3592b5e3,0x35ceb509b56435de,0x35e4b5a1800035a1,0xb5e435a19b7bb5a1,0xb5ba35e2b592b39f,0x35ceb5d9356434c5
.quad 0x351cb5c535e0b592,0xb59235e0b5c5351c,0x34ec352eb5c535e2,0x34ecb5b535e4b5b5,0xb5ae34ec351cb5ba,0x349e3540b5c535e3,0x35e3b5b5351c34c5,0xb583339f3564b5ca,0xb5c535e4b5c53564,0x35c5b56480003564,0x3540b5b535e0b5d9,0xb5e335c0b564339f,0x349e34ecb59235ce,0x35d6b5e335c5b583,0xb5a1352e9b7bb52e,0xb5a135d2b5e435d2
.quad 0x35c5b51cb5e08000,0x351cb5c5b5923592,0xb5a1358b35c5b52e,0xb4ec35d23564b5b5,0x3564b5bab59235a1,0x349eb5dcb51c35ce,0xb4ec35d9351cb5d2,0xb41f35e2349eb5de,0x9b7bb5e4800035e4,0x9b7bb5e4800035e4,0x34ec35d9b51cb5d2,0x341f35e2b49eb5de,0xb564b5ba359235a1,0xb49eb5dc351c35ce,0x35a1358bb5c5b52e,0x34ec35d2b564b5b5
.quad 0xb5c5b51c35e09b7b,0xb51cb5c535923592,0x35dc339fb5e0352e,0x354035b5b5aeb552,0xb5e434ec35c5b5a1,0xb564b5a135c534ec,0x35dcb575b59235d2,0x3583358bb5d6b39f,0xb5c535ae351cb5e4,0xb592b56435e0b49e,0x35a1b5d2800035d2,0x35a1352eb5e4352e,0xb56435e3b51cb5a1,0xb5aeb4ec35e0b583,0x34ecb5de3592352e,0x35ba346eb5d635a8
.quad 0x800035c5b5c58000,0xb5c5800035c5b5c5,0xb4ecb59a35e0b52e,0x35ceb46eb5ae35d9,0x35643540b5e035a1,0xb5d634ec3592b5e3,0xb5a1b46e35c5b5d2,0x35dcb52eb56435e2,0x35c5b49eb59235e4,0xb5e03564351cb5d6,0xb5dc3552351cb5d2,0x35e3b58bb49e35c0,0x35e4b5a1800035a1,0xb5e435a19b7bb5a1,0xb5dc35cab51cb52e,0x35e3b5b5349e3575
.quad 0x35c5b5e035929b7b,0xb5e035c5b51cb51c,0xb5a135e2b5c5352e,0x35dcb5d23564346e,0x3564b5ce35e0b5a1,0xb5d635dcb592341f,0xb4ec35a8b5e035d2,0x35ceb5e235aeb509,0x9b7bb56435c5b5e4,0xb5c535e4b5c53564,0x34ec34c5b59235d2,0x35bab5e235d6b59a,0xb564341f351cb5a1,0xb5ae35dcb5e035ba,0x35a1b52e8000352e,0x35a1b5d235e4b5d2
.quad 0x800035e0,0x0,0x9afbb5e2,0x0,0x800035e3,0x0,0x9afbb5e3,0x0,0x800035e4,0x0,0x9afbb5e3,0x0,0x800035e3,0x0,0x9afbb5e2,0x0
.quad 0x800035e0,0x0,0x9afbb5de,0x0,0x800035dc,0x0,0x9afbb5d9,0x0,0x800035d6,0x0,0x9afbb5d2,0x0,0x800035ce,0x0,0x9afbb5ca,0x0
.quad 0x800035c5,0x0,0x9afbb5c0,0x0,0x800035ba,0x0,0x9afbb5b5,0x0,0x800035ae,0x0,0x9afbb5a8,0x0,0x800035a1,0x0,0x9afbb59a,0x0
.quad 0x80003592,0x0,0x9afbb58b,0x0,0x80003583,0x0,0x9afbb575,0x0,0x80003564,0x0,0x9afbb552,0x0,0x80003540,0x0,0x9afbb52e,0x0
.quad 0x0,0x0,0x0,0x0,0x0,0x0,0x0,0x0,0x0,0x0,0x0,0x0,0x0,0x0,0x0,0x0
.quad 0x0,0x0,0x0,0x0,0x0,0x0,0x0,0x0,0x0,0x0,0x0,0x0,0x0,0x0,0x0,0x0
.quad 0x0,0x0,0x0,0x0,0x0,0x0,0x0,0x0,0x0,0x0,0x0,0x0,0x0,0x0,0x0,0x0
.quad 0x0,0x0,0x0,0x0,0x0,0x0,0x0,0x0,0x0,0x0,0x0,0x0,0x0,0x0,0x0,0x0
.quad 0xb56435aeb5d63564,0x35aeb564349e349e,0xb58b35bab5d93564,0x3575b4ecb39f351c,0xb5a135c5b5dc3564,0x34ec9bbcb4ec3564,0xb5b535ceb5de3564,0xb39f34ecb5523592,0xb5c535d6b5e03564,0xb51c3564b59235ae,0xb5d235dcb5e23564,0xb58b35a1b5b535c5,0xb5dc35e0b5e33564,0xb5ba35c5b5ce35d6,0xb5e235e3b5e33564,0xb5d935dcb5de35e0
.quad 0xb5e435e4b5e43564,0xb5e435e4b5e435e4,0xb5e235e3b5e33564,0xb5d935dcb5de35e0,0xb5dc35e0b5e33564,0xb5ba35c5b5ce35d6,0xb5d235dcb5e23564,0xb58b35a1b5b535c5,0xb5c535d6b5e03564,0xb51c3564b59235ae,0xb5b535ceb5de3564,0xb39f34ecb5523592,0xb5a135c5b5dc3564,0x34ec1afbb4ec3564,0xb58b35bab5d93564,0x3575b4ecb39f351c
.quad 0xb56435aeb5d63564,0x35aeb564349e349e,0xb52e35a1b5d23564,0x35d2b5a1352e1afb,0xb4ec3592b5ce3564,0x35e3b5c53583b49e,0xb46e3583b5ca3564,0x35deb5dc35a8b51c,0x9bbc3564b5c53564,0x35c5b5e435c5b564,0x346e3540b5c03564,0x359ab5dc35d9b592,0x34ec351cb5ba3564,0x3540b5c535e3b5ae,0x352e34ecb5b53564,0x346eb5a135e2b5c5
.quad 0x3564349eb5ae3564,0xb49eb56435d6b5d6,0x358b341fb5a83564,0xb552b4ec35c0b5e0,0x35a11afbb5a13564,0xb5a19bbc35a1b5e4,0x35b5b41fb59a3564,0xb5ca34ec3575b5e0,0x35c5b49eb5923564,0xb5e03564351cb5d6,0x35d2b4ecb58b3564,0xb5e235a1346eb5c5,0x35dcb51cb5833564,0xb5ce35c5b41fb5ae,0x35e2b540b5753564,0xb5a835dcb509b592
.quad 0x35aeb5d635e4b5d6,0xb564349e349eb564,0x35deb5e335d2b5ae,0x346eb540359ab5c5,0x35dcb5c535a1b564,0x35a1b5c535dcb5e4,0x35a8b583352eb49e,0x35e2b5e335d9b5c5,0x351cb49e1afb349e,0x35c5b5ae3592b564,0xb46e34ecb52e3564,0x352eb4ec346e9bbc,0xb5833592b5a135ae,0xb4ec351cb5403564,0xb5ca35ceb5d235d6,0xb5b535bab5c035c5
.quad 0xb5e435e4b5e435e4,0xb5e435e4b5e435e4,0xb5ca35ceb5d235d6,0xb5b535bab5c035c5,0xb5833592b5a135ae,0xb4ec351cb5403564,0xb46e34ecb52e3564,0x352eb4ec346e1afb,0x351cb49e9bbc349e,0x35c5b5ae3592b564,0x35a8b583352eb49e,0x35e2b5e335d9b5c5,0x35dcb5c535a1b564,0x35a1b5c535dcb5e4,0x35deb5e335d2b5ae,0x346eb540359ab5c5
.quad 0x35aeb5d635e4b5d6,0xb564349e349eb564,0x352eb5a135d2b5e4,0xb5d235a1b52e9bbc,0xb41fb51c35a1b5d6,0xb5dc35e0b5ba3564,0xb575341f352eb5ae,0xb58b35ceb5e335c5,0xb5c535641afbb564,0x9bbc3564b5c535e4,0xb5e335bab52eb49e,0x358bb41fb55235c5,0xb5ce35e0b5a1349e,0x35dcb592341f3564,0xb58b35dcb5d23564,0x35d2b5dc358b1afb
.quad 0xb49e35aeb5e435ae,0x3564b5d635d6b564,0x35093540b5d235d6,0xb46eb58335deb5c5,0x35a11afbb5a135e4,0xb5a19bbc35a1b5e4,0x35d9b540b52e35d6,0xb5e2358334c5b5c5,0x35e0b5ae9bbc35ae,0xb5c535d6b51cb564,0x35b5b5dc352e3564,0xb52e35dcb5b59bbc,0x3540b5e035a1349e,0x34ec3592b5e33564,0xb39fb5ba35d2b49e,0x35b5341fb5ca35c5
.quad 0xb5d635e4b5d635ae,0x349e349eb56435ae,0xb5ca35a1b552349e,0xb5a835ceb5e235e0,0xb4ec1afb34ecb564,0xb5dc35c5b5a13564,0x3575b5a135c0b5d6,0xb509341f346eb51c,0x35e0b5e435e0b5d6,0x3592b5ae35c5b5d6,0x35b5b5a1358bb564,0x35e2b5dc35d2b5c5,0x341f9bbcb41f349e,0x3540b51c34ecb49e,0xb59a35a1b5a835ae,0xb5753583b58b3592
.quad 0xb5e435e4b5e435e4,0xb5e435e4b5e435e4,0xb59a35a1b5a835ae,0xb5753583b58b3592,0x341f1afbb41f349e,0x3540b51c34ecb49e,0x35b5b5a1358bb564,0x35e2b5dc35d2b5c5,0x35e0b5e435e0b5d6,0x3592b5ae35c5b5d6,0x3575b5a135c0b5d6,0xb509341f346eb51c,0xb4ec9bbc34ecb564,0xb5dc35c5b5a13564,0xb5ca35a1b552349e,0xb5a835ceb5e235e0
.quad 0xb5d635e4b5d635ae,0x349e349eb56435ae,0xb52e35a1b5d235e4,0x35d2b5a1352e1afb,0x35401afbb54035ae,0x35bab5e035dcb5ae,0x35d9b5a13509349e,0xb39fb54035b5b5e0,0x35c5b5e435c5b564,0xb5c535641afbb564,0x34c5b5a135deb5d6,0xb5ca35e3b5b5351c,0xb5839bbc3583b5d6,0xb41f3592b5dc35d6,0xb5e235a1b46eb564,0x35b5b4ecb52e35c5
.quad 0xb5ae35e4b5ae349e,0x35d6b5d63564349e,0xb39f35a1b5e335ae,0x34c5b5ba35e2b592,0x35a11afbb5a135e4,0xb5a19bbc35a1b5e4,0x35e3b5a1b39f35ae,0xb5de35bab46eb592,0x3592b5e43592349e,0xb51c35d6b5c5349e,0xb46eb5a135e2b564,0x358b34ecb5d235c5,0xb5ba9bbc35bab5d6,0x35e3b592b4ec35d6,0xb5de35a134c5b5d6,0x3552b5e3358b351c
.quad 0x35e4b5d635aeb564,0x349eb56435aeb5d6,0x352eb41fb4c53564,0x35e3b5dc35c0b592,0xb5a135c5b5dc35e4,0x34ec9bbcb4ec3564,0xb5d235bab59a3564,0xb5ca35dcb5e335e0,0x9bbcb49e351cb564,0xb5923564b51c349e,0x35d2b5dc35e2b5e4,0x358bb5a135b5b5c5,0x35a1b5923583b564,0x35ceb5c535bab5ae,0xb52e3540b5523564,0xb4c534ecb509351c
.quad 0xb5e435e4b5e435e4,0xb5e435e4b5e435e4,0xb52e3540b5523564,0xb4c534ecb509351c,0x35a1b5923583b564,0x35ceb5c535bab5ae,0x35d2b5dc35e2b5e4,0x358bb5a135b5b5c5,0x1afbb49e351cb564,0xb5923564b51c349e,0xb5d235bab59a3564,0xb5ca35dcb5e335e0,0xb5a135c5b5dc35e4,0x34ec1afbb4ec3564,0x352eb41fb4c53564,0x35e3b5dc35c0b592
.quad 0x35e4b5d635aeb564,0x349eb56435aeb5d6,0x352eb5a135d2b5e4,0xb5d235a1b52e9bbc,0xb5a1351c341fb564,0xb58335c5b5e335d6,0xb5d235e3b5c03564,0x359ab4ecb4c53592,0x9bbc3564b5c535e4,0x35c5b5e435c5b564,0x35d2b583339f3564,0xb509b4ec35a8b5e0,0x35a1b5e035ceb564,0xb5e335c5b540b49e,0xb52eb4ec35b5b5e4,0xb46e35a1b5e235c5
.quad 0xb5e435aeb49eb564,0x35d6b564b49e35ae,0xb52e35ceb5d93564,0x3575b5dc35cab51c,0x35a11afbb5a135e4,0xb5a19bbc35a1b5e4,0x35d2b5ce35093564,0xb5c035dcb552b51c,0x1afbb5ae35e0b564,0x351c3564b5e035ae,0xb5d234ec358bb5e4,0x35e2b5a1b46e35c5,0xb5a135e0b540b564,0x341fb5c535ceb49e,0x352e3583b5e33564,0xb5d934ec359ab5e0
.quad 0xb5d635aeb564349e,0xb56435aeb5d635e4,0x3509b58335b5b5d6,0xb5b53583b5091afb,0x35dcb5c535a1b564,0x35a1b5c535dcb5e4,0xb4c53540b58b35ae,0x358bb54034c59bbc,0xb5e035d6b5c535ae,0xb5c535d6b5e035e4,0x346eb4ec352eb564,0xb52e34ecb46e1afb,0x35e3b5e035dcb5d6,0x35dcb5e035e3b5e4,0xb39f341fb46e349e,0x346eb41f339f9bbc
.quad 0xb5e435e4b5e435e4,0xb5e435e4b5e435e4,0xb39f341fb46e349e,0x346eb41f339f1afb,0x35e3b5e035dcb5d6,0x35dcb5e035e3b5e4,0x346eb4ec352eb564,0xb52e34ecb46e9bbc,0xb5e035d6b5c535ae,0xb5c535d6b5e035e4,0xb4c53540b58b35ae,0x358bb54034c51afb,0x35dcb5c535a1b564,0x35a1b5c535dcb5e4,0x3509b58335b5b5d6,0xb5b53583b5099bbc
.quad 0xb5d635aeb564349e,0xb56435aeb5d635e4,0xb52e35a1b5d235e4,0x35d2b5a1352e1afb,0x35ceb59234ec349e,0x34ecb59235ceb5e4,0x3552b5ba35e2b5d6,0xb5e235bab5529bbc,0xb5c535641afbb564,0x9bbc3564b5c535e4,0xb57535ceb5e235ae,0x35e2b5ce35751afb,0x35bab51cb4ec35ae,0xb4ecb51c35bab5e4,0x358bb5dc35d2b564,0xb5d235dcb58b9bbc
.quad 0xb5ae349e3564b5d6,0x3564349eb5ae35e4,0xb59a35e3b5b5349e,0x35b5b5e3359a1afb,0x35a11afbb5a135e4,0xb5a19bbc35a1b5e4,0x35a8b5e3358b349e,0xb58b35e3b5a89bbc,0xb592b49e35c5b5d6,0x35c5b49eb59235e4,0xb5b535dcb52eb564,0x352eb5dc35b51afb,0x3583351cb5dc35ae,0xb5dc351c3583b5e4,0x35c0b5ce346e35ae,0xb46e35ceb5c09bbc
.quad 0x35aeb564349e349e,0x35aeb5d635e4b5d6,0xb5c035dcb5e335d6,0x34c5341fb52e3592,0xb4ec1afb34ecb564,0xb5dc35c5b5a13564,0x35e3b5dc35cab5ae,0x359ab5ba35d2b5e0,0xb51c3564b59235ae,0x351cb49e1afb349e,0xb5b535a1b58b3564,0xb5e235dcb5d235c5,0x35bab5c535ceb5d6,0x3583b59235a1b5ae,0x3509b4ec34c5b49e,0x3552b540352eb51c
.quad 0xb5e435e4b5e435e4,0xb5e435e4b5e435e4,0x3509b4ec34c5b49e,0x3552b540352eb51c,0x35bab5c535ceb5d6,0x3583b59235a1b5ae,0xb5b535a1b58b3564,0xb5e235dcb5d235c5,0xb51c3564b59235ae,0x351cb49e9bbc349e,0x35e3b5dc35cab5ae,0x359ab5ba35d2b5e0,0xb4ec9bbc34ecb564,0xb5dc35c5b5a13564,0xb5c035dcb5e335d6,0x34c5341fb52e3592
.quad 0x35aeb564349e349e,0x35aeb5d635e4b5d6,0x352eb5a135d2b5e4,0xb5d235a1b52e9bbc,0xb5e335c5b583349e,0x341f351cb5a135d6,0x34c534ecb59a35d6,0x35c0b5e335d2b592,0x35c5b5e435c5b564,0xb5c535641afbb564,0xb5a834ec3509b5ae,0xb39f3583b5d235e0,0xb54035c5b5e335ae,0x35ceb5e035a1b49e,0x35e2b5a1346e3564,0xb5b534ec352eb5c5
.quad 0xb49eb56435d6b5d6,0xb49e35aeb5e435ae,0xb5ca35dcb575b49e,0x35d9b5ce352e351c,0x35a11afbb5a135e4,0xb5a19bbc35a1b5e4,0x3552b5dc35c0b49e,0xb50935ceb5d2351c,0xb5e03564351cb5d6,0x35e0b5ae9bbc35ae,0x346e35a1b5e23564,0xb58bb4ec35d2b5c5,0x35ceb5c5341f35ae,0xb54035e0b5a1b49e,0xb59ab4ec35d9b5ae,0x35e3b583b52e35e0
.quad 0xb564349e349eb564,0xb5d635e4b5d635ae,0x35e2b5ce35a8b564,0x3552b5a135cab5e0,0xb5a135c5b5dc35e4,0x34ec9bbcb4ec3564,0xb46eb41f3509b564,0xb5c035a1b575351c,0x35c5b5ae3592b564,0x35e0b5e435e0b5d6,0xb5d235dcb5e235e4,0xb58b35a1b5b535c5,0x34ecb51c3540b564,0xb41f1afb341fb49e,0x358bb5833575b564,0x35a8b5a1359ab592
.quad 0xb5e435e4b5e435e4,0xb5e435e4b5e435e4,0x358bb5833575b564,0x35a8b5a1359ab592,0x34ecb51c3540b564,0xb41f9bbc341fb49e,0xb5d235dcb5e235e4,0xb58b35a1b5b535c5,0x35c5b5ae3592b564,0x35e0b5e435e0b5d6,0xb46eb41f3509b564,0xb5c035a1b575351c,0xb5a135c5b5dc35e4,0x34ec1afbb4ec3564,0x35e2b5ce35a8b564,0x3552b5a135cab5e0
.quad 0xb564349e349eb564,0xb5d635e4b5d635ae,0xb52e35a1b5d235e4,0x35d2b5a1352e1afb,0x35dcb5e035bab564,0xb5409bbc3540b5ae,0xb5b53540339fb564,0xb50935a1b5d935e0,0x9bbc3564b5c535e4,0x35c5b5e435c5b564,0x35b5b5e335cab564,0xb5de35a1b4c5b51c,0xb5dc3592b41fb564,0x35831afbb58335d6,0x352e34ecb5b535e4,0x346eb5a135e2b5c5
.quad 0x3564b5d635d6b564,0xb5ae35e4b5ae349e,0xb5e235bab4c5b564,0x35e3b5a1339f3592,0x35a11afbb5a135e4,0xb5a19bbc35a1b5e4,0x346eb5ba35deb564,0x339f35a1b5e33592,0xb5c535d6b51cb564,0x3592b5e43592349e,0x35d2b4ecb58b35e4,0xb5e235a1346eb5c5,0xb4ecb59235e3b564,0x35ba1afbb5ba35d6,0xb58b35e3b552b564,0xb4c5b5a135deb51c
.quad 0x349e349eb56435ae,0x35e4b5d635aeb564,0xb59a3540b46eb49e,0xb5d235e3b5de35c5,0x35dcb5c535a1b564,0x35a1b5c535dcb5e4,0xb5d935e3b5e235d6,0xb52e3583b5a835c5,0x3592b5ae35c5b5d6,0x9bbcb49e351cb564,0xb46e34ecb52e3564,0x352eb4ec346e9bbc,0xb540351cb4ec349e,0xb5a13592b5833564,0x35c0b5ba35b5b5ae,0x35d2b5ce35cab5c5
.quad 0xb5e435e4b5e435e4,0xb5e435e4b5e435e4,0x35c0b5ba35b5b5ae,0x35d2b5ce35cab5c5,0xb540351cb4ec349e,0xb5a13592b5833564,0xb46e34ecb52e3564,0x352eb4ec346e1afb,0x3592b5ae35c5b5d6,0x1afbb49e351cb564,0xb5d935e3b5e235d6,0xb52e3583b5a835c5,0x35dcb5c535a1b564,0x35a1b5c535dcb5e4,0xb59a3540b46eb49e,0xb5d235e3b5de35c5
.quad 0x349e349eb56435ae,0x35e4b5d635aeb564,0x352eb5a135d2b5e4,0xb5d235a1b52e9bbc,0xb5ba35e0b5dc35ae,0x35a1b51cb41f3564,0x35e3b5ce358bb49e,0xb52eb41f3575b5c5,0xb5c535641afbb564,0x9bbc3564b5c535e4,0x3552341fb58b35d6,0x352eb5ba35e3b5c5,0x341fb59235dcb5d6,0xb5a135e0b5ce3564,0xb58b35dcb5d23564,0x35d2b5dc358b1afb
.quad 0x35d6b5d63564349e,0xb5e435aeb49eb564,0xb5de3583346eb5ae,0x35d2b540b50935c5,0x35a11afbb5a135e4,0xb5a19bbc35a1b5e4,0xb4c5b58335e2b5ae,0x352e3540b5d935c5,0xb51c35d6b5c5349e,0x1afbb5ae35e0b564,0x35b5b5dc352e3564,0xb52e35dcb5b59bbc,0xb5e3359234ecb5d6,0x35a1b5e035403564,0x35cab41fb5b535d6,0xb5d235ba339fb5c5
.quad 0x349eb56435aeb5d6,0xb5d635aeb564349e,0x339f34ecb57535ae,0x35d9b5ba358bb51c,0xb4ec1afb34ecb564,0xb5dc35c5b5a13564,0x3552b4ec339f349e,0x35deb5ce35b5b592,0xb5923564b51c349e,0xb5e035d6b5c535ae,0x35b5b5a1358bb564,0x35e2b5dc35d2b5c5,0xb5ce35c5b5ba35ae,0xb5e335e0b5dc35d6,0x35deb5dc35d9b5d6,0x35e3b5e335e2b5e0
.quad 0xb5e435e4b5e435e4,0xb5e435e4b5e435e4,0x35deb5dc35d9b5d6,0x35e3b5e335e2b5e0,0xb5ce35c5b5ba35ae,0xb5e335e0b5dc35d6,0x35b5b5a1358bb564,0x35e2b5dc35d2b5c5,0xb5923564b51c349e,0xb5e035d6b5c535ae,0x3552b4ec339f349e,0x35deb5ce35b5b592,0xb4ec9bbc34ecb564,0xb5dc35c5b5a13564,0x339f34ecb57535ae,0x35d9b5ba358bb51c
.quad 0x349eb56435aeb5d6,0xb5d635aeb564349e,0xb52e35a1b5d235e4,0x35d2b5a1352e1afb,0x3583b5c535e3b5d6,0xb5ce3592b4ecb49e,0xb5a835dcb5de35ae,0x35cab583346e351c,0x35c5b5e435c5b564,0xb5c535641afbb564,0xb5d935dcb59a349e,0x35c0b540b46e3592,0x35e3b5c53540349e,0xb5ba351c34ecb5ae,0xb5e235a1b46eb564,0x35b5b4ecb52e35c5
.quad 0x35d6b564b49e35ae,0xb5ae349e3564b5d6,0xb5c034ec3552b5d6,0x35a8b41fb58b35e0,0x35a11afbb5a135e4,0xb5a19bbc35a1b5e4,0xb575b4ec35cab5d6,0x359a341fb5b535e0,0x351c3564b5e035ae,0xb592b49e35c5b5d6,0xb46eb5a135e2b564,0x358b34ecb5d235c5,0xb41f35c5b5ce349e,0xb583b51c35dcb5ae,0x3509b5dc35a8349e,0x35753540b5e23592
.quad 0x3592b51c80003564,0x35c5b5e035e0b5c5,0x3583b5098000b564,0x35dcb5e335d6b5b5,0x3564b4ec80003564,0x35e4b5dc35c5b5a1,0x3540b4c58000b564,0x35dcb5ca35aeb58b,0x351cb49e80003564,0x35c5b5ae3592b564,0x34ecb46e8000b564,0x35a1b58b3564b52e,0x349eb41f80003564,0x3564b540351cb4ec,0x341fb39f8000b564,0x34ecb4c5349eb46e
.quad 0x80009b7b80003564,0x80009b7b80009b7b,0xb41f339f8000b564,0xb4ec34c5b49e346e,0xb49e341f80003564,0xb5643540b51c34ec,0xb4ec346e8000b564,0xb5a1358bb564352e,0xb51c349e80003564,0xb5c535aeb5923564,0xb54034c58000b564,0xb5dc35cab5ae358b,0xb56434ec80003564,0xb5e435dcb5c535a1,0xb58335098000b564,0xb5dc35e3b5d635b5
.quad 0xb592351c80003564,0xb5c535e0b5e035c5,0xb5a1352e8000b564,0xb5a135d2b5e435d2,0xb5ae354080003564,0xb56435bab5e035dc,0xb5ba35528000b564,0xb4ec359ab5d635e2,0xb5c5356480003564,0x9b7b3564b5c535e4,0xb5ce35758000b564,0x34ec3509b5ae35e2,0xb5d6358380003564,0x3564341fb59235dc,0xb5dc358b8000b564,0x35a1b46eb56435d2
.quad 0xb5e0359280003564,0x35c5b51cb51c35c5,0xb5e3359a8000b564,0x35dcb575b49e35b5,0xb5e435a180003564,0x35e4b5a19b7b35a1,0xb5e335a88000b564,0x35dcb5c0349e358b,0xb5e035ae80003564,0x35c5b5d6351c3564,0xb5dc35b58000b564,0x35a1b5e23564352e,0xb5d635ba80003564,0x3564b5e3359234ec,0xb5ce35c08000b564,0x34ecb5d935ae346e
.quad 0xb51c8000351cb592,0xb5e035e0b5c53592,0x341fb52e3592b5c0,0xb5ce35a8b56434c5,0x3564b5a135c5b5dc,0xb56434ec9b7bb4ec,0x35bab5d235e0b5e3,0x341fb5093564b59a,0x35e0b5e435e0b5d6,0x3592b5ae35c5b5d6,0x35dcb5d235c5b5b5,0x35dcb5e235e4b5e2,0x35aeb5a13592b583,0x35d6b5ce35c5b5ba,0x3540b52e351cb509,0x3583b5753564b552
.quad 0x80009b7b80009b7b,0x80009b7b80009b7b,0xb540352eb51c3509,0xb5833575b5643552,0xb5ae35a1b5923583,0xb5d635ceb5c535ba,0xb5dc35d2b5c535b5,0xb5dc35e2b5e435e2,0xb5e035e4b5e035d6,0xb59235aeb5c535d6,0xb5ba35d2b5e035e3,0xb41f3509b564359a,0xb56435a1b5c535dc,0x3564b4ec9b7b34ec,0xb41f352eb59235c0,0x35ceb5a83564b4c5
.quad 0x351c8000b51c3592,0x35e0b5e035c5b592,0x35a1b52e9b7b352e,0x35a1b5d235e4b5d2,0x35d6b5a1351c341f,0x349eb58335c5b5e3,0x35e3b5d23592b4c5,0xb540b39f3564b5c0,0x35c5b5e435c5b564,0xb5c535648000b564,0x3583b5d235e0b5a8,0xb5e335cab564b39f,0x349eb5a135e0b5ce,0xb5ae35e3b5c53540,0xb4ecb52e35c5b5e2,0xb4ec35b5b5e435b5
.quad 0xb5929b7b3592b5e0,0x351c351cb5c535e0,0xb5ce352e351cb5ca,0x35bab4c5b56435d9,0xb5e435a18000b5a1,0x35e4b5a19b7b35a1,0xb5ce35d2b51cb552,0x35bab5de35643509,0xb59235e4b592b49e,0x351cb5d635c5b49e,0xb4ec35d2b5c5346e,0xb4ecb58b35e4b58b,0x349e35a1b5e03540,0xb5aeb41f35c5b5ce,0x3583352eb5e0359a,0xb5e335523564b5e3
.quad 0x8000351cb59235c5,0x35e0b5c53592b51c,0xb5a135cab5e035e2,0x3540b46eb49e3552,0xb5e435dcb5c535a1,0xb56435a1b5c535dc,0xb5a13575b51c346e,0xb5e335e2b5d635c0,0x9b7bb49e351cb564,0xb5923564b51c349e,0x35a1b5b535c5b5d2,0x34ecb52e3564b58b,0x35e4b5e335e0b5dc,0x35d6b5dc35e0b5e3,0x35a1b59a3592b58b,0x35bab5b535aeb5a8
.quad 0x80009b7b80009b7b,0x80009b7b80009b7b,0xb5a1359ab592358b,0xb5ba35b5b5ae35a8,0xb5e435e3b5e035dc,0xb5d635dcb5e035e3,0xb5a135b5b5c535d2,0xb4ec352eb564358b,0x9b7b349eb51c3564,0x3592b564351cb49e,0x35a1b575351cb46e,0x35e3b5e235d6b5c0,0x35e4b5dc35c5b5a1,0x3564b5a135c5b5dc,0x35a1b5ca35e0b5e2,0xb540346e349eb552
.quad 0x8000b51c3592b5c5,0xb5e035c5b592351c,0xb5a1352e8000b52e,0xb5a135d2b5e435d2,0xb5e435ceb59234ec,0x349e34ecb59235ce,0xb5a135d9b5e035b5,0x35ceb58b349e3509,0x9b7b3564b5c535e4,0x35c5b5e435c5b564,0x35a1b4c5b51c35b5,0x341fb58b35d6b5de,0x35e4b5ba351c34ec,0xb5ae34ec351cb5ba,0x35a1b5e235c5b52e,0xb5dc35d2b564b46e
.quad 0x8000b59235e0b5c5,0xb51c35c5b5e03592,0xb5a1339f3592b5e2,0x3583346eb5ae35e3,0xb5e435a18000b5a1,0x35e4b5a19b7b35a1,0xb5a135e3b592b46e,0x3583b5e235aeb39f,0x9b7b35aeb5e03564,0xb51cb56435e0b5ae,0x35a1346eb5c535d2,0xb5dc352e3564b5e2,0x35e4b583b51c35dc,0xb5ae35dcb51cb583,0x35a1b5de351c358b,0x341f35b5b5d634c5
.quad 0x351cb59235c5b5e0,0xb5c53592b51c8000,0x35e3b5de35c5b59a,0x34ecb57535aeb5d2,0x3564b4ec800034ec,0x35e4b5dc35c5b5a1,0xb58335a8b5c535d9,0x34ecb39fb49e352e,0xb5e035d6b5c535ae,0xb5c535d6b5e035e4,0xb4ec346e9b7bb46e,0xb5a1358bb564352e,0x35aeb5ba35c5b5ce,0x3564b5833592b5a1,0x35ceb5ca35c5b5c0,0x35dcb5d935d6b5d2
.quad 0x80009b7b80009b7b,0x80009b7b80009b7b,0xb5ce35cab5c535c0,0xb5dc35d9b5d635d2,0xb5ae35bab5c535ce,0xb5643583b59235a1,0x34ecb46e9b7b346e,0x35a1b58b3564b52e,0x35e0b5d635c5b5ae,0x35c5b5d635e0b5e4,0x3583b5a835c5b5d9,0xb4ec339f349eb52e,0xb56434ec8000b4ec,0xb5e435dcb5c535a1,0xb5e335deb5c5359a,0xb4ec3575b5ae35d2
.quad 0xb51c3592b5c535e0,0x35c5b592351c8000,0x35a1b52e9b7b352e,0x35a1b5d235e4b5d2,0x35d6b5e335c5b583,0xb564341f351cb5a1,0x341fb57535c5b5e3,0xb5dc35deb5ae352e,0xb5c535648000b564,0x9b7b3564b5c535e4,0xb5ba35e3b5c53552,0x35dcb59a349e352e,0x349e3540b5c535e3,0x3564b5ce35e0b5a1,0x35dcb58b9b7b358b,0xb5a1346e3564b5d2
.quad 0x3592b5e035c5b51c,0xb5c535e0b5929b7b,0xb540b50935c5b5de,0x34ec3552b5d635d2,0xb5e435a18000b5a1,0x35e4b5a19b7b35a1,0xb54035d9b5c534c5,0x34ecb5ca35d6b52e,0x3592349eb5c535d6,0xb5c5349e3592b5e4,0x35dcb5b59b7b35b5,0xb5a135e2b564b52e,0x349eb5ce35c5b41f,0x35643540b5e035a1,0xb5bab39f35c5b5ca,0x35dcb5a8b49e35d2
.quad 0xb59235c5b5e035e0,0x3592b51c8000351c,0xb5ba358bb51c339f,0xb5ba35d9b5e435d9,0x3564b5a135c5b5dc,0xb56434ec9b7bb4ec,0x35ceb5b53592b552,0x35ceb5de35e4b5de,0xb51c3564b59235ae,0x351cb49e8000349e,0xb5dc35d2b5c535b5,0xb5dc35e2b5e435e2,0x349eb4ec351cb540,0xb49e341f9b7bb41f,0x35e3b5e235e0b5de,0x35e3b5e335e4b5e3
.quad 0x80009b7b80009b7b,0x80009b7b80009b7b,0xb5e335e2b5e035de,0xb5e335e3b5e435e3,0xb49e34ecb51c3540,0x349eb41f9b7b341f,0x35dcb5d235c5b5b5,0x35dcb5e235e4b5e2,0x351cb5643592b5ae,0xb51c349e8000b49e,0xb5ce35b5b5923552,0xb5ce35deb5e435de,0xb56435a1b5c535dc,0x3564b4ec9b7b34ec,0x35bab58b351cb39f,0x35bab5d935e4b5d9
.quad 0x3592b5c535e0b5e0,0xb592351c8000b51c,0xb5a1352e8000b52e,0xb5a135d2b5e435d2,0xb5ae35dcb5e035ba,0x35aeb5409b7b3540,0x3583b46eb51c35a8,0x3583b5ca35e4b5ca,0x35c5b5e435c5b564,0xb5c535648000b564,0xb540b46e3592b5d9,0xb54035c0b5e435c0,0xb5d635dcb592341f,0x35d6b5839b7b3583,0x34ec352eb5c535e2,0x34ecb5b535e4b5b5
.quad 0x35e0b5c5351c351c,0xb5e035928000b592,0xb41fb58b35e0b5c0,0xb41f35a8b5e435a8,0xb5e435a18000b5a1,0x35e4b5a19b7b35a1,0xb41f35b5b5e03575,0xb41fb59a35e4b59a,0x35e0b564b51c35d6,0xb5e035ae8000b5ae,0x34ecb5d235c5b46e,0x34ec358bb5e4358b,0xb5d634ec3592b5e3,0x35d6b5ba9b7b35ba,0xb54035e2b592b509,0xb540b57535e4b575
.quad 0x35c5b5e035e0b5c5,0xb51c8000351cb592,0x34ec339fb51c358b,0x35e3b5d235aeb575,0xb5e435dcb5c535a1,0xb56435a1b5c535dc,0x34ecb5523592b5b5,0xb583352eb49eb39f,0x35c5b5ae3592b564,0x35e0b5e435e0b5d6,0xb5a135b5b5c535d2,0xb4ec352eb564358b,0xb5643540b51c34ec,0xb5ae35a1b5923583,0x35dcb5de35e0b5e2,0x35ceb5d235d6b5d9
.quad 0x80009b7b80009b7b,0x80009b7b80009b7b,0xb5dc35deb5e035e2,0xb5ce35d2b5d635d9,0x3564b540351cb4ec,0x35aeb5a13592b583,0x35a1b5b535c5b5d2,0x34ecb52e3564b58b,0xb5c535aeb5923564,0xb5e035e4b5e035d6,0xb4ec3552b59235b5,0x3583b52e349e339f,0x35e4b5dc35c5b5a1,0x3564b5a135c5b5dc,0xb4ecb39f351cb58b,0xb5e335d2b5ae3575
.quad 0xb5c535e0b5e035c5,0x351c8000b51c3592,0x35a1b52e9b7b352e,0x35a1b5d235e4b5d2,0x3564b5ba35e0b5dc,0xb5d635a1b51cb41f,0xb5dc35a8b51cb46e,0x341f352eb5ae35de,0x9b7b3564b5c535e4,0x35c5b5e435c5b564,0x35dcb5d93592b46e,0xb5ba352e349eb59a,0xb564b41f3592b5dc,0xb49e35a1b5e035ce,0xb5a135e2b5c5352e,0x35dcb5d23564346e
.quad 0x35c5b51cb51c35c5,0xb5929b7b3592b5e0,0x34ecb5c035e0b58b,0xb54035d2b5d63552,0xb5e435a18000b5a1,0x35e4b5a19b7b35a1,0x34ec3575b5e035b5,0xb540b52e35d6b5ca,0x35c5b5d6351c3564,0xb59235e4b592b49e,0xb5a1b46e35c5b5d2,0x35dcb52eb56435e2,0xb56435e3b592b4ec,0xb49eb5a135e0b540,0x35dcb509b59235e2,0xb5ba35d2b49eb5a8
.quad 0xb5e035e0b5c53592,0x8000351cb59235c5,0x3540b59a35c5b5de,0xb5a13552b49eb46e,0x3564b4ec800034ec,0x35e4b5dc35c5b5a1,0xb5e335d9b5c535a8,0xb5a135c0b5d635e2,0x3592b5ae35c5b5d6,0x9b7bb49e351cb564,0x34ecb46e8000346e,0x35a1b58b3564b52e,0xb5d635ceb5c535ba,0xb5e435e3b5e035dc,0x35bab5c035c5b5ca,0x35a1b5a835aeb5b5
.quad 0x80009b7b80009b7b,0x80009b7b80009b7b,0xb5ba35c0b5c535ca,0xb5a135a8b5ae35b5,0x35d6b5ce35c5b5ba,0x35e4b5e335e0b5dc,0xb4ec346e8000b46e,0xb5a1358bb564352e,0xb59235aeb5c535d6,0x9b7b349eb51c3564,0x35e3b5d935c5b5a8,0x35a1b5c035d6b5e2,0xb56434ec8000b4ec,0xb5e435dcb5c535a1,0xb540359ab5c535de,0x35a1b552349e346e
.quad 0x35e0b5e035c5b592,0x8000b51c3592b5c5,0xb5a1352e8000b52e,0xb5a135d2b5e435d2,0xb49e3583b5c535e3,0x35e4b5ce3592b4ec,0x35ceb5e335c5b575,0xb5a13509349eb58b,0xb5c535648000b564,0x9b7b3564b5c535e4,0x341f3552b5c535e3,0x35a1b5de35d6b58b,0x35aeb5e335c5b540,0xb5e435bab51cb4ec,0xb5dc358b8000b58b,0x35a1b46eb56435d2
.quad 0x351c351cb5c535e0,0x8000b59235e0b5c5,0x3583b5de35c5b509,0xb5a135e3b5ae346e,0xb5e435a18000b5a1,0x35e4b5a19b7b35a1,0x358334c5b5c535d9,0xb5a1b39f35aeb5e2,0x351cb5d635c5b49e,0x9b7b35aeb5e03564,0xb5dc35b58000b5b5,0x35a1b5e23564352e,0x35ae341fb5c535ce,0xb5e43583351cb5dc,0x341fb5ca35c5b39f,0x35a134c5b5d635b5
.quad 0x35e0b5c53592b51c,0x351cb59235c5b5e0,0xb5ce35e2b5e035ca,0x341f34c5b56435a8,0x3564b5a135c5b5dc,0xb56434ec9b7bb4ec,0x341f346eb51c3575,0x35bab59a3564b509,0xb5923564b51c349e,0xb5e035d6b5c535ae,0x35dcb5d235c5b5b5,0x35dcb5e235e4b5e2,0xb5d635dcb5e035e3,0xb5ae35bab5c535ce,0x3583b58b3592b59a,0x3540b5523564b575
.quad 0x80009b7b80009b7b,0x80009b7b80009b7b,0xb583358bb592359a,0xb5403552b5643575,0x35d6b5dc35e0b5e3,0x35aeb5ba35c5b5ce,0xb5dc35d2b5c535b5,0xb5dc35e2b5e435e2,0x3592b564351cb49e,0x35e0b5d635c5b5ae,0xb41fb46e351cb575,0xb5ba359ab5643509,0xb56435a1b5c535dc,0x3564b4ec9b7b34ec,0x35ceb5e235e0b5ca,0xb41fb4c53564b5a8
.quad 0xb5e035c5b592351c,0xb51c3592b5c535e0,0x35a1b52e9b7b352e,0x35a1b5d235e4b5d2,0xb49eb4ec3592b5ce,0xb5d635e3b5c53583,0xb54035b5b5e035d9,0x35e3b5c03564b39f,0x35c5b5e435c5b564,0xb5c535648000b564,0xb5e335b5b51cb4c5,0x3583b39fb56435ca,0x35aeb4ecb51c35ba,0xb49eb54035c5b5e3,0xb4ecb52e35c5b5e2,0xb4ec35b5b5e435b5
.quad 0xb51c35c5b5e03592,0x3592b5e035c5b51c,0x35bab5e23592339f,0xb5ce35d9b564b4c5,0xb5e435a18000b5a1,0x35e4b5a19b7b35a1,0x35bab46eb59235e3,0xb5ce35093564b5de,0xb51cb56435e0b5ae,0x3592349eb5c535d6,0xb4ec35d2b5c5346e,0xb4ecb58b35e4b58b,0x35aeb5dc351c3583,0xb49e35ceb5c5341f,0xb5e3358b351cb5de,0x3583b5e335643552
.quad 0xb5c53592b51c8000,0xb59235c5b5e035e0,0x35dcb5c03592b52e,0x3583b5b535d6b5e3,0xb5e435dcb5c535a1,0xb56435a1b5c535dc,0x35dcb5e335e0b5d2,0x3540b58b35aeb5ca,0xb5c535d6b5e035e4,0xb51c3564b59235ae,0x35a1b5b535c5b5d2,0x34ecb52e3564b58b,0xb5643583b59235a1,0xb49e34ecb51c3540,0x34ecb509351cb52e,0x341fb46e349eb4c5
.quad 0x80009b7b80009b7b,0x80009b7b80009b7b,0xb4ec3509b51c352e,0xb41f346eb49e34c5,0x3564b5833592b5a1,0x349eb4ec351cb540,0xb5a135b5b5c535d2,0xb4ec352eb564358b,0x35c5b5d635e0b5e4,0x351cb5643592b5ae,0xb5dc35e3b5e035d2,0xb540358bb5ae35ca,0x35e4b5dc35c5b5a1,0x3564b5a135c5b5dc,0xb5dc35c0b592352e,0xb58335b5b5d635e3
.quad 0x35c5b592351c8000,0x3592b5c535e0b5e0,0xb5a1352e8000b52e,0xb5a135d2b5e435d2,0x3564b41fb51c35a1,0x35aeb5dc35e0b5ba,0xb4ecb4c53592b5d2,0xb5ba35e2b5d6359a,0x9b7b3564b5c535e4,0x35c5b5e435c5b564,0x34ecb5a835e0b5d2,0xb5ce35e2b5ae3509,0xb56435ceb5e035a1,0x35d6b5dc3592b41f,0x35a1b5e235c5b52e,0xb5dc35d2b564b46e
.quad 0xb5c535e0b5929b7b,0x35e0b5c5351c351c,0x35dcb5ca351c352e,0xb5e335b5b49eb575,0xb5e435a18000b5a1,0x35e4b5a19b7b35a1,0x35dcb552b51c35d2,0xb5e3358b349eb5c0,0xb5c5349e3592b5e4,0x35e0b564b51c35d6,0x35a1346eb5c535d2,0xb5dc352e3564b5e2,0xb564b54035e0b5a1,0x35d6b4ecb59235e3,0x34ec359ab5e0352e,0xb5ce346e35aeb5d9
.quad 0x8000351c,0x0,0x9afbb509,0x0,0x800034ec,0x0,0x9afbb4c5,0x0,0x8000349e,0x0,0x9afbb46e,0x0,0x8000341f,0x0,0x9afbb39f,0x0
.quad 0x80009b7b,0x0,0x9afb339f,0x0,0x8000b41f,0x0,0x9afb346e,0x0,0x8000b49e,0x0,0x9afb34c5,0x0,0x8000b4ec,0x0,0x9afb3509,0x0
.quad 0x8000b51c,0x0,0x9afb352e,0x0,0x8000b540,0x0,0x9afb3552,0x0,0x8000b564,0x0,0x9afb3575,0x0,0x8000b583,0x0,0x9afb358b,0x0
.quad 0x8000b592,0x0,0x9afb359a,0x0,0x8000b5a1,0x0,0x9afb35a8,0x0,0x8000b5ae,0x0,0x9afb35b5,0x0,0x8000b5ba,0x0,0x9afb35c0,0x0
.quad 0x0,0x0,0x0,0x0,0x0,0x0,0x0,0x0,0x0,0x0,0x0,0x0,0x0,0x0,0x0,0x0
.quad 0x0,0x0,0x0,0x0,0x0,0x0,0x0,0x0,0x0,0x0,0x0,0x0,0x0,0x0,0x0,0x0
.quad 0x0,0x0,0x0,0x0,0x0,0x0,0x0,0x0,0x0,0x0,0x0,0x0,0x0,0x0,0x0,0x0
.quad 0x0,0x0,0x0,0x0,0x0,0x0,0x0,0x0,0x0,0x0,0x0,0x0,0x0,0x0,0x0,0x0
.quad 0x35e4b564b5643564,0xb56435e4b564b564,0x35e2b583b5523564,0xb4c535dcb59ab51c,0x35dcb592b5403564,0x341f35c5b5bab49e,0x35d2b5a1b52e3564,0x352e35a1b5d29bbc,0x35c5b5aeb51c3564,0x35923564b5e0349e,0x35b5b5bab5093564,0x35c034ecb5e3351c,0x35a1b5c5b4ec3564,0x35dc1afbb5dc3564,0x358bb5ceb4c53564,0x35e3b4ecb5ca3592
.quad 0x3564b5d6b49e3564,0x35d6b564b5ae35ae,0x352eb5dcb46e3564,0x35b5b5a1b58b35c5,0x34ecb5e0b41f3564,0x3583b5c5b54035d6,0x346eb5e3b39f3564,0x3509b5dcb4c535e0,0x1afbb5e49bbc3564,0x1afbb5e49bbc35e4,0xb46eb5e3339f3564,0xb509b5dc34c535e0,0xb4ecb5e0341f3564,0xb583b5c5354035d6,0xb52eb5dc346e3564,0xb5b5b5a1358b35c5
.quad 0xb564b5d6349e3564,0xb5d6b56435ae35ae,0xb58bb5ce34c53564,0xb5e3b4ec35ca3592,0xb5a1b5c534ec3564,0xb5dc9bbc35dc3564,0xb5b5b5ba35093564,0xb5c034ec35e3351c,0xb5c5b5ae351c3564,0xb592356435e0349e,0xb5d2b5a1352e3564,0xb52e35a135d21afb,0xb5dcb59235403564,0xb41f35c535bab49e,0xb5e2b58335523564,0x34c535dc359ab51c
.quad 0xb5e4b56435643564,0x356435e43564b564,0xb5e2b54035753564,0x35a835dc3509b592,0xb5dcb51c35833564,0x35ce35c5341fb5ae,0xb5d2b4ec358b3564,0x35e235a1b46eb5c5,0xb5c5b49e35923564,0x35e03564b51cb5d6,0xb5b5b41f359a3564,0x35ca34ecb575b5e0,0xb5a19bbc35a13564,0x35a11afbb5a1b5e4,0xb58b341f35a83564,0x3552b4ecb5c0b5e0
.quad 0xb564b56435e4b564,0x35e4b564b56435e4,0xb5c0b41f35d2b5ae,0x35b5b5ce339f35c5,0xb5e3351c35a1b5d6,0x34ecb5e035833564,0xb5d235a1352eb5e4,0xb52eb5a135d21afb,0xb59235d61afbb5d6,0xb5c5b49e35e0b564,0xb4c535e3b52eb5ae,0xb5e2354035a8b5c5,0x34ec35c5b5a1b564,0xb5a135c534ecb5e4,0x359a3583b5d2b49e,0xb46e35e3b509b5c5
.quad 0x35d6349eb5e4349e,0x356435aeb5aeb564,0x35e2b4ecb5d23564,0x35d234ecb5e29bbc,0x35bab592b5a135ae,0x35dcb51cb5ce3564,0x3552b5ceb52e35d6,0x358bb5bab57535c5,0x1afbb5e49bbc35e4,0x1afbb5e49bbc35e4,0xb552b5ce352e35d6,0xb58bb5ba357535c5,0xb5bab59235a135ae,0xb5dcb51c35ce3564,0xb5e2b4ec35d23564,0xb5d234ec35e21afb
.quad 0xb5d6349e35e4349e,0xb56435ae35aeb564,0xb59a358335d2b49e,0x346e35e33509b5c5,0xb4ec35c535a1b564,0x35a135c5b4ecb5e4,0x34c535e3352eb5ae,0x35e23540b5a8b5c5,0x359235d61afbb5d6,0x35c5b49eb5e0b564,0x35d235a1b52eb5e4,0x352eb5a1b5d29bbc,0x35e3351cb5a1b5d6,0xb4ecb5e0b5833564,0x35c0b41fb5d2b5ae,0xb5b5b5ceb39f35c5
.quad 0x3564b564b5e4b564,0xb5e4b564356435e4,0x339fb5bab5d2b49e,0xb5b5341f35ca35c5,0xb540b5e0b5a1349e,0xb4ec359235e33564,0xb5b5b5dcb52e3564,0x352e35dc35b51afb,0xb5e0b5ae9bbc35ae,0x35c535d6351cb564,0xb5d9b540352e35d6,0x35e23583b4c5b5c5,0xb5a19bbc35a135e4,0x35a11afbb5a1b5e4,0xb509354035d235d6,0x346eb583b5deb5c5
.quad 0xb56435e4b564b564,0xb564b56435e4b564,0x350935a1b5d9349e,0xb5e33540358bb5e0,0x35ce1afbb5ce35ae,0xb58335e0b4ecb5ae,0x35d2b5a1b52e35e4,0x352e35a1b5d29bbc,0x351cb5e4351c35ae,0x35e0b49eb5c535ae,0xb552b5a135ca349e,0x359ab5ceb46e35e0,0xb5dc9bbc35dcb564,0xb4ecb5c535a13564,0xb5c035a13575b5d6,0xb5d9b41f35e2b51c
.quad 0xb49e35e4b49eb5d6,0xb5ae35ae3564b5d6,0x358b35a1b5b5b564,0x346e35dcb52eb5c5,0x35e31afbb5e3349e,0x35ce351cb5dcb49e,0x35a8b5a1b59a35ae,0x35c0b583b5b53592,0x1afbb5e49bbc35e4,0x1afbb5e49bbc35e4,0xb5a8b5a1359a35ae,0xb5c0b58335b53592,0xb5e39bbc35e3349e,0xb5ce351c35dcb49e,0xb58b35a135b5b564,0xb46e35dc352eb5c5
.quad 0x349e35e4349eb5d6,0x35ae35aeb564b5d6,0x35c035a1b575b5d6,0x35d9b41fb5e2b51c,0x35dc1afbb5dcb564,0x34ecb5c5b5a13564,0x3552b5a1b5ca349e,0xb59ab5ce346e35e0,0xb51cb5e4b51c35ae,0xb5e0b49e35c535ae,0xb5d2b5a1352e35e4,0xb52e35a135d21afb,0xb5ce9bbc35ce35ae,0x358335e034ecb5ae,0xb50935a135d9349e,0x35e33540b58bb5e0
.quad 0x356435e43564b564,0x3564b564b5e4b564,0x35de35a1b4c5b5d6,0xb552b5e3b58b351c,0x35ba1afbb5bab5d6,0xb5e3b59234ec35d6,0x346eb5a1b5e2b564,0xb58b34ec35d235c5,0xb592b5e4b592349e,0x351c35d635c5349e,0xb5e3b5a1339f35ae,0x35de35ba346eb592,0xb5a19bbc35a135e4,0x35a11afbb5a1b5e4,0x339f35a135e335ae,0xb4c5b5bab5e2b592
.quad 0x35e4b564b56435e4,0xb56435e4b564b564,0x352eb5e335753564,0x35a834ecb5de3592,0xb5a1b51c35e3b564,0x35bab5c5b41f35d6,0xb5d235a1352eb5e4,0xb52eb5a135d21afb,0x9bbc35d6b592b564,0xb5e035643592b5d6,0x35d2341fb5de3564,0xb39f35dcb575b592,0x35a1b5c5b4ec35e4,0x35dc1afbb5dc3564,0xb52eb5ba35a83564,0x3552b5dcb39f35e0
.quad 0xb5e4349e35d6b564,0xb5aeb56435d6349e,0xb52e35dc346eb5e4,0xb5b535a1358bb5c5,0x35a13592b5bab564,0x354035c5b583b5ae,0x35d2b540b5ca3564,0x35deb4ecb5d9351c,0x1afbb5e49bbc35e4,0x1afbb5e49bbc35e4,0xb5d2b54035ca3564,0xb5deb4ec35d9351c,0xb5a1359235bab564,0xb54035c53583b5ae,0x352e35dcb46eb5e4,0x35b535a1b58bb5c5
.quad 0x35e4349eb5d6b564,0x35aeb564b5d6349e,0x352eb5bab5a83564,0xb552b5dc339f35e0,0xb5a1b5c534ec35e4,0xb5dc9bbc35dc3564,0xb5d2341f35de3564,0x339f35dc3575b592,0x9bbc35d63592b564,0x35e03564b592b5d6,0x35d235a1b52eb5e4,0x352eb5a1b5d29bbc,0x35a1b51cb5e3b564,0xb5bab5c5341f35d6,0xb52eb5e3b5753564,0xb5a834ec35de3592
.quad 0xb5e4b564356435e4,0x356435e43564b564,0xb52e358335e33564,0x35d934ecb59ab5e0,0x35a135e03540b564,0xb41fb5c5b5ceb49e,0x35d234ecb58bb5e4,0xb5e2b5a1346e35c5,0x1afbb5aeb5e0b564,0xb51c356435e035ae,0xb5d2b5ceb5093564,0x35c035dc3552b51c,0xb5a19bbc35a135e4,0x35a11afbb5a1b5e4,0x352e35ce35d93564,0xb575b5dcb5cab51c
.quad 0xb564b56435e4b564,0x35e4b564b56435e4,0xb5ca35ba346eb5d6,0xb46eb5ba35ca1afb,0x35403592b5dc349e,0xb5dc35923540b5e4,0x35d2b5a1b52e35e4,0x352e35a1b5d29bbc,0xb51cb5ae35c5349e,0x35c5b5aeb51c35e4,0xb5d93583358bb5d6,0xb58bb58335d91afb,0x34ec35c5b5a1b564,0xb5a135c534ecb5e4,0x35deb540b5b535ae,0x35b53540b5de9bbc
.quad 0xb49eb5d6356435ae,0x3564b5d6b49e35e4,0xb5e234ec35d2b564,0xb5d2b4ec35e21afb,0x341f35e0b4ecb5d6,0xb4ec35e0341fb5e4,0x35e3b41fb5e2349e,0x35e2341fb5e39bbc,0x1afbb5e49bbc35e4,0x1afbb5e49bbc35e4,0xb5e3b41f35e2349e,0xb5e2341f35e31afb,0xb41f35e034ecb5d6,0x34ec35e0b41fb5e4,0x35e234ecb5d2b564,0x35d2b4ecb5e29bbc
.quad 0x349eb5d6b56435ae,0xb564b5d6349e35e4,0xb5deb54035b535ae,0xb5b5354035de1afb,0xb4ec35c535a1b564,0x35a135c5b4ecb5e4,0x35d93583b58bb5d6,0x358bb583b5d99bbc,0x351cb5aeb5c5349e,0xb5c5b5ae351c35e4,0xb5d2b5a1352e35e4,0xb52e35a135d21afb,0xb540359235dc349e,0x35dc3592b540b5e4,0x35ca35bab46eb5d6,0x346eb5bab5ca9bbc
.quad 0x3564b564b5e4b564,0xb5e4b564356435e4,0xb5c0b5ceb46e35ae,0x346e35ce35c01afb,0xb583351c35dc35ae,0x35dc351cb583b5e4,0x35b535dc352eb564,0xb52eb5dcb5b59bbc,0x3592b49eb5c5b5d6,0xb5c5b49e359235e4,0xb5a8b5e3b58b349e,0x358b35e335a81afb,0xb5a19bbc35a135e4,0x35a11afbb5a1b5e4,0x359a35e335b5349e,0xb5b5b5e3b59a9bbc
.quad 0xb56435e4b564b564,0xb564b56435e4b564,0x35deb4ecb5a835d6,0xb57535e3b52eb592,0xb41fb5c535ba349e,0x35e3b51cb5a135d6,0xb5d235a1352eb5e4,0xb52eb5a135d21afb,0x35923564b5e0349e,0xb59235d61afbb5d6,0x3575b5dc339f35d6,0x35deb41fb5d23592,0xb5dc9bbc35dcb564,0xb4ecb5c535a13564,0x339f35dcb552b5ae,0xb5a835ba352eb5e0
.quad 0x35d6b564b5ae35ae,0x35d6349eb5e4349e,0xb58bb5a135b53564,0xb46eb5dc352e35c5,0xb58335c53540b5d6,0xb5ba359235a1b5ae,0x35d934ecb5deb49e,0x35ca3540b5d2b51c,0x1afbb5e49bbc35e4,0x1afbb5e49bbc35e4,0xb5d934ec35deb49e,0xb5ca354035d2b51c,0x358335c5b540b5d6,0x35ba3592b5a1b5ae,0x358bb5a1b5b53564,0x346eb5dcb52e35c5
.quad 0xb5d6b56435ae35ae,0xb5d6349e35e4349e,0xb39f35dc3552b5ae,0x35a835bab52eb5e0,0x35dc1afbb5dcb564,0x34ecb5c5b5a13564,0xb575b5dcb39f35d6,0xb5deb41f35d23592,0xb592356435e0349e,0x359235d61afbb5d6,0x35d235a1b52eb5e4,0x352eb5a1b5d29bbc,0x341fb5c5b5ba349e,0xb5e3b51c35a135d6,0xb5deb4ec35a835d6,0x357535e3352eb592
.quad 0x356435e43564b564,0x3564b564b5e4b564,0x359ab4ecb5d9b5ae,0xb5e3b583352e35e0,0xb5ceb5c5b41f35ae,0x354035e035a1b49e,0xb46e35a135e23564,0x358bb4ecb5d2b5c5,0x35e03564b51cb5d6,0xb5e0b5ae9bbc35ae,0xb552b5dcb5c0b49e,0x350935ce35d2351c,0xb5a19bbc35a135e4,0x35a11afbb5a1b5e4,0x35ca35dc3575b49e,0xb5d9b5ceb52e351c
.quad 0x35e4b564b56435e4,0xb56435e4b564b564,0xb58bb54035e3b564,0x35d9b5a1b50935e0,0xb4ec35e0b583b564,0xb5ce9bbc35ceb5ae,0x35d2b5a1b52e35e4,0x352e35a1b5d29bbc,0xb5c5b49e35e0b564,0x351cb5e4351c35ae,0x346e35ceb59ab564,0xb5ca35a13552b5e0,0x35a1b5c5b4ec35e4,0x35dc1afbb5dc3564,0xb5e2341f35d9b564,0xb575b5a135c0351c
.quad 0x356435aeb5aeb564,0xb49e35e4b49eb5d6,0x352eb5dcb46e35e4,0x35b5b5a1b58b35c5,0xb5dc351c35ceb564,0xb5e39bbc35e3b49e,0x35b53583b5c0b564,0x359a35a1b5a8b592,0x1afbb5e49bbc35e4,0x1afbb5e49bbc35e4,0xb5b5358335c0b564,0xb59a35a135a8b592,0x35dc351cb5ceb564,0x35e31afbb5e3b49e,0xb52eb5dc346e35e4,0xb5b5b5a1358b35c5
.quad 0xb56435ae35aeb564,0x349e35e4349eb5d6,0x35e2341fb5d9b564,0x3575b5a1b5c0351c,0xb5a1b5c534ec35e4,0xb5dc9bbc35dc3564,0xb46e35ce359ab564,0x35ca35a1b552b5e0,0x35c5b49eb5e0b564,0xb51cb5e4b51c35ae,0xb5d2b5a1352e35e4,0xb52e35a135d21afb,0x34ec35e03583b564,0x35ce1afbb5ceb5ae,0x358bb540b5e3b564,0xb5d9b5a1350935e0
.quad 0xb5e4b564356435e4,0x356435e43564b564,0x358b35e33552b564,0x34c5b5a1b5deb51c,0x34ecb592b5e3b564,0xb5ba9bbc35ba35d6,0xb5d2b4ec358b35e4,0x35e235a1b46eb5c5,0x35c535d6351cb564,0xb592b5e4b592349e,0xb46eb5bab5deb564,0xb39f35a135e33592,0xb5a19bbc35a135e4,0x35a11afbb5a1b5e4,0x35e235ba34c5b564,0xb5e3b5a1b39f3592
.quad 0xb564b56435e4b564,0x35e4b564b56435e4,0xb39f35ceb5b5b49e,0xb5d2341f35c0b5c5,0x3583b5e034ec35ae,0x35a1351cb5e33564,0xb5d235a1352eb5e4,0xb52eb5a135d21afb,0x35e0b49eb5c535ae,0x9bbc35d6b592b564,0xb5a8b54035e2b49e,0x352eb5e334c535c5,0x34ec35c5b5a1b564,0xb5a135c534ecb5e4,0x3509b5e3346e35d6,0x35d2b583b59a35c5
.quad 0xb5ae35ae3564b5d6,0xb5e4349e35d6b564,0x35e2b4ecb5d23564,0x35d234ecb5e29bbc,0xb5ceb51c35dc349e,0xb5a1b59235ba3564,0x357535bab58bb5ae,0x352e35ceb552b5c5,0x1afbb5e49bbc35e4,0x1afbb5e49bbc35e4,0xb57535ba358bb5ae,0xb52e35ce3552b5c5,0x35ceb51cb5dc349e,0x35a1b592b5ba3564,0xb5e2b4ec35d23564,0xb5d234ec35e21afb
.quad 0x35ae35aeb564b5d6,0x35e4349eb5d6b564,0xb509b5e3b46e35d6,0xb5d2b583359a35c5,0xb4ec35c535a1b564,0x35a135c5b4ecb5e4,0x35a8b540b5e2b49e,0xb52eb5e3b4c535c5,0xb5e0b49e35c535ae,0x9bbc35d63592b564,0x35d235a1b52eb5e4,0x352eb5a1b5d29bbc,0xb583b5e0b4ec35ae,0xb5a1351c35e33564,0x339f35ce35b5b49e,0x35d2341fb5c0b5c5
.quad 0x3564b564b5e4b564,0xb5e4b564356435e4,0xb5cab41f35b535d6,0x35d235bab39fb5c5,0x35e33592b4ecb5d6,0xb5a1b5e0b5403564,0xb5b5b5dcb52e3564,0x352e35dc35b51afb,0x351c35d635c5349e,0x1afbb5aeb5e0b564,0x34c5b583b5e2b5ae,0xb52e354035d935c5,0xb5a19bbc35a135e4,0x35a11afbb5a1b5e4,0x35de3583b46eb5ae,0xb5d2b540350935c5
.quad 0xb56435e4b564b564,0xb564b56435e4b564,0x359ab5dc34c535ae,0x35523583b5e2351c,0xb5ba35c5341fb5d6,0xb540b59235dcb49e,0x35d2b5a1b52e35e4,0x352e35a1b5d29bbc,0xb5e035643592b5d6,0xb51cb5ae35c5349e,0x35e3b4ecb5c035ae,0x350935bab5b5b51c,0xb5dc9bbc35dcb564,0xb4ecb5c535a13564,0x35ca34ecb5e3349e,0x34c535ceb58bb592
.quad 0xb5aeb56435d6349e,0xb49eb5d6356435ae,0x358b35a1b5b5b564,0x346e35dcb52eb5c5,0xb540b5c5358335ae,0xb41fb5e034ec35d6,0x34c535dcb509b5d6,0x339f35e3b46eb5e0,0x1afbb5e49bbc35e4,0x1afbb5e49bbc35e4,0xb4c535dc3509b5d6,0xb39f35e3346eb5e0,0x3540b5c5b58335ae,0x341fb5e0b4ec35d6,0xb58b35a135b5b564,0xb46e35dc352eb5c5
.quad 0x35aeb564b5d6349e,0x349eb5d6b56435ae,0xb5ca34ec35e3349e,0xb4c535ce358bb592,0x35dc1afbb5dcb564,0x34ecb5c5b5a13564,0xb5e3b4ec35c035ae,0xb50935ba35b5b51c,0x35e03564b592b5d6,0x351cb5aeb5c5349e,0xb5d2b5a1352e35e4,0xb52e35a135d21afb,0x35ba35c5b41fb5d6,0x3540b592b5dcb49e,0xb59ab5dcb4c535ae,0xb552358335e2351c
.quad 0x356435e43564b564,0x3564b564b5e4b564,0xb509b5dcb5a8349e,0xb575354035e23592,0x341f35c535ce349e,0x3583b51cb5dcb5ae,0x346eb5a1b5e2b564,0xb58b34ec35d235c5,0xb51c356435e035ae,0x3592b49eb5c5b5d6,0x3575b4ecb5cab5d6,0xb59a341f35b535e0,0xb5a19bbc35a135e4,0x35a11afbb5a1b5e4,0x35c034ecb552b5d6,0xb5a8b41f358b35e0
.quad 0xb5c535c580003564,0x8000b5c535c58000,0xb5ba35ca8000b564,0xb4ecb5a835d6b46e,0xb5ae35ce80003564,0xb564b58335e0b4ec,0xb5a135d28000b564,0xb5a1b52e35e4b52e,0xb59235d680003564,0xb5c5b49e35e0b564,0xb58335d98000b564,0xb5dc339f35d6b58b,0xb56435dc80003564,0xb5e434ec35c5b5a1,0xb54035de8000b564,0xb5dc355235aeb5b5
.quad 0xb51c35e080003564,0xb5c535923592b5c5,0xb4ec35e28000b564,0xb5a135b53564b5d2,0xb49e35e380003564,0xb56435ce351cb5dc,0xb41f35e38000b564,0xb4ec35de349eb5e2,0x9b7b35e480003564,0x9b7b35e48000b5e4,0x341f35e38000b564,0x34ec35deb49eb5e2,0x349e35e380003564,0x356435ceb51cb5dc,0x34ec35e28000b564,0x35a135b5b564b5d2
.quad 0x351c35e080003564,0x35c53592b592b5c5,0x354035de8000b564,0x35dc3552b5aeb5b5,0x356435dc80003564,0x35e434ecb5c5b5a1,0x358335d98000b564,0x35dc339fb5d6b58b,0x359235d680003564,0x35c5b49eb5e0b564,0x35a135d28000b564,0x35a1b52eb5e4b52e,0x35ae35ce80003564,0x3564b583b5e0b4ec,0x35ba35ca8000b564,0x34ecb5a8b5d6b46e
.quad 0x35c535c580003564,0x8000b5c5b5c59b7b,0x35ce35c08000b564,0xb4ecb5d9b5ae346e,0x35d635ba80003564,0xb564b5e3b59234ec,0x35dc35b58000b564,0xb5a1b5e2b564352e,0x35e035ae80003564,0xb5c5b5d6b51c3564,0x35e335a88000b564,0xb5dcb5c0b49e358b,0x35e435a180003564,0xb5e4b5a19b7b35a1,0x35e3359a8000b564,0xb5dcb575349e35b5
.quad 0x35c58000b5c535c5,0xb5c535c58000b5c5,0x35e3b52eb59235de,0xb54035e3b564b575,0x35d6b5a1b51c35e3,0x349e35bab5c5b41f,0x35a1b5d29b7b35d2,0x35a1352eb5e4352e,0x351cb5e4351c35ae,0x35e0b49eb5c535ae,0xb41fb5d235923575,0x35ceb59ab56435de,0xb564b5a135c534ec,0x3564b5dc9b7b35dc,0xb5bab52e35e0b39f,0xb41fb5d9356435a8
.quad 0xb5e09b7b35e0b51c,0xb592b59235c5351c,0xb5dc352e35c5b58b,0xb5dcb46e35e4b46e,0xb5ae35a13592b5ba,0xb5d6354035c5b583,0xb54035d2351cb5d9,0xb58335c03564b5ca,0x9b7b35e48000b5e4,0x9b7b35e48000b5e4,0x354035d2b51cb5d9,0x358335c0b564b5ca,0x35ae35a1b592b5ba,0x35d63540b5c5b583,0x35dc352eb5c5b58b,0x35dcb46eb5e4b46e
.quad 0x35e08000b5e0b51c,0x3592b592b5c5351c,0x35bab52eb5e0b39f,0x341fb5d9b56435a8,0x3564b5a1b5c534ec,0xb564b5dc9b7b35dc,0x341fb5d2b5923575,0xb5ceb59a356435de,0xb51cb5e4b51c35ae,0xb5e0b49e35c535ae,0xb5a1b5d29b7b35d2,0xb5a1352e35e4352e,0xb5d6b5a1351c35e3,0xb49e35ba35c5b41f,0xb5e3b52e359235de,0x354035e33564b575
.quad 0xb5c59b7b35c535c5,0x35c535c58000b5c5,0xb583352e35e0359a,0x35e33552b564b5e3,0xb49e35a135e03540,0x35aeb41fb5c5b5ce,0x34ec35d235c5346e,0x34ecb58bb5e4b58b,0x359235e43592b49e,0xb51cb5d6b5c5b49e,0x35ce35d2351cb552,0xb5bab5deb5643509,0x35e435a18000b5a1,0xb5e4b5a19b7b35a1,0x35ce352eb51cb5ca,0xb5bab4c5356435d9
.quad 0x8000b5c535c58000,0x35c58000b5c535c5,0xb5a1b50935e0b58b,0x35ceb5b5b49e35d9,0xb5e435403592b5dc,0x349eb5dc35923540,0xb5a135d28000b5d2,0xb5a1b52e35e4b52e,0x9b7b35d6b592b564,0xb5e035643592b5d6,0x35a13552b5e0346e,0xb54035e2b49eb5ca,0x35e4b4ecb5c535a1,0x356435a1b5c5b4ec,0x35a1b5c0b51c35e2,0x35e3b46eb5d63575
.quad 0x8000b5e0351c35c5,0x3592b5c5b51c35e0,0xb5a1b58b35c5352e,0xb4ecb5d2356435b5,0xb5e4341f35e0b4ec,0xb5d6b4ec35e0341f,0xb5a135a83592b5b5,0xb5ba358b35aeb59a,0x9b7b35e48000b5e4,0x9b7b35e48000b5e4,0x35a135a8b592b5b5,0x35ba358bb5aeb59a,0x35e4341fb5e0b4ec,0x35d6b4ecb5e0341f,0x35a1b58bb5c5352e,0x34ecb5d2b56435b5
.quad 0x8000b5e0b51c35c5,0xb592b5c5351c35e0,0xb5a1b5c0351c35e2,0xb5e3b46e35d63575,0xb5e4b4ec35c535a1,0xb56435a135c5b4ec,0xb5a1355235e0346e,0x354035e2349eb5ca,0x9b7b35d63592b564,0x35e03564b592b5d6,0x35a135d28000b5d2,0x35a1b52eb5e4b52e,0x35e43540b592b5dc,0xb49eb5dcb5923540,0x35a1b509b5e0b58b,0xb5ceb5b5349e35d9
.quad 0x8000b5c5b5c59b7b,0xb5c59b7b35c535c5,0xb5a1b5deb51c358b,0xb41f35b535d634c5,0xb5e4b583351c35dc,0x35ae35dc351cb583,0xb5a1346e35c535d2,0x35dc352eb564b5e2,0x9b7b35ae35e03564,0x351cb564b5e0b5ae,0x35a135e33592b46e,0xb583b5e2b5aeb39f,0x35e435a18000b5a1,0xb5e4b5a19b7b35a1,0x35a1339fb592b5e2,0xb583346e35ae35e3
.quad 0xb5c535c58000b5c5,0x8000b5c535c58000,0x341f35c0b5c5b39f,0xb5dc34c535aeb5d2,0x35d6b41fb5c535ba,0xb56435e3b51cb5a1,0x35a1b5d29b7b35d2,0x35a1352eb5e4352e,0xb51cb5ae35c5349e,0x35c5b5aeb51c35e4,0xb5e334c535c5b5a8,0xb4ecb5c035ae352e,0xb56435dc8000b5dc,0xb5e434ec35c5b5a1,0x3583359ab5c5b509,0xb4ec35e3b49eb5d2
.quad 0x35e0b51cb5c53592,0x35c5351cb5e09b7b,0x34ecb5e29b7b35e2,0x35a1b5b5b56435d2,0xb5aeb58335c53540,0xb564b5ba359235a1,0xb5ce355235c5b575,0xb5dc350935d6b52e,0x9b7b35e48000b5e4,0x9b7b35e48000b5e4,0x35ce3552b5c5b575,0x35dc3509b5d6b52e,0x35aeb583b5c53540,0x3564b5bab59235a1,0xb4ecb5e29b7b35e2,0xb5a1b5b5356435d2
.quad 0xb5e0b51c35c53592,0xb5c5351c35e08000,0xb583359a35c5b509,0x34ec35e3349eb5d2,0x356435dc8000b5dc,0x35e434ecb5c5b5a1,0x35e334c5b5c5b5a8,0x34ecb5c0b5ae352e,0x351cb5aeb5c5349e,0xb5c5b5ae351c35e4,0xb5a1b5d29b7b35d2,0xb5a1352e35e4352e,0xb5d6b41f35c535ba,0x356435e3351cb5a1,0xb41f35c035c5b39f,0x35dc34c5b5aeb5d2
.quad 0x35c535c58000b5c5,0x8000b5c5b5c59b7b,0x35bab39fb5c5b5ca,0xb5dcb5a8349e35d2,0xb49eb5ceb5c5b41f,0xb564354035e035a1,0xb5dcb5b59b7b35b5,0x35a135e23564b52e,0xb592349e35c535d6,0x35c5349eb592b5e4,0x354035d935c534c5,0xb4ecb5cab5d6b52e,0x35e435a18000b5a1,0xb5e4b5a19b7b35a1,0x3540b509b5c5b5de,0xb4ec355235d635d2
.quad 0x35c58000b5c535c5,0xb5c535c58000b5c5,0x3583b5e2351c359a,0x35833552b5e43552,0xb5aeb4ec35e0b583,0x35aeb5ce9b7b35ce,0xb5a135d28000b5d2,0xb5a1b52e35e4b52e,0x35923564b5e0349e,0xb59235d68000b5d6,0x35bab5b5b51c35e3,0x35ba3509b5e43509,0xb564b5a135c534ec,0x3564b5dc9b7b35dc,0xb5ce358b3592b5ca,0xb5ceb4c535e4b4c5
.quad 0x351c35c5b592b592,0xb51c35e08000b5e0,0x35dcb52eb5c5358b,0x35dc346eb5e4346e,0xb49eb5dc351c35ce,0x349eb5e39b7b35e3,0xb5e3346e35e0b4c5,0xb5e3b39f35e4b39f,0x9b7b35e48000b5e4,0x9b7b35e48000b5e4,0x35e3346eb5e0b4c5,0x35e3b39fb5e4b39f,0x349eb5dcb51c35ce,0xb49eb5e39b7b35e3,0xb5dcb52e35c5358b,0xb5dc346e35e4346e
.quad 0xb51c35c53592b592,0x351c35e08000b5e0,0x35ce358bb592b5ca,0x35ceb4c5b5e4b4c5,0x3564b5a1b5c534ec,0xb564b5dc9b7b35dc,0xb5bab5b5351c35e3,0xb5ba350935e43509,0xb592356435e0349e,0x359235d68000b5d6,0x35a135d28000b5d2,0x35a1b52eb5e4b52e,0x35aeb4ecb5e0b583,0xb5aeb5ce9b7b35ce,0xb583b5e2b51c359a,0xb583355235e43552
.quad 0xb5c59b7b35c535c5,0x35c535c58000b5c5,0x354035e23592b509,0x3540b575b5e4b575,0x35d634ecb592b5e3,0xb5d6b5ba9b7b35ba,0xb4ecb5d2b5c5b46e,0xb4ec358b35e4358b,0xb5e0b564351c35d6,0x35e035ae8000b5ae,0x341f35b535e03575,0x341fb59ab5e4b59a,0x35e435a18000b5a1,0xb5e4b5a19b7b35a1,0x341fb58bb5e0b5c0,0x341f35a835e435a8
.quad 0x8000b5c535c58000,0x35c58000b5c535c5,0xb5dc359a351cb5e2,0x341fb5d235ae34c5,0x35643583b5e034ec,0xb5d635a1351cb5e3,0x35a1b5d29b7b35d2,0x35a1352eb5e4352e,0xb5c5b49e35e0b564,0x351cb5e4351c35ae,0xb4ec35e3b51cb5b5,0xb5e3352e35aeb5c0,0x35e4b4ecb5c535a1,0x356435a1b5c5b4ec,0xb4ecb5ca3592358b,0x3583b5d2b49e35e3
.quad 0xb5c535923592b5c5,0xb5e09b7b35e0b51c,0x35a1358bb5c5b52e,0x34ec35d2b564b5b5,0x3564b5ceb51c35dc,0x35aeb5a1b59235ba,0xb5dcb4c535e0346e,0xb5ceb52e35d63509,0x9b7b35e48000b5e4,0x9b7b35e48000b5e4,0x35dcb4c5b5e0346e,0x35ceb52eb5d63509,0xb564b5ce351c35dc,0xb5aeb5a1359235ba,0xb5a1358b35c5b52e,0xb4ec35d23564b5b5
.quad 0x35c53592b592b5c5,0x35e08000b5e0b51c,0x34ecb5cab592358b,0xb583b5d2349e35e3,0xb5e4b4ec35c535a1,0xb56435a135c5b4ec,0x34ec35e3351cb5b5,0x35e3352eb5aeb5c0,0x35c5b49eb5e0b564,0xb51cb5e4b51c35ae,0xb5a1b5d29b7b35d2,0xb5a1352e35e4352e,0xb564358335e034ec,0x35d635a1b51cb5e3,0x35dc359ab51cb5e2,0xb41fb5d2b5ae34c5
.quad 0x8000b5c5b5c59b7b,0xb5c59b7b35c535c5,0xb5dcb509359235e2,0x35ba35d2349eb5a8,0x356435e33592b4ec,0x349eb5a1b5e0b540,0x35a1b46eb5c5b5d2,0xb5dcb52e356435e2,0xb5c5b5d6b51c3564,0x359235e43592b49e,0xb4ec357535e035b5,0x3540b52eb5d6b5ca,0x35e435a18000b5a1,0xb5e4b5a19b7b35a1,0xb4ecb5c0b5e0b58b,0x354035d235d63552
.quad 0xb5c535c58000b5c5,0x8000b5c535c58000,0x35ceb39fb5c535c0,0xb5a135d9b49eb5b5,0xb49eb5ba35c5341f,0x35e4b540b59235dc,0xb5a135d28000b5d2,0xb5a1b52e35e4b52e,0x35e0b49eb5c535ae,0x9b7b35d6b592b564,0xb540b5a835c534c5,0x35a1b5cab49e35e2,0xb56435dc8000b5dc,0xb5e434ec35c5b5a1,0x35e3b509b5c5359a,0x35a13575b5d6b46e
.quad 0xb592b59235c5351c,0x8000b5e0351c35c5,0xb4ec35e28000b5e2,0xb5a135b53564b5d2,0x35d6b540b5c53583,0x35e4b41fb5e034ec,0xb5bab57535c53552,0xb5a1b59a35ae358b,0x9b7b35e48000b5e4,0x9b7b35e48000b5e4,0x35bab575b5c53552,0x35a1b59ab5ae358b,0xb5d6b54035c53583,0xb5e4b41f35e034ec,0x34ec35e28000b5e2,0x35a135b5b564b5d2
.quad 0x3592b592b5c5351c,0x8000b5e0b51c35c5,0xb5e3b50935c5359a,0xb5a1357535d6b46e,0x356435dc8000b5dc,0x35e434ecb5c5b5a1,0x3540b5a8b5c534c5,0xb5a1b5ca349e35e2,0xb5e0b49e35c535ae,0x9b7b35d63592b564,0x35a135d28000b5d2,0x35a1b52eb5e4b52e,0x349eb5bab5c5341f,0xb5e4b540359235dc,0xb5ceb39f35c535c0,0x35a135d9349eb5b5
.quad 0x35c535c58000b5c5,0x8000b5c5b5c59b7b,0xb41fb5cab5c5b39f,0xb5a134c535d635b5,0xb5ae341f35c535ce,0x35e43583b51cb5dc,0x35dc35b58000b5b5,0xb5a1b5e2b564352e,0xb51cb5d6b5c5b49e,0x9b7b35ae35e03564,0xb58334c535c535d9,0x35a1b39fb5aeb5e2,0x35e435a18000b5a1,0xb5e4b5a19b7b35a1,0xb583b5deb5c5b509,0x35a135e335ae346e
.quad 0x35c58000b5c535c5,0xb5c535c58000b5c5,0xb540b58b35e0b509,0x35e3b575b56435e3,0xb49e35dcb592b540,0xb5d6341f35c5b5ba,0x35a1b5d29b7b35d2,0x35a1352eb5e4352e,0xb5e035643592b5d6,0xb51cb5ae35c5349e,0x35ce346eb5e03552,0xb41f35deb564b59a,0xb564b5a135c534ec,0x3564b5dc9b7b35dc,0xb41f35e2b51cb5c0,0xb5ba35a83564b5d9
.quad 0x3592b5c5b51c35e0,0x35e0b51cb5c53592,0xb5dc352e35c5b58b,0xb5dcb46e35e4b46e,0x35d634ecb5e0b41f,0x35ae3583b5c5b540,0xb583b5b5359235a8,0xb540b5ca356435c0,0x9b7b35e48000b5e4,0x9b7b35e48000b5e4,0x3583b5b5b59235a8,0x3540b5cab56435c0,0xb5d634ec35e0b41f,0xb5ae358335c5b540,0x35dc352eb5c5b58b,0x35dcb46eb5e4b46e
.quad 0xb592b5c5351c35e0,0xb5e0b51c35c53592,0x341f35e2351cb5c0,0x35ba35a8b564b5d9,0x3564b5a1b5c534ec,0xb564b5dc9b7b35dc,0xb5ce346e35e03552,0x341f35de3564b59a,0x35e03564b592b5d6,0x351cb5aeb5c5349e,0xb5a1b5d29b7b35d2,0xb5a1352e35e4352e,0x349e35dc3592b540,0x35d6341fb5c5b5ba,0x3540b58bb5e0b509,0xb5e3b575356435e3
.quad 0xb5c59b7b35c535c5,0x35c535c58000b5c5,0x35e3358bb51cb5de,0xb583b5e3b5643552,0xb5aeb5dcb51c3583,0x349e35ce35c5341f,0x34ec35d235c5346e,0x34ecb58bb5e4b58b,0x351cb564b5e0b5ae,0xb592349e35c535d6,0xb5bab46e359235e3,0x35ce3509b564b5de,0x35e435a18000b5a1,0xb5e4b5a19b7b35a1,0xb5bab5e2b592339f,0x35ce35d93564b4c5
.quad 0x8000b5c535c58000,0x35c58000b5c535c5,0xb4ec35deb592b52e,0xb5bab46e35d6b5a8,0x3564b5e3351c35a1,0x35ae34ecb5e03583,0xb5a135d28000b5d2,0xb5a1b52e35e4b52e,0x35c5b5aeb51c35e4,0x35923564b5e0349e,0xb5dc35753592b5d2,0xb583b58b35d6339f,0x35e4b4ecb5c535a1,0x356435a1b5c5b4ec,0xb5dcb39f35e0b52e,0xb540b5b535ae3552
.quad 0x35c5351cb5e09b7b,0x351c35c5b592b592,0xb5a1b58b35c5352e,0xb4ecb5d2356435b5,0x356435bab592b5a1,0x349e35dcb51cb5ce,0xb4ecb5d9351c35d2,0xb41fb5e2349e35de,0x9b7b35e48000b5e4,0x9b7b35e48000b5e4,0x34ecb5d9b51c35d2,0x341fb5e2b49e35de,0xb56435ba3592b5a1,0xb49e35dc351cb5ce,0x35a1b58bb5c5352e,0x34ecb5d2b56435b5
.quad 0xb5c5351c35e08000,0xb51c35c53592b592,0x35dcb39fb5e0b52e,0x3540b5b5b5ae3552,0xb5e4b4ec35c535a1,0xb56435a135c5b4ec,0x35dc3575b592b5d2,0x3583b58bb5d6339f,0xb5c5b5ae351c35e4,0xb592356435e0349e,0x35a135d28000b5d2,0x35a1b52eb5e4b52e,0xb564b5e3b51c35a1,0xb5ae34ec35e03583,0x34ec35de3592b52e,0x35bab46eb5d6b5a8
.quad 0x8000b5c5b5c59b7b,0xb5c59b7b35c535c5,0xb4ec359a35e0352e,0x35ce346eb5aeb5d9,0x3564b540b5e0b5a1,0xb5d6b4ec359235e3,0xb5a1346e35c535d2,0x35dc352eb564b5e2,0x35c5349eb592b5e4,0xb5e0b564351c35d6,0xb5dcb552351c35d2,0x35e3358bb49eb5c0,0x35e435a18000b5a1,0xb5e4b5a19b7b35a1,0xb5dcb5cab51c352e,0x35e335b5349eb575
.quad 0x8000b5c5,0x0,0x9afb35ca,0x0,0x8000b5ce,0x0,0x9afb35d2,0x0,0x8000b5d6,0x0,0x9afb35d9,0x0,0x8000b5dc,0x0,0x9afb35de,0x0
.quad 0x8000b5e0,0x0,0x9afb35e2,0x0,0x8000b5e3,0x0,0x9afb35e3,0x0,0x8000b5e4,0x0,0x9afb35e3,0x0,0x8000b5e3,0x0,0x9afb35e2,0x0
.quad 0x8000b5e0,0x0,0x9afb35de,0x0,0x8000b5dc,0x0,0x9afb35d9,0x0,0x8000b5d6,0x0,0x9afb35d2,0x0,0x8000b5ce,0x0,0x9afb35ca,0x0
.quad 0x8000b5c5,0x0,0x9afb35c0,0x0,0x8000b5ba,0x0,0x9afb35b5,0x0,0x8000b5ae,0x0,0x9afb35a8,0x0,0x8000b5a1,0x0,0x9afb359a,0x0
.quad 0x0,0x0,0x0,0x0,0x0,0x0,0x0,0x0,0x0,0x0,0x0,0x0,0x0,0x0,0x0,0x0
.quad 0x0,0x0,0x0,0x0,0x0,0x0,0x0,0x0,0x0,0x0,0x0,0x0,0x0,0x0,0x0,0x0
.quad 0x0,0x0,0x0,0x0,0x0,0x0,0x0,0x0,0x0,0x0,0x0,0x0,0x0,0x0,0x0,0x0
.quad 0x0,0x0,0x0,0x0,0x0,0x0,0x0,0x0,0x0,0x0,0x0,0x0,0x0,0x0,0x0,0x0
.quad 0xb564349e35ae3564,0x349eb564b5d6b5d6,0xb52e34ec35b53564,0xb46eb5a1b5e2b5c5,0xb4ec351c35ba3564,0xb540b5c5b5e3b5ae,0xb46e354035c03564,0xb59ab5dcb5d9b592,0x9bbc356435c53564,0xb5c5b5e4b5c5b564,0x346e358335ca3564,0xb5deb5dcb5a8b51c,0x34ec359235ce3564,0xb5e3b5c5b583b49e,0x352e35a135d23564,0xb5d2b5a1b52e9bbc
.quad 0x356435ae35d63564,0xb5aeb564b49e349e,0x358b35ba35d93564,0xb575b4ec339f351c,0x35a135c535dc3564,0xb4ec9bbc34ec3564,0x35b535ce35de3564,0x339f34ec35523592,0x35c535d635e03564,0x351c3564359235ae,0x35d235dc35e23564,0x358b35a135b535c5,0x35dc35e035e33564,0x35ba35c535ce35d6,0x35e235e335e33564,0x35d935dc35de35e0
.quad 0x0,0x0,0x0,0x0,0x0,0x0,0x0,0x0,0x0,0x0,0x0,0x0,0x0,0x0,0x0,0x0
.quad 0x0,0x0,0x0,0x0,0x0,0x0,0x0,0x0,0x0,0x0,0x0,0x0,0x0,0x0,0x0,0x0
.quad 0x349e35ae35e435ae,0xb564b5d6b5d6b564,0x358b35dc35d23564,0xb5d2b5dcb58b9bbc,0x35ce35e035a1349e,0xb5dcb592b41f3564,0x35e335ba352eb49e,0xb58bb41f355235c5,0x35c535641afbb564,0x9bbc356435c535e4,0x3575341fb52eb5ae,0x358b35ce35e335c5,0x341fb51cb5a1b5d6,0x35dc35e035ba3564,0xb52eb5a1b5d2b5e4,0x35d235a1352e1afb
.quad 0xb5aeb5d6b5e4b5d6,0x3564349eb49eb564,0xb5deb5e3b5d2b5ae,0xb46eb540b59ab5c5,0xb5dcb5c5b5a1b564,0xb5a1b5c5b5dcb5e4,0xb5a8b583b52eb49e,0xb5e2b5e3b5d9b5c5,0xb51cb49e9bbc349e,0xb5c5b5aeb592b564,0x346e34ec352e3564,0xb52eb4ecb46e9bbc,0x3583359235a135ae,0x34ec351c35403564,0x35ca35ce35d235d6,0x35b535ba35c035c5
.quad 0x0,0x0,0x0,0x0,0x0,0x0,0x0,0x0,0x0,0x0,0x0,0x0,0x0,0x0,0x0,0x0
.quad 0x0,0x0,0x0,0x0,0x0,0x0,0x0,0x0,0x0,0x0,0x0,0x0,0x0,0x0,0x0,0x0
.quad 0x35ae35e435ae349e,0xb5d6b5d6b564349e,0x35e235a1346eb564,0xb5b5b4ec352e35c5,0x35831afbb583b5d6,0x341f359235dc35d6,0xb4c5b5a1b5deb5d6,0x35ca35e335b5351c,0xb5c5b5e4b5c5b564,0x35c535641afbb564,0xb5d9b5a1b509349e,0x339fb540b5b5b5e0,0xb5409bbc354035ae,0xb5bab5e0b5dcb5ae,0x352e35a135d235e4,0xb5d2b5a1b52e9bbc
.quad 0x35d635e435d635ae,0xb49e349e356435ae,0x35ca35a13552349e,0x35a835ce35e235e0,0x34ec1afbb4ecb564,0x35dc35c535a13564,0xb575b5a1b5c0b5d6,0x3509341fb46eb51c,0xb5e0b5e4b5e0b5d6,0xb592b5aeb5c5b5d6,0xb5b5b5a1b58bb564,0xb5e2b5dcb5d2b5c5,0xb41f9bbc341f349e,0xb540b51cb4ecb49e,0x359a35a135a835ae,0x35753583358b3592
.quad 0x0,0x0,0x0,0x0,0x0,0x0,0x0,0x0,0x0,0x0,0x0,0x0,0x0,0x0,0x0,0x0
.quad 0x0,0x0,0x0,0x0,0x0,0x0,0x0,0x0,0x0,0x0,0x0,0x0,0x0,0x0,0x0,0x0
.quad 0x35e435ae349eb564,0xb5d6b564349e35ae,0x352eb4ecb5b5b5e4,0x346e35a135e235c5,0xb5a1b5e0b5ceb564,0x35e335c53540b49e,0xb5d2b583b39f3564,0x3509b4ecb5a8b5e0,0x9bbc356435c535e4,0xb5c5b5e4b5c5b564,0x35d235e335c03564,0xb59ab4ec34c53592,0x35a1351cb41fb564,0x358335c535e335d6,0xb52eb5a1b5d2b5e4,0x35d235a1352e1afb
.quad 0xb5e4b5d6b5aeb564,0xb49eb564b5aeb5d6,0xb52eb41f34c53564,0xb5e3b5dcb5c0b592,0x35a135c535dc35e4,0xb4ec9bbc34ec3564,0x35d235ba359a3564,0x35ca35dc35e335e0,0x1afbb49eb51cb564,0x35923564351c349e,0xb5d2b5dcb5e2b5e4,0xb58bb5a1b5b5b5c5,0xb5a1b592b583b564,0xb5ceb5c5b5bab5ae,0x352e354035523564,0x34c534ec3509351c
.quad 0x0,0x0,0x0,0x0,0x0,0x0,0x0,0x0,0x0,0x0,0x0,0x0,0x0,0x0,0x0,0x0
.quad 0x0,0x0,0x0,0x0,0x0,0x0,0x0,0x0,0x0,0x0,0x0,0x0,0x0,0x0,0x0,0x0
.quad 0x35ae349eb564b5d6,0xb564349e35ae35e4,0xb58bb5dcb5d2b564,0x35d235dc358b1afb,0xb5bab51c34ec35ae,0x34ecb51cb5bab5e4,0x357535ce35e235ae,0xb5e2b5ceb5759bbc,0x35c535641afbb564,0x9bbc356435c535e4,0xb552b5bab5e2b5d6,0x35e235ba35521afb,0xb5ceb592b4ec349e,0xb4ecb592b5ceb5e4,0x352e35a135d235e4,0xb5d2b5a1b52e9bbc
.quad 0x35d635ae3564349e,0x356435ae35d635e4,0xb509b583b5b5b5d6,0x35b5358335091afb,0xb5dcb5c5b5a1b564,0xb5a1b5c5b5dcb5e4,0x34c53540358b35ae,0xb58bb540b4c59bbc,0x35e035d635c535ae,0x35c535d635e035e4,0xb46eb4ecb52eb564,0x352e34ec346e1afb,0xb5e3b5e0b5dcb5d6,0xb5dcb5e0b5e3b5e4,0x339f341f346e349e,0xb46eb41fb39f9bbc
.quad 0x0,0x0,0x0,0x0,0x0,0x0,0x0,0x0,0x0,0x0,0x0,0x0,0x0,0x0,0x0,0x0
.quad 0x0,0x0,0x0,0x0,0x0,0x0,0x0,0x0,0x0,0x0,0x0,0x0,0x0,0x0,0x0,0x0
.quad 0x349eb564b5d6b5d6,0x349e35ae35e435ae,0xb5e2b5a1b46e3564,0x35b534ecb52eb5c5,0x354035c535e335ae,0xb5ceb5e0b5a1b49e,0x35a834ecb509b5ae,0x339f358335d235e0,0xb5c5b5e4b5c5b564,0x35c535641afbb564,0xb4c534ec359a35d6,0xb5c0b5e3b5d2b592,0x35e335c53583349e,0xb41f351c35a135d6,0xb52eb5a1b5d2b5e4,0x35d235a1352e1afb
.quad 0xb5aeb564b49e349e,0xb5aeb5d6b5e4b5d6,0x35c035dc35e335d6,0xb4c5341f352e3592,0x34ec1afbb4ecb564,0x35dc35c535a13564,0xb5e3b5dcb5cab5ae,0xb59ab5bab5d2b5e0,0x351c3564359235ae,0xb51cb49e9bbc349e,0x35b535a1358b3564,0x35e235dc35d235c5,0xb5bab5c5b5ceb5d6,0xb583b592b5a1b5ae,0xb509b4ecb4c5b49e,0xb552b540b52eb51c
.quad 0x0,0x0,0x0,0x0,0x0,0x0,0x0,0x0,0x0,0x0,0x0,0x0,0x0,0x0,0x0,0x0
.quad 0x0,0x0,0x0,0x0,0x0,0x0,0x0,0x0,0x0,0x0,0x0,0x0,0x0,0x0,0x0,0x0
.quad 0xb564b5d6b5d6b564,0x35ae35e435ae349e,0xb52e34ec35b535e4,0xb46eb5a1b5e2b5c5,0x35dc3592341fb564,0xb5839bbc358335d6,0xb5b5b5e3b5cab564,0x35de35a134c5b51c,0x9bbc356435c535e4,0xb5c5b5e4b5c5b564,0x35b53540b39fb564,0x350935a135d935e0,0xb5dcb5e0b5bab564,0x35401afbb540b5ae,0x352e35a135d235e4,0xb5d2b5a1b52e9bbc
.quad 0x3564349eb49eb564,0x35d635e435d635ae,0xb5e2b5ceb5a8b564,0xb552b5a1b5cab5e0,0x35a135c535dc35e4,0xb4ec9bbc34ec3564,0x346eb41fb509b564,0x35c035a13575351c,0xb5c5b5aeb592b564,0xb5e0b5e4b5e0b5d6,0x35d235dc35e235e4,0x358b35a135b535c5,0xb4ecb51cb540b564,0x341f1afbb41fb49e,0xb58bb583b575b564,0xb5a8b5a1b59ab592
.quad 0x0,0x0,0x0,0x0,0x0,0x0,0x0,0x0,0x0,0x0,0x0,0x0,0x0,0x0,0x0,0x0
.quad 0x0,0x0,0x0,0x0,0x0,0x0,0x0,0x0,0x0,0x0,0x0,0x0,0x0,0x0,0x0,0x0
.quad 0xb5d6b5d6b564349e,0x35e435ae349eb564,0x358b35dc35d23564,0xb5d2b5dcb58b9bbc,0xb41fb592b5dcb5d6,0x35a135e035ce3564,0xb552341f358b35d6,0xb52eb5bab5e3b5c5,0x35c535641afbb564,0x9bbc356435c535e4,0xb5e3b5ceb58bb49e,0x352eb41fb575b5c5,0x35ba35e035dc35ae,0xb5a1b51c341f3564,0xb52eb5a1b5d2b5e4,0x35d235a1352e1afb
.quad 0xb49e349e356435ae,0xb5e4b5d6b5aeb564,0x359a3540346eb49e,0x35d235e335de35c5,0xb5dcb5c5b5a1b564,0xb5a1b5c5b5dcb5e4,0x35d935e335e235d6,0x352e358335a835c5,0xb592b5aeb5c5b5d6,0x1afbb49eb51cb564,0x346e34ec352e3564,0xb52eb4ecb46e9bbc,0x3540351c34ec349e,0x35a1359235833564,0xb5c0b5bab5b5b5ae,0xb5d2b5ceb5cab5c5
.quad 0x0,0x0,0x0,0x0,0x0,0x0,0x0,0x0,0x0,0x0,0x0,0x0,0x0,0x0,0x0,0x0
.quad 0x0,0x0,0x0,0x0,0x0,0x0,0x0,0x0,0x0,0x0,0x0,0x0,0x0,0x0,0x0,0x0
.quad 0xb5d6b564349e35ae,0x35ae349eb564b5d6,0x35e235a1346eb564,0xb5b5b4ec352e35c5,0xb5e3b5c5b540349e,0x35ba351cb4ecb5ae,0x35d935dc359a349e,0xb5c0b540346e3592,0xb5c5b5e4b5c5b564,0x35c535641afbb564,0x35a835dc35de35ae,0xb5cab583b46e351c,0xb583b5c5b5e3b5d6,0x35ce359234ecb49e,0x352e35a135d235e4,0xb5d2b5a1b52e9bbc
.quad 0xb49eb564b5aeb5d6,0x35d635ae3564349e,0xb39f34ec357535ae,0xb5d9b5bab58bb51c,0x34ec1afbb4ecb564,0x35dc35c535a13564,0xb552b4ecb39f349e,0xb5deb5ceb5b5b592,0x35923564351c349e,0x35e035d635c535ae,0xb5b5b5a1b58bb564,0xb5e2b5dcb5d2b5c5,0x35ce35c535ba35ae,0x35e335e035dc35d6,0xb5deb5dcb5d9b5d6,0xb5e3b5e3b5e2b5e0
.quad 0x0,0x0,0x0,0x0,0x0,0x0,0x0,0x0,0x0,0x0,0x0,0x0,0x0,0x0,0x0,0x0
.quad 0x0,0x0,0x0,0x0,0x0,0x0,0x0,0x0,0x0,0x0,0x0,0x0,0x0,0x0,0x0,0x0
.quad 0x35e0359280003564,0xb5c5b51c351c35c5,0x35dc358b8000b564,0xb5a1b46e356435d2,0x35d6358380003564,0xb564341f359235dc,0x35ce35758000b564,0xb4ec350935ae35e2,0x35c5356480003564,0x9b7b356435c535e4,0x35ba35528000b564,0x34ec359a35d635e2,0x35ae354080003564,0x356435ba35e035dc,0x35a1352e8000b564,0x35a135d235e435d2
.quad 0x3592351c80003564,0x35c535e035e035c5,0x358335098000b564,0x35dc35e335d635b5,0x356434ec80003564,0x35e435dc35c535a1,0x354034c58000b564,0x35dc35ca35ae358b,0x351c349e80003564,0x35c535ae35923564,0x34ec346e8000b564,0x35a1358b3564352e,0x349e341f80003564,0x35643540351c34ec,0x341f339f8000b564,0x34ec34c5349e346e
.quad 0x0,0x0,0x0,0x0,0x0,0x0,0x0,0x0,0x0,0x0,0x0,0x0,0x0,0x0,0x0,0x0
.quad 0x0,0x0,0x0,0x0,0x0,0x0,0x0,0x0,0x0,0x0,0x0,0x0,0x0,0x0,0x0,0x0
.quad 0x35928000b592b5e0,0xb51c351c35c535e0,0x34ecb52eb5c5b5e2,0x34ec35b535e435b5,0xb49eb5a1b5e0b5ce,0x35ae35e335c53540,0xb583b5d2b5e0b5a8,0x35e335ca3564b39f,0xb5c5b5e4b5c5b564,0x35c535648000b564,0xb5e3b5d2b592b4c5,0x3540b39fb564b5c0,0xb5d6b5a1b51c341f,0xb49eb583b5c5b5e3,0xb5a1b52e9b7b352e,0xb5a1b5d2b5e4b5d2
.quad 0xb51c9b7b351c3592,0xb5e0b5e0b5c5b592,0x341f352e359235c0,0xb5ceb5a8b564b4c5,0x356435a135c535dc,0xb564b4ec9b7b34ec,0x35ba35d235e035e3,0x341f35093564359a,0x35e035e435e035d6,0x359235ae35c535d6,0x35dc35d235c535b5,0x35dc35e235e435e2,0x35ae35a135923583,0x35d635ce35c535ba,0x3540352e351c3509,0x3583357535643552
.quad 0x0,0x0,0x0,0x0,0x0,0x0,0x0,0x0,0x0,0x0,0x0,0x0,0x0,0x0,0x0,0x0
.quad 0x0,0x0,0x0,0x0,0x0,0x0,0x0,0x0,0x0,0x0,0x0,0x0,0x0,0x0,0x0,0x0
.quad 0x8000b592b5e0b5c5,0x351c35c535e03592,0xb5a1b5e2b5c5b52e,0x35dc35d23564b46e,0xb5e4b5bab51c34ec,0x35ae34ecb51cb5ba,0xb5a1b4c5351c35b5,0xb41fb58bb5d6b5de,0x9b7b356435c535e4,0xb5c5b5e4b5c5b564,0x35a135d935e035b5,0xb5ceb58bb49e3509,0x35e435ce359234ec,0xb49e34ec359235ce,0x35a1352e8000b52e,0x35a135d235e435d2
.quad 0x8000b51cb592b5c5,0x35e035c53592351c,0xb5a1b5cab5e0b5e2,0x3540346eb49eb552,0xb5e4b5dcb5c5b5a1,0xb564b5a1b5c5b5dc,0xb5a1b575b51cb46e,0xb5e3b5e2b5d6b5c0,0x9b7b349e351c3564,0xb592b564b51cb49e,0x35a135b535c535d2,0x34ec352e3564358b,0x35e435e335e035dc,0x35d635dc35e035e3,0x35a1359a3592358b,0x35ba35b535ae35a8
.quad 0x0,0x0,0x0,0x0,0x0,0x0,0x0,0x0,0x0,0x0,0x0,0x0,0x0,0x0,0x0,0x0
.quad 0x0,0x0,0x0,0x0,0x0,0x0,0x0,0x0,0x0,0x0,0x0,0x0,0x0,0x0,0x0,0x0
.quad 0xb592b5e0b5c5b51c,0x35c535e035928000,0xb5dcb58b9b7b358b,0x35a1346eb564b5d2,0xb49e354035c535e3,0xb564b5ceb5e0b5a1,0x35ba35e335c53552,0xb5dcb59ab49e352e,0x35c535648000b564,0x9b7b356435c535e4,0xb41fb575b5c5b5e3,0x35dc35de35ae352e,0xb5d6b5e3b5c5b583,0x3564341fb51cb5a1,0xb5a1b52e9b7b352e,0xb5a1b5d2b5e4b5d2
.quad 0x351c359235c535e0,0xb5c5b592b51c9b7b,0x35e335de35c5359a,0x34ec357535ae35d2,0x356434ec8000b4ec,0x35e435dc35c535a1,0xb583b5a8b5c5b5d9,0x34ec339fb49eb52e,0xb5e0b5d6b5c5b5ae,0xb5c5b5d6b5e0b5e4,0xb4ecb46e9b7b346e,0xb5a1b58bb564b52e,0x35ae35ba35c535ce,0x35643583359235a1,0x35ce35ca35c535c0,0x35dc35d935d635d2
.quad 0x0,0x0,0x0,0x0,0x0,0x0,0x0,0x0,0x0,0x0,0x0,0x0,0x0,0x0,0x0,0x0
.quad 0x0,0x0,0x0,0x0,0x0,0x0,0x0,0x0,0x0,0x0,0x0,0x0,0x0,0x0,0x0,0x0
.quad 0xb5e0b5c5b51c351c,0x35e035928000b592,0xb4ec352e35c535e2,0xb4ecb5b5b5e4b5b5,0x35d635dc3592341f,0xb5d6b5839b7b3583,0x3540b46eb592b5d9,0x354035c035e435c0,0xb5c5b5e4b5c5b564,0x35c535648000b564,0xb583b46e351c35a8,0xb583b5cab5e4b5ca,0x35ae35dc35e035ba,0xb5aeb5409b7b3540,0x35a1352e8000b52e,0x35a135d235e435d2
.quad 0xb592b5c5b5e0b5e0,0x3592351c8000b51c,0xb5bab58bb51cb39f,0xb5bab5d9b5e4b5d9,0x356435a135c535dc,0xb564b4ec9b7b34ec,0x35ce35b535923552,0x35ce35de35e435de,0xb51cb564b592b5ae,0x351c349e8000b49e,0xb5dcb5d2b5c5b5b5,0xb5dcb5e2b5e4b5e2,0x349e34ec351c3540,0xb49eb41f9b7b341f,0x35e335e235e035de,0x35e335e335e435e3
.quad 0x0,0x0,0x0,0x0,0x0,0x0,0x0,0x0,0x0,0x0,0x0,0x0,0x0,0x0,0x0,0x0
.quad 0x0,0x0,0x0,0x0,0x0,0x0,0x0,0x0,0x0,0x0,0x0,0x0,0x0,0x0,0x0,0x0
.quad 0xb5c5b51c351c35c5,0x35928000b592b5e0,0x35a135e235c5352e,0xb5dcb5d2b564346e,0x3564b41fb592b5dc,0x349e35a135e035ce,0xb5dcb5d9b592b46e,0x35ba352eb49eb59a,0x9b7b356435c535e4,0xb5c5b5e4b5c5b564,0x35dc35a8351cb46e,0xb41f352e35ae35de,0xb564b5bab5e0b5dc,0x35d635a1351cb41f,0xb5a1b52e9b7b352e,0xb5a1b5d2b5e4b5d2
.quad 0x35c535e035e035c5,0xb51c9b7b351c3592,0x34ecb39fb51cb58b,0x35e335d235ae3575,0xb5e4b5dcb5c5b5a1,0xb564b5a1b5c5b5dc,0x34ec3552359235b5,0xb583b52eb49e339f,0x35c535ae35923564,0x35e035e435e035d6,0xb5a1b5b5b5c5b5d2,0xb4ecb52eb564b58b,0xb564b540b51cb4ec,0xb5aeb5a1b592b583,0x35dc35de35e035e2,0x35ce35d235d635d9
.quad 0x0,0x0,0x0,0x0,0x0,0x0,0x0,0x0,0x0,0x0,0x0,0x0,0x0,0x0,0x0,0x0
.quad 0x0,0x0,0x0,0x0,0x0,0x0,0x0,0x0,0x0,0x0,0x0,0x0,0x0,0x0,0x0,0x0
.quad 0xb51c351c35c535e0,0x8000b592b5e0b5c5,0x35dc358b8000b58b,0xb5a1b46e356435d2,0xb5aeb5e3b5c5b540,0x35e435ba351cb4ec,0xb41f355235c535e3,0xb5a1b5deb5d6b58b,0x35c535648000b564,0x9b7b356435c535e4,0xb5ceb5e3b5c5b575,0x35a13509b49eb58b,0x349e358335c535e3,0xb5e4b5ceb592b4ec,0x35a1352e8000b52e,0x35a135d235e435d2
.quad 0xb5e0b5e0b5c5b592,0x8000b51cb592b5c5,0x3540359a35c535de,0xb5a1b552b49e346e,0x356434ec8000b4ec,0x35e435dc35c535a1,0xb5e3b5d9b5c5b5a8,0xb5a1b5c0b5d6b5e2,0x359235ae35c535d6,0x9b7b349e351c3564,0x34ec346e8000b46e,0x35a1358b3564352e,0xb5d6b5ceb5c5b5ba,0xb5e4b5e3b5e0b5dc,0x35ba35c035c535ca,0x35a135a835ae35b5
.quad 0x0,0x0,0x0,0x0,0x0,0x0,0x0,0x0,0x0,0x0,0x0,0x0,0x0,0x0,0x0,0x0
.quad 0x0,0x0,0x0,0x0,0x0,0x0,0x0,0x0,0x0,0x0,0x0,0x0,0x0,0x0,0x0,0x0
.quad 0x351c35c535e03592,0xb592b5e0b5c5b51c,0x34ecb52eb5c5b5e2,0x34ec35b535e435b5,0xb5aeb4ec351c35ba,0x349eb540b5c5b5e3,0x35e335b5351cb4c5,0xb583b39f356435ca,0xb5c5b5e4b5c5b564,0x35c535648000b564,0x354035b535e035d9,0xb5e3b5c0b564b39f,0x349eb4ecb592b5ce,0x35d635e335c53583,0xb5a1b52e9b7b352e,0xb5a1b5d2b5e4b5d2
.quad 0x35e035c53592351c,0x351c359235c535e0,0xb5ceb5e2b5e0b5ca,0x341fb4c5b564b5a8,0x356435a135c535dc,0xb564b4ec9b7b34ec,0x341fb46eb51cb575,0x35ba359a35643509,0xb592b564b51cb49e,0xb5e0b5d6b5c5b5ae,0x35dc35d235c535b5,0x35dc35e235e435e2,0xb5d6b5dcb5e0b5e3,0xb5aeb5bab5c5b5ce,0x3583358b3592359a,0x3540355235643575
.quad 0x0,0x0,0x0,0x0,0x0,0x0,0x0,0x0,0x0,0x0,0x0,0x0,0x0,0x0,0x0,0x0
.quad 0x0,0x0,0x0,0x0,0x0,0x0,0x0,0x0,0x0,0x0,0x0,0x0,0x0,0x0,0x0,0x0
.quad 0x35c535e035928000,0xb5e0b5c5b51c351c,0xb5a1b5e2b5c5b52e,0x35dc35d23564b46e,0x356435ce35e035a1,0xb5d6b5dcb592b41f,0xb4ecb5a8b5e0b5d2,0x35ce35e235ae3509,0x9b7b356435c535e4,0xb5c5b5e4b5c5b564,0x34ecb4c5b592b5d2,0x35ba35e235d6359a,0xb564b41f351c35a1,0xb5aeb5dcb5e0b5ba,0x35a1352e8000b52e,0x35a135d235e435d2
.quad 0xb5c5b592b51c9b7b,0xb592b5c5b5e0b5e0,0x35dc35c03592352e,0x358335b535d635e3,0xb5e4b5dcb5c5b5a1,0xb564b5a1b5c5b5dc,0x35dc35e335e035d2,0x3540358b35ae35ca,0xb5c5b5d6b5e0b5e4,0xb51cb564b592b5ae,0x35a135b535c535d2,0x34ec352e3564358b,0xb564b583b592b5a1,0xb49eb4ecb51cb540,0x34ec3509351c352e,0x341f346e349e34c5
.quad 0x0,0x0,0x0,0x0,0x0,0x0,0x0,0x0,0x0,0x0,0x0,0x0,0x0,0x0,0x0,0x0
.quad 0x0,0x0,0x0,0x0,0x0,0x0,0x0,0x0,0x0,0x0,0x0,0x0,0x0,0x0,0x0,0x0
.quad 0x8000b592,0x0,0x9afb358b,0x0,0x8000b583,0x0,0x9afb3575,0x0,0x8000b564,0x0,0x9afb3552,0x0,0x8000b540,0x0,0x9afb352e,0x0
.quad 0x8000b51c,0x0,0x9afb3509,0x0,0x8000b4ec,0x0,0x9afb34c5,0x0,0x8000b49e,0x0,0x9afb346e,0x0,0x8000b41f,0x0,0x9afb339f,0x0
.quad 0x0,0x0,0x0,0x0,0x0,0x0,0x0,0x0,0x0,0x0,0x0,0x0,0x0,0x0,0x0,0x0
.quad 0x0,0x0,0x0,0x0,0x0,0x0,0x0,0x0,0x0,0x0,0x0,0x0,0x0,0x0,0x0,0x0
.quad 0x0,0x0,0x0,0x0,0x0,0x0,0x0,0x0,0x0,0x0,0x0,0x0,0x0,0x0,0x0,0x0
.quad 0x0,0x0,0x0,0x0,0x0,0x0,0x0,0x0,0x0,0x0,0x0,0x0,0x0,0x0,0x0,0x0
.quad 0x0,0x0,0x0,0x0,0x0,0x0,0x0,0x0,0x0,0x0,0x0,0x0,0x0,0x0,0x0,0x0
.quad 0x0,0x0,0x0,0x0,0x0,0x0,0x0,0x0,0x0,0x0,0x0,0x0,0x0,0x0,0x0,0x0
.size tab_a3, 51200
```
